```python
import torch

def _softmax(x, axis=-1):
    return torch.softmax(x, dim=axis)
def _gelu(x):
    return torch.nn.functional.gelu(x, approximate="tanh")
def _silu(x):
    return torch.nn.functional.silu(x)
def _sigmoid(x):
    return torch.sigmoid(x)
def _layernorm(x, axis=-1, eps=1e-5):
    m = x.mean(dim=axis, keepdim=True)
    v = x.var(dim=axis, keepdim=True, unbiased=False)
    return (x - m) / torch.sqrt(v + eps)
def _scatter_add(tgt, idx, src, axis=0):
    return tgt.clone().index_add_(axis, idx, src)
def _segment_sum(src, seg, n):
    out = torch.zeros((n,) + src.shape[1:], dtype=src.dtype)
    return out.index_add_(0, seg, src)
def _pad(x, pw):
    flat = tuple(v for pair in reversed(pw) for v in pair)
    return torch.nn.functional.pad(x, flat)

kernel_name = 'recurrent_scan__softmax_full_mha__glu_gated_reglu__prompt'

def setup_inputs():

    _w = (lambda a: (lambda t: t.to(torch.bfloat16) if t.is_floating_point() else t)(torch.as_tensor(a)))
    def _A_setup():
        B, S, D = 1, 2048, 1024
        return {
            "x": _w((lambda *s: torch.randn(*s, dtype=torch.bfloat16) * 0.05)(B, S, D)),
            "wqkv": _w((lambda *s: torch.randn(*s, dtype=torch.bfloat16) * 0.2)(D, 3 * D)),
            "wo": _w((lambda *s: torch.randn(*s, dtype=torch.bfloat16) * 0.2)(D, D)),
        }
    _A_in = _A_setup()

    def _B_setup():
        B, S, D, F = 1, 2048, 1024, 3584
        return {
            "x": _w((lambda *s: torch.randn(*s, dtype=torch.bfloat16) * 0.05)(B, S, D)),
            "W_gate": _w((lambda *s: torch.randn(*s, dtype=torch.bfloat16) * 0.1)(D, F) * (2.0 / D) ** 0.5),
            "W_up": _w((lambda *s: torch.randn(*s, dtype=torch.bfloat16) * 0.1)(D, F) * (2.0 / D) ** 0.5),
            "W_down": _w((lambda *s: torch.randn(*s, dtype=torch.bfloat16) * 0.1)(F, D) * (1.0 / F) ** 0.5),
        }
    _B_in = _B_setup()

    return {
        "A_x": _A_in["x"],
        "A_wqkv": _A_in["wqkv"],
        "A_wo": _A_in["wo"],
        "B_x": _B_in["x"],
        "B_W_gate": _B_in["W_gate"],
        "B_W_up": _B_in["W_up"],
        "B_W_down": _B_in["W_down"],
    }

def reference(A_x, A_wqkv, A_wo, B_x, B_W_gate, B_W_up, B_W_down):
    def _A_ref(x, wqkv, wo):
        B, S, D = x.shape
        H = 32; Dh = D // H
        qkv = (lambda x, *d: x.permute(*d))((x @ wqkv).reshape(B, S, 3, H, Dh), 2, 0, 3, 1, 4)
        q, k, v = qkv[0], qkv[1], qkv[2]
        scale = Dh ** -0.5
        scores = torch.einsum("bhqd,bhkd->bhqk", q, k) * scale
        p = _softmax(scores, axis=-1)
        o = torch.einsum("bhqk,bhkd->bhqd", p, v)
        return (lambda x, *d: x.permute(*d))(o, 0, 2, 1, 3).reshape(B, S, D) @ wo

    def _B_ref(x, W_gate, W_up, W_down):
        gate = torch.einsum("bsd,df->bsf", x, W_gate)
        up = torch.einsum("bsd,df->bsf", x, W_up)
        gate = gate * (lambda x, dt: x.to(dt))(gate > 0, gate.dtype)
        h = gate * up
        return torch.einsum("bsf,fd->bsd", h, W_down)

    x = A_x
    xn = _layernorm(x, axis=-1)
    s = _A_ref(xn, A_wqkv, A_wo)
    g = _silu(_B_ref(xn, B_W_gate, B_W_up, B_W_down))
    return x + s * g
```

```asm
; @launch kernel=block_kernel grid=(256,1,1) block=(512,1,1) lds=163840
.amdgcn_target "amdgcn-amd-amdhsa--gfx950"
.text
.globl block_kernel
.p2align 8
.type block_kernel,@function
block_kernel:
    s_cmp_ge_u32 s2, 256
    s_cbranch_scc1 L_g1_end
    s_load_dwordx2 s[4:5], s[0:1], 8
    s_load_dwordx4 s[8:11], s[0:1], 32
    s_load_dwordx2 s[6:7], s[0:1], 72
    s_load_dwordx2 s[100:101], s[0:1], 0
    s_load_dwordx4 s[96:99], s[0:1], 56
    s_load_dwordx2 s[94:95], s[0:1], 16
    s_load_dwordx2 s[68:69], s[0:1], 48
    v_lshrrev_b32 v2, 6, v0
    v_and_b32 v1, 63, v0
    s_and_b32 s46, s2, 7
    s_bfe_u32 s47, s2, 0x20003
    s_lshr_b32 s48, s2, 5
    v_readfirstlane_b32 s49, v2
    v_lshlrev_b32 v86, 4, v1
    s_lshr_b32 s50, s49, 2
    s_cmp_ge_u32 s49, 4
    s_cbranch_scc1 L_g1_roleX
    v_and_b32 v4, 7, v1
    v_bfe_u32 v5, v1, 4, 1
    v_lshlrev_b32 v5, 1, v5
    v_xor_b32 v4, v4, v5
    s_and_b32 s52, s49, 1
    s_lshl_b32 s52, s52, 2
    v_xor_b32 v4, s52, v4
    v_lshlrev_b32 v4, 4, v4
    v_lshrrev_b32 v3, 3, v1
    s_lshl_b32 s52, s49, 3
    v_add_u32 v3, s52, v3
    v_mov_b32 v6, 6144
    v_mov_b32 v7, 7168
    v_mad_u32_u24 v82, v3, v6, v4
    v_mad_u32_u24 v84, v3, v7, v4
    s_mul_i32 s44, s49, 5120
    s_mov_b32 s36, 0
    s_mov_b32 s37, 0
    s_mov_b32 s38, 0
    s_mov_b32 s40, 196608
    s_mov_b32 s42, 229376
    s_lshl_b32 s52, s46, 7
    s_mul_i32 s53, s46, 896
    s_cmp_eq_u32 s47, 0
    s_cbranch_scc0 L_g1_typeA
    v_mov_b32 v83, v82
    s_mov_b32 s41, 196608
    s_add_u32 s54, s52, 4096
    s_add_u32 s55, s52, 2048
    s_waitcnt lgkmcnt(0)
    s_sub_u32 s59, s54, 0
    s_ashr_i32 s58, s59, 31
    s_add_u32 s12, s4, s59
    s_addc_u32 s13, s5, s58
    s_sub_u32 s14, 6291456, s59
    s_mov_b32 s15, 0x20000
    s_sub_u32 s59, s52, 1024
    s_ashr_i32 s58, s59, 31
    s_add_u32 s16, s4, s59
    s_addc_u32 s17, s5, s58
    s_sub_u32 s18, 6291456, s59
    s_mov_b32 s19, 0x20000
    s_sub_u32 s59, s55, 2048
    s_ashr_i32 s58, s59, 31
    s_add_u32 s20, s4, s59
    s_addc_u32 s21, s5, s58
    s_sub_u32 s22, 6291456, s59
    s_mov_b32 s23, 0x20000
    s_sub_u32 s59, s53, 3072
    s_ashr_i32 s58, s59, 31
    s_add_u32 s24, s8, s59
    s_addc_u32 s25, s9, s58
    s_sub_u32 s26, 7340032, s59
    s_mov_b32 s27, 0x20000
    s_sub_u32 s59, s53, 0
    s_ashr_i32 s58, s59, 31
    s_add_u32 s28, s10, s59
    s_addc_u32 s29, s11, s58
    s_sub_u32 s30, 7340032, s59
    s_mov_b32 s31, 0x20000
    s_branch L_g1_roleWV
L_g1_typeA:
    v_mov_b32 v83, v84
    s_mov_b32 s41, 229376
    s_sub_u32 s56, s47, 1
    s_lshl_b32 s54, s56, 11
    s_add_u32 s54, s54, s52
    s_add_u32 s54, s54, 1024
    s_lshl_b32 s55, s56, 8
    s_add_u32 s55, s55, s53
    s_add_u32 s55, s55, 128
    s_add_u32 s56, s55, 128
    s_waitcnt lgkmcnt(0)
    s_sub_u32 s59, s54, 0
    s_ashr_i32 s58, s59, 31
    s_add_u32 s12, s4, s59
    s_addc_u32 s13, s5, s58
    s_sub_u32 s14, 6291456, s59
    s_mov_b32 s15, 0x20000
    s_sub_u32 s59, s55, 1024
    s_ashr_i32 s58, s59, 31
    s_add_u32 s16, s8, s59
    s_addc_u32 s17, s9, s58
    s_sub_u32 s18, 7340032, s59
    s_mov_b32 s19, 0x20000
    s_sub_u32 s59, s55, 2048
    s_ashr_i32 s58, s59, 31
    s_add_u32 s20, s10, s59
    s_addc_u32 s21, s11, s58
    s_sub_u32 s22, 7340032, s59
    s_mov_b32 s23, 0x20000
    s_sub_u32 s59, s56, 3072
    s_ashr_i32 s58, s59, 31
    s_add_u32 s24, s8, s59
    s_addc_u32 s25, s9, s58
    s_sub_u32 s26, 7340032, s59
    s_mov_b32 s27, 0x20000
    s_sub_u32 s59, s56, 0
    s_ashr_i32 s58, s59, 31
    s_add_u32 s28, s10, s59
    s_addc_u32 s29, s11, s58
    s_sub_u32 s30, 7340032, s59
    s_mov_b32 s31, 0x20000
    s_cmp_eq_u32 s47, 3
    s_cbranch_scc1 L_g1_roleWV
    s_mov_b32 s32, s6
    s_mov_b32 s33, s7
    s_mov_b32 s34, 52826112
    s_mov_b32 s35, 0x20000
    s_and_b32 s52, s48, 1
    s_mul_i32 s60, s40, s52
    s_lshl_b32 s60, s60, 5
    s_lshr_b32 s53, s60, 1
    s_add_u32 s36, s36, s53
    s_mul_i32 s61, s41, s52
    s_lshl_b32 s61, s61, 5
    s_lshr_b32 s53, s61, 1
    s_add_u32 s37, s37, s53
    s_mul_i32 s62, s42, s52
    s_lshl_b32 s62, s62, 5
    s_lshr_b32 s53, s62, 1
    s_add_u32 s38, s38, s53
    s_add_u32 m0, s44, 0
    s_nop 0
    buffer_load_dwordx4 v82, s[12:15], s36 offen offset:0 lds
    s_add_u32 s36, s36, s40
    buffer_load_dwordx4 v83, s[16:19], s37 offen offset:1024 lds
    buffer_load_dwordx4 v83, s[20:23], s37 offen offset:2048 lds
    s_add_u32 s37, s37, s41
    buffer_load_dwordx4 v84, s[24:27], s38 offen offset:3072 lds
    s_add_u32 m0, s44, 4096
    s_nop 0
    buffer_load_dwordx4 v84, s[28:31], s38 offen offset:0 lds
    s_add_u32 s38, s38, s42
    s_barrier
    s_add_u32 m0, s44, 20480
    s_nop 0
    buffer_load_dwordx4 v82, s[12:15], s36 offen offset:0 lds
    s_add_u32 s36, s36, s40
    buffer_load_dwordx4 v83, s[16:19], s37 offen offset:1024 lds
    buffer_load_dwordx4 v83, s[20:23], s37 offen offset:2048 lds
    s_add_u32 s37, s37, s41
    buffer_load_dwordx4 v84, s[24:27], s38 offen offset:3072 lds
    s_add_u32 m0, s44, 24576
    s_nop 0
    buffer_load_dwordx4 v84, s[28:31], s38 offen offset:0 lds
    s_add_u32 s38, s38, s42
    s_add_u32 m0, s44, 40960
    s_nop 0
    buffer_load_dwordx4 v82, s[12:15], s36 offen offset:0 lds
    s_add_u32 s36, s36, s40
    buffer_load_dwordx4 v83, s[16:19], s37 offen offset:1024 lds
    buffer_load_dwordx4 v83, s[20:23], s37 offen offset:2048 lds
    s_add_u32 s37, s37, s41
    buffer_load_dwordx4 v84, s[24:27], s38 offen offset:3072 lds
    s_add_u32 m0, s44, 45056
    s_nop 0
    buffer_load_dwordx4 v84, s[28:31], s38 offen offset:0 lds
    s_add_u32 s38, s38, s42
    s_mov_b32 s52, s100
    s_mov_b32 s53, s101
    s_mov_b32 s54, 4194304
    s_mov_b32 s55, 0x20000
    s_lshl_b32 s59, s2, 3
    s_add_u32 s59, s59, s49
    s_lshl_b32 s59, s59, 11
    buffer_load_dwordx4 v[76:79], v86, s[52:55], s59 offen
    buffer_load_dwordx4 v[92:95], v86, s[52:55], s59 offen offset:1024
    v_lshrrev_b32 v3, 4, v1
    v_bfe_u32 v4, v1, 2, 2
    v_and_b32 v5, 3, v1
    v_mul_u32_u24 v6, 5120, v3
    v_lshl_add_u32 v6, v4, 7, v6
    v_lshl_add_u32 v6, v5, 3, v6
    v_lshrrev_b32 v7, 1, v4
    v_lshlrev_b32 v7, 5, v7
    v_and_b32 v8, 1, v3
    v_lshl_or_b32 v7, v8, 6, v7
    s_lshl_b32 s52, s50, 6
    v_xor_b32 v8, s52, v7
    v_add_u32 v68, v6, v8
    v_xor_b32 v8, 32, v8
    v_add_u32 v69, v6, v8
    s_cmp_eq_u32 s47, 0
    s_cbranch_scc1 L_g1_taB_1
    s_lshl_b32 s52, s50, 11
    v_add_u32 v9, s52, v6
    v_xor_b32 v8, 0, v7
    v_add_u32 v70, v9, v8
    v_xor_b32 v8, 32, v7
    v_add_u32 v71, v9, v8
    v_xor_b32 v8, 64, v7
    v_add_u32 v72, v9, v8
    v_xor_b32 v8, 96, v7
    v_add_u32 v73, v9, v8
    s_branch L_g1_ta_done_2
L_g1_taB_1:
    v_mov_b32 v70, v68
    v_mov_b32 v71, v69
    v_add_u32 v72, 2048, v68
    v_add_u32 v73, 2048, v69
L_g1_ta_done_2:
    s_and_b32 s52, s49, 3
    s_lshl_b32 s53, s52, 13
    s_add_u32 s53, s53, 81920
    v_and_b32 v4, 15, v1
    v_lshrrev_b32 v5, 1, v4
    v_xor_b32 v5, v5, v3
    v_lshlrev_b32 v5, 4, v5
    v_lshl_add_u32 v5, v4, 7, v5
    v_add_u32 v80, s53, v5
    v_xor_b32 v81, 64, v80
    s_mov_b32 s51, s52
    s_lshr_b32 s52, s48, 1
    s_sub_u32 s63, 7, s52
    s_sub_u32 s64, 6, s52
    s_mov_b32 s86, 2147418112
    s_mov_b32 s87, 0xffff0000
    s_mov_b32 s65, 2147418112
    s_mov_b32 s66, 2147418112
    s_lshl_b32 s52, s48, 5
    s_cmp_eq_u32 s49, 0
    s_cselect_b32 s67, s52, s86
    s_cselect_b32 s92, 0, s86
    s_mov_b32 s88, s98
    s_mov_b32 s89, s99
    s_mov_b32 s90, 256
    s_mov_b32 s91, 0x20000
    v_and_b32 v87, 7, v1
    v_lshlrev_b32 v87, 5, v87
    v_mov_b32 v208, 0
    v_mov_b32 v209, 0
    v_mov_b32 v210, 0
    v_mov_b32 v211, 0
    v_mov_b32 v212, 0
    v_mov_b32 v213, 0
    v_mov_b32 v214, 0
    v_mov_b32 v215, 0
    v_mov_b32 v216, 0
    v_mov_b32 v217, 0
    v_mov_b32 v218, 0
    v_mov_b32 v219, 0
    v_mov_b32 v220, 0
    v_mov_b32 v221, 0
    v_mov_b32 v222, 0
    v_mov_b32 v223, 0
    v_mov_b32 v224, 0
    v_mov_b32 v225, 0
    v_mov_b32 v226, 0
    v_mov_b32 v227, 0
    v_mov_b32 v228, 0
    v_mov_b32 v229, 0
    v_mov_b32 v230, 0
    v_mov_b32 v231, 0
    v_mov_b32 v232, 0
    v_mov_b32 v233, 0
    v_mov_b32 v234, 0
    v_mov_b32 v235, 0
    v_mov_b32 v236, 0
    v_mov_b32 v237, 0
    v_mov_b32 v238, 0
    v_mov_b32 v239, 0
    v_mov_b32 v240, 0
    v_mov_b32 v241, 0
    v_mov_b32 v242, 0
    v_mov_b32 v243, 0
    v_mov_b32 v244, 0
    v_mov_b32 v245, 0
    v_mov_b32 v246, 0
    v_mov_b32 v247, 0
    v_mov_b32 v248, 0
    v_mov_b32 v249, 0
    v_mov_b32 v250, 0
    v_mov_b32 v251, 0
    v_mov_b32 v252, 0
    v_mov_b32 v253, 0
    v_mov_b32 v254, 0
    v_mov_b32 v255, 0
    v_mov_b32 v86, 1
    v_mov_b32 v4, 0
    v_mov_b32 v5, 0
    v_mov_b32 v6, 0
    v_mov_b32 v7, 0
    v_mov_b32 v8, 0
    v_mov_b32 v9, 0
    v_mov_b32 v10, 0
    v_mov_b32 v11, 0
    v_mov_b32 v12, 0
    v_mov_b32 v13, 0
    v_mov_b32 v14, 0
    v_mov_b32 v15, 0
    v_mov_b32 v88, 0x3f803f80
    v_mov_b32 v89, 0x3f803f80
    v_mov_b32 v90, 0x3f803f80
    v_mov_b32 v91, 0x3f803f80
    s_waitcnt vmcnt(12)
    s_barrier
    buffer_store_dword v1, v1, s[32:35], s86 offen
    buffer_store_dword v1, v1, s[32:35], s86 offen
    ds_read_b128 v[36:39], v80 offset:0
    ds_read_b128 v[40:43], v80 offset:2048
    ds_read_b128 v[44:47], v80 offset:4096
    ds_read_b128 v[48:51], v80 offset:6144
    ds_read_b64_tr_b16 v[16:17], v68 offset:0
    ds_read_b64_tr_b16 v[18:19], v68 offset:512
    ds_read_b64_tr_b16 v[20:21], v69 offset:0
    ds_read_b64_tr_b16 v[22:23], v69 offset:512
    ds_read_b64_tr_b16 v[24:25], v70 offset:1024
    ds_read_b64_tr_b16 v[26:27], v70 offset:1536
    s_waitcnt lgkmcnt(4)
    v_mfma_f32_16x16x32_bf16 v[96:99], v[16:19], v[36:39], 0
    ds_read_b128 v[52:55], v81 offset:0
    ds_read_b128 v[56:59], v81 offset:2048
    v_mfma_f32_16x16x32_bf16 v[100:103], v[16:19], v[40:43], 0
    ds_read_b64_tr_b16 v[28:29], v70 offset:2048
    ds_read_b64_tr_b16 v[30:31], v70 offset:2560
    v_mfma_f32_16x16x32_bf16 v[104:107], v[16:19], v[44:47], 0
    ds_read_b128 v[60:63], v81 offset:4096
    ds_read_b128 v[64:67], v81 offset:6144
    v_mfma_f32_16x16x32_bf16 v[108:111], v[16:19], v[48:51], 0
    s_add_u32 m0, s44, 61440
    s_nop 0
    buffer_load_dwordx4 v82, s[12:15], s36 offen offset:0 lds
    s_add_u32 s36, s36, s40
    s_waitcnt lgkmcnt(8)
    v_mfma_f32_16x16x32_bf16 v[112:115], v[20:23], v[36:39], 0
    v_mfma_f32_16x16x32_bf16 v[116:119], v[20:23], v[40:43], 0
    ds_read_b64_tr_b16 v[32:33], v71 offset:1024
    ds_read_b64_tr_b16 v[34:35], v71 offset:1536
    v_mfma_f32_16x16x32_bf16 v[120:123], v[20:23], v[44:47], 0
    v_mfma_f32_16x16x32_bf16 v[124:127], v[20:23], v[48:51], 0
    buffer_load_dwordx4 v83, s[16:19], s37 offen offset:1024 lds
    s_waitcnt lgkmcnt(8)
    v_mfma_f32_16x16x32_bf16 v[128:131], v[24:27], v[36:39], 0
    v_mfma_f32_16x16x32_bf16 v[132:135], v[24:27], v[40:43], 0
    ds_read_b64_tr_b16 v[16:17], v71 offset:2048
    ds_read_b64_tr_b16 v[18:19], v71 offset:2560
    v_mfma_f32_16x16x32_bf16 v[136:139], v[24:27], v[44:47], 0
    v_mfma_f32_16x16x32_bf16 v[140:143], v[24:27], v[48:51], 0
    buffer_load_dwordx4 v83, s[20:23], s37 offen offset:2048 lds
    s_add_u32 s37, s37, s41
    s_waitcnt lgkmcnt(6)
    v_mfma_f32_16x16x32_bf16 v[144:147], v[28:31], v[36:39], 0
    v_mfma_f32_16x16x32_bf16 v[148:151], v[28:31], v[40:43], 0
    ds_read_b64_tr_b16 v[20:21], v72 offset:1024
    ds_read_b64_tr_b16 v[22:23], v72 offset:1536
    v_mfma_f32_16x16x32_bf16 v[152:155], v[28:31], v[44:47], 0
    v_mfma_f32_16x16x32_bf16 v[156:159], v[28:31], v[48:51], 0
    buffer_load_dwordx4 v84, s[24:27], s38 offen offset:3072 lds
    s_waitcnt lgkmcnt(4)
    v_mfma_f32_16x16x32_bf16 v[160:163], v[32:35], v[36:39], 0
    v_mfma_f32_16x16x32_bf16 v[164:167], v[32:35], v[40:43], 0
    ds_read_b64_tr_b16 v[24:25], v72 offset:2048
    ds_read_b64_tr_b16 v[26:27], v72 offset:2560
    v_mfma_f32_16x16x32_bf16 v[168:171], v[32:35], v[44:47], 0
    v_mfma_f32_16x16x32_bf16 v[172:175], v[32:35], v[48:51], 0
    s_add_u32 m0, s44, 65536
    s_nop 0
    buffer_load_dwordx4 v84, s[28:31], s38 offen offset:0 lds
    s_add_u32 s38, s38, s42
    s_waitcnt lgkmcnt(4)
    v_mfma_f32_16x16x32_bf16 v[176:179], v[16:19], v[36:39], 0
    ds_read_b64_tr_b16 v[28:29], v73 offset:1024
    ds_read_b64_tr_b16 v[30:31], v73 offset:1536
    v_mfma_f32_16x16x32_bf16 v[180:183], v[16:19], v[40:43], 0
    ds_read_b64_tr_b16 v[32:33], v73 offset:2048
    ds_read_b64_tr_b16 v[34:35], v73 offset:2560
    v_mfma_f32_16x16x32_bf16 v[184:187], v[16:19], v[44:47], 0
    v_mfma_f32_16x16x32_bf16 v[188:191], v[16:19], v[48:51], 0
    s_waitcnt lgkmcnt(6)
    v_mfma_f32_16x16x32_bf16 v[192:195], v[20:23], v[36:39], 0
    v_mfma_f32_16x16x32_bf16 v[196:199], v[20:23], v[40:43], 0
    v_mfma_f32_16x16x32_bf16 v[200:203], v[20:23], v[44:47], 0
    v_mfma_f32_16x16x32_bf16 v[204:207], v[20:23], v[48:51], 0
    buffer_store_dword v1, v1, s[32:35], s86 offen
    buffer_store_dword v1, v1, s[32:35], s86 offen
    s_waitcnt vmcnt(16) lgkmcnt(0)
    s_barrier
    s_mov_b32 s45, 7
    .p2align 6
L_g1_loop_W0:
    s_cmp_eq_u32 s45, s63
    s_cbranch_scc1 L_g1_spec_W0
    v_mfma_f32_16x16x32_bf16 v[208:211], v[24:27], v[36:39], v[208:211]
    v_mfma_f32_16x16x32_bf16 v[212:215], v[24:27], v[40:43], v[212:215]
    v_mfma_f32_16x16x32_bf16 v[216:219], v[24:27], v[44:47], v[216:219]
    ds_read_b64_tr_b16 v[16:17], v68 offset:20480
    ds_read_b64_tr_b16 v[18:19], v68 offset:20992
    v_mfma_f32_16x16x32_bf16 v[220:223], v[24:27], v[48:51], v[220:223]
    v_mfma_f32_16x16x32_bf16 v[224:227], v[28:31], v[36:39], v[224:227]
    v_mfma_f32_16x16x32_bf16 v[228:231], v[28:31], v[40:43], v[228:231]
    ds_read_b64_tr_b16 v[20:21], v69 offset:20480
    ds_read_b64_tr_b16 v[22:23], v69 offset:20992
    v_mfma_f32_16x16x32_bf16 v[232:235], v[28:31], v[44:47], v[232:235]
    v_mfma_f32_16x16x32_bf16 v[236:239], v[28:31], v[48:51], v[236:239]
    s_add_u32 m0, s44, 0
    s_nop 0
    buffer_load_dwordx4 v82, s[12:15], s36 offen offset:0 lds
    s_add_u32 s36, s36, s40
    v_mfma_f32_16x16x32_bf16 v[240:243], v[32:35], v[36:39], v[240:243]
    v_mfma_f32_16x16x32_bf16 v[244:247], v[32:35], v[40:43], v[244:247]
    ds_read_b64_tr_b16 v[24:25], v70 offset:21504
    ds_read_b64_tr_b16 v[26:27], v70 offset:22016
    v_mfma_f32_16x16x32_bf16 v[248:251], v[32:35], v[44:47], v[248:251]
    v_mfma_f32_16x16x32_bf16 v[252:255], v[32:35], v[48:51], v[252:255]
    buffer_load_dwordx4 v83, s[16:19], s37 offen offset:1024 lds
    s_waitcnt lgkmcnt(4)
    v_mfma_f32_16x16x32_bf16 v[96:99], v[16:19], v[52:55], v[96:99]
    v_mfma_f32_16x16x32_bf16 v[100:103], v[16:19], v[56:59], v[100:103]
    ds_read_b64_tr_b16 v[28:29], v70 offset:22528
    ds_read_b64_tr_b16 v[30:31], v70 offset:23040
    v_mfma_f32_16x16x32_bf16 v[104:107], v[16:19], v[60:63], v[104:107]
    v_mfma_f32_16x16x32_bf16 v[108:111], v[16:19], v[64:67], v[108:111]
    buffer_load_dwordx4 v83, s[20:23], s37 offen offset:2048 lds
    s_add_u32 s37, s37, s41
    s_waitcnt lgkmcnt(4)
    v_mfma_f32_16x16x32_bf16 v[112:115], v[20:23], v[52:55], v[112:115]
    v_mfma_f32_16x16x32_bf16 v[116:119], v[20:23], v[56:59], v[116:119]
    ds_read_b64_tr_b16 v[32:33], v71 offset:21504
    ds_read_b64_tr_b16 v[34:35], v71 offset:22016
    v_mfma_f32_16x16x32_bf16 v[120:123], v[20:23], v[60:63], v[120:123]
    v_mfma_f32_16x16x32_bf16 v[124:127], v[20:23], v[64:67], v[124:127]
    buffer_load_dwordx4 v84, s[24:27], s38 offen offset:3072 lds
    s_waitcnt lgkmcnt(4)
    v_mfma_f32_16x16x32_bf16 v[128:131], v[24:27], v[52:55], v[128:131]
    v_mfma_f32_16x16x32_bf16 v[132:135], v[24:27], v[56:59], v[132:135]
    ds_read_b64_tr_b16 v[16:17], v71 offset:22528
    ds_read_b64_tr_b16 v[18:19], v71 offset:23040
    v_mfma_f32_16x16x32_bf16 v[136:139], v[24:27], v[60:63], v[136:139]
    v_mfma_f32_16x16x32_bf16 v[140:143], v[24:27], v[64:67], v[140:143]
    s_add_u32 m0, s44, 4096
    s_nop 0
    buffer_load_dwordx4 v84, s[28:31], s38 offen offset:0 lds
    s_add_u32 s38, s38, s42
    s_waitcnt lgkmcnt(4)
    v_mfma_f32_16x16x32_bf16 v[144:147], v[28:31], v[52:55], v[144:147]
    v_mfma_f32_16x16x32_bf16 v[148:151], v[28:31], v[56:59], v[148:151]
    ds_read_b64_tr_b16 v[20:21], v72 offset:21504
    ds_read_b64_tr_b16 v[22:23], v72 offset:22016
    v_mfma_f32_16x16x32_bf16 v[152:155], v[28:31], v[60:63], v[152:155]
    v_mfma_f32_16x16x32_bf16 v[156:159], v[28:31], v[64:67], v[156:159]
    s_waitcnt lgkmcnt(4)
    v_mfma_f32_16x16x32_bf16 v[160:163], v[32:35], v[52:55], v[160:163]
    v_mfma_f32_16x16x32_bf16 v[164:167], v[32:35], v[56:59], v[164:167]
    ds_read_b64_tr_b16 v[24:25], v72 offset:22528
    ds_read_b64_tr_b16 v[26:27], v72 offset:23040
    v_mfma_f32_16x16x32_bf16 v[168:171], v[32:35], v[60:63], v[168:171]
    v_mfma_f32_16x16x32_bf16 v[172:175], v[32:35], v[64:67], v[172:175]
    s_waitcnt lgkmcnt(4)
    v_mfma_f32_16x16x32_bf16 v[176:179], v[16:19], v[52:55], v[176:179]
    ds_read_b64_tr_b16 v[28:29], v73 offset:21504
    ds_read_b64_tr_b16 v[30:31], v73 offset:22016
    v_mfma_f32_16x16x32_bf16 v[180:183], v[16:19], v[56:59], v[180:183]
    ds_read_b64_tr_b16 v[32:33], v73 offset:22528
    ds_read_b64_tr_b16 v[34:35], v73 offset:23040
    v_mfma_f32_16x16x32_bf16 v[184:187], v[16:19], v[60:63], v[184:187]
    v_mfma_f32_16x16x32_bf16 v[188:191], v[16:19], v[64:67], v[188:191]
    s_waitcnt lgkmcnt(6)
    v_mfma_f32_16x16x32_bf16 v[192:195], v[20:23], v[52:55], v[192:195]
    v_mfma_f32_16x16x32_bf16 v[196:199], v[20:23], v[56:59], v[196:199]
    v_mfma_f32_16x16x32_bf16 v[200:203], v[20:23], v[60:63], v[200:203]
    v_mfma_f32_16x16x32_bf16 v[204:207], v[20:23], v[64:67], v[204:207]
    s_waitcnt vmcnt(14) lgkmcnt(0)
    s_barrier
    v_mfma_f32_16x16x32_bf16 v[208:211], v[24:27], v[52:55], v[208:211]
    ds_read_b128 v[36:39], v80 offset:32768
    ds_read_b128 v[40:43], v80 offset:34816
    v_mfma_f32_16x16x32_bf16 v[212:215], v[24:27], v[56:59], v[212:215]
    ds_read_b128 v[44:47], v80 offset:36864
    ds_read_b128 v[48:51], v80 offset:38912
    v_mfma_f32_16x16x32_bf16 v[216:219], v[24:27], v[60:63], v[216:219]
    ds_read_b64_tr_b16 v[16:17], v68 offset:40960
    ds_read_b64_tr_b16 v[18:19], v68 offset:41472
    v_mfma_f32_16x16x32_bf16 v[220:223], v[24:27], v[64:67], v[220:223]
    v_mfma_f32_16x16x32_bf16 v[224:227], v[28:31], v[52:55], v[224:227]
    v_mfma_f32_16x16x32_bf16 v[228:231], v[28:31], v[56:59], v[228:231]
    ds_read_b64_tr_b16 v[20:21], v69 offset:40960
    ds_read_b64_tr_b16 v[22:23], v69 offset:41472
    v_mfma_f32_16x16x32_bf16 v[232:235], v[28:31], v[60:63], v[232:235]
    v_mfma_f32_16x16x32_bf16 v[236:239], v[28:31], v[64:67], v[236:239]
    s_add_u32 m0, s44, 20480
    s_nop 0
    buffer_load_dwordx4 v82, s[12:15], s36 offen offset:0 lds
    s_add_u32 s36, s36, s40
    v_mfma_f32_16x16x32_bf16 v[240:243], v[32:35], v[52:55], v[240:243]
    v_mfma_f32_16x16x32_bf16 v[244:247], v[32:35], v[56:59], v[244:247]
    ds_read_b64_tr_b16 v[24:25], v70 offset:41984
    ds_read_b64_tr_b16 v[26:27], v70 offset:42496
    v_mfma_f32_16x16x32_bf16 v[248:251], v[32:35], v[60:63], v[248:251]
    v_mfma_f32_16x16x32_bf16 v[252:255], v[32:35], v[64:67], v[252:255]
    buffer_load_dwordx4 v83, s[16:19], s37 offen offset:1024 lds
    s_waitcnt lgkmcnt(4)
    v_mfma_f32_16x16x32_bf16 v[96:99], v[16:19], v[36:39], v[96:99]
    ds_read_b128 v[52:55], v81 offset:32768
    ds_read_b128 v[56:59], v81 offset:34816
    v_mfma_f32_16x16x32_bf16 v[100:103], v[16:19], v[40:43], v[100:103]
    ds_read_b64_tr_b16 v[28:29], v70 offset:43008
    ds_read_b64_tr_b16 v[30:31], v70 offset:43520
    v_mfma_f32_16x16x32_bf16 v[104:107], v[16:19], v[44:47], v[104:107]
    ds_read_b128 v[60:63], v81 offset:36864
    ds_read_b128 v[64:67], v81 offset:38912
    v_mfma_f32_16x16x32_bf16 v[108:111], v[16:19], v[48:51], v[108:111]
    buffer_load_dwordx4 v83, s[20:23], s37 offen offset:2048 lds
    s_add_u32 s37, s37, s41
    s_waitcnt lgkmcnt(8)
    v_mfma_f32_16x16x32_bf16 v[112:115], v[20:23], v[36:39], v[112:115]
    v_mfma_f32_16x16x32_bf16 v[116:119], v[20:23], v[40:43], v[116:119]
    ds_read_b64_tr_b16 v[32:33], v71 offset:41984
    ds_read_b64_tr_b16 v[34:35], v71 offset:42496
    v_mfma_f32_16x16x32_bf16 v[120:123], v[20:23], v[44:47], v[120:123]
    v_mfma_f32_16x16x32_bf16 v[124:127], v[20:23], v[48:51], v[124:127]
    buffer_load_dwordx4 v84, s[24:27], s38 offen offset:3072 lds
    s_waitcnt lgkmcnt(8)
    v_mfma_f32_16x16x32_bf16 v[128:131], v[24:27], v[36:39], v[128:131]
    v_mfma_f32_16x16x32_bf16 v[132:135], v[24:27], v[40:43], v[132:135]
    ds_read_b64_tr_b16 v[16:17], v71 offset:43008
    ds_read_b64_tr_b16 v[18:19], v71 offset:43520
    v_mfma_f32_16x16x32_bf16 v[136:139], v[24:27], v[44:47], v[136:139]
    v_mfma_f32_16x16x32_bf16 v[140:143], v[24:27], v[48:51], v[140:143]
    s_add_u32 m0, s44, 24576
    s_nop 0
    buffer_load_dwordx4 v84, s[28:31], s38 offen offset:0 lds
    s_add_u32 s38, s38, s42
    s_waitcnt lgkmcnt(6)
    v_mfma_f32_16x16x32_bf16 v[144:147], v[28:31], v[36:39], v[144:147]
    v_mfma_f32_16x16x32_bf16 v[148:151], v[28:31], v[40:43], v[148:151]
    ds_read_b64_tr_b16 v[20:21], v72 offset:41984
    ds_read_b64_tr_b16 v[22:23], v72 offset:42496
    v_mfma_f32_16x16x32_bf16 v[152:155], v[28:31], v[44:47], v[152:155]
    v_mfma_f32_16x16x32_bf16 v[156:159], v[28:31], v[48:51], v[156:159]
    s_waitcnt lgkmcnt(4)
    v_mfma_f32_16x16x32_bf16 v[160:163], v[32:35], v[36:39], v[160:163]
    v_mfma_f32_16x16x32_bf16 v[164:167], v[32:35], v[40:43], v[164:167]
    ds_read_b64_tr_b16 v[24:25], v72 offset:43008
    ds_read_b64_tr_b16 v[26:27], v72 offset:43520
    v_mfma_f32_16x16x32_bf16 v[168:171], v[32:35], v[44:47], v[168:171]
    v_mfma_f32_16x16x32_bf16 v[172:175], v[32:35], v[48:51], v[172:175]
    s_waitcnt lgkmcnt(4)
    v_mfma_f32_16x16x32_bf16 v[176:179], v[16:19], v[36:39], v[176:179]
    ds_read_b64_tr_b16 v[28:29], v73 offset:41984
    ds_read_b64_tr_b16 v[30:31], v73 offset:42496
    v_mfma_f32_16x16x32_bf16 v[180:183], v[16:19], v[40:43], v[180:183]
    ds_read_b64_tr_b16 v[32:33], v73 offset:43008
    ds_read_b64_tr_b16 v[34:35], v73 offset:43520
    v_mfma_f32_16x16x32_bf16 v[184:187], v[16:19], v[44:47], v[184:187]
    v_mfma_f32_16x16x32_bf16 v[188:191], v[16:19], v[48:51], v[188:191]
    s_waitcnt lgkmcnt(6)
    v_mfma_f32_16x16x32_bf16 v[192:195], v[20:23], v[36:39], v[192:195]
    v_mfma_f32_16x16x32_bf16 v[196:199], v[20:23], v[40:43], v[196:199]
    v_mfma_f32_16x16x32_bf16 v[200:203], v[20:23], v[44:47], v[200:203]
    v_mfma_f32_16x16x32_bf16 v[204:207], v[20:23], v[48:51], v[204:207]
    s_waitcnt vmcnt(12) lgkmcnt(0)
    s_barrier
    v_mfma_f32_16x16x32_bf16 v[208:211], v[24:27], v[36:39], v[208:211]
    v_mfma_f32_16x16x32_bf16 v[212:215], v[24:27], v[40:43], v[212:215]
    v_mfma_f32_16x16x32_bf16 v[216:219], v[24:27], v[44:47], v[216:219]
    ds_read_b64_tr_b16 v[16:17], v68 offset:61440
    ds_read_b64_tr_b16 v[18:19], v68 offset:61952
    v_mfma_f32_16x16x32_bf16 v[220:223], v[24:27], v[48:51], v[220:223]
    v_mfma_f32_16x16x32_bf16 v[224:227], v[28:31], v[36:39], v[224:227]
    v_mfma_f32_16x16x32_bf16 v[228:231], v[28:31], v[40:43], v[228:231]
    ds_read_b64_tr_b16 v[20:21], v69 offset:61440
    ds_read_b64_tr_b16 v[22:23], v69 offset:61952
    v_mfma_f32_16x16x32_bf16 v[232:235], v[28:31], v[44:47], v[232:235]
    v_mfma_f32_16x16x32_bf16 v[236:239], v[28:31], v[48:51], v[236:239]
    s_add_u32 m0, s44, 40960
    s_nop 0
    buffer_load_dwordx4 v82, s[12:15], s36 offen offset:0 lds
    s_add_u32 s36, s36, s40
    v_mfma_f32_16x16x32_bf16 v[240:243], v[32:35], v[36:39], v[240:243]
    v_mfma_f32_16x16x32_bf16 v[244:247], v[32:35], v[40:43], v[244:247]
    ds_read_b64_tr_b16 v[24:25], v70 offset:62464
    ds_read_b64_tr_b16 v[26:27], v70 offset:62976
    v_mfma_f32_16x16x32_bf16 v[248:251], v[32:35], v[44:47], v[248:251]
    v_mfma_f32_16x16x32_bf16 v[252:255], v[32:35], v[48:51], v[252:255]
    buffer_load_dwordx4 v83, s[16:19], s37 offen offset:1024 lds
    s_waitcnt lgkmcnt(4)
    v_mfma_f32_16x16x32_bf16 v[96:99], v[16:19], v[52:55], v[96:99]
    v_mfma_f32_16x16x32_bf16 v[100:103], v[16:19], v[56:59], v[100:103]
    ds_read_b64_tr_b16 v[28:29], v70 offset:63488
    ds_read_b64_tr_b16 v[30:31], v70 offset:64000
    v_mfma_f32_16x16x32_bf16 v[104:107], v[16:19], v[60:63], v[104:107]
    v_mfma_f32_16x16x32_bf16 v[108:111], v[16:19], v[64:67], v[108:111]
    buffer_load_dwordx4 v83, s[20:23], s37 offen offset:2048 lds
    s_add_u32 s37, s37, s41
    s_waitcnt lgkmcnt(4)
    v_mfma_f32_16x16x32_bf16 v[112:115], v[20:23], v[52:55], v[112:115]
    v_mfma_f32_16x16x32_bf16 v[116:119], v[20:23], v[56:59], v[116:119]
    ds_read_b64_tr_b16 v[32:33], v71 offset:62464
    ds_read_b64_tr_b16 v[34:35], v71 offset:62976
    v_mfma_f32_16x16x32_bf16 v[120:123], v[20:23], v[60:63], v[120:123]
    v_mfma_f32_16x16x32_bf16 v[124:127], v[20:23], v[64:67], v[124:127]
    buffer_load_dwordx4 v84, s[24:27], s38 offen offset:3072 lds
    s_waitcnt lgkmcnt(4)
    v_mfma_f32_16x16x32_bf16 v[128:131], v[24:27], v[52:55], v[128:131]
    v_mfma_f32_16x16x32_bf16 v[132:135], v[24:27], v[56:59], v[132:135]
    ds_read_b64_tr_b16 v[16:17], v71 offset:63488
    ds_read_b64_tr_b16 v[18:19], v71 offset:64000
    v_mfma_f32_16x16x32_bf16 v[136:139], v[24:27], v[60:63], v[136:139]
    v_mfma_f32_16x16x32_bf16 v[140:143], v[24:27], v[64:67], v[140:143]
    s_add_u32 m0, s44, 45056
    s_nop 0
    buffer_load_dwordx4 v84, s[28:31], s38 offen offset:0 lds
    s_add_u32 s38, s38, s42
    s_waitcnt lgkmcnt(4)
    v_mfma_f32_16x16x32_bf16 v[144:147], v[28:31], v[52:55], v[144:147]
    v_mfma_f32_16x16x32_bf16 v[148:151], v[28:31], v[56:59], v[148:151]
    ds_read_b64_tr_b16 v[20:21], v72 offset:62464
    ds_read_b64_tr_b16 v[22:23], v72 offset:62976
    v_mfma_f32_16x16x32_bf16 v[152:155], v[28:31], v[60:63], v[152:155]
    v_mfma_f32_16x16x32_bf16 v[156:159], v[28:31], v[64:67], v[156:159]
    s_waitcnt lgkmcnt(4)
    v_mfma_f32_16x16x32_bf16 v[160:163], v[32:35], v[52:55], v[160:163]
    v_mfma_f32_16x16x32_bf16 v[164:167], v[32:35], v[56:59], v[164:167]
    ds_read_b64_tr_b16 v[24:25], v72 offset:63488
    ds_read_b64_tr_b16 v[26:27], v72 offset:64000
    v_mfma_f32_16x16x32_bf16 v[168:171], v[32:35], v[60:63], v[168:171]
    v_mfma_f32_16x16x32_bf16 v[172:175], v[32:35], v[64:67], v[172:175]
    s_waitcnt lgkmcnt(4)
    v_mfma_f32_16x16x32_bf16 v[176:179], v[16:19], v[52:55], v[176:179]
    ds_read_b64_tr_b16 v[28:29], v73 offset:62464
    ds_read_b64_tr_b16 v[30:31], v73 offset:62976
    v_mfma_f32_16x16x32_bf16 v[180:183], v[16:19], v[56:59], v[180:183]
    ds_read_b64_tr_b16 v[32:33], v73 offset:63488
    ds_read_b64_tr_b16 v[34:35], v73 offset:64000
    v_mfma_f32_16x16x32_bf16 v[184:187], v[16:19], v[60:63], v[184:187]
    v_mfma_f32_16x16x32_bf16 v[188:191], v[16:19], v[64:67], v[188:191]
    s_waitcnt lgkmcnt(6)
    v_mfma_f32_16x16x32_bf16 v[192:195], v[20:23], v[52:55], v[192:195]
    v_mfma_f32_16x16x32_bf16 v[196:199], v[20:23], v[56:59], v[196:199]
    v_mfma_f32_16x16x32_bf16 v[200:203], v[20:23], v[60:63], v[200:203]
    v_mfma_f32_16x16x32_bf16 v[204:207], v[20:23], v[64:67], v[204:207]
    s_waitcnt vmcnt(10) lgkmcnt(0)
    s_barrier
    s_mov_b64 exec, 1
    buffer_atomic_add v86, v87, s[88:91], s65 offen
    s_mov_b64 exec, -1
    buffer_load_dword v85, v87, s[88:91], s66 offen sc0 sc1
    v_mfma_f32_16x16x32_bf16 v[208:211], v[24:27], v[52:55], v[208:211]
    ds_read_b128 v[36:39], v80 offset:0
    ds_read_b128 v[40:43], v80 offset:2048
    v_mfma_f32_16x16x32_bf16 v[212:215], v[24:27], v[56:59], v[212:215]
    ds_read_b128 v[44:47], v80 offset:4096
    ds_read_b128 v[48:51], v80 offset:6144
    v_mfma_f32_16x16x32_bf16 v[216:219], v[24:27], v[60:63], v[216:219]
    ds_read_b64_tr_b16 v[16:17], v68 offset:0
    ds_read_b64_tr_b16 v[18:19], v68 offset:512
    v_mfma_f32_16x16x32_bf16 v[220:223], v[24:27], v[64:67], v[220:223]
    v_mfma_f32_16x16x32_bf16 v[224:227], v[28:31], v[52:55], v[224:227]
    v_mfma_f32_16x16x32_bf16 v[228:231], v[28:31], v[56:59], v[228:231]
    ds_read_b64_tr_b16 v[20:21], v69 offset:0
    ds_read_b64_tr_b16 v[22:23], v69 offset:512
    v_mfma_f32_16x16x32_bf16 v[232:235], v[28:31], v[60:63], v[232:235]
    v_mfma_f32_16x16x32_bf16 v[236:239], v[28:31], v[64:67], v[236:239]
    s_add_u32 m0, s44, 61440
    s_nop 0
    buffer_load_dwordx4 v82, s[12:15], s36 offen offset:0 lds
    s_add_u32 s36, s36, s40
    v_mfma_f32_16x16x32_bf16 v[240:243], v[32:35], v[52:55], v[240:243]
    v_mfma_f32_16x16x32_bf16 v[244:247], v[32:35], v[56:59], v[244:247]
    ds_read_b64_tr_b16 v[24:25], v70 offset:1024
    ds_read_b64_tr_b16 v[26:27], v70 offset:1536
    v_mfma_f32_16x16x32_bf16 v[248:251], v[32:35], v[60:63], v[248:251]
    v_mfma_f32_16x16x32_bf16 v[252:255], v[32:35], v[64:67], v[252:255]
    buffer_load_dwordx4 v83, s[16:19], s37 offen offset:1024 lds
    s_waitcnt lgkmcnt(4)
    v_mfma_f32_16x16x32_bf16 v[96:99], v[16:19], v[36:39], v[96:99]
    ds_read_b128 v[52:55], v81 offset:0
    ds_read_b128 v[56:59], v81 offset:2048
    v_mfma_f32_16x16x32_bf16 v[100:103], v[16:19], v[40:43], v[100:103]
    ds_read_b64_tr_b16 v[28:29], v70 offset:2048
    ds_read_b64_tr_b16 v[30:31], v70 offset:2560
    v_mfma_f32_16x16x32_bf16 v[104:107], v[16:19], v[44:47], v[104:107]
    ds_read_b128 v[60:63], v81 offset:4096
    ds_read_b128 v[64:67], v81 offset:6144
    v_mfma_f32_16x16x32_bf16 v[108:111], v[16:19], v[48:51], v[108:111]
    buffer_load_dwordx4 v83, s[20:23], s37 offen offset:2048 lds
    s_add_u32 s37, s37, s41
    s_waitcnt lgkmcnt(8)
    v_mfma_f32_16x16x32_bf16 v[112:115], v[20:23], v[36:39], v[112:115]
    v_mfma_f32_16x16x32_bf16 v[116:119], v[20:23], v[40:43], v[116:119]
    ds_read_b64_tr_b16 v[32:33], v71 offset:1024
    ds_read_b64_tr_b16 v[34:35], v71 offset:1536
    v_mfma_f32_16x16x32_bf16 v[120:123], v[20:23], v[44:47], v[120:123]
    v_mfma_f32_16x16x32_bf16 v[124:127], v[20:23], v[48:51], v[124:127]
    buffer_load_dwordx4 v84, s[24:27], s38 offen offset:3072 lds
    s_waitcnt lgkmcnt(8)
    v_mfma_f32_16x16x32_bf16 v[128:131], v[24:27], v[36:39], v[128:131]
    v_mfma_f32_16x16x32_bf16 v[132:135], v[24:27], v[40:43], v[132:135]
    ds_read_b64_tr_b16 v[16:17], v71 offset:2048
    ds_read_b64_tr_b16 v[18:19], v71 offset:2560
    v_mfma_f32_16x16x32_bf16 v[136:139], v[24:27], v[44:47], v[136:139]
    v_mfma_f32_16x16x32_bf16 v[140:143], v[24:27], v[48:51], v[140:143]
    s_add_u32 m0, s44, 65536
    s_nop 0
    buffer_load_dwordx4 v84, s[28:31], s38 offen offset:0 lds
    s_add_u32 s38, s38, s42
    s_waitcnt lgkmcnt(6)
    v_mfma_f32_16x16x32_bf16 v[144:147], v[28:31], v[36:39], v[144:147]
    v_mfma_f32_16x16x32_bf16 v[148:151], v[28:31], v[40:43], v[148:151]
    ds_read_b64_tr_b16 v[20:21], v72 offset:1024
    ds_read_b64_tr_b16 v[22:23], v72 offset:1536
    v_mfma_f32_16x16x32_bf16 v[152:155], v[28:31], v[44:47], v[152:155]
    v_mfma_f32_16x16x32_bf16 v[156:159], v[28:31], v[48:51], v[156:159]
    s_waitcnt lgkmcnt(4)
    v_mfma_f32_16x16x32_bf16 v[160:163], v[32:35], v[36:39], v[160:163]
    v_mfma_f32_16x16x32_bf16 v[164:167], v[32:35], v[40:43], v[164:167]
    ds_read_b64_tr_b16 v[24:25], v72 offset:2048
    ds_read_b64_tr_b16 v[26:27], v72 offset:2560
    v_mfma_f32_16x16x32_bf16 v[168:171], v[32:35], v[44:47], v[168:171]
    v_mfma_f32_16x16x32_bf16 v[172:175], v[32:35], v[48:51], v[172:175]
    s_waitcnt lgkmcnt(4)
    v_mfma_f32_16x16x32_bf16 v[176:179], v[16:19], v[36:39], v[176:179]
    ds_read_b64_tr_b16 v[28:29], v73 offset:1024
    ds_read_b64_tr_b16 v[30:31], v73 offset:1536
    v_mfma_f32_16x16x32_bf16 v[180:183], v[16:19], v[40:43], v[180:183]
    ds_read_b64_tr_b16 v[32:33], v73 offset:2048
    ds_read_b64_tr_b16 v[34:35], v73 offset:2560
    v_mfma_f32_16x16x32_bf16 v[184:187], v[16:19], v[44:47], v[184:187]
    v_mfma_f32_16x16x32_bf16 v[188:191], v[16:19], v[48:51], v[188:191]
    s_waitcnt lgkmcnt(6)
    v_mfma_f32_16x16x32_bf16 v[192:195], v[20:23], v[36:39], v[192:195]
    v_mfma_f32_16x16x32_bf16 v[196:199], v[20:23], v[40:43], v[196:199]
    v_mfma_f32_16x16x32_bf16 v[200:203], v[20:23], v[44:47], v[200:203]
    v_mfma_f32_16x16x32_bf16 v[204:207], v[20:23], v[48:51], v[204:207]
    buffer_store_dword v1, v1, s[32:35], s86 offen
    buffer_store_dword v1, v1, s[32:35], s86 offen
    s_cmp_eq_u32 s45, 5
    s_cselect_b32 s52, s60, 0
    s_sub_u32 s36, s36, s52
    s_cmp_eq_u32 s45, 5
    s_cselect_b32 s52, s61, 0
    s_sub_u32 s37, s37, s52
    s_cmp_eq_u32 s45, 5
    s_cselect_b32 s52, s62, 0
    s_sub_u32 s38, s38, s52
    s_cmp_eq_u32 s45, 5
    s_sub_u32 s45, s45, 1
    s_cmp_eq_u32 s45, s64
    s_cselect_b32 s65, s67, s86
    s_cmp_eq_u32 s45, 2
    s_cselect_b32 s66, s92, s86
    s_cmp_lg_u32 s45, 1
    s_waitcnt vmcnt(14) lgkmcnt(0)
    s_barrier
    s_cbranch_scc1 L_g1_loop_W0
L_g1_lastit_W0:
    v_mfma_f32_16x16x32_bf16 v[208:211], v[24:27], v[36:39], v[208:211]
    v_mfma_f32_16x16x32_bf16 v[212:215], v[24:27], v[40:43], v[212:215]
    v_mfma_f32_16x16x32_bf16 v[216:219], v[24:27], v[44:47], v[216:219]
    ds_read_b64_tr_b16 v[16:17], v68 offset:20480
    ds_read_b64_tr_b16 v[18:19], v68 offset:20992
    v_mfma_f32_16x16x32_bf16 v[220:223], v[24:27], v[48:51], v[220:223]
    v_mfma_f32_16x16x32_bf16 v[224:227], v[28:31], v[36:39], v[224:227]
    v_mfma_f32_16x16x32_bf16 v[228:231], v[28:31], v[40:43], v[228:231]
    ds_read_b64_tr_b16 v[20:21], v69 offset:20480
    ds_read_b64_tr_b16 v[22:23], v69 offset:20992
    v_mfma_f32_16x16x32_bf16 v[232:235], v[28:31], v[44:47], v[232:235]
    v_mfma_f32_16x16x32_bf16 v[236:239], v[28:31], v[48:51], v[236:239]
    s_add_u32 m0, s44, 0
    s_nop 0
    buffer_load_dwordx4 v82, s[12:15], s36 offen offset:0 lds
    s_add_u32 s36, s36, s40
    v_mfma_f32_16x16x32_bf16 v[240:243], v[32:35], v[36:39], v[240:243]
    v_mfma_f32_16x16x32_bf16 v[244:247], v[32:35], v[40:43], v[244:247]
    ds_read_b64_tr_b16 v[24:25], v70 offset:21504
    ds_read_b64_tr_b16 v[26:27], v70 offset:22016
    v_mfma_f32_16x16x32_bf16 v[248:251], v[32:35], v[44:47], v[248:251]
    v_mfma_f32_16x16x32_bf16 v[252:255], v[32:35], v[48:51], v[252:255]
    buffer_load_dwordx4 v83, s[16:19], s37 offen offset:1024 lds
    s_waitcnt lgkmcnt(4)
    v_mfma_f32_16x16x32_bf16 v[96:99], v[16:19], v[52:55], v[96:99]
    v_mfma_f32_16x16x32_bf16 v[100:103], v[16:19], v[56:59], v[100:103]
    ds_read_b64_tr_b16 v[28:29], v70 offset:22528
    ds_read_b64_tr_b16 v[30:31], v70 offset:23040
    v_mfma_f32_16x16x32_bf16 v[104:107], v[16:19], v[60:63], v[104:107]
    v_mfma_f32_16x16x32_bf16 v[108:111], v[16:19], v[64:67], v[108:111]
    buffer_load_dwordx4 v83, s[20:23], s37 offen offset:2048 lds
    s_add_u32 s37, s37, s41
    s_waitcnt lgkmcnt(4)
    v_mfma_f32_16x16x32_bf16 v[112:115], v[20:23], v[52:55], v[112:115]
    v_mfma_f32_16x16x32_bf16 v[116:119], v[20:23], v[56:59], v[116:119]
    ds_read_b64_tr_b16 v[32:33], v71 offset:21504
    ds_read_b64_tr_b16 v[34:35], v71 offset:22016
    v_mfma_f32_16x16x32_bf16 v[120:123], v[20:23], v[60:63], v[120:123]
    v_mfma_f32_16x16x32_bf16 v[124:127], v[20:23], v[64:67], v[124:127]
    buffer_load_dwordx4 v84, s[24:27], s38 offen offset:3072 lds
    s_waitcnt lgkmcnt(4)
    v_mfma_f32_16x16x32_bf16 v[128:131], v[24:27], v[52:55], v[128:131]
    v_mfma_f32_16x16x32_bf16 v[132:135], v[24:27], v[56:59], v[132:135]
    ds_read_b64_tr_b16 v[16:17], v71 offset:22528
    ds_read_b64_tr_b16 v[18:19], v71 offset:23040
    v_mfma_f32_16x16x32_bf16 v[136:139], v[24:27], v[60:63], v[136:139]
    v_mfma_f32_16x16x32_bf16 v[140:143], v[24:27], v[64:67], v[140:143]
    s_add_u32 m0, s44, 4096
    s_nop 0
    buffer_load_dwordx4 v84, s[28:31], s38 offen offset:0 lds
    s_add_u32 s38, s38, s42
    s_waitcnt lgkmcnt(4)
    v_mfma_f32_16x16x32_bf16 v[144:147], v[28:31], v[52:55], v[144:147]
    v_mfma_f32_16x16x32_bf16 v[148:151], v[28:31], v[56:59], v[148:151]
    ds_read_b64_tr_b16 v[20:21], v72 offset:21504
    ds_read_b64_tr_b16 v[22:23], v72 offset:22016
    v_mfma_f32_16x16x32_bf16 v[152:155], v[28:31], v[60:63], v[152:155]
    v_mfma_f32_16x16x32_bf16 v[156:159], v[28:31], v[64:67], v[156:159]
    s_waitcnt lgkmcnt(4)
    v_mfma_f32_16x16x32_bf16 v[160:163], v[32:35], v[52:55], v[160:163]
    v_mfma_f32_16x16x32_bf16 v[164:167], v[32:35], v[56:59], v[164:167]
    ds_read_b64_tr_b16 v[24:25], v72 offset:22528
    ds_read_b64_tr_b16 v[26:27], v72 offset:23040
    v_mfma_f32_16x16x32_bf16 v[168:171], v[32:35], v[60:63], v[168:171]
    v_mfma_f32_16x16x32_bf16 v[172:175], v[32:35], v[64:67], v[172:175]
    s_waitcnt lgkmcnt(4)
    v_mfma_f32_16x16x32_bf16 v[176:179], v[16:19], v[52:55], v[176:179]
    ds_read_b64_tr_b16 v[28:29], v73 offset:21504
    ds_read_b64_tr_b16 v[30:31], v73 offset:22016
    v_mfma_f32_16x16x32_bf16 v[180:183], v[16:19], v[56:59], v[180:183]
    ds_read_b64_tr_b16 v[32:33], v73 offset:22528
    ds_read_b64_tr_b16 v[34:35], v73 offset:23040
    v_mfma_f32_16x16x32_bf16 v[184:187], v[16:19], v[60:63], v[184:187]
    v_mfma_f32_16x16x32_bf16 v[188:191], v[16:19], v[64:67], v[188:191]
    s_waitcnt lgkmcnt(6)
    v_mfma_f32_16x16x32_bf16 v[192:195], v[20:23], v[52:55], v[192:195]
    v_mfma_f32_16x16x32_bf16 v[196:199], v[20:23], v[56:59], v[196:199]
    v_mfma_f32_16x16x32_bf16 v[200:203], v[20:23], v[60:63], v[200:203]
    v_mfma_f32_16x16x32_bf16 v[204:207], v[20:23], v[64:67], v[204:207]
    s_waitcnt vmcnt(12)
    s_cmp_eq_u32 s49, 0
    s_cbranch_scc0 L_g1_zok_4
    s_mov_b32 s52, 0
L_g1_z_3:
    v_cmp_ne_u32 vcc, 32, v85
    s_cbranch_vccz L_g1_zok_4
    s_add_u32 s52, s52, 1
    s_cmp_lt_u32 s52, 65536
    s_cbranch_scc0 L_g1_zok_4
    buffer_load_dword v85, v87, s[88:91], s92 offen sc0 sc1
    s_waitcnt vmcnt(0)
    s_branch L_g1_z_3
L_g1_zok_4:
    s_waitcnt vmcnt(14) lgkmcnt(0)
    s_barrier
    v_mfma_f32_16x16x32_bf16 v[208:211], v[24:27], v[52:55], v[208:211]
    ds_read_b128 v[36:39], v80 offset:32768
    ds_read_b128 v[40:43], v80 offset:34816
    s_lshl_b32 s52, s49, 6
    v_add_u32 v4, s52, v1
    v_mfma_f32_16x16x32_bf16 v[212:215], v[24:27], v[56:59], v[212:215]
    ds_read_b128 v[44:47], v80 offset:36864
    ds_read_b128 v[48:51], v80 offset:38912
    v_lshrrev_b32 v5, 3, v4
    v_mfma_f32_16x16x32_bf16 v[216:219], v[24:27], v[60:63], v[216:219]
    ds_read_b64_tr_b16 v[16:17], v68 offset:40960
    ds_read_b64_tr_b16 v[18:19], v68 offset:41472
    v_lshlrev_b32 v5, 7, v5
    v_mfma_f32_16x16x32_bf16 v[220:223], v[24:27], v[64:67], v[220:223]
    v_and_b32 v6, 7, v1
    v_mfma_f32_16x16x32_bf16 v[224:227], v[28:31], v[52:55], v[224:227]
    v_lshl_add_u32 v5, v6, 3, v5
    v_mfma_f32_16x16x32_bf16 v[228:231], v[28:31], v[56:59], v[228:231]
    ds_read_b64_tr_b16 v[20:21], v69 offset:40960
    ds_read_b64_tr_b16 v[22:23], v69 offset:41472
    v_cmp_gt_u32 vcc, 256, v4
    v_mfma_f32_16x16x32_bf16 v[232:235], v[28:31], v[60:63], v[232:235]
    v_mov_b32 v6, 2147418112
    v_mfma_f32_16x16x32_bf16 v[236:239], v[28:31], v[64:67], v[236:239]
    s_add_u32 m0, s44, 20480
    s_nop 0
    buffer_load_dwordx4 v82, s[12:15], s36 offen offset:0 lds
    s_add_u32 s36, s36, s40
    v_cndmask_b32 v5, v6, v5, vcc
    v_mfma_f32_16x16x32_bf16 v[240:243], v[32:35], v[52:55], v[240:243]
    v_cmp_gt_u32 vcc, 320, v4
    v_mfma_f32_16x16x32_bf16 v[244:247], v[32:35], v[56:59], v[244:247]
    ds_read_b64_tr_b16 v[24:25], v70 offset:41984
    ds_read_b64_tr_b16 v[26:27], v70 offset:42496
    v_lshlrev_b32 v4, 2, v4
    v_mfma_f32_16x16x32_bf16 v[248:251], v[32:35], v[60:63], v[248:251]
    v_cndmask_b32 v7, v6, v4, vcc
    v_mfma_f32_16x16x32_bf16 v[252:255], v[32:35], v[64:67], v[252:255]
    buffer_load_dwordx4 v83, s[16:19], s37 offen offset:1024 lds
    s_and_b32 s52, s2, 31
    s_mul_i32 s52, s52, 10240
    s_add_u32 s52, s52, 52498432
    s_add_u32 s53, s52, 5120
    buffer_load_dword v88, v7, s[32:35], s52 offen offset:0 sc0 sc1
    s_waitcnt lgkmcnt(4)
    v_mfma_f32_16x16x32_bf16 v[96:99], v[16:19], v[36:39], v[96:99]
    ds_read_b128 v[52:55], v81 offset:32768
    ds_read_b128 v[56:59], v81 offset:34816
    buffer_load_dword v89, v7, s[32:35], s52 offen offset:1280 sc0 sc1
    v_mfma_f32_16x16x32_bf16 v[100:103], v[16:19], v[40:43], v[100:103]
    ds_read_b64_tr_b16 v[28:29], v70 offset:43008
    ds_read_b64_tr_b16 v[30:31], v70 offset:43520
    buffer_load_dword v90, v7, s[32:35], s52 offen offset:2560 sc0 sc1
    v_mfma_f32_16x16x32_bf16 v[104:107], v[16:19], v[44:47], v[104:107]
    ds_read_b128 v[60:63], v81 offset:36864
    ds_read_b128 v[64:67], v81 offset:38912
    buffer_load_dword v91, v7, s[32:35], s52 offen offset:3840 sc0 sc1
    v_mfma_f32_16x16x32_bf16 v[108:111], v[16:19], v[48:51], v[108:111]
    buffer_load_dwordx4 v83, s[20:23], s37 offen offset:2048 lds
    s_add_u32 s37, s37, s41
    buffer_load_dword v92, v7, s[32:35], s53 offen offset:0 sc0 sc1
    s_waitcnt lgkmcnt(8)
    v_mfma_f32_16x16x32_bf16 v[112:115], v[20:23], v[36:39], v[112:115]
    buffer_load_dword v93, v7, s[32:35], s53 offen offset:1280 sc0 sc1
    v_mfma_f32_16x16x32_bf16 v[116:119], v[20:23], v[40:43], v[116:119]
    ds_read_b64_tr_b16 v[32:33], v71 offset:41984
    ds_read_b64_tr_b16 v[34:35], v71 offset:42496
    buffer_load_dword v94, v7, s[32:35], s53 offen offset:2560 sc0 sc1
    v_mfma_f32_16x16x32_bf16 v[120:123], v[20:23], v[44:47], v[120:123]
    buffer_load_dword v95, v7, s[32:35], s53 offen offset:3840 sc0 sc1
    v_mfma_f32_16x16x32_bf16 v[124:127], v[20:23], v[48:51], v[124:127]
    buffer_load_dwordx4 v84, s[24:27], s38 offen offset:3072 lds
    s_lshl_b32 s52, s48, 12
    s_add_u32 s52, s52, 52465664
    buffer_load_dwordx2 v[74:75], v5, s[32:35], s52 offen sc0 sc1
    s_waitcnt lgkmcnt(8)
    v_mfma_f32_16x16x32_bf16 v[128:131], v[24:27], v[36:39], v[128:131]
    v_mfma_f32_16x16x32_bf16 v[132:135], v[24:27], v[40:43], v[132:135]
    ds_read_b64_tr_b16 v[16:17], v71 offset:43008
    ds_read_b64_tr_b16 v[18:19], v71 offset:43520
    v_mfma_f32_16x16x32_bf16 v[136:139], v[24:27], v[44:47], v[136:139]
    v_mfma_f32_16x16x32_bf16 v[140:143], v[24:27], v[48:51], v[140:143]
    s_add_u32 m0, s44, 24576
    s_nop 0
    buffer_load_dwordx4 v84, s[28:31], s38 offen offset:0 lds
    s_add_u32 s38, s38, s42
    s_waitcnt lgkmcnt(6)
    v_mfma_f32_16x16x32_bf16 v[144:147], v[28:31], v[36:39], v[144:147]
    v_mfma_f32_16x16x32_bf16 v[148:151], v[28:31], v[40:43], v[148:151]
    ds_read_b64_tr_b16 v[20:21], v72 offset:41984
    ds_read_b64_tr_b16 v[22:23], v72 offset:42496
    v_mfma_f32_16x16x32_bf16 v[152:155], v[28:31], v[44:47], v[152:155]
    v_mfma_f32_16x16x32_bf16 v[156:159], v[28:31], v[48:51], v[156:159]
    s_waitcnt lgkmcnt(4)
    v_mfma_f32_16x16x32_bf16 v[160:163], v[32:35], v[36:39], v[160:163]
    v_mfma_f32_16x16x32_bf16 v[164:167], v[32:35], v[40:43], v[164:167]
    ds_read_b64_tr_b16 v[24:25], v72 offset:43008
    ds_read_b64_tr_b16 v[26:27], v72 offset:43520
    v_mfma_f32_16x16x32_bf16 v[168:171], v[32:35], v[44:47], v[168:171]
    v_mfma_f32_16x16x32_bf16 v[172:175], v[32:35], v[48:51], v[172:175]
    s_waitcnt lgkmcnt(4)
    v_mfma_f32_16x16x32_bf16 v[176:179], v[16:19], v[36:39], v[176:179]
    ds_read_b64_tr_b16 v[28:29], v73 offset:41984
    ds_read_b64_tr_b16 v[30:31], v73 offset:42496
    v_mfma_f32_16x16x32_bf16 v[180:183], v[16:19], v[40:43], v[180:183]
    ds_read_b64_tr_b16 v[32:33], v73 offset:43008
    ds_read_b64_tr_b16 v[34:35], v73 offset:43520
    v_mfma_f32_16x16x32_bf16 v[184:187], v[16:19], v[44:47], v[184:187]
    v_mfma_f32_16x16x32_bf16 v[188:191], v[16:19], v[48:51], v[188:191]
    s_waitcnt lgkmcnt(6)
    v_mfma_f32_16x16x32_bf16 v[192:195], v[20:23], v[36:39], v[192:195]
    v_mfma_f32_16x16x32_bf16 v[196:199], v[20:23], v[40:43], v[196:199]
    v_mfma_f32_16x16x32_bf16 v[200:203], v[20:23], v[44:47], v[200:203]
    v_mfma_f32_16x16x32_bf16 v[204:207], v[20:23], v[48:51], v[204:207]
    s_waitcnt vmcnt(21) lgkmcnt(0)
    s_barrier
    v_mfma_f32_16x16x32_bf16 v[208:211], v[24:27], v[36:39], v[208:211]
    v_mfma_f32_16x16x32_bf16 v[212:215], v[24:27], v[40:43], v[212:215]
    v_mfma_f32_16x16x32_bf16 v[216:219], v[24:27], v[44:47], v[216:219]
    ds_read_b64_tr_b16 v[16:17], v68 offset:61440
    ds_read_b64_tr_b16 v[18:19], v68 offset:61952
    v_mfma_f32_16x16x32_bf16 v[220:223], v[24:27], v[48:51], v[220:223]
    v_mfma_f32_16x16x32_bf16 v[224:227], v[28:31], v[36:39], v[224:227]
    v_mfma_f32_16x16x32_bf16 v[228:231], v[28:31], v[40:43], v[228:231]
    ds_read_b64_tr_b16 v[20:21], v69 offset:61440
    ds_read_b64_tr_b16 v[22:23], v69 offset:61952
    v_mfma_f32_16x16x32_bf16 v[232:235], v[28:31], v[44:47], v[232:235]
    v_mfma_f32_16x16x32_bf16 v[236:239], v[28:31], v[48:51], v[236:239]
    s_add_u32 m0, s44, 40960
    s_nop 0
    buffer_load_dwordx4 v82, s[12:15], s36 offen offset:0 lds
    s_add_u32 s36, s36, s40
    v_mfma_f32_16x16x32_bf16 v[240:243], v[32:35], v[36:39], v[240:243]
    v_mfma_f32_16x16x32_bf16 v[244:247], v[32:35], v[40:43], v[244:247]
    ds_read_b64_tr_b16 v[24:25], v70 offset:62464
    ds_read_b64_tr_b16 v[26:27], v70 offset:62976
    v_mfma_f32_16x16x32_bf16 v[248:251], v[32:35], v[44:47], v[248:251]
    v_mfma_f32_16x16x32_bf16 v[252:255], v[32:35], v[48:51], v[252:255]
    buffer_load_dwordx4 v83, s[16:19], s37 offen offset:1024 lds
    s_waitcnt lgkmcnt(4)
    v_mfma_f32_16x16x32_bf16 v[96:99], v[16:19], v[52:55], v[96:99]
    v_mfma_f32_16x16x32_bf16 v[100:103], v[16:19], v[56:59], v[100:103]
    ds_read_b64_tr_b16 v[28:29], v70 offset:63488
    ds_read_b64_tr_b16 v[30:31], v70 offset:64000
    v_mfma_f32_16x16x32_bf16 v[104:107], v[16:19], v[60:63], v[104:107]
    v_mfma_f32_16x16x32_bf16 v[108:111], v[16:19], v[64:67], v[108:111]
    buffer_load_dwordx4 v83, s[20:23], s37 offen offset:2048 lds
    s_add_u32 s37, s37, s41
    s_waitcnt lgkmcnt(4)
    v_mfma_f32_16x16x32_bf16 v[112:115], v[20:23], v[52:55], v[112:115]
    v_mfma_f32_16x16x32_bf16 v[116:119], v[20:23], v[56:59], v[116:119]
    ds_read_b64_tr_b16 v[32:33], v71 offset:62464
    ds_read_b64_tr_b16 v[34:35], v71 offset:62976
    v_mfma_f32_16x16x32_bf16 v[120:123], v[20:23], v[60:63], v[120:123]
    v_mfma_f32_16x16x32_bf16 v[124:127], v[20:23], v[64:67], v[124:127]
    buffer_load_dwordx4 v84, s[24:27], s38 offen offset:3072 lds
    s_waitcnt lgkmcnt(4)
    v_mfma_f32_16x16x32_bf16 v[128:131], v[24:27], v[52:55], v[128:131]
    v_mfma_f32_16x16x32_bf16 v[132:135], v[24:27], v[56:59], v[132:135]
    ds_read_b64_tr_b16 v[16:17], v71 offset:63488
    ds_read_b64_tr_b16 v[18:19], v71 offset:64000
    v_mfma_f32_16x16x32_bf16 v[136:139], v[24:27], v[60:63], v[136:139]
    v_mfma_f32_16x16x32_bf16 v[140:143], v[24:27], v[64:67], v[140:143]
    s_add_u32 m0, s44, 45056
    s_nop 0
    buffer_load_dwordx4 v84, s[28:31], s38 offen offset:0 lds
    s_add_u32 s38, s38, s42
    s_waitcnt lgkmcnt(4)
    v_mfma_f32_16x16x32_bf16 v[144:147], v[28:31], v[52:55], v[144:147]
    v_mfma_f32_16x16x32_bf16 v[148:151], v[28:31], v[56:59], v[148:151]
    ds_read_b64_tr_b16 v[20:21], v72 offset:62464
    ds_read_b64_tr_b16 v[22:23], v72 offset:62976
    v_mfma_f32_16x16x32_bf16 v[152:155], v[28:31], v[60:63], v[152:155]
    v_mfma_f32_16x16x32_bf16 v[156:159], v[28:31], v[64:67], v[156:159]
    s_waitcnt lgkmcnt(4)
    v_mfma_f32_16x16x32_bf16 v[160:163], v[32:35], v[52:55], v[160:163]
    v_mfma_f32_16x16x32_bf16 v[164:167], v[32:35], v[56:59], v[164:167]
    ds_read_b64_tr_b16 v[24:25], v72 offset:63488
    ds_read_b64_tr_b16 v[26:27], v72 offset:64000
    v_mfma_f32_16x16x32_bf16 v[168:171], v[32:35], v[60:63], v[168:171]
    v_mfma_f32_16x16x32_bf16 v[172:175], v[32:35], v[64:67], v[172:175]
    s_waitcnt lgkmcnt(4)
    v_mfma_f32_16x16x32_bf16 v[176:179], v[16:19], v[52:55], v[176:179]
    ds_read_b64_tr_b16 v[28:29], v73 offset:62464
    ds_read_b64_tr_b16 v[30:31], v73 offset:62976
    v_mfma_f32_16x16x32_bf16 v[180:183], v[16:19], v[56:59], v[180:183]
    ds_read_b64_tr_b16 v[32:33], v73 offset:63488
    ds_read_b64_tr_b16 v[34:35], v73 offset:64000
    v_mfma_f32_16x16x32_bf16 v[184:187], v[16:19], v[60:63], v[184:187]
    v_mfma_f32_16x16x32_bf16 v[188:191], v[16:19], v[64:67], v[188:191]
    s_waitcnt lgkmcnt(6)
    v_mfma_f32_16x16x32_bf16 v[192:195], v[20:23], v[52:55], v[192:195]
    v_mfma_f32_16x16x32_bf16 v[196:199], v[20:23], v[56:59], v[196:199]
    v_mfma_f32_16x16x32_bf16 v[200:203], v[20:23], v[60:63], v[200:203]
    v_mfma_f32_16x16x32_bf16 v[204:207], v[20:23], v[64:67], v[204:207]
    s_waitcnt vmcnt(19) lgkmcnt(0)
    s_barrier
    v_mfma_f32_16x16x32_bf16 v[208:211], v[24:27], v[52:55], v[208:211]
    ds_read_b128 v[36:39], v80 offset:0
    ds_read_b128 v[40:43], v80 offset:2048
    v_mfma_f32_16x16x32_bf16 v[212:215], v[24:27], v[56:59], v[212:215]
    ds_read_b128 v[44:47], v80 offset:4096
    ds_read_b128 v[48:51], v80 offset:6144
    v_mfma_f32_16x16x32_bf16 v[216:219], v[24:27], v[60:63], v[216:219]
    ds_read_b64_tr_b16 v[16:17], v68 offset:0
    ds_read_b64_tr_b16 v[18:19], v68 offset:512
    v_mfma_f32_16x16x32_bf16 v[220:223], v[24:27], v[64:67], v[220:223]
    v_mfma_f32_16x16x32_bf16 v[224:227], v[28:31], v[52:55], v[224:227]
    v_mfma_f32_16x16x32_bf16 v[228:231], v[28:31], v[56:59], v[228:231]
    ds_read_b64_tr_b16 v[20:21], v69 offset:0
    ds_read_b64_tr_b16 v[22:23], v69 offset:512
    v_mfma_f32_16x16x32_bf16 v[232:235], v[28:31], v[60:63], v[232:235]
    v_mfma_f32_16x16x32_bf16 v[236:239], v[28:31], v[64:67], v[236:239]
    s_add_u32 m0, s44, 61440
    s_nop 0
    buffer_load_dwordx4 v82, s[12:15], s36 offen offset:0 lds
    s_add_u32 s36, s36, s40
    v_mfma_f32_16x16x32_bf16 v[240:243], v[32:35], v[52:55], v[240:243]
    v_mfma_f32_16x16x32_bf16 v[244:247], v[32:35], v[56:59], v[244:247]
    ds_read_b64_tr_b16 v[24:25], v70 offset:1024
    ds_read_b64_tr_b16 v[26:27], v70 offset:1536
    v_mfma_f32_16x16x32_bf16 v[248:251], v[32:35], v[60:63], v[248:251]
    v_mfma_f32_16x16x32_bf16 v[252:255], v[32:35], v[64:67], v[252:255]
    buffer_load_dwordx4 v83, s[16:19], s37 offen offset:1024 lds
    s_waitcnt lgkmcnt(4)
    v_mfma_f32_16x16x32_bf16 v[96:99], v[16:19], v[36:39], v[96:99]
    ds_read_b128 v[52:55], v81 offset:0
    ds_read_b128 v[56:59], v81 offset:2048
    v_mfma_f32_16x16x32_bf16 v[100:103], v[16:19], v[40:43], v[100:103]
    ds_read_b64_tr_b16 v[28:29], v70 offset:2048
    ds_read_b64_tr_b16 v[30:31], v70 offset:2560
    v_mfma_f32_16x16x32_bf16 v[104:107], v[16:19], v[44:47], v[104:107]
    ds_read_b128 v[60:63], v81 offset:4096
    ds_read_b128 v[64:67], v81 offset:6144
    v_mfma_f32_16x16x32_bf16 v[108:111], v[16:19], v[48:51], v[108:111]
    buffer_load_dwordx4 v83, s[20:23], s37 offen offset:2048 lds
    s_add_u32 s37, s37, s41
    s_waitcnt lgkmcnt(8)
    v_mfma_f32_16x16x32_bf16 v[112:115], v[20:23], v[36:39], v[112:115]
    v_mfma_f32_16x16x32_bf16 v[116:119], v[20:23], v[40:43], v[116:119]
    ds_read_b64_tr_b16 v[32:33], v71 offset:1024
    ds_read_b64_tr_b16 v[34:35], v71 offset:1536
    v_mfma_f32_16x16x32_bf16 v[120:123], v[20:23], v[44:47], v[120:123]
    v_mfma_f32_16x16x32_bf16 v[124:127], v[20:23], v[48:51], v[124:127]
    buffer_load_dwordx4 v84, s[24:27], s38 offen offset:3072 lds
    s_waitcnt lgkmcnt(8)
    v_mfma_f32_16x16x32_bf16 v[128:131], v[24:27], v[36:39], v[128:131]
    v_mfma_f32_16x16x32_bf16 v[132:135], v[24:27], v[40:43], v[132:135]
    ds_read_b64_tr_b16 v[16:17], v71 offset:2048
    ds_read_b64_tr_b16 v[18:19], v71 offset:2560
    v_mfma_f32_16x16x32_bf16 v[136:139], v[24:27], v[44:47], v[136:139]
    v_mfma_f32_16x16x32_bf16 v[140:143], v[24:27], v[48:51], v[140:143]
    s_add_u32 m0, s44, 65536
    s_nop 0
    buffer_load_dwordx4 v84, s[28:31], s38 offen offset:0 lds
    s_add_u32 s38, s38, s42
    s_waitcnt lgkmcnt(6)
    v_mfma_f32_16x16x32_bf16 v[144:147], v[28:31], v[36:39], v[144:147]
    v_mfma_f32_16x16x32_bf16 v[148:151], v[28:31], v[40:43], v[148:151]
    ds_read_b64_tr_b16 v[20:21], v72 offset:1024
    ds_read_b64_tr_b16 v[22:23], v72 offset:1536
    v_mfma_f32_16x16x32_bf16 v[152:155], v[28:31], v[44:47], v[152:155]
    v_mfma_f32_16x16x32_bf16 v[156:159], v[28:31], v[48:51], v[156:159]
    s_waitcnt lgkmcnt(4)
    v_mfma_f32_16x16x32_bf16 v[160:163], v[32:35], v[36:39], v[160:163]
    v_mfma_f32_16x16x32_bf16 v[164:167], v[32:35], v[40:43], v[164:167]
    ds_read_b64_tr_b16 v[24:25], v72 offset:2048
    ds_read_b64_tr_b16 v[26:27], v72 offset:2560
    v_mfma_f32_16x16x32_bf16 v[168:171], v[32:35], v[44:47], v[168:171]
    v_mfma_f32_16x16x32_bf16 v[172:175], v[32:35], v[48:51], v[172:175]
    s_waitcnt lgkmcnt(4)
    v_mfma_f32_16x16x32_bf16 v[176:179], v[16:19], v[36:39], v[176:179]
    ds_read_b64_tr_b16 v[28:29], v73 offset:1024
    ds_read_b64_tr_b16 v[30:31], v73 offset:1536
    v_mfma_f32_16x16x32_bf16 v[180:183], v[16:19], v[40:43], v[180:183]
    ds_read_b64_tr_b16 v[32:33], v73 offset:2048
    ds_read_b64_tr_b16 v[34:35], v73 offset:2560
    v_mfma_f32_16x16x32_bf16 v[184:187], v[16:19], v[44:47], v[184:187]
    v_mfma_f32_16x16x32_bf16 v[188:191], v[16:19], v[48:51], v[188:191]
    s_waitcnt lgkmcnt(6)
    v_mfma_f32_16x16x32_bf16 v[192:195], v[20:23], v[36:39], v[192:195]
    v_mfma_f32_16x16x32_bf16 v[196:199], v[20:23], v[40:43], v[196:199]
    v_mfma_f32_16x16x32_bf16 v[200:203], v[20:23], v[44:47], v[200:203]
    v_mfma_f32_16x16x32_bf16 v[204:207], v[20:23], v[48:51], v[204:207]
    s_waitcnt vmcnt(10)
    v_add_f32 v88, v88, v89
    v_add_f32 v90, v90, v91
    v_add_f32 v92, v92, v93
    v_add_f32 v94, v94, v95
    v_add_f32 v88, v88, v90
    v_add_f32 v92, v92, v94
    v_add_f32 v88, v88, v92
    v_add_u32 v4, 147456, v4
    s_lshl_b32 s52, s49, 9
    s_add_u32 s52, s52, 149504
    v_lshl_add_u32 v5, v1, 2, s52
    ds_write_b32 v4, v88
    ds_write2_b32 v5, v74, v75 offset0:0 offset1:64
    s_waitcnt lgkmcnt(0)
    s_barrier
    s_branch L_g1_tail
L_g1_spec_W0:
    s_cmp_eq_u32 s51, 0
    s_cbranch_scc1 L_cs_5
    v_mfma_f32_16x16x32_bf16 v[208:211], v[24:27], v[36:39], v[208:211]
    v_mfma_f32_16x16x32_bf16 v[212:215], v[24:27], v[40:43], v[212:215]
    v_mfma_f32_16x16x32_bf16 v[216:219], v[24:27], v[44:47], v[216:219]
    ds_read_b64_tr_b16 v[16:17], v68 offset:20480
    ds_read_b64_tr_b16 v[18:19], v68 offset:20992
    v_mfma_f32_16x16x32_bf16 v[220:223], v[24:27], v[48:51], v[220:223]
    v_mfma_f32_16x16x32_bf16 v[224:227], v[28:31], v[36:39], v[224:227]
    v_mfma_f32_16x16x32_bf16 v[228:231], v[28:31], v[40:43], v[228:231]
    ds_read_b64_tr_b16 v[20:21], v69 offset:20480
    ds_read_b64_tr_b16 v[22:23], v69 offset:20992
    v_mfma_f32_16x16x32_bf16 v[232:235], v[28:31], v[44:47], v[232:235]
    v_mfma_f32_16x16x32_bf16 v[236:239], v[28:31], v[48:51], v[236:239]
    s_add_u32 m0, s44, 0
    s_nop 0
    buffer_load_dwordx4 v82, s[12:15], s36 offen offset:0 lds
    s_add_u32 s36, s36, s40
    v_mfma_f32_16x16x32_bf16 v[240:243], v[32:35], v[36:39], v[240:243]
    v_mfma_f32_16x16x32_bf16 v[244:247], v[32:35], v[40:43], v[244:247]
    ds_read_b64_tr_b16 v[24:25], v70 offset:21504
    ds_read_b64_tr_b16 v[26:27], v70 offset:22016
    v_mfma_f32_16x16x32_bf16 v[248:251], v[32:35], v[44:47], v[248:251]
    v_mfma_f32_16x16x32_bf16 v[252:255], v[32:35], v[48:51], v[252:255]
    buffer_load_dwordx4 v83, s[16:19], s37 offen offset:1024 lds
L_cs_5_ret:
    s_cmp_eq_u32 s51, 1
    s_cbranch_scc1 L_cs_6
    s_waitcnt lgkmcnt(4)
    v_mfma_f32_16x16x32_bf16 v[96:99], v[16:19], v[52:55], v[96:99]
    v_mfma_f32_16x16x32_bf16 v[100:103], v[16:19], v[56:59], v[100:103]
    ds_read_b64_tr_b16 v[28:29], v70 offset:22528
    ds_read_b64_tr_b16 v[30:31], v70 offset:23040
    v_mfma_f32_16x16x32_bf16 v[104:107], v[16:19], v[60:63], v[104:107]
    v_mfma_f32_16x16x32_bf16 v[108:111], v[16:19], v[64:67], v[108:111]
    buffer_load_dwordx4 v83, s[20:23], s37 offen offset:2048 lds
    s_add_u32 s37, s37, s41
    s_waitcnt lgkmcnt(4)
    v_mfma_f32_16x16x32_bf16 v[112:115], v[20:23], v[52:55], v[112:115]
    v_mfma_f32_16x16x32_bf16 v[116:119], v[20:23], v[56:59], v[116:119]
    ds_read_b64_tr_b16 v[32:33], v71 offset:21504
    ds_read_b64_tr_b16 v[34:35], v71 offset:22016
    v_mfma_f32_16x16x32_bf16 v[120:123], v[20:23], v[60:63], v[120:123]
    v_mfma_f32_16x16x32_bf16 v[124:127], v[20:23], v[64:67], v[124:127]
    buffer_load_dwordx4 v84, s[24:27], s38 offen offset:3072 lds
    s_waitcnt lgkmcnt(4)
    v_mfma_f32_16x16x32_bf16 v[128:131], v[24:27], v[52:55], v[128:131]
    v_mfma_f32_16x16x32_bf16 v[132:135], v[24:27], v[56:59], v[132:135]
    ds_read_b64_tr_b16 v[16:17], v71 offset:22528
    ds_read_b64_tr_b16 v[18:19], v71 offset:23040
    v_mfma_f32_16x16x32_bf16 v[136:139], v[24:27], v[60:63], v[136:139]
    v_mfma_f32_16x16x32_bf16 v[140:143], v[24:27], v[64:67], v[140:143]
    s_add_u32 m0, s44, 4096
    s_nop 0
    buffer_load_dwordx4 v84, s[28:31], s38 offen offset:0 lds
    s_add_u32 s38, s38, s42
L_cs_6_ret:
    s_cmp_eq_u32 s51, 2
    s_cbranch_scc1 L_cs_7
    s_waitcnt lgkmcnt(4)
    v_mfma_f32_16x16x32_bf16 v[144:147], v[28:31], v[52:55], v[144:147]
    v_mfma_f32_16x16x32_bf16 v[148:151], v[28:31], v[56:59], v[148:151]
    ds_read_b64_tr_b16 v[20:21], v72 offset:21504
    ds_read_b64_tr_b16 v[22:23], v72 offset:22016
    v_mfma_f32_16x16x32_bf16 v[152:155], v[28:31], v[60:63], v[152:155]
    v_mfma_f32_16x16x32_bf16 v[156:159], v[28:31], v[64:67], v[156:159]
    s_waitcnt lgkmcnt(4)
    v_mfma_f32_16x16x32_bf16 v[160:163], v[32:35], v[52:55], v[160:163]
    v_mfma_f32_16x16x32_bf16 v[164:167], v[32:35], v[56:59], v[164:167]
    ds_read_b64_tr_b16 v[24:25], v72 offset:22528
    ds_read_b64_tr_b16 v[26:27], v72 offset:23040
    v_mfma_f32_16x16x32_bf16 v[168:171], v[32:35], v[60:63], v[168:171]
    v_mfma_f32_16x16x32_bf16 v[172:175], v[32:35], v[64:67], v[172:175]
L_cs_7_ret:
    s_cmp_eq_u32 s51, 3
    s_cbranch_scc1 L_cs_8
    s_waitcnt lgkmcnt(4)
    v_mfma_f32_16x16x32_bf16 v[176:179], v[16:19], v[52:55], v[176:179]
    ds_read_b64_tr_b16 v[28:29], v73 offset:21504
    ds_read_b64_tr_b16 v[30:31], v73 offset:22016
    v_mfma_f32_16x16x32_bf16 v[180:183], v[16:19], v[56:59], v[180:183]
    ds_read_b64_tr_b16 v[32:33], v73 offset:22528
    ds_read_b64_tr_b16 v[34:35], v73 offset:23040
    v_mfma_f32_16x16x32_bf16 v[184:187], v[16:19], v[60:63], v[184:187]
    v_mfma_f32_16x16x32_bf16 v[188:191], v[16:19], v[64:67], v[188:191]
    s_waitcnt lgkmcnt(6)
    v_mfma_f32_16x16x32_bf16 v[192:195], v[20:23], v[52:55], v[192:195]
    v_mfma_f32_16x16x32_bf16 v[196:199], v[20:23], v[56:59], v[196:199]
    v_mfma_f32_16x16x32_bf16 v[200:203], v[20:23], v[60:63], v[200:203]
    v_mfma_f32_16x16x32_bf16 v[204:207], v[20:23], v[64:67], v[204:207]
L_cs_8_ret:
    s_waitcnt vmcnt(14) lgkmcnt(0)
    s_barrier
    s_cmp_eq_u32 s51, 0
    s_cbranch_scc1 L_cs_9
    v_mfma_f32_16x16x32_bf16 v[208:211], v[24:27], v[52:55], v[208:211]
    ds_read_b128 v[36:39], v80 offset:32768
    ds_read_b128 v[40:43], v80 offset:34816
    v_lshlrev_b32 v74, 16, v76
    v_mfma_f32_16x16x32_bf16 v[212:215], v[24:27], v[56:59], v[212:215]
    ds_read_b128 v[44:47], v80 offset:36864
    ds_read_b128 v[48:51], v80 offset:38912
    v_and_b32 v75, s87, v76
    v_mfma_f32_16x16x32_bf16 v[216:219], v[24:27], v[60:63], v[216:219]
    ds_read_b64_tr_b16 v[16:17], v68 offset:40960
    ds_read_b64_tr_b16 v[18:19], v68 offset:41472
    v_lshlrev_b32 v2, 16, v77
    v_mfma_f32_16x16x32_bf16 v[220:223], v[24:27], v[64:67], v[220:223]
    v_and_b32 v3, s87, v77
    v_mfma_f32_16x16x32_bf16 v[224:227], v[28:31], v[52:55], v[224:227]
    v_add_f32 v74, v74, v2
    v_mfma_f32_16x16x32_bf16 v[228:231], v[28:31], v[56:59], v[228:231]
    ds_read_b64_tr_b16 v[20:21], v69 offset:40960
    ds_read_b64_tr_b16 v[22:23], v69 offset:41472
    v_add_f32 v75, v75, v3
    v_mfma_f32_16x16x32_bf16 v[232:235], v[28:31], v[60:63], v[232:235]
    v_lshlrev_b32 v2, 16, v78
    v_mfma_f32_16x16x32_bf16 v[236:239], v[28:31], v[64:67], v[236:239]
    s_add_u32 m0, s44, 20480
    s_nop 0
    buffer_load_dwordx4 v82, s[12:15], s36 offen offset:0 lds
    s_add_u32 s36, s36, s40
    v_and_b32 v3, s87, v78
    v_mfma_f32_16x16x32_bf16 v[240:243], v[32:35], v[52:55], v[240:243]
    v_add_f32 v74, v74, v2
    v_mfma_f32_16x16x32_bf16 v[244:247], v[32:35], v[56:59], v[244:247]
    ds_read_b64_tr_b16 v[24:25], v70 offset:41984
    ds_read_b64_tr_b16 v[26:27], v70 offset:42496
    v_add_f32 v75, v75, v3
    v_mfma_f32_16x16x32_bf16 v[248:251], v[32:35], v[60:63], v[248:251]
    v_lshlrev_b32 v2, 16, v79
    v_mfma_f32_16x16x32_bf16 v[252:255], v[32:35], v[64:67], v[252:255]
    buffer_load_dwordx4 v83, s[16:19], s37 offen offset:1024 lds
    v_and_b32 v3, s87, v79
L_cs_9_ret:
    s_cmp_eq_u32 s51, 1
    s_cbranch_scc1 L_cs_10
    s_waitcnt lgkmcnt(4)
    v_mfma_f32_16x16x32_bf16 v[96:99], v[16:19], v[36:39], v[96:99]
    ds_read_b128 v[52:55], v81 offset:32768
    ds_read_b128 v[56:59], v81 offset:34816
    v_add_f32 v74, v74, v2
    v_mfma_f32_16x16x32_bf16 v[100:103], v[16:19], v[40:43], v[100:103]
    ds_read_b64_tr_b16 v[28:29], v70 offset:43008
    ds_read_b64_tr_b16 v[30:31], v70 offset:43520
    v_add_f32 v75, v75, v3
    v_mfma_f32_16x16x32_bf16 v[104:107], v[16:19], v[44:47], v[104:107]
    ds_read_b128 v[60:63], v81 offset:36864
    ds_read_b128 v[64:67], v81 offset:38912
    v_lshlrev_b32 v2, 16, v92
    v_mfma_f32_16x16x32_bf16 v[108:111], v[16:19], v[48:51], v[108:111]
    buffer_load_dwordx4 v83, s[20:23], s37 offen offset:2048 lds
    s_add_u32 s37, s37, s41
    v_and_b32 v3, s87, v92
    s_waitcnt lgkmcnt(8)
    v_mfma_f32_16x16x32_bf16 v[112:115], v[20:23], v[36:39], v[112:115]
    v_add_f32 v74, v74, v2
    v_mfma_f32_16x16x32_bf16 v[116:119], v[20:23], v[40:43], v[116:119]
    ds_read_b64_tr_b16 v[32:33], v71 offset:41984
    ds_read_b64_tr_b16 v[34:35], v71 offset:42496
    v_add_f32 v75, v75, v3
    v_mfma_f32_16x16x32_bf16 v[120:123], v[20:23], v[44:47], v[120:123]
    v_lshlrev_b32 v2, 16, v93
    v_mfma_f32_16x16x32_bf16 v[124:127], v[20:23], v[48:51], v[124:127]
    buffer_load_dwordx4 v84, s[24:27], s38 offen offset:3072 lds
    v_and_b32 v3, s87, v93
    s_waitcnt lgkmcnt(8)
    v_mfma_f32_16x16x32_bf16 v[128:131], v[24:27], v[36:39], v[128:131]
    v_add_f32 v74, v74, v2
    v_mfma_f32_16x16x32_bf16 v[132:135], v[24:27], v[40:43], v[132:135]
    ds_read_b64_tr_b16 v[16:17], v71 offset:43008
    ds_read_b64_tr_b16 v[18:19], v71 offset:43520
    v_add_f32 v75, v75, v3
    v_mfma_f32_16x16x32_bf16 v[136:139], v[24:27], v[44:47], v[136:139]
    v_lshlrev_b32 v2, 16, v94
    v_mfma_f32_16x16x32_bf16 v[140:143], v[24:27], v[48:51], v[140:143]
    s_add_u32 m0, s44, 24576
    s_nop 0
    buffer_load_dwordx4 v84, s[28:31], s38 offen offset:0 lds
    s_add_u32 s38, s38, s42
    v_and_b32 v3, s87, v94
L_cs_10_ret:
    s_cmp_eq_u32 s51, 2
    s_cbranch_scc1 L_cs_11
    s_waitcnt lgkmcnt(6)
    v_mfma_f32_16x16x32_bf16 v[144:147], v[28:31], v[36:39], v[144:147]
    v_add_f32 v74, v74, v2
    v_mfma_f32_16x16x32_bf16 v[148:151], v[28:31], v[40:43], v[148:151]
    ds_read_b64_tr_b16 v[20:21], v72 offset:41984
    ds_read_b64_tr_b16 v[22:23], v72 offset:42496
    v_add_f32 v75, v75, v3
    v_mfma_f32_16x16x32_bf16 v[152:155], v[28:31], v[44:47], v[152:155]
    v_lshlrev_b32 v2, 16, v95
    v_mfma_f32_16x16x32_bf16 v[156:159], v[28:31], v[48:51], v[156:159]
    v_and_b32 v3, s87, v95
    s_waitcnt lgkmcnt(4)
    v_mfma_f32_16x16x32_bf16 v[160:163], v[32:35], v[36:39], v[160:163]
    v_add_f32 v74, v74, v2
    v_mfma_f32_16x16x32_bf16 v[164:167], v[32:35], v[40:43], v[164:167]
    ds_read_b64_tr_b16 v[24:25], v72 offset:43008
    ds_read_b64_tr_b16 v[26:27], v72 offset:43520
    v_add_f32 v75, v75, v3
    v_mfma_f32_16x16x32_bf16 v[168:171], v[32:35], v[44:47], v[168:171]
    v_add_f32 v74, v74, v75
    v_mfma_f32_16x16x32_bf16 v[172:175], v[32:35], v[48:51], v[172:175]
    s_nop 1
    v_add_f32_dpp v74, v74, v74 row_ror:8 row_mask:0xf bank_mask:0xf
L_cs_11_ret:
    s_cmp_eq_u32 s51, 3
    s_cbranch_scc1 L_cs_12
    s_waitcnt lgkmcnt(4)
    v_mfma_f32_16x16x32_bf16 v[176:179], v[16:19], v[36:39], v[176:179]
    ds_read_b64_tr_b16 v[28:29], v73 offset:41984
    ds_read_b64_tr_b16 v[30:31], v73 offset:42496
    s_nop 1
    v_add_f32_dpp v74, v74, v74 row_ror:4 row_mask:0xf bank_mask:0xf
    v_mfma_f32_16x16x32_bf16 v[180:183], v[16:19], v[40:43], v[180:183]
    ds_read_b64_tr_b16 v[32:33], v73 offset:43008
    ds_read_b64_tr_b16 v[34:35], v73 offset:43520
    s_nop 1
    v_add_f32_dpp v74, v74, v74 row_ror:2 row_mask:0xf bank_mask:0xf
    v_mfma_f32_16x16x32_bf16 v[184:187], v[16:19], v[44:47], v[184:187]
    s_nop 1
    v_add_f32_dpp v74, v74, v74 row_ror:1 row_mask:0xf bank_mask:0xf
    v_mfma_f32_16x16x32_bf16 v[188:191], v[16:19], v[48:51], v[188:191]
    v_mov_b32 v2, v74
    s_waitcnt lgkmcnt(6)
    v_mfma_f32_16x16x32_bf16 v[192:195], v[20:23], v[36:39], v[192:195]
    s_nop 1
    v_permlane16_swap_b32 v74, v2
    v_mfma_f32_16x16x32_bf16 v[196:199], v[20:23], v[40:43], v[196:199]
    s_nop 1
    v_add_f32 v74, v74, v2
    v_mfma_f32_16x16x32_bf16 v[200:203], v[20:23], v[44:47], v[200:203]
    v_mov_b32 v2, v74
    v_mfma_f32_16x16x32_bf16 v[204:207], v[20:23], v[48:51], v[204:207]
    s_nop 1
    v_permlane32_swap_b32 v74, v2
L_cs_12_ret:
    s_waitcnt vmcnt(12) lgkmcnt(0)
    s_barrier
    s_cmp_eq_u32 s51, 0
    s_cbranch_scc1 L_cs_13
    v_mfma_f32_16x16x32_bf16 v[208:211], v[24:27], v[36:39], v[208:211]
    s_nop 1
    v_add_f32 v74, v74, v2
    v_mfma_f32_16x16x32_bf16 v[212:215], v[24:27], v[40:43], v[212:215]
    v_mul_f32 v74, 0x3a800000, v74
    v_mfma_f32_16x16x32_bf16 v[216:219], v[24:27], v[44:47], v[216:219]
    ds_read_b64_tr_b16 v[16:17], v68 offset:61440
    ds_read_b64_tr_b16 v[18:19], v68 offset:61952
    v_mov_b32 v75, 0
    v_mfma_f32_16x16x32_bf16 v[220:223], v[24:27], v[48:51], v[220:223]
    v_lshlrev_b32 v2, 16, v76
    v_mfma_f32_16x16x32_bf16 v[224:227], v[28:31], v[36:39], v[224:227]
    v_and_b32 v3, s87, v76
    v_mfma_f32_16x16x32_bf16 v[228:231], v[28:31], v[40:43], v[228:231]
    ds_read_b64_tr_b16 v[20:21], v69 offset:61440
    ds_read_b64_tr_b16 v[22:23], v69 offset:61952
    v_sub_f32 v2, v2, v74
    v_mfma_f32_16x16x32_bf16 v[232:235], v[28:31], v[44:47], v[232:235]
    v_sub_f32 v3, v3, v74
    v_mfma_f32_16x16x32_bf16 v[236:239], v[28:31], v[48:51], v[236:239]
    s_add_u32 m0, s44, 40960
    s_nop 0
    buffer_load_dwordx4 v82, s[12:15], s36 offen offset:0 lds
    s_add_u32 s36, s36, s40
    v_fma_f32 v75, v2, v2, v75
    v_mfma_f32_16x16x32_bf16 v[240:243], v[32:35], v[36:39], v[240:243]
    v_fma_f32 v75, v3, v3, v75
    v_mfma_f32_16x16x32_bf16 v[244:247], v[32:35], v[40:43], v[244:247]
    ds_read_b64_tr_b16 v[24:25], v70 offset:62464
    ds_read_b64_tr_b16 v[26:27], v70 offset:62976
    v_lshlrev_b32 v2, 16, v77
    v_mfma_f32_16x16x32_bf16 v[248:251], v[32:35], v[44:47], v[248:251]
    v_and_b32 v3, s87, v77
    v_mfma_f32_16x16x32_bf16 v[252:255], v[32:35], v[48:51], v[252:255]
    buffer_load_dwordx4 v83, s[16:19], s37 offen offset:1024 lds
    v_sub_f32 v2, v2, v74
L_cs_13_ret:
    s_cmp_eq_u32 s51, 1
    s_cbranch_scc1 L_cs_14
    s_waitcnt lgkmcnt(4)
    v_mfma_f32_16x16x32_bf16 v[96:99], v[16:19], v[52:55], v[96:99]
    v_sub_f32 v3, v3, v74
    v_mfma_f32_16x16x32_bf16 v[100:103], v[16:19], v[56:59], v[100:103]
    ds_read_b64_tr_b16 v[28:29], v70 offset:63488
    ds_read_b64_tr_b16 v[30:31], v70 offset:64000
    v_fma_f32 v75, v2, v2, v75
    v_mfma_f32_16x16x32_bf16 v[104:107], v[16:19], v[60:63], v[104:107]
    v_fma_f32 v75, v3, v3, v75
    v_mfma_f32_16x16x32_bf16 v[108:111], v[16:19], v[64:67], v[108:111]
    buffer_load_dwordx4 v83, s[20:23], s37 offen offset:2048 lds
    s_add_u32 s37, s37, s41
    v_lshlrev_b32 v2, 16, v78
    s_waitcnt lgkmcnt(4)
    v_mfma_f32_16x16x32_bf16 v[112:115], v[20:23], v[52:55], v[112:115]
    v_and_b32 v3, s87, v78
    v_mfma_f32_16x16x32_bf16 v[116:119], v[20:23], v[56:59], v[116:119]
    ds_read_b64_tr_b16 v[32:33], v71 offset:62464
    ds_read_b64_tr_b16 v[34:35], v71 offset:62976
    v_sub_f32 v2, v2, v74
    v_mfma_f32_16x16x32_bf16 v[120:123], v[20:23], v[60:63], v[120:123]
    v_sub_f32 v3, v3, v74
    v_mfma_f32_16x16x32_bf16 v[124:127], v[20:23], v[64:67], v[124:127]
    buffer_load_dwordx4 v84, s[24:27], s38 offen offset:3072 lds
    v_fma_f32 v75, v2, v2, v75
    s_waitcnt lgkmcnt(4)
    v_mfma_f32_16x16x32_bf16 v[128:131], v[24:27], v[52:55], v[128:131]
    v_fma_f32 v75, v3, v3, v75
    v_mfma_f32_16x16x32_bf16 v[132:135], v[24:27], v[56:59], v[132:135]
    ds_read_b64_tr_b16 v[16:17], v71 offset:63488
    ds_read_b64_tr_b16 v[18:19], v71 offset:64000
    v_lshlrev_b32 v2, 16, v79
    v_mfma_f32_16x16x32_bf16 v[136:139], v[24:27], v[60:63], v[136:139]
    v_and_b32 v3, s87, v79
    v_mfma_f32_16x16x32_bf16 v[140:143], v[24:27], v[64:67], v[140:143]
    s_add_u32 m0, s44, 45056
    s_nop 0
    buffer_load_dwordx4 v84, s[28:31], s38 offen offset:0 lds
    s_add_u32 s38, s38, s42
    v_sub_f32 v2, v2, v74
L_cs_14_ret:
    s_cmp_eq_u32 s51, 2
    s_cbranch_scc1 L_cs_15
    s_waitcnt lgkmcnt(4)
    v_mfma_f32_16x16x32_bf16 v[144:147], v[28:31], v[52:55], v[144:147]
    v_sub_f32 v3, v3, v74
    v_mfma_f32_16x16x32_bf16 v[148:151], v[28:31], v[56:59], v[148:151]
    ds_read_b64_tr_b16 v[20:21], v72 offset:62464
    ds_read_b64_tr_b16 v[22:23], v72 offset:62976
    v_fma_f32 v75, v2, v2, v75
    v_mfma_f32_16x16x32_bf16 v[152:155], v[28:31], v[60:63], v[152:155]
    v_fma_f32 v75, v3, v3, v75
    v_mfma_f32_16x16x32_bf16 v[156:159], v[28:31], v[64:67], v[156:159]
    v_lshlrev_b32 v2, 16, v92
    s_waitcnt lgkmcnt(4)
    v_mfma_f32_16x16x32_bf16 v[160:163], v[32:35], v[52:55], v[160:163]
    v_and_b32 v3, s87, v92
    v_mfma_f32_16x16x32_bf16 v[164:167], v[32:35], v[56:59], v[164:167]
    ds_read_b64_tr_b16 v[24:25], v72 offset:63488
    ds_read_b64_tr_b16 v[26:27], v72 offset:64000
    v_sub_f32 v2, v2, v74
    v_mfma_f32_16x16x32_bf16 v[168:171], v[32:35], v[60:63], v[168:171]
    v_sub_f32 v3, v3, v74
    v_mfma_f32_16x16x32_bf16 v[172:175], v[32:35], v[64:67], v[172:175]
    v_fma_f32 v75, v2, v2, v75
L_cs_15_ret:
    s_cmp_eq_u32 s51, 3
    s_cbranch_scc1 L_cs_16
    s_waitcnt lgkmcnt(4)
    v_mfma_f32_16x16x32_bf16 v[176:179], v[16:19], v[52:55], v[176:179]
    ds_read_b64_tr_b16 v[28:29], v73 offset:62464
    ds_read_b64_tr_b16 v[30:31], v73 offset:62976
    v_fma_f32 v75, v3, v3, v75
    v_mfma_f32_16x16x32_bf16 v[180:183], v[16:19], v[56:59], v[180:183]
    ds_read_b64_tr_b16 v[32:33], v73 offset:63488
    ds_read_b64_tr_b16 v[34:35], v73 offset:64000
    v_lshlrev_b32 v2, 16, v93
    v_mfma_f32_16x16x32_bf16 v[184:187], v[16:19], v[60:63], v[184:187]
    v_and_b32 v3, s87, v93
    v_mfma_f32_16x16x32_bf16 v[188:191], v[16:19], v[64:67], v[188:191]
    v_sub_f32 v2, v2, v74
    s_waitcnt lgkmcnt(6)
    v_mfma_f32_16x16x32_bf16 v[192:195], v[20:23], v[52:55], v[192:195]
    v_sub_f32 v3, v3, v74
    v_mfma_f32_16x16x32_bf16 v[196:199], v[20:23], v[56:59], v[196:199]
    v_fma_f32 v75, v2, v2, v75
    v_mfma_f32_16x16x32_bf16 v[200:203], v[20:23], v[60:63], v[200:203]
    v_fma_f32 v75, v3, v3, v75
    v_mfma_f32_16x16x32_bf16 v[204:207], v[20:23], v[64:67], v[204:207]
    v_lshlrev_b32 v2, 16, v94
L_cs_16_ret:
    s_waitcnt vmcnt(10) lgkmcnt(0)
    s_barrier
    s_mov_b64 exec, 1
    buffer_atomic_add v86, v87, s[88:91], s65 offen
    s_mov_b64 exec, -1
    buffer_load_dword v85, v87, s[88:91], s66 offen sc0 sc1
    s_cmp_eq_u32 s51, 0
    s_cbranch_scc1 L_cs_17
    v_mfma_f32_16x16x32_bf16 v[208:211], v[24:27], v[52:55], v[208:211]
    ds_read_b128 v[36:39], v80 offset:0
    ds_read_b128 v[40:43], v80 offset:2048
    v_and_b32 v3, s87, v94
    v_mfma_f32_16x16x32_bf16 v[212:215], v[24:27], v[56:59], v[212:215]
    ds_read_b128 v[44:47], v80 offset:4096
    ds_read_b128 v[48:51], v80 offset:6144
    v_sub_f32 v2, v2, v74
    v_mfma_f32_16x16x32_bf16 v[216:219], v[24:27], v[60:63], v[216:219]
    ds_read_b64_tr_b16 v[16:17], v68 offset:0
    ds_read_b64_tr_b16 v[18:19], v68 offset:512
    v_sub_f32 v3, v3, v74
    v_mfma_f32_16x16x32_bf16 v[220:223], v[24:27], v[64:67], v[220:223]
    v_fma_f32 v75, v2, v2, v75
    v_mfma_f32_16x16x32_bf16 v[224:227], v[28:31], v[52:55], v[224:227]
    v_fma_f32 v75, v3, v3, v75
    v_mfma_f32_16x16x32_bf16 v[228:231], v[28:31], v[56:59], v[228:231]
    ds_read_b64_tr_b16 v[20:21], v69 offset:0
    ds_read_b64_tr_b16 v[22:23], v69 offset:512
    v_lshlrev_b32 v2, 16, v95
    v_mfma_f32_16x16x32_bf16 v[232:235], v[28:31], v[60:63], v[232:235]
    v_and_b32 v3, s87, v95
    v_mfma_f32_16x16x32_bf16 v[236:239], v[28:31], v[64:67], v[236:239]
    s_add_u32 m0, s44, 61440
    s_nop 0
    buffer_load_dwordx4 v82, s[12:15], s36 offen offset:0 lds
    s_add_u32 s36, s36, s40
    v_sub_f32 v2, v2, v74
    v_mfma_f32_16x16x32_bf16 v[240:243], v[32:35], v[52:55], v[240:243]
    v_sub_f32 v3, v3, v74
    v_mfma_f32_16x16x32_bf16 v[244:247], v[32:35], v[56:59], v[244:247]
    ds_read_b64_tr_b16 v[24:25], v70 offset:1024
    ds_read_b64_tr_b16 v[26:27], v70 offset:1536
    v_fma_f32 v75, v2, v2, v75
    v_mfma_f32_16x16x32_bf16 v[248:251], v[32:35], v[60:63], v[248:251]
    v_fma_f32 v75, v3, v3, v75
    v_mfma_f32_16x16x32_bf16 v[252:255], v[32:35], v[64:67], v[252:255]
    buffer_load_dwordx4 v83, s[16:19], s37 offen offset:1024 lds
    s_nop 1
    v_add_f32_dpp v75, v75, v75 row_ror:8 row_mask:0xf bank_mask:0xf
L_cs_17_ret:
    s_cmp_eq_u32 s51, 1
    s_cbranch_scc1 L_cs_18
    s_waitcnt lgkmcnt(4)
    v_mfma_f32_16x16x32_bf16 v[96:99], v[16:19], v[36:39], v[96:99]
    ds_read_b128 v[52:55], v81 offset:0
    ds_read_b128 v[56:59], v81 offset:2048
    s_nop 1
    v_add_f32_dpp v75, v75, v75 row_ror:4 row_mask:0xf bank_mask:0xf
    v_mfma_f32_16x16x32_bf16 v[100:103], v[16:19], v[40:43], v[100:103]
    ds_read_b64_tr_b16 v[28:29], v70 offset:2048
    ds_read_b64_tr_b16 v[30:31], v70 offset:2560
    s_nop 1
    v_add_f32_dpp v75, v75, v75 row_ror:2 row_mask:0xf bank_mask:0xf
    v_mfma_f32_16x16x32_bf16 v[104:107], v[16:19], v[44:47], v[104:107]
    ds_read_b128 v[60:63], v81 offset:4096
    ds_read_b128 v[64:67], v81 offset:6144
    s_nop 1
    v_add_f32_dpp v75, v75, v75 row_ror:1 row_mask:0xf bank_mask:0xf
    v_mfma_f32_16x16x32_bf16 v[108:111], v[16:19], v[48:51], v[108:111]
    buffer_load_dwordx4 v83, s[20:23], s37 offen offset:2048 lds
    s_add_u32 s37, s37, s41
    v_mov_b32 v2, v75
    s_waitcnt lgkmcnt(8)
    v_mfma_f32_16x16x32_bf16 v[112:115], v[20:23], v[36:39], v[112:115]
    s_nop 1
    v_permlane16_swap_b32 v75, v2
    v_mfma_f32_16x16x32_bf16 v[116:119], v[20:23], v[40:43], v[116:119]
    ds_read_b64_tr_b16 v[32:33], v71 offset:1024
    ds_read_b64_tr_b16 v[34:35], v71 offset:1536
    s_nop 1
    v_add_f32 v75, v75, v2
    v_mfma_f32_16x16x32_bf16 v[120:123], v[20:23], v[44:47], v[120:123]
    v_mov_b32 v2, v75
    v_mfma_f32_16x16x32_bf16 v[124:127], v[20:23], v[48:51], v[124:127]
    buffer_load_dwordx4 v84, s[24:27], s38 offen offset:3072 lds
    s_nop 1
    v_permlane32_swap_b32 v75, v2
    s_waitcnt lgkmcnt(8)
    v_mfma_f32_16x16x32_bf16 v[128:131], v[24:27], v[36:39], v[128:131]
    s_nop 1
    v_add_f32 v75, v75, v2
    v_mfma_f32_16x16x32_bf16 v[132:135], v[24:27], v[40:43], v[132:135]
    ds_read_b64_tr_b16 v[16:17], v71 offset:2048
    ds_read_b64_tr_b16 v[18:19], v71 offset:2560
    v_mov_b32 v2, 0x3727c5ac
    v_mfma_f32_16x16x32_bf16 v[136:139], v[24:27], v[44:47], v[136:139]
    v_mov_b32 v3, 0x3a800000
    v_mfma_f32_16x16x32_bf16 v[140:143], v[24:27], v[48:51], v[140:143]
    s_add_u32 m0, s44, 65536
    s_nop 0
    buffer_load_dwordx4 v84, s[28:31], s38 offen offset:0 lds
    s_add_u32 s38, s38, s42
    v_fma_f32 v75, v75, v3, v2
L_cs_18_ret:
    s_cmp_eq_u32 s51, 2
    s_cbranch_scc1 L_cs_19
    s_waitcnt lgkmcnt(6)
    v_mfma_f32_16x16x32_bf16 v[144:147], v[28:31], v[36:39], v[144:147]
    s_nop 0
    v_rsq_f32 v75, v75
    v_mfma_f32_16x16x32_bf16 v[148:151], v[28:31], v[40:43], v[148:151]
    ds_read_b64_tr_b16 v[20:21], v72 offset:1024
    ds_read_b64_tr_b16 v[22:23], v72 offset:1536
    s_nop 0
    s_lshl_b32 s52, s51, 2
    s_lshr_b32 s52, 0x5307, s52
    s_and_b32 s52, s52, 15
    s_lshr_b32 s53, s51, 1
    s_sub_u32 s53, 3, s53
    v_lshrrev_b32 v76, 4, v1
    v_mfma_f32_16x16x32_bf16 v[152:155], v[28:31], v[44:47], v[152:155]
    v_cmp_gt_u32 vcc, s53, v76
    v_mfma_f32_16x16x32_bf16 v[156:159], v[28:31], v[48:51], v[156:159]
    v_add_u32 v76, s52, v76
    s_waitcnt lgkmcnt(4)
    v_mfma_f32_16x16x32_bf16 v[160:163], v[32:35], v[36:39], v[160:163]
    v_and_b32 v77, 15, v1
    v_mfma_f32_16x16x32_bf16 v[164:167], v[32:35], v[40:43], v[164:167]
    ds_read_b64_tr_b16 v[24:25], v72 offset:2048
    ds_read_b64_tr_b16 v[26:27], v72 offset:2560
    v_lshlrev_b32 v77, 2, v77
    v_mfma_f32_16x16x32_bf16 v[168:171], v[32:35], v[44:47], v[168:171]
    v_lshl_add_u32 v76, v76, 6, v77
    v_mfma_f32_16x16x32_bf16 v[172:175], v[32:35], v[48:51], v[172:175]
    v_mov_b32 v77, 2147418112
L_cs_19_ret:
    s_cmp_eq_u32 s51, 3
    s_cbranch_scc1 L_cs_20
    s_waitcnt lgkmcnt(4)
    v_mfma_f32_16x16x32_bf16 v[176:179], v[16:19], v[36:39], v[176:179]
    ds_read_b64_tr_b16 v[28:29], v73 offset:1024
    ds_read_b64_tr_b16 v[30:31], v73 offset:1536
    v_cndmask_b32 v76, v77, v76, vcc
    v_mfma_f32_16x16x32_bf16 v[180:183], v[16:19], v[40:43], v[180:183]
    ds_read_b64_tr_b16 v[32:33], v73 offset:2048
    ds_read_b64_tr_b16 v[34:35], v73 offset:2560
    v_cmp_eq_u32 vcc, 0, v1
    v_mfma_f32_16x16x32_bf16 v[184:187], v[16:19], v[44:47], v[184:187]
    s_and_b32 s52, s2, 31
    s_mul_i32 s52, s52, 10240
    s_mul_i32 s53, s48, 1280
    s_add_u32 s52, s52, s53
    s_mul_i32 s53, s50, 640
    s_add_u32 s52, s52, s53
    s_add_u32 s54, s52, 52498432
    v_cndmask_b32 v77, v77, v1, vcc
    v_mfma_f32_16x16x32_bf16 v[188:191], v[16:19], v[48:51], v[188:191]
    s_lshl_b32 s55, s2, 7
    s_lshl_b32 s53, s49, 3
    s_add_u32 s55, s55, s53
    s_add_u32 s55, s55, 52465664
    s_waitcnt lgkmcnt(6)
    v_mfma_f32_16x16x32_bf16 v[192:195], v[20:23], v[36:39], v[192:195]
    v_mfma_f32_16x16x32_bf16 v[196:199], v[20:23], v[40:43], v[196:199]
    v_mfma_f32_16x16x32_bf16 v[200:203], v[20:23], v[44:47], v[200:203]
    v_mfma_f32_16x16x32_bf16 v[204:207], v[20:23], v[48:51], v[204:207]
L_cs_20_ret:
    s_nop 7
    s_nop 7
    v_mov_b32_dpp v4, v8 quad_perm:[0,1,2,3] row_mask:0x2 bank_mask:0xf
    v_mov_b32_dpp v4, v12 quad_perm:[0,1,2,3] row_mask:0x4 bank_mask:0xf
    buffer_store_dwordx2 v[74:75], v77, s[32:35], s55 offen sc0 sc1
    buffer_store_dword v4, v76, s[32:35], s54 offen sc0 sc1
    s_cmp_eq_u32 s45, 5
    s_cselect_b32 s52, s60, 0
    s_sub_u32 s36, s36, s52
    s_cmp_eq_u32 s45, 5
    s_cselect_b32 s52, s61, 0
    s_sub_u32 s37, s37, s52
    s_cmp_eq_u32 s45, 5
    s_cselect_b32 s52, s62, 0
    s_sub_u32 s38, s38, s52
    s_cmp_eq_u32 s45, 5
    s_sub_u32 s45, s45, 1
    s_cmp_eq_u32 s45, s64
    s_cselect_b32 s65, s67, s86
    s_cmp_eq_u32 s45, 2
    s_cselect_b32 s66, s92, s86
    s_cmp_lg_u32 s45, 1
    s_waitcnt vmcnt(14) lgkmcnt(0)
    s_barrier
    s_branch L_g1_loop_W0
L_cs_5:
    v_mfma_f32_16x16x32_bf16 v[208:211], v[24:27], v[36:39], v[208:211]
    v_mfma_f32_16x16x32_bf16 v[212:215], v[24:27], v[40:43], v[212:215]
    v_mfma_f32_16x16x32_bf16 v[216:219], v[24:27], v[44:47], v[216:219]
    ds_read_b64_tr_b16 v[16:17], v68 offset:20480
    ds_read_b64_tr_b16 v[18:19], v68 offset:20992
    v_mfma_f32_16x16x32_bf16 v[220:223], v[24:27], v[48:51], v[220:223]
    v_mfma_f32_16x16x32_bf16 v[4:7], v[88:91], v[24:27], v[4:7]
    v_mfma_f32_16x16x32_bf16 v[224:227], v[28:31], v[36:39], v[224:227]
    v_mfma_f32_16x16x32_bf16 v[228:231], v[28:31], v[40:43], v[228:231]
    ds_read_b64_tr_b16 v[20:21], v69 offset:20480
    ds_read_b64_tr_b16 v[22:23], v69 offset:20992
    v_mfma_f32_16x16x32_bf16 v[232:235], v[28:31], v[44:47], v[232:235]
    v_mfma_f32_16x16x32_bf16 v[236:239], v[28:31], v[48:51], v[236:239]
    s_add_u32 m0, s44, 0
    s_nop 0
    buffer_load_dwordx4 v82, s[12:15], s36 offen offset:0 lds
    s_add_u32 s36, s36, s40
    v_mfma_f32_16x16x32_bf16 v[8:11], v[88:91], v[28:31], v[8:11]
    v_mfma_f32_16x16x32_bf16 v[240:243], v[32:35], v[36:39], v[240:243]
    v_mfma_f32_16x16x32_bf16 v[244:247], v[32:35], v[40:43], v[244:247]
    ds_read_b64_tr_b16 v[24:25], v70 offset:21504
    ds_read_b64_tr_b16 v[26:27], v70 offset:22016
    v_mfma_f32_16x16x32_bf16 v[248:251], v[32:35], v[44:47], v[248:251]
    v_mfma_f32_16x16x32_bf16 v[252:255], v[32:35], v[48:51], v[252:255]
    buffer_load_dwordx4 v83, s[16:19], s37 offen offset:1024 lds
    v_mfma_f32_16x16x32_bf16 v[12:15], v[88:91], v[32:35], v[12:15]
    s_branch L_cs_5_ret
L_cs_6:
    s_waitcnt lgkmcnt(4)
    v_mfma_f32_16x16x32_bf16 v[96:99], v[16:19], v[52:55], v[96:99]
    v_mfma_f32_16x16x32_bf16 v[100:103], v[16:19], v[56:59], v[100:103]
    ds_read_b64_tr_b16 v[28:29], v70 offset:22528
    ds_read_b64_tr_b16 v[30:31], v70 offset:23040
    v_mfma_f32_16x16x32_bf16 v[104:107], v[16:19], v[60:63], v[104:107]
    v_mfma_f32_16x16x32_bf16 v[108:111], v[16:19], v[64:67], v[108:111]
    buffer_load_dwordx4 v83, s[20:23], s37 offen offset:2048 lds
    s_add_u32 s37, s37, s41
    v_mfma_f32_16x16x32_bf16 v[4:7], v[88:91], v[16:19], v[4:7]
    s_waitcnt lgkmcnt(4)
    v_mfma_f32_16x16x32_bf16 v[112:115], v[20:23], v[52:55], v[112:115]
    v_mfma_f32_16x16x32_bf16 v[116:119], v[20:23], v[56:59], v[116:119]
    ds_read_b64_tr_b16 v[32:33], v71 offset:21504
    ds_read_b64_tr_b16 v[34:35], v71 offset:22016
    v_mfma_f32_16x16x32_bf16 v[120:123], v[20:23], v[60:63], v[120:123]
    v_mfma_f32_16x16x32_bf16 v[124:127], v[20:23], v[64:67], v[124:127]
    buffer_load_dwordx4 v84, s[24:27], s38 offen offset:3072 lds
    v_mfma_f32_16x16x32_bf16 v[8:11], v[88:91], v[20:23], v[8:11]
    s_waitcnt lgkmcnt(4)
    v_mfma_f32_16x16x32_bf16 v[128:131], v[24:27], v[52:55], v[128:131]
    v_mfma_f32_16x16x32_bf16 v[132:135], v[24:27], v[56:59], v[132:135]
    ds_read_b64_tr_b16 v[16:17], v71 offset:22528
    ds_read_b64_tr_b16 v[18:19], v71 offset:23040
    v_mfma_f32_16x16x32_bf16 v[136:139], v[24:27], v[60:63], v[136:139]
    v_mfma_f32_16x16x32_bf16 v[140:143], v[24:27], v[64:67], v[140:143]
    s_add_u32 m0, s44, 4096
    s_nop 0
    buffer_load_dwordx4 v84, s[28:31], s38 offen offset:0 lds
    s_add_u32 s38, s38, s42
    v_mfma_f32_16x16x32_bf16 v[12:15], v[88:91], v[24:27], v[12:15]
    s_branch L_cs_6_ret
L_cs_7:
    s_waitcnt lgkmcnt(4)
    v_mfma_f32_16x16x32_bf16 v[144:147], v[28:31], v[52:55], v[144:147]
    v_mfma_f32_16x16x32_bf16 v[148:151], v[28:31], v[56:59], v[148:151]
    ds_read_b64_tr_b16 v[20:21], v72 offset:21504
    ds_read_b64_tr_b16 v[22:23], v72 offset:22016
    v_mfma_f32_16x16x32_bf16 v[152:155], v[28:31], v[60:63], v[152:155]
    v_mfma_f32_16x16x32_bf16 v[156:159], v[28:31], v[64:67], v[156:159]
    v_mfma_f32_16x16x32_bf16 v[4:7], v[88:91], v[28:31], v[4:7]
    s_waitcnt lgkmcnt(4)
    v_mfma_f32_16x16x32_bf16 v[160:163], v[32:35], v[52:55], v[160:163]
    v_mfma_f32_16x16x32_bf16 v[164:167], v[32:35], v[56:59], v[164:167]
    ds_read_b64_tr_b16 v[24:25], v72 offset:22528
    ds_read_b64_tr_b16 v[26:27], v72 offset:23040
    v_mfma_f32_16x16x32_bf16 v[168:171], v[32:35], v[60:63], v[168:171]
    v_mfma_f32_16x16x32_bf16 v[172:175], v[32:35], v[64:67], v[172:175]
    v_mfma_f32_16x16x32_bf16 v[8:11], v[88:91], v[32:35], v[8:11]
    s_branch L_cs_7_ret
L_cs_8:
    s_waitcnt lgkmcnt(4)
    v_mfma_f32_16x16x32_bf16 v[176:179], v[16:19], v[52:55], v[176:179]
    ds_read_b64_tr_b16 v[28:29], v73 offset:21504
    ds_read_b64_tr_b16 v[30:31], v73 offset:22016
    v_mfma_f32_16x16x32_bf16 v[180:183], v[16:19], v[56:59], v[180:183]
    ds_read_b64_tr_b16 v[32:33], v73 offset:22528
    ds_read_b64_tr_b16 v[34:35], v73 offset:23040
    v_mfma_f32_16x16x32_bf16 v[184:187], v[16:19], v[60:63], v[184:187]
    v_mfma_f32_16x16x32_bf16 v[188:191], v[16:19], v[64:67], v[188:191]
    v_mfma_f32_16x16x32_bf16 v[4:7], v[88:91], v[16:19], v[4:7]
    s_waitcnt lgkmcnt(6)
    v_mfma_f32_16x16x32_bf16 v[192:195], v[20:23], v[52:55], v[192:195]
    v_mfma_f32_16x16x32_bf16 v[196:199], v[20:23], v[56:59], v[196:199]
    v_mfma_f32_16x16x32_bf16 v[200:203], v[20:23], v[60:63], v[200:203]
    v_mfma_f32_16x16x32_bf16 v[204:207], v[20:23], v[64:67], v[204:207]
    v_mfma_f32_16x16x32_bf16 v[8:11], v[88:91], v[20:23], v[8:11]
    s_branch L_cs_8_ret
L_cs_9:
    v_mfma_f32_16x16x32_bf16 v[208:211], v[24:27], v[52:55], v[208:211]
    ds_read_b128 v[36:39], v80 offset:32768
    ds_read_b128 v[40:43], v80 offset:34816
    v_lshlrev_b32 v74, 16, v76
    v_mfma_f32_16x16x32_bf16 v[212:215], v[24:27], v[56:59], v[212:215]
    ds_read_b128 v[44:47], v80 offset:36864
    ds_read_b128 v[48:51], v80 offset:38912
    v_and_b32 v75, s87, v76
    v_mfma_f32_16x16x32_bf16 v[216:219], v[24:27], v[60:63], v[216:219]
    ds_read_b64_tr_b16 v[16:17], v68 offset:40960
    ds_read_b64_tr_b16 v[18:19], v68 offset:41472
    v_lshlrev_b32 v2, 16, v77
    v_mfma_f32_16x16x32_bf16 v[220:223], v[24:27], v[64:67], v[220:223]
    v_mfma_f32_16x16x32_bf16 v[4:7], v[88:91], v[24:27], v[4:7]
    v_and_b32 v3, s87, v77
    v_mfma_f32_16x16x32_bf16 v[224:227], v[28:31], v[52:55], v[224:227]
    v_add_f32 v74, v74, v2
    v_mfma_f32_16x16x32_bf16 v[228:231], v[28:31], v[56:59], v[228:231]
    ds_read_b64_tr_b16 v[20:21], v69 offset:40960
    ds_read_b64_tr_b16 v[22:23], v69 offset:41472
    v_add_f32 v75, v75, v3
    v_mfma_f32_16x16x32_bf16 v[232:235], v[28:31], v[60:63], v[232:235]
    v_lshlrev_b32 v2, 16, v78
    v_mfma_f32_16x16x32_bf16 v[236:239], v[28:31], v[64:67], v[236:239]
    s_add_u32 m0, s44, 20480
    s_nop 0
    buffer_load_dwordx4 v82, s[12:15], s36 offen offset:0 lds
    s_add_u32 s36, s36, s40
    v_mfma_f32_16x16x32_bf16 v[8:11], v[88:91], v[28:31], v[8:11]
    v_and_b32 v3, s87, v78
    v_mfma_f32_16x16x32_bf16 v[240:243], v[32:35], v[52:55], v[240:243]
    v_add_f32 v74, v74, v2
    v_mfma_f32_16x16x32_bf16 v[244:247], v[32:35], v[56:59], v[244:247]
    ds_read_b64_tr_b16 v[24:25], v70 offset:41984
    ds_read_b64_tr_b16 v[26:27], v70 offset:42496
    v_add_f32 v75, v75, v3
    v_mfma_f32_16x16x32_bf16 v[248:251], v[32:35], v[60:63], v[248:251]
    v_lshlrev_b32 v2, 16, v79
    v_mfma_f32_16x16x32_bf16 v[252:255], v[32:35], v[64:67], v[252:255]
    buffer_load_dwordx4 v83, s[16:19], s37 offen offset:1024 lds
    v_mfma_f32_16x16x32_bf16 v[12:15], v[88:91], v[32:35], v[12:15]
    v_and_b32 v3, s87, v79
    s_branch L_cs_9_ret
L_cs_10:
    s_waitcnt lgkmcnt(4)
    v_mfma_f32_16x16x32_bf16 v[96:99], v[16:19], v[36:39], v[96:99]
    ds_read_b128 v[52:55], v81 offset:32768
    ds_read_b128 v[56:59], v81 offset:34816
    v_add_f32 v74, v74, v2
    v_mfma_f32_16x16x32_bf16 v[100:103], v[16:19], v[40:43], v[100:103]
    ds_read_b64_tr_b16 v[28:29], v70 offset:43008
    ds_read_b64_tr_b16 v[30:31], v70 offset:43520
    v_add_f32 v75, v75, v3
    v_mfma_f32_16x16x32_bf16 v[104:107], v[16:19], v[44:47], v[104:107]
    ds_read_b128 v[60:63], v81 offset:36864
    ds_read_b128 v[64:67], v81 offset:38912
    v_lshlrev_b32 v2, 16, v92
    v_mfma_f32_16x16x32_bf16 v[108:111], v[16:19], v[48:51], v[108:111]
    buffer_load_dwordx4 v83, s[20:23], s37 offen offset:2048 lds
    s_add_u32 s37, s37, s41
    v_mfma_f32_16x16x32_bf16 v[4:7], v[88:91], v[16:19], v[4:7]
    v_and_b32 v3, s87, v92
    s_waitcnt lgkmcnt(8)
    v_mfma_f32_16x16x32_bf16 v[112:115], v[20:23], v[36:39], v[112:115]
    v_add_f32 v74, v74, v2
    v_mfma_f32_16x16x32_bf16 v[116:119], v[20:23], v[40:43], v[116:119]
    ds_read_b64_tr_b16 v[32:33], v71 offset:41984
    ds_read_b64_tr_b16 v[34:35], v71 offset:42496
    v_add_f32 v75, v75, v3
    v_mfma_f32_16x16x32_bf16 v[120:123], v[20:23], v[44:47], v[120:123]
    v_lshlrev_b32 v2, 16, v93
    v_mfma_f32_16x16x32_bf16 v[124:127], v[20:23], v[48:51], v[124:127]
    buffer_load_dwordx4 v84, s[24:27], s38 offen offset:3072 lds
    v_mfma_f32_16x16x32_bf16 v[8:11], v[88:91], v[20:23], v[8:11]
    v_and_b32 v3, s87, v93
    s_waitcnt lgkmcnt(8)
    v_mfma_f32_16x16x32_bf16 v[128:131], v[24:27], v[36:39], v[128:131]
    v_add_f32 v74, v74, v2
    v_mfma_f32_16x16x32_bf16 v[132:135], v[24:27], v[40:43], v[132:135]
    ds_read_b64_tr_b16 v[16:17], v71 offset:43008
    ds_read_b64_tr_b16 v[18:19], v71 offset:43520
    v_add_f32 v75, v75, v3
    v_mfma_f32_16x16x32_bf16 v[136:139], v[24:27], v[44:47], v[136:139]
    v_lshlrev_b32 v2, 16, v94
    v_mfma_f32_16x16x32_bf16 v[140:143], v[24:27], v[48:51], v[140:143]
    s_add_u32 m0, s44, 24576
    s_nop 0
    buffer_load_dwordx4 v84, s[28:31], s38 offen offset:0 lds
    s_add_u32 s38, s38, s42
    v_mfma_f32_16x16x32_bf16 v[12:15], v[88:91], v[24:27], v[12:15]
    v_and_b32 v3, s87, v94
    s_branch L_cs_10_ret
L_cs_11:
    s_waitcnt lgkmcnt(6)
    v_mfma_f32_16x16x32_bf16 v[144:147], v[28:31], v[36:39], v[144:147]
    v_add_f32 v74, v74, v2
    v_mfma_f32_16x16x32_bf16 v[148:151], v[28:31], v[40:43], v[148:151]
    ds_read_b64_tr_b16 v[20:21], v72 offset:41984
    ds_read_b64_tr_b16 v[22:23], v72 offset:42496
    v_add_f32 v75, v75, v3
    v_mfma_f32_16x16x32_bf16 v[152:155], v[28:31], v[44:47], v[152:155]
    v_lshlrev_b32 v2, 16, v95
    v_mfma_f32_16x16x32_bf16 v[156:159], v[28:31], v[48:51], v[156:159]
    v_mfma_f32_16x16x32_bf16 v[4:7], v[88:91], v[28:31], v[4:7]
    v_and_b32 v3, s87, v95
    s_waitcnt lgkmcnt(4)
    v_mfma_f32_16x16x32_bf16 v[160:163], v[32:35], v[36:39], v[160:163]
    v_add_f32 v74, v74, v2
    v_mfma_f32_16x16x32_bf16 v[164:167], v[32:35], v[40:43], v[164:167]
    ds_read_b64_tr_b16 v[24:25], v72 offset:43008
    ds_read_b64_tr_b16 v[26:27], v72 offset:43520
    v_add_f32 v75, v75, v3
    v_mfma_f32_16x16x32_bf16 v[168:171], v[32:35], v[44:47], v[168:171]
    v_add_f32 v74, v74, v75
    v_mfma_f32_16x16x32_bf16 v[172:175], v[32:35], v[48:51], v[172:175]
    v_mfma_f32_16x16x32_bf16 v[8:11], v[88:91], v[32:35], v[8:11]
    s_nop 1
    v_add_f32_dpp v74, v74, v74 row_ror:8 row_mask:0xf bank_mask:0xf
    s_branch L_cs_11_ret
L_cs_12:
    s_waitcnt lgkmcnt(4)
    v_mfma_f32_16x16x32_bf16 v[176:179], v[16:19], v[36:39], v[176:179]
    ds_read_b64_tr_b16 v[28:29], v73 offset:41984
    ds_read_b64_tr_b16 v[30:31], v73 offset:42496
    s_nop 1
    v_add_f32_dpp v74, v74, v74 row_ror:4 row_mask:0xf bank_mask:0xf
    v_mfma_f32_16x16x32_bf16 v[180:183], v[16:19], v[40:43], v[180:183]
    ds_read_b64_tr_b16 v[32:33], v73 offset:43008
    ds_read_b64_tr_b16 v[34:35], v73 offset:43520
    s_nop 1
    v_add_f32_dpp v74, v74, v74 row_ror:2 row_mask:0xf bank_mask:0xf
    v_mfma_f32_16x16x32_bf16 v[184:187], v[16:19], v[44:47], v[184:187]
    s_nop 1
    v_add_f32_dpp v74, v74, v74 row_ror:1 row_mask:0xf bank_mask:0xf
    v_mfma_f32_16x16x32_bf16 v[188:191], v[16:19], v[48:51], v[188:191]
    v_mfma_f32_16x16x32_bf16 v[4:7], v[88:91], v[16:19], v[4:7]
    v_mov_b32 v2, v74
    s_waitcnt lgkmcnt(6)
    v_mfma_f32_16x16x32_bf16 v[192:195], v[20:23], v[36:39], v[192:195]
    s_nop 1
    v_permlane16_swap_b32 v74, v2
    v_mfma_f32_16x16x32_bf16 v[196:199], v[20:23], v[40:43], v[196:199]
    s_nop 1
    v_add_f32 v74, v74, v2
    v_mfma_f32_16x16x32_bf16 v[200:203], v[20:23], v[44:47], v[200:203]
    v_mov_b32 v2, v74
    v_mfma_f32_16x16x32_bf16 v[204:207], v[20:23], v[48:51], v[204:207]
    v_mfma_f32_16x16x32_bf16 v[8:11], v[88:91], v[20:23], v[8:11]
    s_nop 1
    v_permlane32_swap_b32 v74, v2
    s_branch L_cs_12_ret
L_cs_13:
    v_mfma_f32_16x16x32_bf16 v[208:211], v[24:27], v[36:39], v[208:211]
    s_nop 1
    v_add_f32 v74, v74, v2
    v_mfma_f32_16x16x32_bf16 v[212:215], v[24:27], v[40:43], v[212:215]
    v_mul_f32 v74, 0x3a800000, v74
    v_mfma_f32_16x16x32_bf16 v[216:219], v[24:27], v[44:47], v[216:219]
    ds_read_b64_tr_b16 v[16:17], v68 offset:61440
    ds_read_b64_tr_b16 v[18:19], v68 offset:61952
    v_mov_b32 v75, 0
    v_mfma_f32_16x16x32_bf16 v[220:223], v[24:27], v[48:51], v[220:223]
    v_mfma_f32_16x16x32_bf16 v[4:7], v[88:91], v[24:27], v[4:7]
    v_lshlrev_b32 v2, 16, v76
    v_mfma_f32_16x16x32_bf16 v[224:227], v[28:31], v[36:39], v[224:227]
    v_and_b32 v3, s87, v76
    v_mfma_f32_16x16x32_bf16 v[228:231], v[28:31], v[40:43], v[228:231]
    ds_read_b64_tr_b16 v[20:21], v69 offset:61440
    ds_read_b64_tr_b16 v[22:23], v69 offset:61952
    v_sub_f32 v2, v2, v74
    v_mfma_f32_16x16x32_bf16 v[232:235], v[28:31], v[44:47], v[232:235]
    v_sub_f32 v3, v3, v74
    v_mfma_f32_16x16x32_bf16 v[236:239], v[28:31], v[48:51], v[236:239]
    s_add_u32 m0, s44, 40960
    s_nop 0
    buffer_load_dwordx4 v82, s[12:15], s36 offen offset:0 lds
    s_add_u32 s36, s36, s40
    v_mfma_f32_16x16x32_bf16 v[8:11], v[88:91], v[28:31], v[8:11]
    v_fma_f32 v75, v2, v2, v75
    v_mfma_f32_16x16x32_bf16 v[240:243], v[32:35], v[36:39], v[240:243]
    v_fma_f32 v75, v3, v3, v75
    v_mfma_f32_16x16x32_bf16 v[244:247], v[32:35], v[40:43], v[244:247]
    ds_read_b64_tr_b16 v[24:25], v70 offset:62464
    ds_read_b64_tr_b16 v[26:27], v70 offset:62976
    v_lshlrev_b32 v2, 16, v77
    v_mfma_f32_16x16x32_bf16 v[248:251], v[32:35], v[44:47], v[248:251]
    v_and_b32 v3, s87, v77
    v_mfma_f32_16x16x32_bf16 v[252:255], v[32:35], v[48:51], v[252:255]
    buffer_load_dwordx4 v83, s[16:19], s37 offen offset:1024 lds
    v_mfma_f32_16x16x32_bf16 v[12:15], v[88:91], v[32:35], v[12:15]
    v_sub_f32 v2, v2, v74
    s_branch L_cs_13_ret
L_cs_14:
    s_waitcnt lgkmcnt(4)
    v_mfma_f32_16x16x32_bf16 v[96:99], v[16:19], v[52:55], v[96:99]
    v_sub_f32 v3, v3, v74
    v_mfma_f32_16x16x32_bf16 v[100:103], v[16:19], v[56:59], v[100:103]
    ds_read_b64_tr_b16 v[28:29], v70 offset:63488
    ds_read_b64_tr_b16 v[30:31], v70 offset:64000
    v_fma_f32 v75, v2, v2, v75
    v_mfma_f32_16x16x32_bf16 v[104:107], v[16:19], v[60:63], v[104:107]
    v_fma_f32 v75, v3, v3, v75
    v_mfma_f32_16x16x32_bf16 v[108:111], v[16:19], v[64:67], v[108:111]
    buffer_load_dwordx4 v83, s[20:23], s37 offen offset:2048 lds
    s_add_u32 s37, s37, s41
    v_mfma_f32_16x16x32_bf16 v[4:7], v[88:91], v[16:19], v[4:7]
    v_lshlrev_b32 v2, 16, v78
    s_waitcnt lgkmcnt(4)
    v_mfma_f32_16x16x32_bf16 v[112:115], v[20:23], v[52:55], v[112:115]
    v_and_b32 v3, s87, v78
    v_mfma_f32_16x16x32_bf16 v[116:119], v[20:23], v[56:59], v[116:119]
    ds_read_b64_tr_b16 v[32:33], v71 offset:62464
    ds_read_b64_tr_b16 v[34:35], v71 offset:62976
    v_sub_f32 v2, v2, v74
    v_mfma_f32_16x16x32_bf16 v[120:123], v[20:23], v[60:63], v[120:123]
    v_sub_f32 v3, v3, v74
    v_mfma_f32_16x16x32_bf16 v[124:127], v[20:23], v[64:67], v[124:127]
    buffer_load_dwordx4 v84, s[24:27], s38 offen offset:3072 lds
    v_mfma_f32_16x16x32_bf16 v[8:11], v[88:91], v[20:23], v[8:11]
    v_fma_f32 v75, v2, v2, v75
    s_waitcnt lgkmcnt(4)
    v_mfma_f32_16x16x32_bf16 v[128:131], v[24:27], v[52:55], v[128:131]
    v_fma_f32 v75, v3, v3, v75
    v_mfma_f32_16x16x32_bf16 v[132:135], v[24:27], v[56:59], v[132:135]
    ds_read_b64_tr_b16 v[16:17], v71 offset:63488
    ds_read_b64_tr_b16 v[18:19], v71 offset:64000
    v_lshlrev_b32 v2, 16, v79
    v_mfma_f32_16x16x32_bf16 v[136:139], v[24:27], v[60:63], v[136:139]
    v_and_b32 v3, s87, v79
    v_mfma_f32_16x16x32_bf16 v[140:143], v[24:27], v[64:67], v[140:143]
    s_add_u32 m0, s44, 45056
    s_nop 0
    buffer_load_dwordx4 v84, s[28:31], s38 offen offset:0 lds
    s_add_u32 s38, s38, s42
    v_mfma_f32_16x16x32_bf16 v[12:15], v[88:91], v[24:27], v[12:15]
    v_sub_f32 v2, v2, v74
    s_branch L_cs_14_ret
L_cs_15:
    s_waitcnt lgkmcnt(4)
    v_mfma_f32_16x16x32_bf16 v[144:147], v[28:31], v[52:55], v[144:147]
    v_sub_f32 v3, v3, v74
    v_mfma_f32_16x16x32_bf16 v[148:151], v[28:31], v[56:59], v[148:151]
    ds_read_b64_tr_b16 v[20:21], v72 offset:62464
    ds_read_b64_tr_b16 v[22:23], v72 offset:62976
    v_fma_f32 v75, v2, v2, v75
    v_mfma_f32_16x16x32_bf16 v[152:155], v[28:31], v[60:63], v[152:155]
    v_fma_f32 v75, v3, v3, v75
    v_mfma_f32_16x16x32_bf16 v[156:159], v[28:31], v[64:67], v[156:159]
    v_mfma_f32_16x16x32_bf16 v[4:7], v[88:91], v[28:31], v[4:7]
    v_lshlrev_b32 v2, 16, v92
    s_waitcnt lgkmcnt(4)
    v_mfma_f32_16x16x32_bf16 v[160:163], v[32:35], v[52:55], v[160:163]
    v_and_b32 v3, s87, v92
    v_mfma_f32_16x16x32_bf16 v[164:167], v[32:35], v[56:59], v[164:167]
    ds_read_b64_tr_b16 v[24:25], v72 offset:63488
    ds_read_b64_tr_b16 v[26:27], v72 offset:64000
    v_sub_f32 v2, v2, v74
    v_mfma_f32_16x16x32_bf16 v[168:171], v[32:35], v[60:63], v[168:171]
    v_sub_f32 v3, v3, v74
    v_mfma_f32_16x16x32_bf16 v[172:175], v[32:35], v[64:67], v[172:175]
    v_mfma_f32_16x16x32_bf16 v[8:11], v[88:91], v[32:35], v[8:11]
    v_fma_f32 v75, v2, v2, v75
    s_branch L_cs_15_ret
L_cs_16:
    s_waitcnt lgkmcnt(4)
    v_mfma_f32_16x16x32_bf16 v[176:179], v[16:19], v[52:55], v[176:179]
    ds_read_b64_tr_b16 v[28:29], v73 offset:62464
    ds_read_b64_tr_b16 v[30:31], v73 offset:62976
    v_fma_f32 v75, v3, v3, v75
    v_mfma_f32_16x16x32_bf16 v[180:183], v[16:19], v[56:59], v[180:183]
    ds_read_b64_tr_b16 v[32:33], v73 offset:63488
    ds_read_b64_tr_b16 v[34:35], v73 offset:64000
    v_lshlrev_b32 v2, 16, v93
    v_mfma_f32_16x16x32_bf16 v[184:187], v[16:19], v[60:63], v[184:187]
    v_and_b32 v3, s87, v93
    v_mfma_f32_16x16x32_bf16 v[188:191], v[16:19], v[64:67], v[188:191]
    v_mfma_f32_16x16x32_bf16 v[4:7], v[88:91], v[16:19], v[4:7]
    v_sub_f32 v2, v2, v74
    s_waitcnt lgkmcnt(6)
    v_mfma_f32_16x16x32_bf16 v[192:195], v[20:23], v[52:55], v[192:195]
    v_sub_f32 v3, v3, v74
    v_mfma_f32_16x16x32_bf16 v[196:199], v[20:23], v[56:59], v[196:199]
    v_fma_f32 v75, v2, v2, v75
    v_mfma_f32_16x16x32_bf16 v[200:203], v[20:23], v[60:63], v[200:203]
    v_fma_f32 v75, v3, v3, v75
    v_mfma_f32_16x16x32_bf16 v[204:207], v[20:23], v[64:67], v[204:207]
    v_mfma_f32_16x16x32_bf16 v[8:11], v[88:91], v[20:23], v[8:11]
    v_lshlrev_b32 v2, 16, v94
    s_branch L_cs_16_ret
L_cs_17:
    v_mfma_f32_16x16x32_bf16 v[208:211], v[24:27], v[52:55], v[208:211]
    ds_read_b128 v[36:39], v80 offset:0
    ds_read_b128 v[40:43], v80 offset:2048
    v_and_b32 v3, s87, v94
    v_mfma_f32_16x16x32_bf16 v[212:215], v[24:27], v[56:59], v[212:215]
    ds_read_b128 v[44:47], v80 offset:4096
    ds_read_b128 v[48:51], v80 offset:6144
    v_sub_f32 v2, v2, v74
    v_mfma_f32_16x16x32_bf16 v[216:219], v[24:27], v[60:63], v[216:219]
    ds_read_b64_tr_b16 v[16:17], v68 offset:0
    ds_read_b64_tr_b16 v[18:19], v68 offset:512
    v_sub_f32 v3, v3, v74
    v_mfma_f32_16x16x32_bf16 v[220:223], v[24:27], v[64:67], v[220:223]
    v_mfma_f32_16x16x32_bf16 v[4:7], v[88:91], v[24:27], v[4:7]
    v_fma_f32 v75, v2, v2, v75
    v_mfma_f32_16x16x32_bf16 v[224:227], v[28:31], v[52:55], v[224:227]
    v_fma_f32 v75, v3, v3, v75
    v_mfma_f32_16x16x32_bf16 v[228:231], v[28:31], v[56:59], v[228:231]
    ds_read_b64_tr_b16 v[20:21], v69 offset:0
    ds_read_b64_tr_b16 v[22:23], v69 offset:512
    v_lshlrev_b32 v2, 16, v95
    v_mfma_f32_16x16x32_bf16 v[232:235], v[28:31], v[60:63], v[232:235]
    v_and_b32 v3, s87, v95
    v_mfma_f32_16x16x32_bf16 v[236:239], v[28:31], v[64:67], v[236:239]
    s_add_u32 m0, s44, 61440
    s_nop 0
    buffer_load_dwordx4 v82, s[12:15], s36 offen offset:0 lds
    s_add_u32 s36, s36, s40
    v_mfma_f32_16x16x32_bf16 v[8:11], v[88:91], v[28:31], v[8:11]
    v_sub_f32 v2, v2, v74
    v_mfma_f32_16x16x32_bf16 v[240:243], v[32:35], v[52:55], v[240:243]
    v_sub_f32 v3, v3, v74
    v_mfma_f32_16x16x32_bf16 v[244:247], v[32:35], v[56:59], v[244:247]
    ds_read_b64_tr_b16 v[24:25], v70 offset:1024
    ds_read_b64_tr_b16 v[26:27], v70 offset:1536
    v_fma_f32 v75, v2, v2, v75
    v_mfma_f32_16x16x32_bf16 v[248:251], v[32:35], v[60:63], v[248:251]
    v_fma_f32 v75, v3, v3, v75
    v_mfma_f32_16x16x32_bf16 v[252:255], v[32:35], v[64:67], v[252:255]
    buffer_load_dwordx4 v83, s[16:19], s37 offen offset:1024 lds
    v_mfma_f32_16x16x32_bf16 v[12:15], v[88:91], v[32:35], v[12:15]
    s_nop 1
    v_add_f32_dpp v75, v75, v75 row_ror:8 row_mask:0xf bank_mask:0xf
    s_branch L_cs_17_ret
L_cs_18:
    s_waitcnt lgkmcnt(4)
    v_mfma_f32_16x16x32_bf16 v[96:99], v[16:19], v[36:39], v[96:99]
    ds_read_b128 v[52:55], v81 offset:0
    ds_read_b128 v[56:59], v81 offset:2048
    s_nop 1
    v_add_f32_dpp v75, v75, v75 row_ror:4 row_mask:0xf bank_mask:0xf
    v_mfma_f32_16x16x32_bf16 v[100:103], v[16:19], v[40:43], v[100:103]
    ds_read_b64_tr_b16 v[28:29], v70 offset:2048
    ds_read_b64_tr_b16 v[30:31], v70 offset:2560
    s_nop 1
    v_add_f32_dpp v75, v75, v75 row_ror:2 row_mask:0xf bank_mask:0xf
    v_mfma_f32_16x16x32_bf16 v[104:107], v[16:19], v[44:47], v[104:107]
    ds_read_b128 v[60:63], v81 offset:4096
    ds_read_b128 v[64:67], v81 offset:6144
    s_nop 1
    v_add_f32_dpp v75, v75, v75 row_ror:1 row_mask:0xf bank_mask:0xf
    v_mfma_f32_16x16x32_bf16 v[108:111], v[16:19], v[48:51], v[108:111]
    buffer_load_dwordx4 v83, s[20:23], s37 offen offset:2048 lds
    s_add_u32 s37, s37, s41
    v_mfma_f32_16x16x32_bf16 v[4:7], v[88:91], v[16:19], v[4:7]
    v_mov_b32 v2, v75
    s_waitcnt lgkmcnt(8)
    v_mfma_f32_16x16x32_bf16 v[112:115], v[20:23], v[36:39], v[112:115]
    s_nop 1
    v_permlane16_swap_b32 v75, v2
    v_mfma_f32_16x16x32_bf16 v[116:119], v[20:23], v[40:43], v[116:119]
    ds_read_b64_tr_b16 v[32:33], v71 offset:1024
    ds_read_b64_tr_b16 v[34:35], v71 offset:1536
    s_nop 1
    v_add_f32 v75, v75, v2
    v_mfma_f32_16x16x32_bf16 v[120:123], v[20:23], v[44:47], v[120:123]
    v_mov_b32 v2, v75
    v_mfma_f32_16x16x32_bf16 v[124:127], v[20:23], v[48:51], v[124:127]
    buffer_load_dwordx4 v84, s[24:27], s38 offen offset:3072 lds
    v_mfma_f32_16x16x32_bf16 v[8:11], v[88:91], v[20:23], v[8:11]
    s_nop 1
    v_permlane32_swap_b32 v75, v2
    s_waitcnt lgkmcnt(8)
    v_mfma_f32_16x16x32_bf16 v[128:131], v[24:27], v[36:39], v[128:131]
    s_nop 1
    v_add_f32 v75, v75, v2
    v_mfma_f32_16x16x32_bf16 v[132:135], v[24:27], v[40:43], v[132:135]
    ds_read_b64_tr_b16 v[16:17], v71 offset:2048
    ds_read_b64_tr_b16 v[18:19], v71 offset:2560
    v_mov_b32 v2, 0x3727c5ac
    v_mfma_f32_16x16x32_bf16 v[136:139], v[24:27], v[44:47], v[136:139]
    v_mov_b32 v3, 0x3a800000
    v_mfma_f32_16x16x32_bf16 v[140:143], v[24:27], v[48:51], v[140:143]
    s_add_u32 m0, s44, 65536
    s_nop 0
    buffer_load_dwordx4 v84, s[28:31], s38 offen offset:0 lds
    s_add_u32 s38, s38, s42
    v_mfma_f32_16x16x32_bf16 v[12:15], v[88:91], v[24:27], v[12:15]
    v_fma_f32 v75, v75, v3, v2
    s_branch L_cs_18_ret
L_cs_19:
    s_waitcnt lgkmcnt(6)
    v_mfma_f32_16x16x32_bf16 v[144:147], v[28:31], v[36:39], v[144:147]
    s_nop 0
    v_rsq_f32 v75, v75
    v_mfma_f32_16x16x32_bf16 v[148:151], v[28:31], v[40:43], v[148:151]
    ds_read_b64_tr_b16 v[20:21], v72 offset:1024
    ds_read_b64_tr_b16 v[22:23], v72 offset:1536
    s_nop 0
    s_lshl_b32 s52, s51, 2
    s_lshr_b32 s52, 0x5307, s52
    s_and_b32 s52, s52, 15
    s_lshr_b32 s53, s51, 1
    s_sub_u32 s53, 3, s53
    v_lshrrev_b32 v76, 4, v1
    v_mfma_f32_16x16x32_bf16 v[152:155], v[28:31], v[44:47], v[152:155]
    v_cmp_gt_u32 vcc, s53, v76
    v_mfma_f32_16x16x32_bf16 v[156:159], v[28:31], v[48:51], v[156:159]
    v_mfma_f32_16x16x32_bf16 v[4:7], v[88:91], v[28:31], v[4:7]
    v_add_u32 v76, s52, v76
    s_waitcnt lgkmcnt(4)
    v_mfma_f32_16x16x32_bf16 v[160:163], v[32:35], v[36:39], v[160:163]
    v_and_b32 v77, 15, v1
    v_mfma_f32_16x16x32_bf16 v[164:167], v[32:35], v[40:43], v[164:167]
    ds_read_b64_tr_b16 v[24:25], v72 offset:2048
    ds_read_b64_tr_b16 v[26:27], v72 offset:2560
    v_lshlrev_b32 v77, 2, v77
    v_mfma_f32_16x16x32_bf16 v[168:171], v[32:35], v[44:47], v[168:171]
    v_lshl_add_u32 v76, v76, 6, v77
    v_mfma_f32_16x16x32_bf16 v[172:175], v[32:35], v[48:51], v[172:175]
    v_mfma_f32_16x16x32_bf16 v[8:11], v[88:91], v[32:35], v[8:11]
    v_mov_b32 v77, 2147418112
    s_branch L_cs_19_ret
L_cs_20:
    s_waitcnt lgkmcnt(4)
    v_mfma_f32_16x16x32_bf16 v[176:179], v[16:19], v[36:39], v[176:179]
    ds_read_b64_tr_b16 v[28:29], v73 offset:1024
    ds_read_b64_tr_b16 v[30:31], v73 offset:1536
    v_cndmask_b32 v76, v77, v76, vcc
    v_mfma_f32_16x16x32_bf16 v[180:183], v[16:19], v[40:43], v[180:183]
    ds_read_b64_tr_b16 v[32:33], v73 offset:2048
    ds_read_b64_tr_b16 v[34:35], v73 offset:2560
    v_cmp_eq_u32 vcc, 0, v1
    v_mfma_f32_16x16x32_bf16 v[184:187], v[16:19], v[44:47], v[184:187]
    s_and_b32 s52, s2, 31
    s_mul_i32 s52, s52, 10240
    s_mul_i32 s53, s48, 1280
    s_add_u32 s52, s52, s53
    s_mul_i32 s53, s50, 640
    s_add_u32 s52, s52, s53
    s_add_u32 s54, s52, 52498432
    v_cndmask_b32 v77, v77, v1, vcc
    v_mfma_f32_16x16x32_bf16 v[188:191], v[16:19], v[48:51], v[188:191]
    v_mfma_f32_16x16x32_bf16 v[4:7], v[88:91], v[16:19], v[4:7]
    s_lshl_b32 s55, s2, 7
    s_lshl_b32 s53, s49, 3
    s_add_u32 s55, s55, s53
    s_add_u32 s55, s55, 52465664
    s_waitcnt lgkmcnt(6)
    v_mfma_f32_16x16x32_bf16 v[192:195], v[20:23], v[36:39], v[192:195]
    v_mfma_f32_16x16x32_bf16 v[196:199], v[20:23], v[40:43], v[196:199]
    v_mfma_f32_16x16x32_bf16 v[200:203], v[20:23], v[44:47], v[200:203]
    v_mfma_f32_16x16x32_bf16 v[204:207], v[20:23], v[48:51], v[204:207]
    v_mfma_f32_16x16x32_bf16 v[8:11], v[88:91], v[20:23], v[8:11]
    s_branch L_cs_20_ret
L_g1_roleWV:
    s_mov_b32 s32, s6
    s_mov_b32 s33, s7
    s_mov_b32 s34, 52826112
    s_mov_b32 s35, 0x20000
    s_and_b32 s52, s48, 1
    s_mul_i32 s60, s40, s52
    s_lshl_b32 s60, s60, 5
    s_lshr_b32 s53, s60, 1
    s_add_u32 s36, s36, s53
    s_mul_i32 s61, s41, s52
    s_lshl_b32 s61, s61, 5
    s_lshr_b32 s53, s61, 1
    s_add_u32 s37, s37, s53
    s_mul_i32 s62, s42, s52
    s_lshl_b32 s62, s62, 5
    s_lshr_b32 s53, s62, 1
    s_add_u32 s38, s38, s53
    s_add_u32 m0, s44, 0
    s_nop 0
    buffer_load_dwordx4 v82, s[12:15], s36 offen offset:0 lds
    s_add_u32 s36, s36, s40
    buffer_load_dwordx4 v83, s[16:19], s37 offen offset:1024 lds
    buffer_load_dwordx4 v83, s[20:23], s37 offen offset:2048 lds
    s_add_u32 s37, s37, s41
    buffer_load_dwordx4 v84, s[24:27], s38 offen offset:3072 lds
    s_add_u32 m0, s44, 4096
    s_nop 0
    buffer_load_dwordx4 v84, s[28:31], s38 offen offset:0 lds
    s_add_u32 s38, s38, s42
    s_barrier
    s_add_u32 m0, s44, 20480
    s_nop 0
    buffer_load_dwordx4 v82, s[12:15], s36 offen offset:0 lds
    s_add_u32 s36, s36, s40
    buffer_load_dwordx4 v83, s[16:19], s37 offen offset:1024 lds
    buffer_load_dwordx4 v83, s[20:23], s37 offen offset:2048 lds
    s_add_u32 s37, s37, s41
    buffer_load_dwordx4 v84, s[24:27], s38 offen offset:3072 lds
    s_add_u32 m0, s44, 24576
    s_nop 0
    buffer_load_dwordx4 v84, s[28:31], s38 offen offset:0 lds
    s_add_u32 s38, s38, s42
    s_add_u32 m0, s44, 40960
    s_nop 0
    buffer_load_dwordx4 v82, s[12:15], s36 offen offset:0 lds
    s_add_u32 s36, s36, s40
    buffer_load_dwordx4 v83, s[16:19], s37 offen offset:1024 lds
    buffer_load_dwordx4 v83, s[20:23], s37 offen offset:2048 lds
    s_add_u32 s37, s37, s41
    buffer_load_dwordx4 v84, s[24:27], s38 offen offset:3072 lds
    s_add_u32 m0, s44, 45056
    s_nop 0
    buffer_load_dwordx4 v84, s[28:31], s38 offen offset:0 lds
    s_add_u32 s38, s38, s42
    s_mov_b32 s52, s100
    s_mov_b32 s53, s101
    s_mov_b32 s54, 4194304
    s_mov_b32 s55, 0x20000
    s_lshl_b32 s59, s2, 3
    s_add_u32 s59, s59, s49
    s_lshl_b32 s59, s59, 11
    buffer_load_dwordx4 v[76:79], v86, s[52:55], s59 offen
    buffer_load_dwordx4 v[92:95], v86, s[52:55], s59 offen offset:1024
    v_lshrrev_b32 v3, 4, v1
    v_bfe_u32 v4, v1, 2, 2
    v_and_b32 v5, 3, v1
    v_mul_u32_u24 v6, 5120, v3
    v_lshl_add_u32 v6, v4, 7, v6
    v_lshl_add_u32 v6, v5, 3, v6
    v_lshrrev_b32 v7, 1, v4
    v_lshlrev_b32 v7, 5, v7
    v_and_b32 v8, 1, v3
    v_lshl_or_b32 v7, v8, 6, v7
    s_lshl_b32 s52, s50, 6
    v_xor_b32 v8, s52, v7
    v_add_u32 v68, v6, v8
    v_xor_b32 v8, 32, v8
    v_add_u32 v69, v6, v8
    s_cmp_eq_u32 s47, 0
    s_cbranch_scc1 L_g1_taB_21
    s_lshl_b32 s52, s50, 11
    v_add_u32 v9, s52, v6
    v_xor_b32 v8, 0, v7
    v_add_u32 v70, v9, v8
    v_xor_b32 v8, 32, v7
    v_add_u32 v71, v9, v8
    v_xor_b32 v8, 64, v7
    v_add_u32 v72, v9, v8
    v_xor_b32 v8, 96, v7
    v_add_u32 v73, v9, v8
    s_branch L_g1_ta_done_22
L_g1_taB_21:
    v_mov_b32 v70, v68
    v_mov_b32 v71, v69
    v_add_u32 v72, 2048, v68
    v_add_u32 v73, 2048, v69
L_g1_ta_done_22:
    s_and_b32 s52, s49, 3
    s_lshl_b32 s53, s52, 13
    s_add_u32 s53, s53, 81920
    v_and_b32 v4, 15, v1
    v_lshrrev_b32 v5, 1, v4
    v_xor_b32 v5, v5, v3
    v_lshlrev_b32 v5, 4, v5
    v_lshl_add_u32 v5, v4, 7, v5
    v_add_u32 v80, s53, v5
    v_xor_b32 v81, 64, v80
    s_mov_b32 s51, s52
    s_lshr_b32 s52, s48, 1
    s_sub_u32 s63, 7, s52
    s_sub_u32 s64, 6, s52
    s_mov_b32 s86, 2147418112
    s_mov_b32 s87, 0xffff0000
    s_mov_b32 s65, 2147418112
    s_mov_b32 s66, 2147418112
    s_lshl_b32 s52, s48, 5
    s_cmp_eq_u32 s49, 0
    s_cselect_b32 s67, s52, s86
    s_cselect_b32 s92, 0, s86
    s_mov_b32 s88, s98
    s_mov_b32 s89, s99
    s_mov_b32 s90, 256
    s_mov_b32 s91, 0x20000
    v_and_b32 v87, 7, v1
    v_lshlrev_b32 v87, 5, v87
    v_mov_b32 v208, 0
    v_mov_b32 v209, 0
    v_mov_b32 v210, 0
    v_mov_b32 v211, 0
    v_mov_b32 v212, 0
    v_mov_b32 v213, 0
    v_mov_b32 v214, 0
    v_mov_b32 v215, 0
    v_mov_b32 v216, 0
    v_mov_b32 v217, 0
    v_mov_b32 v218, 0
    v_mov_b32 v219, 0
    v_mov_b32 v220, 0
    v_mov_b32 v221, 0
    v_mov_b32 v222, 0
    v_mov_b32 v223, 0
    v_mov_b32 v224, 0
    v_mov_b32 v225, 0
    v_mov_b32 v226, 0
    v_mov_b32 v227, 0
    v_mov_b32 v228, 0
    v_mov_b32 v229, 0
    v_mov_b32 v230, 0
    v_mov_b32 v231, 0
    v_mov_b32 v232, 0
    v_mov_b32 v233, 0
    v_mov_b32 v234, 0
    v_mov_b32 v235, 0
    v_mov_b32 v236, 0
    v_mov_b32 v237, 0
    v_mov_b32 v238, 0
    v_mov_b32 v239, 0
    v_mov_b32 v240, 0
    v_mov_b32 v241, 0
    v_mov_b32 v242, 0
    v_mov_b32 v243, 0
    v_mov_b32 v244, 0
    v_mov_b32 v245, 0
    v_mov_b32 v246, 0
    v_mov_b32 v247, 0
    v_mov_b32 v248, 0
    v_mov_b32 v249, 0
    v_mov_b32 v250, 0
    v_mov_b32 v251, 0
    v_mov_b32 v252, 0
    v_mov_b32 v253, 0
    v_mov_b32 v254, 0
    v_mov_b32 v255, 0
    v_mov_b32 v86, 1
    v_mov_b32 v4, 0
    v_mov_b32 v5, 0
    v_mov_b32 v6, 0
    v_mov_b32 v7, 0
    v_mov_b32 v8, 0
    v_mov_b32 v9, 0
    v_mov_b32 v10, 0
    v_mov_b32 v11, 0
    v_mov_b32 v12, 0
    v_mov_b32 v13, 0
    v_mov_b32 v14, 0
    v_mov_b32 v15, 0
    v_mov_b32 v88, 0x3f803f80
    v_mov_b32 v89, 0x3f803f80
    v_mov_b32 v90, 0x3f803f80
    v_mov_b32 v91, 0x3f803f80
    s_waitcnt vmcnt(12)
    s_barrier
    buffer_store_dword v1, v1, s[32:35], s86 offen
    buffer_store_dword v1, v1, s[32:35], s86 offen
    ds_read_b128 v[36:39], v80 offset:0
    ds_read_b128 v[40:43], v80 offset:2048
    ds_read_b128 v[44:47], v80 offset:4096
    ds_read_b128 v[48:51], v80 offset:6144
    ds_read_b64_tr_b16 v[16:17], v68 offset:0
    ds_read_b64_tr_b16 v[18:19], v68 offset:512
    ds_read_b64_tr_b16 v[20:21], v69 offset:0
    ds_read_b64_tr_b16 v[22:23], v69 offset:512
    ds_read_b64_tr_b16 v[24:25], v70 offset:1024
    ds_read_b64_tr_b16 v[26:27], v70 offset:1536
    s_waitcnt lgkmcnt(4)
    v_mfma_f32_16x16x32_bf16 v[96:99], v[36:39], v[16:19], 0
    ds_read_b128 v[52:55], v81 offset:0
    ds_read_b128 v[56:59], v81 offset:2048
    v_mfma_f32_16x16x32_bf16 v[100:103], v[40:43], v[16:19], 0
    ds_read_b64_tr_b16 v[28:29], v70 offset:2048
    ds_read_b64_tr_b16 v[30:31], v70 offset:2560
    v_mfma_f32_16x16x32_bf16 v[104:107], v[44:47], v[16:19], 0
    ds_read_b128 v[60:63], v81 offset:4096
    ds_read_b128 v[64:67], v81 offset:6144
    v_mfma_f32_16x16x32_bf16 v[108:111], v[48:51], v[16:19], 0
    s_add_u32 m0, s44, 61440
    s_nop 0
    buffer_load_dwordx4 v82, s[12:15], s36 offen offset:0 lds
    s_add_u32 s36, s36, s40
    s_waitcnt lgkmcnt(8)
    v_mfma_f32_16x16x32_bf16 v[112:115], v[36:39], v[20:23], 0
    v_mfma_f32_16x16x32_bf16 v[116:119], v[40:43], v[20:23], 0
    ds_read_b64_tr_b16 v[32:33], v71 offset:1024
    ds_read_b64_tr_b16 v[34:35], v71 offset:1536
    v_mfma_f32_16x16x32_bf16 v[120:123], v[44:47], v[20:23], 0
    v_mfma_f32_16x16x32_bf16 v[124:127], v[48:51], v[20:23], 0
    buffer_load_dwordx4 v83, s[16:19], s37 offen offset:1024 lds
    s_waitcnt lgkmcnt(8)
    v_mfma_f32_16x16x32_bf16 v[128:131], v[24:27], v[36:39], 0
    v_mfma_f32_16x16x32_bf16 v[132:135], v[24:27], v[40:43], 0
    ds_read_b64_tr_b16 v[16:17], v71 offset:2048
    ds_read_b64_tr_b16 v[18:19], v71 offset:2560
    v_mfma_f32_16x16x32_bf16 v[136:139], v[24:27], v[44:47], 0
    v_mfma_f32_16x16x32_bf16 v[140:143], v[24:27], v[48:51], 0
    buffer_load_dwordx4 v83, s[20:23], s37 offen offset:2048 lds
    s_add_u32 s37, s37, s41
    s_waitcnt lgkmcnt(6)
    v_mfma_f32_16x16x32_bf16 v[144:147], v[28:31], v[36:39], 0
    v_mfma_f32_16x16x32_bf16 v[148:151], v[28:31], v[40:43], 0
    ds_read_b64_tr_b16 v[20:21], v72 offset:1024
    ds_read_b64_tr_b16 v[22:23], v72 offset:1536
    v_mfma_f32_16x16x32_bf16 v[152:155], v[28:31], v[44:47], 0
    v_mfma_f32_16x16x32_bf16 v[156:159], v[28:31], v[48:51], 0
    buffer_load_dwordx4 v84, s[24:27], s38 offen offset:3072 lds
    s_waitcnt lgkmcnt(4)
    v_mfma_f32_16x16x32_bf16 v[160:163], v[32:35], v[36:39], 0
    v_mfma_f32_16x16x32_bf16 v[164:167], v[32:35], v[40:43], 0
    ds_read_b64_tr_b16 v[24:25], v72 offset:2048
    ds_read_b64_tr_b16 v[26:27], v72 offset:2560
    v_mfma_f32_16x16x32_bf16 v[168:171], v[32:35], v[44:47], 0
    v_mfma_f32_16x16x32_bf16 v[172:175], v[32:35], v[48:51], 0
    s_add_u32 m0, s44, 65536
    s_nop 0
    buffer_load_dwordx4 v84, s[28:31], s38 offen offset:0 lds
    s_add_u32 s38, s38, s42
    s_waitcnt lgkmcnt(4)
    v_mfma_f32_16x16x32_bf16 v[176:179], v[16:19], v[36:39], 0
    ds_read_b64_tr_b16 v[28:29], v73 offset:1024
    ds_read_b64_tr_b16 v[30:31], v73 offset:1536
    v_mfma_f32_16x16x32_bf16 v[180:183], v[16:19], v[40:43], 0
    ds_read_b64_tr_b16 v[32:33], v73 offset:2048
    ds_read_b64_tr_b16 v[34:35], v73 offset:2560
    v_mfma_f32_16x16x32_bf16 v[184:187], v[16:19], v[44:47], 0
    v_mfma_f32_16x16x32_bf16 v[188:191], v[16:19], v[48:51], 0
    s_waitcnt lgkmcnt(6)
    v_mfma_f32_16x16x32_bf16 v[192:195], v[20:23], v[36:39], 0
    v_mfma_f32_16x16x32_bf16 v[196:199], v[20:23], v[40:43], 0
    v_mfma_f32_16x16x32_bf16 v[200:203], v[20:23], v[44:47], 0
    v_mfma_f32_16x16x32_bf16 v[204:207], v[20:23], v[48:51], 0
    buffer_store_dword v1, v1, s[32:35], s86 offen
    buffer_store_dword v1, v1, s[32:35], s86 offen
    s_waitcnt vmcnt(16) lgkmcnt(0)
    s_barrier
    s_mov_b32 s45, 7
    .p2align 6
L_g1_loop_W1:
    s_cmp_eq_u32 s45, s63
    s_cbranch_scc1 L_g1_spec_W1
    v_mfma_f32_16x16x32_bf16 v[208:211], v[24:27], v[36:39], v[208:211]
    v_mfma_f32_16x16x32_bf16 v[212:215], v[24:27], v[40:43], v[212:215]
    v_mfma_f32_16x16x32_bf16 v[216:219], v[24:27], v[44:47], v[216:219]
    ds_read_b64_tr_b16 v[16:17], v68 offset:20480
    ds_read_b64_tr_b16 v[18:19], v68 offset:20992
    v_mfma_f32_16x16x32_bf16 v[220:223], v[24:27], v[48:51], v[220:223]
    v_mfma_f32_16x16x32_bf16 v[224:227], v[28:31], v[36:39], v[224:227]
    v_mfma_f32_16x16x32_bf16 v[228:231], v[28:31], v[40:43], v[228:231]
    ds_read_b64_tr_b16 v[20:21], v69 offset:20480
    ds_read_b64_tr_b16 v[22:23], v69 offset:20992
    v_mfma_f32_16x16x32_bf16 v[232:235], v[28:31], v[44:47], v[232:235]
    v_mfma_f32_16x16x32_bf16 v[236:239], v[28:31], v[48:51], v[236:239]
    s_add_u32 m0, s44, 0
    s_nop 0
    buffer_load_dwordx4 v82, s[12:15], s36 offen offset:0 lds
    s_add_u32 s36, s36, s40
    v_mfma_f32_16x16x32_bf16 v[240:243], v[32:35], v[36:39], v[240:243]
    v_mfma_f32_16x16x32_bf16 v[244:247], v[32:35], v[40:43], v[244:247]
    ds_read_b64_tr_b16 v[24:25], v70 offset:21504
    ds_read_b64_tr_b16 v[26:27], v70 offset:22016
    v_mfma_f32_16x16x32_bf16 v[248:251], v[32:35], v[44:47], v[248:251]
    v_mfma_f32_16x16x32_bf16 v[252:255], v[32:35], v[48:51], v[252:255]
    buffer_load_dwordx4 v83, s[16:19], s37 offen offset:1024 lds
    s_waitcnt lgkmcnt(4)
    v_mfma_f32_16x16x32_bf16 v[96:99], v[52:55], v[16:19], v[96:99]
    v_mfma_f32_16x16x32_bf16 v[100:103], v[56:59], v[16:19], v[100:103]
    ds_read_b64_tr_b16 v[28:29], v70 offset:22528
    ds_read_b64_tr_b16 v[30:31], v70 offset:23040
    v_mfma_f32_16x16x32_bf16 v[104:107], v[60:63], v[16:19], v[104:107]
    v_mfma_f32_16x16x32_bf16 v[108:111], v[64:67], v[16:19], v[108:111]
    buffer_load_dwordx4 v83, s[20:23], s37 offen offset:2048 lds
    s_add_u32 s37, s37, s41
    s_waitcnt lgkmcnt(4)
    v_mfma_f32_16x16x32_bf16 v[112:115], v[52:55], v[20:23], v[112:115]
    v_mfma_f32_16x16x32_bf16 v[116:119], v[56:59], v[20:23], v[116:119]
    ds_read_b64_tr_b16 v[32:33], v71 offset:21504
    ds_read_b64_tr_b16 v[34:35], v71 offset:22016
    v_mfma_f32_16x16x32_bf16 v[120:123], v[60:63], v[20:23], v[120:123]
    v_mfma_f32_16x16x32_bf16 v[124:127], v[64:67], v[20:23], v[124:127]
    buffer_load_dwordx4 v84, s[24:27], s38 offen offset:3072 lds
    s_waitcnt lgkmcnt(4)
    v_mfma_f32_16x16x32_bf16 v[128:131], v[24:27], v[52:55], v[128:131]
    v_mfma_f32_16x16x32_bf16 v[132:135], v[24:27], v[56:59], v[132:135]
    ds_read_b64_tr_b16 v[16:17], v71 offset:22528
    ds_read_b64_tr_b16 v[18:19], v71 offset:23040
    v_mfma_f32_16x16x32_bf16 v[136:139], v[24:27], v[60:63], v[136:139]
    v_mfma_f32_16x16x32_bf16 v[140:143], v[24:27], v[64:67], v[140:143]
    s_add_u32 m0, s44, 4096
    s_nop 0
    buffer_load_dwordx4 v84, s[28:31], s38 offen offset:0 lds
    s_add_u32 s38, s38, s42
    s_waitcnt lgkmcnt(4)
    v_mfma_f32_16x16x32_bf16 v[144:147], v[28:31], v[52:55], v[144:147]
    v_mfma_f32_16x16x32_bf16 v[148:151], v[28:31], v[56:59], v[148:151]
    ds_read_b64_tr_b16 v[20:21], v72 offset:21504
    ds_read_b64_tr_b16 v[22:23], v72 offset:22016
    v_mfma_f32_16x16x32_bf16 v[152:155], v[28:31], v[60:63], v[152:155]
    v_mfma_f32_16x16x32_bf16 v[156:159], v[28:31], v[64:67], v[156:159]
    s_waitcnt lgkmcnt(4)
    v_mfma_f32_16x16x32_bf16 v[160:163], v[32:35], v[52:55], v[160:163]
    v_mfma_f32_16x16x32_bf16 v[164:167], v[32:35], v[56:59], v[164:167]
    ds_read_b64_tr_b16 v[24:25], v72 offset:22528
    ds_read_b64_tr_b16 v[26:27], v72 offset:23040
    v_mfma_f32_16x16x32_bf16 v[168:171], v[32:35], v[60:63], v[168:171]
    v_mfma_f32_16x16x32_bf16 v[172:175], v[32:35], v[64:67], v[172:175]
    s_waitcnt lgkmcnt(4)
    v_mfma_f32_16x16x32_bf16 v[176:179], v[16:19], v[52:55], v[176:179]
    ds_read_b64_tr_b16 v[28:29], v73 offset:21504
    ds_read_b64_tr_b16 v[30:31], v73 offset:22016
    v_mfma_f32_16x16x32_bf16 v[180:183], v[16:19], v[56:59], v[180:183]
    ds_read_b64_tr_b16 v[32:33], v73 offset:22528
    ds_read_b64_tr_b16 v[34:35], v73 offset:23040
    v_mfma_f32_16x16x32_bf16 v[184:187], v[16:19], v[60:63], v[184:187]
    v_mfma_f32_16x16x32_bf16 v[188:191], v[16:19], v[64:67], v[188:191]
    s_waitcnt lgkmcnt(6)
    v_mfma_f32_16x16x32_bf16 v[192:195], v[20:23], v[52:55], v[192:195]
    v_mfma_f32_16x16x32_bf16 v[196:199], v[20:23], v[56:59], v[196:199]
    v_mfma_f32_16x16x32_bf16 v[200:203], v[20:23], v[60:63], v[200:203]
    v_mfma_f32_16x16x32_bf16 v[204:207], v[20:23], v[64:67], v[204:207]
    s_waitcnt vmcnt(14) lgkmcnt(0)
    s_barrier
    v_mfma_f32_16x16x32_bf16 v[208:211], v[24:27], v[52:55], v[208:211]
    ds_read_b128 v[36:39], v80 offset:32768
    ds_read_b128 v[40:43], v80 offset:34816
    v_mfma_f32_16x16x32_bf16 v[212:215], v[24:27], v[56:59], v[212:215]
    ds_read_b128 v[44:47], v80 offset:36864
    ds_read_b128 v[48:51], v80 offset:38912
    v_mfma_f32_16x16x32_bf16 v[216:219], v[24:27], v[60:63], v[216:219]
    ds_read_b64_tr_b16 v[16:17], v68 offset:40960
    ds_read_b64_tr_b16 v[18:19], v68 offset:41472
    v_mfma_f32_16x16x32_bf16 v[220:223], v[24:27], v[64:67], v[220:223]
    v_mfma_f32_16x16x32_bf16 v[224:227], v[28:31], v[52:55], v[224:227]
    v_mfma_f32_16x16x32_bf16 v[228:231], v[28:31], v[56:59], v[228:231]
    ds_read_b64_tr_b16 v[20:21], v69 offset:40960
    ds_read_b64_tr_b16 v[22:23], v69 offset:41472
    v_mfma_f32_16x16x32_bf16 v[232:235], v[28:31], v[60:63], v[232:235]
    v_mfma_f32_16x16x32_bf16 v[236:239], v[28:31], v[64:67], v[236:239]
    s_add_u32 m0, s44, 20480
    s_nop 0
    buffer_load_dwordx4 v82, s[12:15], s36 offen offset:0 lds
    s_add_u32 s36, s36, s40
    v_mfma_f32_16x16x32_bf16 v[240:243], v[32:35], v[52:55], v[240:243]
    v_mfma_f32_16x16x32_bf16 v[244:247], v[32:35], v[56:59], v[244:247]
    ds_read_b64_tr_b16 v[24:25], v70 offset:41984
    ds_read_b64_tr_b16 v[26:27], v70 offset:42496
    v_mfma_f32_16x16x32_bf16 v[248:251], v[32:35], v[60:63], v[248:251]
    v_mfma_f32_16x16x32_bf16 v[252:255], v[32:35], v[64:67], v[252:255]
    buffer_load_dwordx4 v83, s[16:19], s37 offen offset:1024 lds
    s_waitcnt lgkmcnt(4)
    v_mfma_f32_16x16x32_bf16 v[96:99], v[36:39], v[16:19], v[96:99]
    ds_read_b128 v[52:55], v81 offset:32768
    ds_read_b128 v[56:59], v81 offset:34816
    v_mfma_f32_16x16x32_bf16 v[100:103], v[40:43], v[16:19], v[100:103]
    ds_read_b64_tr_b16 v[28:29], v70 offset:43008
    ds_read_b64_tr_b16 v[30:31], v70 offset:43520
    v_mfma_f32_16x16x32_bf16 v[104:107], v[44:47], v[16:19], v[104:107]
    ds_read_b128 v[60:63], v81 offset:36864
    ds_read_b128 v[64:67], v81 offset:38912
    v_mfma_f32_16x16x32_bf16 v[108:111], v[48:51], v[16:19], v[108:111]
    buffer_load_dwordx4 v83, s[20:23], s37 offen offset:2048 lds
    s_add_u32 s37, s37, s41
    s_waitcnt lgkmcnt(8)
    v_mfma_f32_16x16x32_bf16 v[112:115], v[36:39], v[20:23], v[112:115]
    v_mfma_f32_16x16x32_bf16 v[116:119], v[40:43], v[20:23], v[116:119]
    ds_read_b64_tr_b16 v[32:33], v71 offset:41984
    ds_read_b64_tr_b16 v[34:35], v71 offset:42496
    v_mfma_f32_16x16x32_bf16 v[120:123], v[44:47], v[20:23], v[120:123]
    v_mfma_f32_16x16x32_bf16 v[124:127], v[48:51], v[20:23], v[124:127]
    buffer_load_dwordx4 v84, s[24:27], s38 offen offset:3072 lds
    s_waitcnt lgkmcnt(8)
    v_mfma_f32_16x16x32_bf16 v[128:131], v[24:27], v[36:39], v[128:131]
    v_mfma_f32_16x16x32_bf16 v[132:135], v[24:27], v[40:43], v[132:135]
    ds_read_b64_tr_b16 v[16:17], v71 offset:43008
    ds_read_b64_tr_b16 v[18:19], v71 offset:43520
    v_mfma_f32_16x16x32_bf16 v[136:139], v[24:27], v[44:47], v[136:139]
    v_mfma_f32_16x16x32_bf16 v[140:143], v[24:27], v[48:51], v[140:143]
    s_add_u32 m0, s44, 24576
    s_nop 0
    buffer_load_dwordx4 v84, s[28:31], s38 offen offset:0 lds
    s_add_u32 s38, s38, s42
    s_waitcnt lgkmcnt(6)
    v_mfma_f32_16x16x32_bf16 v[144:147], v[28:31], v[36:39], v[144:147]
    v_mfma_f32_16x16x32_bf16 v[148:151], v[28:31], v[40:43], v[148:151]
    ds_read_b64_tr_b16 v[20:21], v72 offset:41984
    ds_read_b64_tr_b16 v[22:23], v72 offset:42496
    v_mfma_f32_16x16x32_bf16 v[152:155], v[28:31], v[44:47], v[152:155]
    v_mfma_f32_16x16x32_bf16 v[156:159], v[28:31], v[48:51], v[156:159]
    s_waitcnt lgkmcnt(4)
    v_mfma_f32_16x16x32_bf16 v[160:163], v[32:35], v[36:39], v[160:163]
    v_mfma_f32_16x16x32_bf16 v[164:167], v[32:35], v[40:43], v[164:167]
    ds_read_b64_tr_b16 v[24:25], v72 offset:43008
    ds_read_b64_tr_b16 v[26:27], v72 offset:43520
    v_mfma_f32_16x16x32_bf16 v[168:171], v[32:35], v[44:47], v[168:171]
    v_mfma_f32_16x16x32_bf16 v[172:175], v[32:35], v[48:51], v[172:175]
    s_waitcnt lgkmcnt(4)
    v_mfma_f32_16x16x32_bf16 v[176:179], v[16:19], v[36:39], v[176:179]
    ds_read_b64_tr_b16 v[28:29], v73 offset:41984
    ds_read_b64_tr_b16 v[30:31], v73 offset:42496
    v_mfma_f32_16x16x32_bf16 v[180:183], v[16:19], v[40:43], v[180:183]
    ds_read_b64_tr_b16 v[32:33], v73 offset:43008
    ds_read_b64_tr_b16 v[34:35], v73 offset:43520
    v_mfma_f32_16x16x32_bf16 v[184:187], v[16:19], v[44:47], v[184:187]
    v_mfma_f32_16x16x32_bf16 v[188:191], v[16:19], v[48:51], v[188:191]
    s_waitcnt lgkmcnt(6)
    v_mfma_f32_16x16x32_bf16 v[192:195], v[20:23], v[36:39], v[192:195]
    v_mfma_f32_16x16x32_bf16 v[196:199], v[20:23], v[40:43], v[196:199]
    v_mfma_f32_16x16x32_bf16 v[200:203], v[20:23], v[44:47], v[200:203]
    v_mfma_f32_16x16x32_bf16 v[204:207], v[20:23], v[48:51], v[204:207]
    s_waitcnt vmcnt(12) lgkmcnt(0)
    s_barrier
    v_mfma_f32_16x16x32_bf16 v[208:211], v[24:27], v[36:39], v[208:211]
    v_mfma_f32_16x16x32_bf16 v[212:215], v[24:27], v[40:43], v[212:215]
    v_mfma_f32_16x16x32_bf16 v[216:219], v[24:27], v[44:47], v[216:219]
    ds_read_b64_tr_b16 v[16:17], v68 offset:61440
    ds_read_b64_tr_b16 v[18:19], v68 offset:61952
    v_mfma_f32_16x16x32_bf16 v[220:223], v[24:27], v[48:51], v[220:223]
    v_mfma_f32_16x16x32_bf16 v[224:227], v[28:31], v[36:39], v[224:227]
    v_mfma_f32_16x16x32_bf16 v[228:231], v[28:31], v[40:43], v[228:231]
    ds_read_b64_tr_b16 v[20:21], v69 offset:61440
    ds_read_b64_tr_b16 v[22:23], v69 offset:61952
    v_mfma_f32_16x16x32_bf16 v[232:235], v[28:31], v[44:47], v[232:235]
    v_mfma_f32_16x16x32_bf16 v[236:239], v[28:31], v[48:51], v[236:239]
    s_add_u32 m0, s44, 40960
    s_nop 0
    buffer_load_dwordx4 v82, s[12:15], s36 offen offset:0 lds
    s_add_u32 s36, s36, s40
    v_mfma_f32_16x16x32_bf16 v[240:243], v[32:35], v[36:39], v[240:243]
    v_mfma_f32_16x16x32_bf16 v[244:247], v[32:35], v[40:43], v[244:247]
    ds_read_b64_tr_b16 v[24:25], v70 offset:62464
    ds_read_b64_tr_b16 v[26:27], v70 offset:62976
    v_mfma_f32_16x16x32_bf16 v[248:251], v[32:35], v[44:47], v[248:251]
    v_mfma_f32_16x16x32_bf16 v[252:255], v[32:35], v[48:51], v[252:255]
    buffer_load_dwordx4 v83, s[16:19], s37 offen offset:1024 lds
    s_waitcnt lgkmcnt(4)
    v_mfma_f32_16x16x32_bf16 v[96:99], v[52:55], v[16:19], v[96:99]
    v_mfma_f32_16x16x32_bf16 v[100:103], v[56:59], v[16:19], v[100:103]
    ds_read_b64_tr_b16 v[28:29], v70 offset:63488
    ds_read_b64_tr_b16 v[30:31], v70 offset:64000
    v_mfma_f32_16x16x32_bf16 v[104:107], v[60:63], v[16:19], v[104:107]
    v_mfma_f32_16x16x32_bf16 v[108:111], v[64:67], v[16:19], v[108:111]
    buffer_load_dwordx4 v83, s[20:23], s37 offen offset:2048 lds
    s_add_u32 s37, s37, s41
    s_waitcnt lgkmcnt(4)
    v_mfma_f32_16x16x32_bf16 v[112:115], v[52:55], v[20:23], v[112:115]
    v_mfma_f32_16x16x32_bf16 v[116:119], v[56:59], v[20:23], v[116:119]
    ds_read_b64_tr_b16 v[32:33], v71 offset:62464
    ds_read_b64_tr_b16 v[34:35], v71 offset:62976
    v_mfma_f32_16x16x32_bf16 v[120:123], v[60:63], v[20:23], v[120:123]
    v_mfma_f32_16x16x32_bf16 v[124:127], v[64:67], v[20:23], v[124:127]
    buffer_load_dwordx4 v84, s[24:27], s38 offen offset:3072 lds
    s_waitcnt lgkmcnt(4)
    v_mfma_f32_16x16x32_bf16 v[128:131], v[24:27], v[52:55], v[128:131]
    v_mfma_f32_16x16x32_bf16 v[132:135], v[24:27], v[56:59], v[132:135]
    ds_read_b64_tr_b16 v[16:17], v71 offset:63488
    ds_read_b64_tr_b16 v[18:19], v71 offset:64000
    v_mfma_f32_16x16x32_bf16 v[136:139], v[24:27], v[60:63], v[136:139]
    v_mfma_f32_16x16x32_bf16 v[140:143], v[24:27], v[64:67], v[140:143]
    s_add_u32 m0, s44, 45056
    s_nop 0
    buffer_load_dwordx4 v84, s[28:31], s38 offen offset:0 lds
    s_add_u32 s38, s38, s42
    s_waitcnt lgkmcnt(4)
    v_mfma_f32_16x16x32_bf16 v[144:147], v[28:31], v[52:55], v[144:147]
    v_mfma_f32_16x16x32_bf16 v[148:151], v[28:31], v[56:59], v[148:151]
    ds_read_b64_tr_b16 v[20:21], v72 offset:62464
    ds_read_b64_tr_b16 v[22:23], v72 offset:62976
    v_mfma_f32_16x16x32_bf16 v[152:155], v[28:31], v[60:63], v[152:155]
    v_mfma_f32_16x16x32_bf16 v[156:159], v[28:31], v[64:67], v[156:159]
    s_waitcnt lgkmcnt(4)
    v_mfma_f32_16x16x32_bf16 v[160:163], v[32:35], v[52:55], v[160:163]
    v_mfma_f32_16x16x32_bf16 v[164:167], v[32:35], v[56:59], v[164:167]
    ds_read_b64_tr_b16 v[24:25], v72 offset:63488
    ds_read_b64_tr_b16 v[26:27], v72 offset:64000
    v_mfma_f32_16x16x32_bf16 v[168:171], v[32:35], v[60:63], v[168:171]
    v_mfma_f32_16x16x32_bf16 v[172:175], v[32:35], v[64:67], v[172:175]
    s_waitcnt lgkmcnt(4)
    v_mfma_f32_16x16x32_bf16 v[176:179], v[16:19], v[52:55], v[176:179]
    ds_read_b64_tr_b16 v[28:29], v73 offset:62464
    ds_read_b64_tr_b16 v[30:31], v73 offset:62976
    v_mfma_f32_16x16x32_bf16 v[180:183], v[16:19], v[56:59], v[180:183]
    ds_read_b64_tr_b16 v[32:33], v73 offset:63488
    ds_read_b64_tr_b16 v[34:35], v73 offset:64000
    v_mfma_f32_16x16x32_bf16 v[184:187], v[16:19], v[60:63], v[184:187]
    v_mfma_f32_16x16x32_bf16 v[188:191], v[16:19], v[64:67], v[188:191]
    s_waitcnt lgkmcnt(6)
    v_mfma_f32_16x16x32_bf16 v[192:195], v[20:23], v[52:55], v[192:195]
    v_mfma_f32_16x16x32_bf16 v[196:199], v[20:23], v[56:59], v[196:199]
    v_mfma_f32_16x16x32_bf16 v[200:203], v[20:23], v[60:63], v[200:203]
    v_mfma_f32_16x16x32_bf16 v[204:207], v[20:23], v[64:67], v[204:207]
    s_waitcnt vmcnt(10) lgkmcnt(0)
    s_barrier
    s_mov_b64 exec, 1
    buffer_atomic_add v86, v87, s[88:91], s65 offen
    s_mov_b64 exec, -1
    buffer_load_dword v85, v87, s[88:91], s66 offen sc0 sc1
    v_mfma_f32_16x16x32_bf16 v[208:211], v[24:27], v[52:55], v[208:211]
    ds_read_b128 v[36:39], v80 offset:0
    ds_read_b128 v[40:43], v80 offset:2048
    v_mfma_f32_16x16x32_bf16 v[212:215], v[24:27], v[56:59], v[212:215]
    ds_read_b128 v[44:47], v80 offset:4096
    ds_read_b128 v[48:51], v80 offset:6144
    v_mfma_f32_16x16x32_bf16 v[216:219], v[24:27], v[60:63], v[216:219]
    ds_read_b64_tr_b16 v[16:17], v68 offset:0
    ds_read_b64_tr_b16 v[18:19], v68 offset:512
    v_mfma_f32_16x16x32_bf16 v[220:223], v[24:27], v[64:67], v[220:223]
    v_mfma_f32_16x16x32_bf16 v[224:227], v[28:31], v[52:55], v[224:227]
    v_mfma_f32_16x16x32_bf16 v[228:231], v[28:31], v[56:59], v[228:231]
    ds_read_b64_tr_b16 v[20:21], v69 offset:0
    ds_read_b64_tr_b16 v[22:23], v69 offset:512
    v_mfma_f32_16x16x32_bf16 v[232:235], v[28:31], v[60:63], v[232:235]
    v_mfma_f32_16x16x32_bf16 v[236:239], v[28:31], v[64:67], v[236:239]
    s_add_u32 m0, s44, 61440
    s_nop 0
    buffer_load_dwordx4 v82, s[12:15], s36 offen offset:0 lds
    s_add_u32 s36, s36, s40
    v_mfma_f32_16x16x32_bf16 v[240:243], v[32:35], v[52:55], v[240:243]
    v_mfma_f32_16x16x32_bf16 v[244:247], v[32:35], v[56:59], v[244:247]
    ds_read_b64_tr_b16 v[24:25], v70 offset:1024
    ds_read_b64_tr_b16 v[26:27], v70 offset:1536
    v_mfma_f32_16x16x32_bf16 v[248:251], v[32:35], v[60:63], v[248:251]
    v_mfma_f32_16x16x32_bf16 v[252:255], v[32:35], v[64:67], v[252:255]
    buffer_load_dwordx4 v83, s[16:19], s37 offen offset:1024 lds
    s_waitcnt lgkmcnt(4)
    v_mfma_f32_16x16x32_bf16 v[96:99], v[36:39], v[16:19], v[96:99]
    ds_read_b128 v[52:55], v81 offset:0
    ds_read_b128 v[56:59], v81 offset:2048
    v_mfma_f32_16x16x32_bf16 v[100:103], v[40:43], v[16:19], v[100:103]
    ds_read_b64_tr_b16 v[28:29], v70 offset:2048
    ds_read_b64_tr_b16 v[30:31], v70 offset:2560
    v_mfma_f32_16x16x32_bf16 v[104:107], v[44:47], v[16:19], v[104:107]
    ds_read_b128 v[60:63], v81 offset:4096
    ds_read_b128 v[64:67], v81 offset:6144
    v_mfma_f32_16x16x32_bf16 v[108:111], v[48:51], v[16:19], v[108:111]
    buffer_load_dwordx4 v83, s[20:23], s37 offen offset:2048 lds
    s_add_u32 s37, s37, s41
    s_waitcnt lgkmcnt(8)
    v_mfma_f32_16x16x32_bf16 v[112:115], v[36:39], v[20:23], v[112:115]
    v_mfma_f32_16x16x32_bf16 v[116:119], v[40:43], v[20:23], v[116:119]
    ds_read_b64_tr_b16 v[32:33], v71 offset:1024
    ds_read_b64_tr_b16 v[34:35], v71 offset:1536
    v_mfma_f32_16x16x32_bf16 v[120:123], v[44:47], v[20:23], v[120:123]
    v_mfma_f32_16x16x32_bf16 v[124:127], v[48:51], v[20:23], v[124:127]
    buffer_load_dwordx4 v84, s[24:27], s38 offen offset:3072 lds
    s_waitcnt lgkmcnt(8)
    v_mfma_f32_16x16x32_bf16 v[128:131], v[24:27], v[36:39], v[128:131]
    v_mfma_f32_16x16x32_bf16 v[132:135], v[24:27], v[40:43], v[132:135]
    ds_read_b64_tr_b16 v[16:17], v71 offset:2048
    ds_read_b64_tr_b16 v[18:19], v71 offset:2560
    v_mfma_f32_16x16x32_bf16 v[136:139], v[24:27], v[44:47], v[136:139]
    v_mfma_f32_16x16x32_bf16 v[140:143], v[24:27], v[48:51], v[140:143]
    s_add_u32 m0, s44, 65536
    s_nop 0
    buffer_load_dwordx4 v84, s[28:31], s38 offen offset:0 lds
    s_add_u32 s38, s38, s42
    s_waitcnt lgkmcnt(6)
    v_mfma_f32_16x16x32_bf16 v[144:147], v[28:31], v[36:39], v[144:147]
    v_mfma_f32_16x16x32_bf16 v[148:151], v[28:31], v[40:43], v[148:151]
    ds_read_b64_tr_b16 v[20:21], v72 offset:1024
    ds_read_b64_tr_b16 v[22:23], v72 offset:1536
    v_mfma_f32_16x16x32_bf16 v[152:155], v[28:31], v[44:47], v[152:155]
    v_mfma_f32_16x16x32_bf16 v[156:159], v[28:31], v[48:51], v[156:159]
    s_waitcnt lgkmcnt(4)
    v_mfma_f32_16x16x32_bf16 v[160:163], v[32:35], v[36:39], v[160:163]
    v_mfma_f32_16x16x32_bf16 v[164:167], v[32:35], v[40:43], v[164:167]
    ds_read_b64_tr_b16 v[24:25], v72 offset:2048
    ds_read_b64_tr_b16 v[26:27], v72 offset:2560
    v_mfma_f32_16x16x32_bf16 v[168:171], v[32:35], v[44:47], v[168:171]
    v_mfma_f32_16x16x32_bf16 v[172:175], v[32:35], v[48:51], v[172:175]
    s_waitcnt lgkmcnt(4)
    v_mfma_f32_16x16x32_bf16 v[176:179], v[16:19], v[36:39], v[176:179]
    ds_read_b64_tr_b16 v[28:29], v73 offset:1024
    ds_read_b64_tr_b16 v[30:31], v73 offset:1536
    v_mfma_f32_16x16x32_bf16 v[180:183], v[16:19], v[40:43], v[180:183]
    ds_read_b64_tr_b16 v[32:33], v73 offset:2048
    ds_read_b64_tr_b16 v[34:35], v73 offset:2560
    v_mfma_f32_16x16x32_bf16 v[184:187], v[16:19], v[44:47], v[184:187]
    v_mfma_f32_16x16x32_bf16 v[188:191], v[16:19], v[48:51], v[188:191]
    s_waitcnt lgkmcnt(6)
    v_mfma_f32_16x16x32_bf16 v[192:195], v[20:23], v[36:39], v[192:195]
    v_mfma_f32_16x16x32_bf16 v[196:199], v[20:23], v[40:43], v[196:199]
    v_mfma_f32_16x16x32_bf16 v[200:203], v[20:23], v[44:47], v[200:203]
    v_mfma_f32_16x16x32_bf16 v[204:207], v[20:23], v[48:51], v[204:207]
    buffer_store_dword v1, v1, s[32:35], s86 offen
    buffer_store_dword v1, v1, s[32:35], s86 offen
    s_cmp_eq_u32 s45, 5
    s_cselect_b32 s52, s60, 0
    s_sub_u32 s36, s36, s52
    s_cmp_eq_u32 s45, 5
    s_cselect_b32 s52, s61, 0
    s_sub_u32 s37, s37, s52
    s_cmp_eq_u32 s45, 5
    s_cselect_b32 s52, s62, 0
    s_sub_u32 s38, s38, s52
    s_cmp_eq_u32 s45, 5
    s_sub_u32 s45, s45, 1
    s_cmp_eq_u32 s45, s64
    s_cselect_b32 s65, s67, s86
    s_cmp_eq_u32 s45, 2
    s_cselect_b32 s66, s92, s86
    s_cmp_lg_u32 s45, 1
    s_waitcnt vmcnt(14) lgkmcnt(0)
    s_barrier
    s_cbranch_scc1 L_g1_loop_W1
L_g1_lastit_W1:
    v_mfma_f32_16x16x32_bf16 v[208:211], v[24:27], v[36:39], v[208:211]
    v_mfma_f32_16x16x32_bf16 v[212:215], v[24:27], v[40:43], v[212:215]
    v_mfma_f32_16x16x32_bf16 v[216:219], v[24:27], v[44:47], v[216:219]
    ds_read_b64_tr_b16 v[16:17], v68 offset:20480
    ds_read_b64_tr_b16 v[18:19], v68 offset:20992
    v_mfma_f32_16x16x32_bf16 v[220:223], v[24:27], v[48:51], v[220:223]
    v_mfma_f32_16x16x32_bf16 v[224:227], v[28:31], v[36:39], v[224:227]
    v_mfma_f32_16x16x32_bf16 v[228:231], v[28:31], v[40:43], v[228:231]
    ds_read_b64_tr_b16 v[20:21], v69 offset:20480
    ds_read_b64_tr_b16 v[22:23], v69 offset:20992
    v_mfma_f32_16x16x32_bf16 v[232:235], v[28:31], v[44:47], v[232:235]
    v_mfma_f32_16x16x32_bf16 v[236:239], v[28:31], v[48:51], v[236:239]
    s_add_u32 m0, s44, 0
    s_nop 0
    buffer_load_dwordx4 v82, s[12:15], s36 offen offset:0 lds
    s_add_u32 s36, s36, s40
    v_mfma_f32_16x16x32_bf16 v[240:243], v[32:35], v[36:39], v[240:243]
    v_mfma_f32_16x16x32_bf16 v[244:247], v[32:35], v[40:43], v[244:247]
    ds_read_b64_tr_b16 v[24:25], v70 offset:21504
    ds_read_b64_tr_b16 v[26:27], v70 offset:22016
    v_mfma_f32_16x16x32_bf16 v[248:251], v[32:35], v[44:47], v[248:251]
    v_mfma_f32_16x16x32_bf16 v[252:255], v[32:35], v[48:51], v[252:255]
    buffer_load_dwordx4 v83, s[16:19], s37 offen offset:1024 lds
    s_waitcnt lgkmcnt(4)
    v_mfma_f32_16x16x32_bf16 v[96:99], v[52:55], v[16:19], v[96:99]
    v_mfma_f32_16x16x32_bf16 v[100:103], v[56:59], v[16:19], v[100:103]
    ds_read_b64_tr_b16 v[28:29], v70 offset:22528
    ds_read_b64_tr_b16 v[30:31], v70 offset:23040
    v_mfma_f32_16x16x32_bf16 v[104:107], v[60:63], v[16:19], v[104:107]
    v_mfma_f32_16x16x32_bf16 v[108:111], v[64:67], v[16:19], v[108:111]
    buffer_load_dwordx4 v83, s[20:23], s37 offen offset:2048 lds
    s_add_u32 s37, s37, s41
    s_waitcnt lgkmcnt(4)
    v_mfma_f32_16x16x32_bf16 v[112:115], v[52:55], v[20:23], v[112:115]
    v_mfma_f32_16x16x32_bf16 v[116:119], v[56:59], v[20:23], v[116:119]
    ds_read_b64_tr_b16 v[32:33], v71 offset:21504
    ds_read_b64_tr_b16 v[34:35], v71 offset:22016
    v_mfma_f32_16x16x32_bf16 v[120:123], v[60:63], v[20:23], v[120:123]
    v_mfma_f32_16x16x32_bf16 v[124:127], v[64:67], v[20:23], v[124:127]
    buffer_load_dwordx4 v84, s[24:27], s38 offen offset:3072 lds
    s_waitcnt lgkmcnt(4)
    v_mfma_f32_16x16x32_bf16 v[128:131], v[24:27], v[52:55], v[128:131]
    v_mfma_f32_16x16x32_bf16 v[132:135], v[24:27], v[56:59], v[132:135]
    ds_read_b64_tr_b16 v[16:17], v71 offset:22528
    ds_read_b64_tr_b16 v[18:19], v71 offset:23040
    v_mfma_f32_16x16x32_bf16 v[136:139], v[24:27], v[60:63], v[136:139]
    v_mfma_f32_16x16x32_bf16 v[140:143], v[24:27], v[64:67], v[140:143]
    s_add_u32 m0, s44, 4096
    s_nop 0
    buffer_load_dwordx4 v84, s[28:31], s38 offen offset:0 lds
    s_add_u32 s38, s38, s42
    s_waitcnt lgkmcnt(4)
    v_mfma_f32_16x16x32_bf16 v[144:147], v[28:31], v[52:55], v[144:147]
    v_mfma_f32_16x16x32_bf16 v[148:151], v[28:31], v[56:59], v[148:151]
    ds_read_b64_tr_b16 v[20:21], v72 offset:21504
    ds_read_b64_tr_b16 v[22:23], v72 offset:22016
    v_mfma_f32_16x16x32_bf16 v[152:155], v[28:31], v[60:63], v[152:155]
    v_mfma_f32_16x16x32_bf16 v[156:159], v[28:31], v[64:67], v[156:159]
    s_waitcnt lgkmcnt(4)
    v_mfma_f32_16x16x32_bf16 v[160:163], v[32:35], v[52:55], v[160:163]
    v_mfma_f32_16x16x32_bf16 v[164:167], v[32:35], v[56:59], v[164:167]
    ds_read_b64_tr_b16 v[24:25], v72 offset:22528
    ds_read_b64_tr_b16 v[26:27], v72 offset:23040
    v_mfma_f32_16x16x32_bf16 v[168:171], v[32:35], v[60:63], v[168:171]
    v_mfma_f32_16x16x32_bf16 v[172:175], v[32:35], v[64:67], v[172:175]
    s_waitcnt lgkmcnt(4)
    v_mfma_f32_16x16x32_bf16 v[176:179], v[16:19], v[52:55], v[176:179]
    ds_read_b64_tr_b16 v[28:29], v73 offset:21504
    ds_read_b64_tr_b16 v[30:31], v73 offset:22016
    v_mfma_f32_16x16x32_bf16 v[180:183], v[16:19], v[56:59], v[180:183]
    ds_read_b64_tr_b16 v[32:33], v73 offset:22528
    ds_read_b64_tr_b16 v[34:35], v73 offset:23040
    v_mfma_f32_16x16x32_bf16 v[184:187], v[16:19], v[60:63], v[184:187]
    v_mfma_f32_16x16x32_bf16 v[188:191], v[16:19], v[64:67], v[188:191]
    s_waitcnt lgkmcnt(6)
    v_mfma_f32_16x16x32_bf16 v[192:195], v[20:23], v[52:55], v[192:195]
    v_mfma_f32_16x16x32_bf16 v[196:199], v[20:23], v[56:59], v[196:199]
    v_mfma_f32_16x16x32_bf16 v[200:203], v[20:23], v[60:63], v[200:203]
    v_mfma_f32_16x16x32_bf16 v[204:207], v[20:23], v[64:67], v[204:207]
    s_waitcnt vmcnt(12)
    s_cmp_eq_u32 s49, 0
    s_cbranch_scc0 L_g1_zok_24
    s_mov_b32 s52, 0
L_g1_z_23:
    v_cmp_ne_u32 vcc, 32, v85
    s_cbranch_vccz L_g1_zok_24
    s_add_u32 s52, s52, 1
    s_cmp_lt_u32 s52, 65536
    s_cbranch_scc0 L_g1_zok_24
    buffer_load_dword v85, v87, s[88:91], s92 offen sc0 sc1
    s_waitcnt vmcnt(0)
    s_branch L_g1_z_23
L_g1_zok_24:
    s_waitcnt vmcnt(14) lgkmcnt(0)
    s_barrier
    v_mfma_f32_16x16x32_bf16 v[208:211], v[24:27], v[52:55], v[208:211]
    ds_read_b128 v[36:39], v80 offset:32768
    ds_read_b128 v[40:43], v80 offset:34816
    s_lshl_b32 s52, s49, 6
    v_add_u32 v4, s52, v1
    v_mfma_f32_16x16x32_bf16 v[212:215], v[24:27], v[56:59], v[212:215]
    ds_read_b128 v[44:47], v80 offset:36864
    ds_read_b128 v[48:51], v80 offset:38912
    v_lshrrev_b32 v5, 3, v4
    v_mfma_f32_16x16x32_bf16 v[216:219], v[24:27], v[60:63], v[216:219]
    ds_read_b64_tr_b16 v[16:17], v68 offset:40960
    ds_read_b64_tr_b16 v[18:19], v68 offset:41472
    v_lshlrev_b32 v5, 7, v5
    v_mfma_f32_16x16x32_bf16 v[220:223], v[24:27], v[64:67], v[220:223]
    v_and_b32 v6, 7, v1
    v_mfma_f32_16x16x32_bf16 v[224:227], v[28:31], v[52:55], v[224:227]
    v_lshl_add_u32 v5, v6, 3, v5
    v_mfma_f32_16x16x32_bf16 v[228:231], v[28:31], v[56:59], v[228:231]
    ds_read_b64_tr_b16 v[20:21], v69 offset:40960
    ds_read_b64_tr_b16 v[22:23], v69 offset:41472
    v_cmp_gt_u32 vcc, 256, v4
    v_mfma_f32_16x16x32_bf16 v[232:235], v[28:31], v[60:63], v[232:235]
    v_mov_b32 v6, 2147418112
    v_mfma_f32_16x16x32_bf16 v[236:239], v[28:31], v[64:67], v[236:239]
    s_add_u32 m0, s44, 20480
    s_nop 0
    buffer_load_dwordx4 v82, s[12:15], s36 offen offset:0 lds
    s_add_u32 s36, s36, s40
    v_cndmask_b32 v5, v6, v5, vcc
    v_mfma_f32_16x16x32_bf16 v[240:243], v[32:35], v[52:55], v[240:243]
    v_cmp_gt_u32 vcc, 320, v4
    v_mfma_f32_16x16x32_bf16 v[244:247], v[32:35], v[56:59], v[244:247]
    ds_read_b64_tr_b16 v[24:25], v70 offset:41984
    ds_read_b64_tr_b16 v[26:27], v70 offset:42496
    v_lshlrev_b32 v4, 2, v4
    v_mfma_f32_16x16x32_bf16 v[248:251], v[32:35], v[60:63], v[248:251]
    v_cndmask_b32 v7, v6, v4, vcc
    v_mfma_f32_16x16x32_bf16 v[252:255], v[32:35], v[64:67], v[252:255]
    buffer_load_dwordx4 v83, s[16:19], s37 offen offset:1024 lds
    s_and_b32 s52, s2, 31
    s_mul_i32 s52, s52, 10240
    s_add_u32 s52, s52, 52498432
    s_add_u32 s53, s52, 5120
    buffer_load_dword v88, v7, s[32:35], s52 offen offset:0 sc0 sc1
    s_waitcnt lgkmcnt(4)
    v_mfma_f32_16x16x32_bf16 v[96:99], v[36:39], v[16:19], v[96:99]
    ds_read_b128 v[52:55], v81 offset:32768
    ds_read_b128 v[56:59], v81 offset:34816
    buffer_load_dword v89, v7, s[32:35], s52 offen offset:1280 sc0 sc1
    v_mfma_f32_16x16x32_bf16 v[100:103], v[40:43], v[16:19], v[100:103]
    ds_read_b64_tr_b16 v[28:29], v70 offset:43008
    ds_read_b64_tr_b16 v[30:31], v70 offset:43520
    buffer_load_dword v90, v7, s[32:35], s52 offen offset:2560 sc0 sc1
    v_mfma_f32_16x16x32_bf16 v[104:107], v[44:47], v[16:19], v[104:107]
    ds_read_b128 v[60:63], v81 offset:36864
    ds_read_b128 v[64:67], v81 offset:38912
    buffer_load_dword v91, v7, s[32:35], s52 offen offset:3840 sc0 sc1
    v_mfma_f32_16x16x32_bf16 v[108:111], v[48:51], v[16:19], v[108:111]
    buffer_load_dwordx4 v83, s[20:23], s37 offen offset:2048 lds
    s_add_u32 s37, s37, s41
    buffer_load_dword v92, v7, s[32:35], s53 offen offset:0 sc0 sc1
    s_waitcnt lgkmcnt(8)
    v_mfma_f32_16x16x32_bf16 v[112:115], v[36:39], v[20:23], v[112:115]
    buffer_load_dword v93, v7, s[32:35], s53 offen offset:1280 sc0 sc1
    v_mfma_f32_16x16x32_bf16 v[116:119], v[40:43], v[20:23], v[116:119]
    ds_read_b64_tr_b16 v[32:33], v71 offset:41984
    ds_read_b64_tr_b16 v[34:35], v71 offset:42496
    buffer_load_dword v94, v7, s[32:35], s53 offen offset:2560 sc0 sc1
    v_mfma_f32_16x16x32_bf16 v[120:123], v[44:47], v[20:23], v[120:123]
    buffer_load_dword v95, v7, s[32:35], s53 offen offset:3840 sc0 sc1
    v_mfma_f32_16x16x32_bf16 v[124:127], v[48:51], v[20:23], v[124:127]
    buffer_load_dwordx4 v84, s[24:27], s38 offen offset:3072 lds
    s_lshl_b32 s52, s48, 12
    s_add_u32 s52, s52, 52465664
    buffer_load_dwordx2 v[74:75], v5, s[32:35], s52 offen sc0 sc1
    s_waitcnt lgkmcnt(8)
    v_mfma_f32_16x16x32_bf16 v[128:131], v[24:27], v[36:39], v[128:131]
    v_mfma_f32_16x16x32_bf16 v[132:135], v[24:27], v[40:43], v[132:135]
    ds_read_b64_tr_b16 v[16:17], v71 offset:43008
    ds_read_b64_tr_b16 v[18:19], v71 offset:43520
    v_mfma_f32_16x16x32_bf16 v[136:139], v[24:27], v[44:47], v[136:139]
    v_mfma_f32_16x16x32_bf16 v[140:143], v[24:27], v[48:51], v[140:143]
    s_add_u32 m0, s44, 24576
    s_nop 0
    buffer_load_dwordx4 v84, s[28:31], s38 offen offset:0 lds
    s_add_u32 s38, s38, s42
    s_waitcnt lgkmcnt(6)
    v_mfma_f32_16x16x32_bf16 v[144:147], v[28:31], v[36:39], v[144:147]
    v_mfma_f32_16x16x32_bf16 v[148:151], v[28:31], v[40:43], v[148:151]
    ds_read_b64_tr_b16 v[20:21], v72 offset:41984
    ds_read_b64_tr_b16 v[22:23], v72 offset:42496
    v_mfma_f32_16x16x32_bf16 v[152:155], v[28:31], v[44:47], v[152:155]
    v_mfma_f32_16x16x32_bf16 v[156:159], v[28:31], v[48:51], v[156:159]
    s_waitcnt lgkmcnt(4)
    v_mfma_f32_16x16x32_bf16 v[160:163], v[32:35], v[36:39], v[160:163]
    v_mfma_f32_16x16x32_bf16 v[164:167], v[32:35], v[40:43], v[164:167]
    ds_read_b64_tr_b16 v[24:25], v72 offset:43008
    ds_read_b64_tr_b16 v[26:27], v72 offset:43520
    v_mfma_f32_16x16x32_bf16 v[168:171], v[32:35], v[44:47], v[168:171]
    v_mfma_f32_16x16x32_bf16 v[172:175], v[32:35], v[48:51], v[172:175]
    s_waitcnt lgkmcnt(4)
    v_mfma_f32_16x16x32_bf16 v[176:179], v[16:19], v[36:39], v[176:179]
    ds_read_b64_tr_b16 v[28:29], v73 offset:41984
    ds_read_b64_tr_b16 v[30:31], v73 offset:42496
    v_mfma_f32_16x16x32_bf16 v[180:183], v[16:19], v[40:43], v[180:183]
    ds_read_b64_tr_b16 v[32:33], v73 offset:43008
    ds_read_b64_tr_b16 v[34:35], v73 offset:43520
    v_mfma_f32_16x16x32_bf16 v[184:187], v[16:19], v[44:47], v[184:187]
    v_mfma_f32_16x16x32_bf16 v[188:191], v[16:19], v[48:51], v[188:191]
    s_waitcnt lgkmcnt(6)
    v_mfma_f32_16x16x32_bf16 v[192:195], v[20:23], v[36:39], v[192:195]
    v_mfma_f32_16x16x32_bf16 v[196:199], v[20:23], v[40:43], v[196:199]
    v_mfma_f32_16x16x32_bf16 v[200:203], v[20:23], v[44:47], v[200:203]
    v_mfma_f32_16x16x32_bf16 v[204:207], v[20:23], v[48:51], v[204:207]
    s_waitcnt vmcnt(21) lgkmcnt(0)
    s_barrier
    v_mfma_f32_16x16x32_bf16 v[208:211], v[24:27], v[36:39], v[208:211]
    v_mfma_f32_16x16x32_bf16 v[212:215], v[24:27], v[40:43], v[212:215]
    v_mfma_f32_16x16x32_bf16 v[216:219], v[24:27], v[44:47], v[216:219]
    ds_read_b64_tr_b16 v[16:17], v68 offset:61440
    ds_read_b64_tr_b16 v[18:19], v68 offset:61952
    v_mfma_f32_16x16x32_bf16 v[220:223], v[24:27], v[48:51], v[220:223]
    v_mfma_f32_16x16x32_bf16 v[224:227], v[28:31], v[36:39], v[224:227]
    v_mfma_f32_16x16x32_bf16 v[228:231], v[28:31], v[40:43], v[228:231]
    ds_read_b64_tr_b16 v[20:21], v69 offset:61440
    ds_read_b64_tr_b16 v[22:23], v69 offset:61952
    v_mfma_f32_16x16x32_bf16 v[232:235], v[28:31], v[44:47], v[232:235]
    v_mfma_f32_16x16x32_bf16 v[236:239], v[28:31], v[48:51], v[236:239]
    s_add_u32 m0, s44, 40960
    s_nop 0
    buffer_load_dwordx4 v82, s[12:15], s36 offen offset:0 lds
    s_add_u32 s36, s36, s40
    v_mfma_f32_16x16x32_bf16 v[240:243], v[32:35], v[36:39], v[240:243]
    v_mfma_f32_16x16x32_bf16 v[244:247], v[32:35], v[40:43], v[244:247]
    ds_read_b64_tr_b16 v[24:25], v70 offset:62464
    ds_read_b64_tr_b16 v[26:27], v70 offset:62976
    v_mfma_f32_16x16x32_bf16 v[248:251], v[32:35], v[44:47], v[248:251]
    v_mfma_f32_16x16x32_bf16 v[252:255], v[32:35], v[48:51], v[252:255]
    buffer_load_dwordx4 v83, s[16:19], s37 offen offset:1024 lds
    s_waitcnt lgkmcnt(4)
    v_mfma_f32_16x16x32_bf16 v[96:99], v[52:55], v[16:19], v[96:99]
    v_mfma_f32_16x16x32_bf16 v[100:103], v[56:59], v[16:19], v[100:103]
    ds_read_b64_tr_b16 v[28:29], v70 offset:63488
    ds_read_b64_tr_b16 v[30:31], v70 offset:64000
    v_mfma_f32_16x16x32_bf16 v[104:107], v[60:63], v[16:19], v[104:107]
    v_mfma_f32_16x16x32_bf16 v[108:111], v[64:67], v[16:19], v[108:111]
    buffer_load_dwordx4 v83, s[20:23], s37 offen offset:2048 lds
    s_add_u32 s37, s37, s41
    s_waitcnt lgkmcnt(4)
    v_mfma_f32_16x16x32_bf16 v[112:115], v[52:55], v[20:23], v[112:115]
    v_mfma_f32_16x16x32_bf16 v[116:119], v[56:59], v[20:23], v[116:119]
    ds_read_b64_tr_b16 v[32:33], v71 offset:62464
    ds_read_b64_tr_b16 v[34:35], v71 offset:62976
    v_mfma_f32_16x16x32_bf16 v[120:123], v[60:63], v[20:23], v[120:123]
    v_mfma_f32_16x16x32_bf16 v[124:127], v[64:67], v[20:23], v[124:127]
    buffer_load_dwordx4 v84, s[24:27], s38 offen offset:3072 lds
    s_waitcnt lgkmcnt(4)
    v_mfma_f32_16x16x32_bf16 v[128:131], v[24:27], v[52:55], v[128:131]
    v_mfma_f32_16x16x32_bf16 v[132:135], v[24:27], v[56:59], v[132:135]
    ds_read_b64_tr_b16 v[16:17], v71 offset:63488
    ds_read_b64_tr_b16 v[18:19], v71 offset:64000
    v_mfma_f32_16x16x32_bf16 v[136:139], v[24:27], v[60:63], v[136:139]
    v_mfma_f32_16x16x32_bf16 v[140:143], v[24:27], v[64:67], v[140:143]
    s_add_u32 m0, s44, 45056
    s_nop 0
    buffer_load_dwordx4 v84, s[28:31], s38 offen offset:0 lds
    s_add_u32 s38, s38, s42
    s_waitcnt lgkmcnt(4)
    v_mfma_f32_16x16x32_bf16 v[144:147], v[28:31], v[52:55], v[144:147]
    v_mfma_f32_16x16x32_bf16 v[148:151], v[28:31], v[56:59], v[148:151]
    ds_read_b64_tr_b16 v[20:21], v72 offset:62464
    ds_read_b64_tr_b16 v[22:23], v72 offset:62976
    v_mfma_f32_16x16x32_bf16 v[152:155], v[28:31], v[60:63], v[152:155]
    v_mfma_f32_16x16x32_bf16 v[156:159], v[28:31], v[64:67], v[156:159]
    s_waitcnt lgkmcnt(4)
    v_mfma_f32_16x16x32_bf16 v[160:163], v[32:35], v[52:55], v[160:163]
    v_mfma_f32_16x16x32_bf16 v[164:167], v[32:35], v[56:59], v[164:167]
    ds_read_b64_tr_b16 v[24:25], v72 offset:63488
    ds_read_b64_tr_b16 v[26:27], v72 offset:64000
    v_mfma_f32_16x16x32_bf16 v[168:171], v[32:35], v[60:63], v[168:171]
    v_mfma_f32_16x16x32_bf16 v[172:175], v[32:35], v[64:67], v[172:175]
    s_waitcnt lgkmcnt(4)
    v_mfma_f32_16x16x32_bf16 v[176:179], v[16:19], v[52:55], v[176:179]
    ds_read_b64_tr_b16 v[28:29], v73 offset:62464
    ds_read_b64_tr_b16 v[30:31], v73 offset:62976
    v_mfma_f32_16x16x32_bf16 v[180:183], v[16:19], v[56:59], v[180:183]
    ds_read_b64_tr_b16 v[32:33], v73 offset:63488
    ds_read_b64_tr_b16 v[34:35], v73 offset:64000
    v_mfma_f32_16x16x32_bf16 v[184:187], v[16:19], v[60:63], v[184:187]
    v_mfma_f32_16x16x32_bf16 v[188:191], v[16:19], v[64:67], v[188:191]
    s_waitcnt lgkmcnt(6)
    v_mfma_f32_16x16x32_bf16 v[192:195], v[20:23], v[52:55], v[192:195]
    v_mfma_f32_16x16x32_bf16 v[196:199], v[20:23], v[56:59], v[196:199]
    v_mfma_f32_16x16x32_bf16 v[200:203], v[20:23], v[60:63], v[200:203]
    v_mfma_f32_16x16x32_bf16 v[204:207], v[20:23], v[64:67], v[204:207]
    s_waitcnt vmcnt(19) lgkmcnt(0)
    s_barrier
    v_mfma_f32_16x16x32_bf16 v[208:211], v[24:27], v[52:55], v[208:211]
    ds_read_b128 v[36:39], v80 offset:0
    ds_read_b128 v[40:43], v80 offset:2048
    v_mfma_f32_16x16x32_bf16 v[212:215], v[24:27], v[56:59], v[212:215]
    ds_read_b128 v[44:47], v80 offset:4096
    ds_read_b128 v[48:51], v80 offset:6144
    v_mfma_f32_16x16x32_bf16 v[216:219], v[24:27], v[60:63], v[216:219]
    ds_read_b64_tr_b16 v[16:17], v68 offset:0
    ds_read_b64_tr_b16 v[18:19], v68 offset:512
    v_mfma_f32_16x16x32_bf16 v[220:223], v[24:27], v[64:67], v[220:223]
    v_mfma_f32_16x16x32_bf16 v[224:227], v[28:31], v[52:55], v[224:227]
    v_mfma_f32_16x16x32_bf16 v[228:231], v[28:31], v[56:59], v[228:231]
    ds_read_b64_tr_b16 v[20:21], v69 offset:0
    ds_read_b64_tr_b16 v[22:23], v69 offset:512
    v_mfma_f32_16x16x32_bf16 v[232:235], v[28:31], v[60:63], v[232:235]
    v_mfma_f32_16x16x32_bf16 v[236:239], v[28:31], v[64:67], v[236:239]
    s_add_u32 m0, s44, 61440
    s_nop 0
    buffer_load_dwordx4 v82, s[12:15], s36 offen offset:0 lds
    s_add_u32 s36, s36, s40
    v_mfma_f32_16x16x32_bf16 v[240:243], v[32:35], v[52:55], v[240:243]
    v_mfma_f32_16x16x32_bf16 v[244:247], v[32:35], v[56:59], v[244:247]
    ds_read_b64_tr_b16 v[24:25], v70 offset:1024
    ds_read_b64_tr_b16 v[26:27], v70 offset:1536
    v_mfma_f32_16x16x32_bf16 v[248:251], v[32:35], v[60:63], v[248:251]
    v_mfma_f32_16x16x32_bf16 v[252:255], v[32:35], v[64:67], v[252:255]
    buffer_load_dwordx4 v83, s[16:19], s37 offen offset:1024 lds
    s_waitcnt lgkmcnt(4)
    v_mfma_f32_16x16x32_bf16 v[96:99], v[36:39], v[16:19], v[96:99]
    ds_read_b128 v[52:55], v81 offset:0
    ds_read_b128 v[56:59], v81 offset:2048
    v_mfma_f32_16x16x32_bf16 v[100:103], v[40:43], v[16:19], v[100:103]
    ds_read_b64_tr_b16 v[28:29], v70 offset:2048
    ds_read_b64_tr_b16 v[30:31], v70 offset:2560
    v_mfma_f32_16x16x32_bf16 v[104:107], v[44:47], v[16:19], v[104:107]
    ds_read_b128 v[60:63], v81 offset:4096
    ds_read_b128 v[64:67], v81 offset:6144
    v_mfma_f32_16x16x32_bf16 v[108:111], v[48:51], v[16:19], v[108:111]
    buffer_load_dwordx4 v83, s[20:23], s37 offen offset:2048 lds
    s_add_u32 s37, s37, s41
    s_waitcnt lgkmcnt(8)
    v_mfma_f32_16x16x32_bf16 v[112:115], v[36:39], v[20:23], v[112:115]
    v_mfma_f32_16x16x32_bf16 v[116:119], v[40:43], v[20:23], v[116:119]
    ds_read_b64_tr_b16 v[32:33], v71 offset:1024
    ds_read_b64_tr_b16 v[34:35], v71 offset:1536
    v_mfma_f32_16x16x32_bf16 v[120:123], v[44:47], v[20:23], v[120:123]
    v_mfma_f32_16x16x32_bf16 v[124:127], v[48:51], v[20:23], v[124:127]
    buffer_load_dwordx4 v84, s[24:27], s38 offen offset:3072 lds
    s_waitcnt lgkmcnt(8)
    v_mfma_f32_16x16x32_bf16 v[128:131], v[24:27], v[36:39], v[128:131]
    v_mfma_f32_16x16x32_bf16 v[132:135], v[24:27], v[40:43], v[132:135]
    ds_read_b64_tr_b16 v[16:17], v71 offset:2048
    ds_read_b64_tr_b16 v[18:19], v71 offset:2560
    v_mfma_f32_16x16x32_bf16 v[136:139], v[24:27], v[44:47], v[136:139]
    v_mfma_f32_16x16x32_bf16 v[140:143], v[24:27], v[48:51], v[140:143]
    s_add_u32 m0, s44, 65536
    s_nop 0
    buffer_load_dwordx4 v84, s[28:31], s38 offen offset:0 lds
    s_add_u32 s38, s38, s42
    s_waitcnt lgkmcnt(6)
    v_mfma_f32_16x16x32_bf16 v[144:147], v[28:31], v[36:39], v[144:147]
    v_mfma_f32_16x16x32_bf16 v[148:151], v[28:31], v[40:43], v[148:151]
    ds_read_b64_tr_b16 v[20:21], v72 offset:1024
    ds_read_b64_tr_b16 v[22:23], v72 offset:1536
    v_mfma_f32_16x16x32_bf16 v[152:155], v[28:31], v[44:47], v[152:155]
    v_mfma_f32_16x16x32_bf16 v[156:159], v[28:31], v[48:51], v[156:159]
    s_waitcnt lgkmcnt(4)
    v_mfma_f32_16x16x32_bf16 v[160:163], v[32:35], v[36:39], v[160:163]
    v_mfma_f32_16x16x32_bf16 v[164:167], v[32:35], v[40:43], v[164:167]
    ds_read_b64_tr_b16 v[24:25], v72 offset:2048
    ds_read_b64_tr_b16 v[26:27], v72 offset:2560
    v_mfma_f32_16x16x32_bf16 v[168:171], v[32:35], v[44:47], v[168:171]
    v_mfma_f32_16x16x32_bf16 v[172:175], v[32:35], v[48:51], v[172:175]
    s_waitcnt lgkmcnt(4)
    v_mfma_f32_16x16x32_bf16 v[176:179], v[16:19], v[36:39], v[176:179]
    ds_read_b64_tr_b16 v[28:29], v73 offset:1024
    ds_read_b64_tr_b16 v[30:31], v73 offset:1536
    v_mfma_f32_16x16x32_bf16 v[180:183], v[16:19], v[40:43], v[180:183]
    ds_read_b64_tr_b16 v[32:33], v73 offset:2048
    ds_read_b64_tr_b16 v[34:35], v73 offset:2560
    v_mfma_f32_16x16x32_bf16 v[184:187], v[16:19], v[44:47], v[184:187]
    v_mfma_f32_16x16x32_bf16 v[188:191], v[16:19], v[48:51], v[188:191]
    s_waitcnt lgkmcnt(6)
    v_mfma_f32_16x16x32_bf16 v[192:195], v[20:23], v[36:39], v[192:195]
    v_mfma_f32_16x16x32_bf16 v[196:199], v[20:23], v[40:43], v[196:199]
    v_mfma_f32_16x16x32_bf16 v[200:203], v[20:23], v[44:47], v[200:203]
    v_mfma_f32_16x16x32_bf16 v[204:207], v[20:23], v[48:51], v[204:207]
    s_waitcnt vmcnt(10)
    v_add_f32 v88, v88, v89
    v_add_f32 v90, v90, v91
    v_add_f32 v92, v92, v93
    v_add_f32 v94, v94, v95
    v_add_f32 v88, v88, v90
    v_add_f32 v92, v92, v94
    v_add_f32 v88, v88, v92
    v_add_u32 v4, 147456, v4
    s_lshl_b32 s52, s49, 9
    s_add_u32 s52, s52, 149504
    v_lshl_add_u32 v5, v1, 2, s52
    ds_write_b32 v4, v88
    ds_write2_b32 v5, v74, v75 offset0:0 offset1:64
    s_waitcnt lgkmcnt(0)
    s_barrier
    s_branch L_g1_tail
L_g1_spec_W1:
    s_cmp_eq_u32 s51, 0
    s_cbranch_scc1 L_cs_25
    v_mfma_f32_16x16x32_bf16 v[208:211], v[24:27], v[36:39], v[208:211]
    v_mfma_f32_16x16x32_bf16 v[212:215], v[24:27], v[40:43], v[212:215]
    v_mfma_f32_16x16x32_bf16 v[216:219], v[24:27], v[44:47], v[216:219]
    ds_read_b64_tr_b16 v[16:17], v68 offset:20480
    ds_read_b64_tr_b16 v[18:19], v68 offset:20992
    v_mfma_f32_16x16x32_bf16 v[220:223], v[24:27], v[48:51], v[220:223]
    v_mfma_f32_16x16x32_bf16 v[224:227], v[28:31], v[36:39], v[224:227]
    v_mfma_f32_16x16x32_bf16 v[228:231], v[28:31], v[40:43], v[228:231]
    ds_read_b64_tr_b16 v[20:21], v69 offset:20480
    ds_read_b64_tr_b16 v[22:23], v69 offset:20992
    v_mfma_f32_16x16x32_bf16 v[232:235], v[28:31], v[44:47], v[232:235]
    v_mfma_f32_16x16x32_bf16 v[236:239], v[28:31], v[48:51], v[236:239]
    s_add_u32 m0, s44, 0
    s_nop 0
    buffer_load_dwordx4 v82, s[12:15], s36 offen offset:0 lds
    s_add_u32 s36, s36, s40
    v_mfma_f32_16x16x32_bf16 v[240:243], v[32:35], v[36:39], v[240:243]
    v_mfma_f32_16x16x32_bf16 v[244:247], v[32:35], v[40:43], v[244:247]
    ds_read_b64_tr_b16 v[24:25], v70 offset:21504
    ds_read_b64_tr_b16 v[26:27], v70 offset:22016
    v_mfma_f32_16x16x32_bf16 v[248:251], v[32:35], v[44:47], v[248:251]
    v_mfma_f32_16x16x32_bf16 v[252:255], v[32:35], v[48:51], v[252:255]
    buffer_load_dwordx4 v83, s[16:19], s37 offen offset:1024 lds
L_cs_25_ret:
    s_cmp_eq_u32 s51, 1
    s_cbranch_scc1 L_cs_26
    s_waitcnt lgkmcnt(4)
    v_mfma_f32_16x16x32_bf16 v[96:99], v[52:55], v[16:19], v[96:99]
    v_mfma_f32_16x16x32_bf16 v[100:103], v[56:59], v[16:19], v[100:103]
    ds_read_b64_tr_b16 v[28:29], v70 offset:22528
    ds_read_b64_tr_b16 v[30:31], v70 offset:23040
    v_mfma_f32_16x16x32_bf16 v[104:107], v[60:63], v[16:19], v[104:107]
    v_mfma_f32_16x16x32_bf16 v[108:111], v[64:67], v[16:19], v[108:111]
    buffer_load_dwordx4 v83, s[20:23], s37 offen offset:2048 lds
    s_add_u32 s37, s37, s41
    s_waitcnt lgkmcnt(4)
    v_mfma_f32_16x16x32_bf16 v[112:115], v[52:55], v[20:23], v[112:115]
    v_mfma_f32_16x16x32_bf16 v[116:119], v[56:59], v[20:23], v[116:119]
    ds_read_b64_tr_b16 v[32:33], v71 offset:21504
    ds_read_b64_tr_b16 v[34:35], v71 offset:22016
    v_mfma_f32_16x16x32_bf16 v[120:123], v[60:63], v[20:23], v[120:123]
    v_mfma_f32_16x16x32_bf16 v[124:127], v[64:67], v[20:23], v[124:127]
    buffer_load_dwordx4 v84, s[24:27], s38 offen offset:3072 lds
    s_waitcnt lgkmcnt(4)
    v_mfma_f32_16x16x32_bf16 v[128:131], v[24:27], v[52:55], v[128:131]
    v_mfma_f32_16x16x32_bf16 v[132:135], v[24:27], v[56:59], v[132:135]
    ds_read_b64_tr_b16 v[16:17], v71 offset:22528
    ds_read_b64_tr_b16 v[18:19], v71 offset:23040
    v_mfma_f32_16x16x32_bf16 v[136:139], v[24:27], v[60:63], v[136:139]
    v_mfma_f32_16x16x32_bf16 v[140:143], v[24:27], v[64:67], v[140:143]
    s_add_u32 m0, s44, 4096
    s_nop 0
    buffer_load_dwordx4 v84, s[28:31], s38 offen offset:0 lds
    s_add_u32 s38, s38, s42
L_cs_26_ret:
    s_cmp_eq_u32 s51, 2
    s_cbranch_scc1 L_cs_27
    s_waitcnt lgkmcnt(4)
    v_mfma_f32_16x16x32_bf16 v[144:147], v[28:31], v[52:55], v[144:147]
    v_mfma_f32_16x16x32_bf16 v[148:151], v[28:31], v[56:59], v[148:151]
    ds_read_b64_tr_b16 v[20:21], v72 offset:21504
    ds_read_b64_tr_b16 v[22:23], v72 offset:22016
    v_mfma_f32_16x16x32_bf16 v[152:155], v[28:31], v[60:63], v[152:155]
    v_mfma_f32_16x16x32_bf16 v[156:159], v[28:31], v[64:67], v[156:159]
    s_waitcnt lgkmcnt(4)
    v_mfma_f32_16x16x32_bf16 v[160:163], v[32:35], v[52:55], v[160:163]
    v_mfma_f32_16x16x32_bf16 v[164:167], v[32:35], v[56:59], v[164:167]
    ds_read_b64_tr_b16 v[24:25], v72 offset:22528
    ds_read_b64_tr_b16 v[26:27], v72 offset:23040
    v_mfma_f32_16x16x32_bf16 v[168:171], v[32:35], v[60:63], v[168:171]
    v_mfma_f32_16x16x32_bf16 v[172:175], v[32:35], v[64:67], v[172:175]
L_cs_27_ret:
    s_cmp_eq_u32 s51, 3
    s_cbranch_scc1 L_cs_28
    s_waitcnt lgkmcnt(4)
    v_mfma_f32_16x16x32_bf16 v[176:179], v[16:19], v[52:55], v[176:179]
    ds_read_b64_tr_b16 v[28:29], v73 offset:21504
    ds_read_b64_tr_b16 v[30:31], v73 offset:22016
    v_mfma_f32_16x16x32_bf16 v[180:183], v[16:19], v[56:59], v[180:183]
    ds_read_b64_tr_b16 v[32:33], v73 offset:22528
    ds_read_b64_tr_b16 v[34:35], v73 offset:23040
    v_mfma_f32_16x16x32_bf16 v[184:187], v[16:19], v[60:63], v[184:187]
    v_mfma_f32_16x16x32_bf16 v[188:191], v[16:19], v[64:67], v[188:191]
    s_waitcnt lgkmcnt(6)
    v_mfma_f32_16x16x32_bf16 v[192:195], v[20:23], v[52:55], v[192:195]
    v_mfma_f32_16x16x32_bf16 v[196:199], v[20:23], v[56:59], v[196:199]
    v_mfma_f32_16x16x32_bf16 v[200:203], v[20:23], v[60:63], v[200:203]
    v_mfma_f32_16x16x32_bf16 v[204:207], v[20:23], v[64:67], v[204:207]
L_cs_28_ret:
    s_waitcnt vmcnt(14) lgkmcnt(0)
    s_barrier
    s_cmp_eq_u32 s51, 0
    s_cbranch_scc1 L_cs_29
    v_mfma_f32_16x16x32_bf16 v[208:211], v[24:27], v[52:55], v[208:211]
    ds_read_b128 v[36:39], v80 offset:32768
    ds_read_b128 v[40:43], v80 offset:34816
    v_lshlrev_b32 v74, 16, v76
    v_mfma_f32_16x16x32_bf16 v[212:215], v[24:27], v[56:59], v[212:215]
    ds_read_b128 v[44:47], v80 offset:36864
    ds_read_b128 v[48:51], v80 offset:38912
    v_and_b32 v75, s87, v76
    v_mfma_f32_16x16x32_bf16 v[216:219], v[24:27], v[60:63], v[216:219]
    ds_read_b64_tr_b16 v[16:17], v68 offset:40960
    ds_read_b64_tr_b16 v[18:19], v68 offset:41472
    v_lshlrev_b32 v2, 16, v77
    v_mfma_f32_16x16x32_bf16 v[220:223], v[24:27], v[64:67], v[220:223]
    v_and_b32 v3, s87, v77
    v_mfma_f32_16x16x32_bf16 v[224:227], v[28:31], v[52:55], v[224:227]
    v_add_f32 v74, v74, v2
    v_mfma_f32_16x16x32_bf16 v[228:231], v[28:31], v[56:59], v[228:231]
    ds_read_b64_tr_b16 v[20:21], v69 offset:40960
    ds_read_b64_tr_b16 v[22:23], v69 offset:41472
    v_add_f32 v75, v75, v3
    v_mfma_f32_16x16x32_bf16 v[232:235], v[28:31], v[60:63], v[232:235]
    v_lshlrev_b32 v2, 16, v78
    v_mfma_f32_16x16x32_bf16 v[236:239], v[28:31], v[64:67], v[236:239]
    s_add_u32 m0, s44, 20480
    s_nop 0
    buffer_load_dwordx4 v82, s[12:15], s36 offen offset:0 lds
    s_add_u32 s36, s36, s40
    v_and_b32 v3, s87, v78
    v_mfma_f32_16x16x32_bf16 v[240:243], v[32:35], v[52:55], v[240:243]
    v_add_f32 v74, v74, v2
    v_mfma_f32_16x16x32_bf16 v[244:247], v[32:35], v[56:59], v[244:247]
    ds_read_b64_tr_b16 v[24:25], v70 offset:41984
    ds_read_b64_tr_b16 v[26:27], v70 offset:42496
    v_add_f32 v75, v75, v3
    v_mfma_f32_16x16x32_bf16 v[248:251], v[32:35], v[60:63], v[248:251]
    v_lshlrev_b32 v2, 16, v79
    v_mfma_f32_16x16x32_bf16 v[252:255], v[32:35], v[64:67], v[252:255]
    buffer_load_dwordx4 v83, s[16:19], s37 offen offset:1024 lds
    v_and_b32 v3, s87, v79
L_cs_29_ret:
    s_cmp_eq_u32 s51, 1
    s_cbranch_scc1 L_cs_30
    s_waitcnt lgkmcnt(4)
    v_mfma_f32_16x16x32_bf16 v[96:99], v[36:39], v[16:19], v[96:99]
    ds_read_b128 v[52:55], v81 offset:32768
    ds_read_b128 v[56:59], v81 offset:34816
    v_add_f32 v74, v74, v2
    v_mfma_f32_16x16x32_bf16 v[100:103], v[40:43], v[16:19], v[100:103]
    ds_read_b64_tr_b16 v[28:29], v70 offset:43008
    ds_read_b64_tr_b16 v[30:31], v70 offset:43520
    v_add_f32 v75, v75, v3
    v_mfma_f32_16x16x32_bf16 v[104:107], v[44:47], v[16:19], v[104:107]
    ds_read_b128 v[60:63], v81 offset:36864
    ds_read_b128 v[64:67], v81 offset:38912
    v_lshlrev_b32 v2, 16, v92
    v_mfma_f32_16x16x32_bf16 v[108:111], v[48:51], v[16:19], v[108:111]
    buffer_load_dwordx4 v83, s[20:23], s37 offen offset:2048 lds
    s_add_u32 s37, s37, s41
    v_and_b32 v3, s87, v92
    s_waitcnt lgkmcnt(8)
    v_mfma_f32_16x16x32_bf16 v[112:115], v[36:39], v[20:23], v[112:115]
    v_add_f32 v74, v74, v2
    v_mfma_f32_16x16x32_bf16 v[116:119], v[40:43], v[20:23], v[116:119]
    ds_read_b64_tr_b16 v[32:33], v71 offset:41984
    ds_read_b64_tr_b16 v[34:35], v71 offset:42496
    v_add_f32 v75, v75, v3
    v_mfma_f32_16x16x32_bf16 v[120:123], v[44:47], v[20:23], v[120:123]
    v_lshlrev_b32 v2, 16, v93
    v_mfma_f32_16x16x32_bf16 v[124:127], v[48:51], v[20:23], v[124:127]
    buffer_load_dwordx4 v84, s[24:27], s38 offen offset:3072 lds
    v_and_b32 v3, s87, v93
    s_waitcnt lgkmcnt(8)
    v_mfma_f32_16x16x32_bf16 v[128:131], v[24:27], v[36:39], v[128:131]
    v_add_f32 v74, v74, v2
    v_mfma_f32_16x16x32_bf16 v[132:135], v[24:27], v[40:43], v[132:135]
    ds_read_b64_tr_b16 v[16:17], v71 offset:43008
    ds_read_b64_tr_b16 v[18:19], v71 offset:43520
    v_add_f32 v75, v75, v3
    v_mfma_f32_16x16x32_bf16 v[136:139], v[24:27], v[44:47], v[136:139]
    v_lshlrev_b32 v2, 16, v94
    v_mfma_f32_16x16x32_bf16 v[140:143], v[24:27], v[48:51], v[140:143]
    s_add_u32 m0, s44, 24576
    s_nop 0
    buffer_load_dwordx4 v84, s[28:31], s38 offen offset:0 lds
    s_add_u32 s38, s38, s42
    v_and_b32 v3, s87, v94
L_cs_30_ret:
    s_cmp_eq_u32 s51, 2
    s_cbranch_scc1 L_cs_31
    s_waitcnt lgkmcnt(6)
    v_mfma_f32_16x16x32_bf16 v[144:147], v[28:31], v[36:39], v[144:147]
    v_add_f32 v74, v74, v2
    v_mfma_f32_16x16x32_bf16 v[148:151], v[28:31], v[40:43], v[148:151]
    ds_read_b64_tr_b16 v[20:21], v72 offset:41984
    ds_read_b64_tr_b16 v[22:23], v72 offset:42496
    v_add_f32 v75, v75, v3
    v_mfma_f32_16x16x32_bf16 v[152:155], v[28:31], v[44:47], v[152:155]
    v_lshlrev_b32 v2, 16, v95
    v_mfma_f32_16x16x32_bf16 v[156:159], v[28:31], v[48:51], v[156:159]
    v_and_b32 v3, s87, v95
    s_waitcnt lgkmcnt(4)
    v_mfma_f32_16x16x32_bf16 v[160:163], v[32:35], v[36:39], v[160:163]
    v_add_f32 v74, v74, v2
    v_mfma_f32_16x16x32_bf16 v[164:167], v[32:35], v[40:43], v[164:167]
    ds_read_b64_tr_b16 v[24:25], v72 offset:43008
    ds_read_b64_tr_b16 v[26:27], v72 offset:43520
    v_add_f32 v75, v75, v3
    v_mfma_f32_16x16x32_bf16 v[168:171], v[32:35], v[44:47], v[168:171]
    v_add_f32 v74, v74, v75
    v_mfma_f32_16x16x32_bf16 v[172:175], v[32:35], v[48:51], v[172:175]
    s_nop 1
    v_add_f32_dpp v74, v74, v74 row_ror:8 row_mask:0xf bank_mask:0xf
L_cs_31_ret:
    s_cmp_eq_u32 s51, 3
    s_cbranch_scc1 L_cs_32
    s_waitcnt lgkmcnt(4)
    v_mfma_f32_16x16x32_bf16 v[176:179], v[16:19], v[36:39], v[176:179]
    ds_read_b64_tr_b16 v[28:29], v73 offset:41984
    ds_read_b64_tr_b16 v[30:31], v73 offset:42496
    s_nop 1
    v_add_f32_dpp v74, v74, v74 row_ror:4 row_mask:0xf bank_mask:0xf
    v_mfma_f32_16x16x32_bf16 v[180:183], v[16:19], v[40:43], v[180:183]
    ds_read_b64_tr_b16 v[32:33], v73 offset:43008
    ds_read_b64_tr_b16 v[34:35], v73 offset:43520
    s_nop 1
    v_add_f32_dpp v74, v74, v74 row_ror:2 row_mask:0xf bank_mask:0xf
    v_mfma_f32_16x16x32_bf16 v[184:187], v[16:19], v[44:47], v[184:187]
    s_nop 1
    v_add_f32_dpp v74, v74, v74 row_ror:1 row_mask:0xf bank_mask:0xf
    v_mfma_f32_16x16x32_bf16 v[188:191], v[16:19], v[48:51], v[188:191]
    v_mov_b32 v2, v74
    s_waitcnt lgkmcnt(6)
    v_mfma_f32_16x16x32_bf16 v[192:195], v[20:23], v[36:39], v[192:195]
    s_nop 1
    v_permlane16_swap_b32 v74, v2
    v_mfma_f32_16x16x32_bf16 v[196:199], v[20:23], v[40:43], v[196:199]
    s_nop 1
    v_add_f32 v74, v74, v2
    v_mfma_f32_16x16x32_bf16 v[200:203], v[20:23], v[44:47], v[200:203]
    v_mov_b32 v2, v74
    v_mfma_f32_16x16x32_bf16 v[204:207], v[20:23], v[48:51], v[204:207]
    s_nop 1
    v_permlane32_swap_b32 v74, v2
L_cs_32_ret:
    s_waitcnt vmcnt(12) lgkmcnt(0)
    s_barrier
    s_cmp_eq_u32 s51, 0
    s_cbranch_scc1 L_cs_33
    v_mfma_f32_16x16x32_bf16 v[208:211], v[24:27], v[36:39], v[208:211]
    s_nop 1
    v_add_f32 v74, v74, v2
    v_mfma_f32_16x16x32_bf16 v[212:215], v[24:27], v[40:43], v[212:215]
    v_mul_f32 v74, 0x3a800000, v74
    v_mfma_f32_16x16x32_bf16 v[216:219], v[24:27], v[44:47], v[216:219]
    ds_read_b64_tr_b16 v[16:17], v68 offset:61440
    ds_read_b64_tr_b16 v[18:19], v68 offset:61952
    v_mov_b32 v75, 0
    v_mfma_f32_16x16x32_bf16 v[220:223], v[24:27], v[48:51], v[220:223]
    v_lshlrev_b32 v2, 16, v76
    v_mfma_f32_16x16x32_bf16 v[224:227], v[28:31], v[36:39], v[224:227]
    v_and_b32 v3, s87, v76
    v_mfma_f32_16x16x32_bf16 v[228:231], v[28:31], v[40:43], v[228:231]
    ds_read_b64_tr_b16 v[20:21], v69 offset:61440
    ds_read_b64_tr_b16 v[22:23], v69 offset:61952
    v_sub_f32 v2, v2, v74
    v_mfma_f32_16x16x32_bf16 v[232:235], v[28:31], v[44:47], v[232:235]
    v_sub_f32 v3, v3, v74
    v_mfma_f32_16x16x32_bf16 v[236:239], v[28:31], v[48:51], v[236:239]
    s_add_u32 m0, s44, 40960
    s_nop 0
    buffer_load_dwordx4 v82, s[12:15], s36 offen offset:0 lds
    s_add_u32 s36, s36, s40
    v_fma_f32 v75, v2, v2, v75
    v_mfma_f32_16x16x32_bf16 v[240:243], v[32:35], v[36:39], v[240:243]
    v_fma_f32 v75, v3, v3, v75
    v_mfma_f32_16x16x32_bf16 v[244:247], v[32:35], v[40:43], v[244:247]
    ds_read_b64_tr_b16 v[24:25], v70 offset:62464
    ds_read_b64_tr_b16 v[26:27], v70 offset:62976
    v_lshlrev_b32 v2, 16, v77
    v_mfma_f32_16x16x32_bf16 v[248:251], v[32:35], v[44:47], v[248:251]
    v_and_b32 v3, s87, v77
    v_mfma_f32_16x16x32_bf16 v[252:255], v[32:35], v[48:51], v[252:255]
    buffer_load_dwordx4 v83, s[16:19], s37 offen offset:1024 lds
    v_sub_f32 v2, v2, v74
L_cs_33_ret:
    s_cmp_eq_u32 s51, 1
    s_cbranch_scc1 L_cs_34
    s_waitcnt lgkmcnt(4)
    v_mfma_f32_16x16x32_bf16 v[96:99], v[52:55], v[16:19], v[96:99]
    v_sub_f32 v3, v3, v74
    v_mfma_f32_16x16x32_bf16 v[100:103], v[56:59], v[16:19], v[100:103]
    ds_read_b64_tr_b16 v[28:29], v70 offset:63488
    ds_read_b64_tr_b16 v[30:31], v70 offset:64000
    v_fma_f32 v75, v2, v2, v75
    v_mfma_f32_16x16x32_bf16 v[104:107], v[60:63], v[16:19], v[104:107]
    v_fma_f32 v75, v3, v3, v75
    v_mfma_f32_16x16x32_bf16 v[108:111], v[64:67], v[16:19], v[108:111]
    buffer_load_dwordx4 v83, s[20:23], s37 offen offset:2048 lds
    s_add_u32 s37, s37, s41
    v_lshlrev_b32 v2, 16, v78
    s_waitcnt lgkmcnt(4)
    v_mfma_f32_16x16x32_bf16 v[112:115], v[52:55], v[20:23], v[112:115]
    v_and_b32 v3, s87, v78
    v_mfma_f32_16x16x32_bf16 v[116:119], v[56:59], v[20:23], v[116:119]
    ds_read_b64_tr_b16 v[32:33], v71 offset:62464
    ds_read_b64_tr_b16 v[34:35], v71 offset:62976
    v_sub_f32 v2, v2, v74
    v_mfma_f32_16x16x32_bf16 v[120:123], v[60:63], v[20:23], v[120:123]
    v_sub_f32 v3, v3, v74
    v_mfma_f32_16x16x32_bf16 v[124:127], v[64:67], v[20:23], v[124:127]
    buffer_load_dwordx4 v84, s[24:27], s38 offen offset:3072 lds
    v_fma_f32 v75, v2, v2, v75
    s_waitcnt lgkmcnt(4)
    v_mfma_f32_16x16x32_bf16 v[128:131], v[24:27], v[52:55], v[128:131]
    v_fma_f32 v75, v3, v3, v75
    v_mfma_f32_16x16x32_bf16 v[132:135], v[24:27], v[56:59], v[132:135]
    ds_read_b64_tr_b16 v[16:17], v71 offset:63488
    ds_read_b64_tr_b16 v[18:19], v71 offset:64000
    v_lshlrev_b32 v2, 16, v79
    v_mfma_f32_16x16x32_bf16 v[136:139], v[24:27], v[60:63], v[136:139]
    v_and_b32 v3, s87, v79
    v_mfma_f32_16x16x32_bf16 v[140:143], v[24:27], v[64:67], v[140:143]
    s_add_u32 m0, s44, 45056
    s_nop 0
    buffer_load_dwordx4 v84, s[28:31], s38 offen offset:0 lds
    s_add_u32 s38, s38, s42
    v_sub_f32 v2, v2, v74
L_cs_34_ret:
    s_cmp_eq_u32 s51, 2
    s_cbranch_scc1 L_cs_35
    s_waitcnt lgkmcnt(4)
    v_mfma_f32_16x16x32_bf16 v[144:147], v[28:31], v[52:55], v[144:147]
    v_sub_f32 v3, v3, v74
    v_mfma_f32_16x16x32_bf16 v[148:151], v[28:31], v[56:59], v[148:151]
    ds_read_b64_tr_b16 v[20:21], v72 offset:62464
    ds_read_b64_tr_b16 v[22:23], v72 offset:62976
    v_fma_f32 v75, v2, v2, v75
    v_mfma_f32_16x16x32_bf16 v[152:155], v[28:31], v[60:63], v[152:155]
    v_fma_f32 v75, v3, v3, v75
    v_mfma_f32_16x16x32_bf16 v[156:159], v[28:31], v[64:67], v[156:159]
    v_lshlrev_b32 v2, 16, v92
    s_waitcnt lgkmcnt(4)
    v_mfma_f32_16x16x32_bf16 v[160:163], v[32:35], v[52:55], v[160:163]
    v_and_b32 v3, s87, v92
    v_mfma_f32_16x16x32_bf16 v[164:167], v[32:35], v[56:59], v[164:167]
    ds_read_b64_tr_b16 v[24:25], v72 offset:63488
    ds_read_b64_tr_b16 v[26:27], v72 offset:64000
    v_sub_f32 v2, v2, v74
    v_mfma_f32_16x16x32_bf16 v[168:171], v[32:35], v[60:63], v[168:171]
    v_sub_f32 v3, v3, v74
    v_mfma_f32_16x16x32_bf16 v[172:175], v[32:35], v[64:67], v[172:175]
    v_fma_f32 v75, v2, v2, v75
L_cs_35_ret:
    s_cmp_eq_u32 s51, 3
    s_cbranch_scc1 L_cs_36
    s_waitcnt lgkmcnt(4)
    v_mfma_f32_16x16x32_bf16 v[176:179], v[16:19], v[52:55], v[176:179]
    ds_read_b64_tr_b16 v[28:29], v73 offset:62464
    ds_read_b64_tr_b16 v[30:31], v73 offset:62976
    v_fma_f32 v75, v3, v3, v75
    v_mfma_f32_16x16x32_bf16 v[180:183], v[16:19], v[56:59], v[180:183]
    ds_read_b64_tr_b16 v[32:33], v73 offset:63488
    ds_read_b64_tr_b16 v[34:35], v73 offset:64000
    v_lshlrev_b32 v2, 16, v93
    v_mfma_f32_16x16x32_bf16 v[184:187], v[16:19], v[60:63], v[184:187]
    v_and_b32 v3, s87, v93
    v_mfma_f32_16x16x32_bf16 v[188:191], v[16:19], v[64:67], v[188:191]
    v_sub_f32 v2, v2, v74
    s_waitcnt lgkmcnt(6)
    v_mfma_f32_16x16x32_bf16 v[192:195], v[20:23], v[52:55], v[192:195]
    v_sub_f32 v3, v3, v74
    v_mfma_f32_16x16x32_bf16 v[196:199], v[20:23], v[56:59], v[196:199]
    v_fma_f32 v75, v2, v2, v75
    v_mfma_f32_16x16x32_bf16 v[200:203], v[20:23], v[60:63], v[200:203]
    v_fma_f32 v75, v3, v3, v75
    v_mfma_f32_16x16x32_bf16 v[204:207], v[20:23], v[64:67], v[204:207]
    v_lshlrev_b32 v2, 16, v94
L_cs_36_ret:
    s_waitcnt vmcnt(10) lgkmcnt(0)
    s_barrier
    s_mov_b64 exec, 1
    buffer_atomic_add v86, v87, s[88:91], s65 offen
    s_mov_b64 exec, -1
    buffer_load_dword v85, v87, s[88:91], s66 offen sc0 sc1
    s_cmp_eq_u32 s51, 0
    s_cbranch_scc1 L_cs_37
    v_mfma_f32_16x16x32_bf16 v[208:211], v[24:27], v[52:55], v[208:211]
    ds_read_b128 v[36:39], v80 offset:0
    ds_read_b128 v[40:43], v80 offset:2048
    v_and_b32 v3, s87, v94
    v_mfma_f32_16x16x32_bf16 v[212:215], v[24:27], v[56:59], v[212:215]
    ds_read_b128 v[44:47], v80 offset:4096
    ds_read_b128 v[48:51], v80 offset:6144
    v_sub_f32 v2, v2, v74
    v_mfma_f32_16x16x32_bf16 v[216:219], v[24:27], v[60:63], v[216:219]
    ds_read_b64_tr_b16 v[16:17], v68 offset:0
    ds_read_b64_tr_b16 v[18:19], v68 offset:512
    v_sub_f32 v3, v3, v74
    v_mfma_f32_16x16x32_bf16 v[220:223], v[24:27], v[64:67], v[220:223]
    v_fma_f32 v75, v2, v2, v75
    v_mfma_f32_16x16x32_bf16 v[224:227], v[28:31], v[52:55], v[224:227]
    v_fma_f32 v75, v3, v3, v75
    v_mfma_f32_16x16x32_bf16 v[228:231], v[28:31], v[56:59], v[228:231]
    ds_read_b64_tr_b16 v[20:21], v69 offset:0
    ds_read_b64_tr_b16 v[22:23], v69 offset:512
    v_lshlrev_b32 v2, 16, v95
    v_mfma_f32_16x16x32_bf16 v[232:235], v[28:31], v[60:63], v[232:235]
    v_and_b32 v3, s87, v95
    v_mfma_f32_16x16x32_bf16 v[236:239], v[28:31], v[64:67], v[236:239]
    s_add_u32 m0, s44, 61440
    s_nop 0
    buffer_load_dwordx4 v82, s[12:15], s36 offen offset:0 lds
    s_add_u32 s36, s36, s40
    v_sub_f32 v2, v2, v74
    v_mfma_f32_16x16x32_bf16 v[240:243], v[32:35], v[52:55], v[240:243]
    v_sub_f32 v3, v3, v74
    v_mfma_f32_16x16x32_bf16 v[244:247], v[32:35], v[56:59], v[244:247]
    ds_read_b64_tr_b16 v[24:25], v70 offset:1024
    ds_read_b64_tr_b16 v[26:27], v70 offset:1536
    v_fma_f32 v75, v2, v2, v75
    v_mfma_f32_16x16x32_bf16 v[248:251], v[32:35], v[60:63], v[248:251]
    v_fma_f32 v75, v3, v3, v75
    v_mfma_f32_16x16x32_bf16 v[252:255], v[32:35], v[64:67], v[252:255]
    buffer_load_dwordx4 v83, s[16:19], s37 offen offset:1024 lds
    s_nop 1
    v_add_f32_dpp v75, v75, v75 row_ror:8 row_mask:0xf bank_mask:0xf
L_cs_37_ret:
    s_cmp_eq_u32 s51, 1
    s_cbranch_scc1 L_cs_38
    s_waitcnt lgkmcnt(4)
    v_mfma_f32_16x16x32_bf16 v[96:99], v[36:39], v[16:19], v[96:99]
    ds_read_b128 v[52:55], v81 offset:0
    ds_read_b128 v[56:59], v81 offset:2048
    s_nop 1
    v_add_f32_dpp v75, v75, v75 row_ror:4 row_mask:0xf bank_mask:0xf
    v_mfma_f32_16x16x32_bf16 v[100:103], v[40:43], v[16:19], v[100:103]
    ds_read_b64_tr_b16 v[28:29], v70 offset:2048
    ds_read_b64_tr_b16 v[30:31], v70 offset:2560
    s_nop 1
    v_add_f32_dpp v75, v75, v75 row_ror:2 row_mask:0xf bank_mask:0xf
    v_mfma_f32_16x16x32_bf16 v[104:107], v[44:47], v[16:19], v[104:107]
    ds_read_b128 v[60:63], v81 offset:4096
    ds_read_b128 v[64:67], v81 offset:6144
    s_nop 1
    v_add_f32_dpp v75, v75, v75 row_ror:1 row_mask:0xf bank_mask:0xf
    v_mfma_f32_16x16x32_bf16 v[108:111], v[48:51], v[16:19], v[108:111]
    buffer_load_dwordx4 v83, s[20:23], s37 offen offset:2048 lds
    s_add_u32 s37, s37, s41
    v_mov_b32 v2, v75
    s_waitcnt lgkmcnt(8)
    v_mfma_f32_16x16x32_bf16 v[112:115], v[36:39], v[20:23], v[112:115]
    s_nop 1
    v_permlane16_swap_b32 v75, v2
    v_mfma_f32_16x16x32_bf16 v[116:119], v[40:43], v[20:23], v[116:119]
    ds_read_b64_tr_b16 v[32:33], v71 offset:1024
    ds_read_b64_tr_b16 v[34:35], v71 offset:1536
    s_nop 1
    v_add_f32 v75, v75, v2
    v_mfma_f32_16x16x32_bf16 v[120:123], v[44:47], v[20:23], v[120:123]
    v_mov_b32 v2, v75
    v_mfma_f32_16x16x32_bf16 v[124:127], v[48:51], v[20:23], v[124:127]
    buffer_load_dwordx4 v84, s[24:27], s38 offen offset:3072 lds
    s_nop 1
    v_permlane32_swap_b32 v75, v2
    s_waitcnt lgkmcnt(8)
    v_mfma_f32_16x16x32_bf16 v[128:131], v[24:27], v[36:39], v[128:131]
    s_nop 1
    v_add_f32 v75, v75, v2
    v_mfma_f32_16x16x32_bf16 v[132:135], v[24:27], v[40:43], v[132:135]
    ds_read_b64_tr_b16 v[16:17], v71 offset:2048
    ds_read_b64_tr_b16 v[18:19], v71 offset:2560
    v_mov_b32 v2, 0x3727c5ac
    v_mfma_f32_16x16x32_bf16 v[136:139], v[24:27], v[44:47], v[136:139]
    v_mov_b32 v3, 0x3a800000
    v_mfma_f32_16x16x32_bf16 v[140:143], v[24:27], v[48:51], v[140:143]
    s_add_u32 m0, s44, 65536
    s_nop 0
    buffer_load_dwordx4 v84, s[28:31], s38 offen offset:0 lds
    s_add_u32 s38, s38, s42
    v_fma_f32 v75, v75, v3, v2
L_cs_38_ret:
    s_cmp_eq_u32 s51, 2
    s_cbranch_scc1 L_cs_39
    s_waitcnt lgkmcnt(6)
    v_mfma_f32_16x16x32_bf16 v[144:147], v[28:31], v[36:39], v[144:147]
    s_nop 0
    v_rsq_f32 v75, v75
    v_mfma_f32_16x16x32_bf16 v[148:151], v[28:31], v[40:43], v[148:151]
    ds_read_b64_tr_b16 v[20:21], v72 offset:1024
    ds_read_b64_tr_b16 v[22:23], v72 offset:1536
    s_nop 0
    s_lshl_b32 s52, s51, 2
    s_lshr_b32 s52, 0x5307, s52
    s_and_b32 s52, s52, 15
    s_lshr_b32 s53, s51, 1
    s_sub_u32 s53, 3, s53
    v_lshrrev_b32 v76, 4, v1
    v_mfma_f32_16x16x32_bf16 v[152:155], v[28:31], v[44:47], v[152:155]
    v_cmp_gt_u32 vcc, s53, v76
    v_mfma_f32_16x16x32_bf16 v[156:159], v[28:31], v[48:51], v[156:159]
    v_add_u32 v76, s52, v76
    s_waitcnt lgkmcnt(4)
    v_mfma_f32_16x16x32_bf16 v[160:163], v[32:35], v[36:39], v[160:163]
    v_and_b32 v77, 15, v1
    v_mfma_f32_16x16x32_bf16 v[164:167], v[32:35], v[40:43], v[164:167]
    ds_read_b64_tr_b16 v[24:25], v72 offset:2048
    ds_read_b64_tr_b16 v[26:27], v72 offset:2560
    v_lshlrev_b32 v77, 2, v77
    v_mfma_f32_16x16x32_bf16 v[168:171], v[32:35], v[44:47], v[168:171]
    v_lshl_add_u32 v76, v76, 6, v77
    v_mfma_f32_16x16x32_bf16 v[172:175], v[32:35], v[48:51], v[172:175]
    v_mov_b32 v77, 2147418112
L_cs_39_ret:
    s_cmp_eq_u32 s51, 3
    s_cbranch_scc1 L_cs_40
    s_waitcnt lgkmcnt(4)
    v_mfma_f32_16x16x32_bf16 v[176:179], v[16:19], v[36:39], v[176:179]
    ds_read_b64_tr_b16 v[28:29], v73 offset:1024
    ds_read_b64_tr_b16 v[30:31], v73 offset:1536
    v_cndmask_b32 v76, v77, v76, vcc
    v_mfma_f32_16x16x32_bf16 v[180:183], v[16:19], v[40:43], v[180:183]
    ds_read_b64_tr_b16 v[32:33], v73 offset:2048
    ds_read_b64_tr_b16 v[34:35], v73 offset:2560
    v_cmp_eq_u32 vcc, 0, v1
    v_mfma_f32_16x16x32_bf16 v[184:187], v[16:19], v[44:47], v[184:187]
    s_and_b32 s52, s2, 31
    s_mul_i32 s52, s52, 10240
    s_mul_i32 s53, s48, 1280
    s_add_u32 s52, s52, s53
    s_mul_i32 s53, s50, 640
    s_add_u32 s52, s52, s53
    s_add_u32 s54, s52, 52498432
    v_cndmask_b32 v77, v77, v1, vcc
    v_mfma_f32_16x16x32_bf16 v[188:191], v[16:19], v[48:51], v[188:191]
    s_lshl_b32 s55, s2, 7
    s_lshl_b32 s53, s49, 3
    s_add_u32 s55, s55, s53
    s_add_u32 s55, s55, 52465664
    s_waitcnt lgkmcnt(6)
    v_mfma_f32_16x16x32_bf16 v[192:195], v[20:23], v[36:39], v[192:195]
    v_mfma_f32_16x16x32_bf16 v[196:199], v[20:23], v[40:43], v[196:199]
    v_mfma_f32_16x16x32_bf16 v[200:203], v[20:23], v[44:47], v[200:203]
    v_mfma_f32_16x16x32_bf16 v[204:207], v[20:23], v[48:51], v[204:207]
L_cs_40_ret:
    s_nop 7
    s_nop 7
    v_mov_b32_dpp v4, v8 quad_perm:[0,1,2,3] row_mask:0x2 bank_mask:0xf
    v_mov_b32_dpp v4, v12 quad_perm:[0,1,2,3] row_mask:0x4 bank_mask:0xf
    buffer_store_dwordx2 v[74:75], v77, s[32:35], s55 offen sc0 sc1
    buffer_store_dword v4, v76, s[32:35], s54 offen sc0 sc1
    s_cmp_eq_u32 s45, 5
    s_cselect_b32 s52, s60, 0
    s_sub_u32 s36, s36, s52
    s_cmp_eq_u32 s45, 5
    s_cselect_b32 s52, s61, 0
    s_sub_u32 s37, s37, s52
    s_cmp_eq_u32 s45, 5
    s_cselect_b32 s52, s62, 0
    s_sub_u32 s38, s38, s52
    s_cmp_eq_u32 s45, 5
    s_sub_u32 s45, s45, 1
    s_cmp_eq_u32 s45, s64
    s_cselect_b32 s65, s67, s86
    s_cmp_eq_u32 s45, 2
    s_cselect_b32 s66, s92, s86
    s_cmp_lg_u32 s45, 1
    s_waitcnt vmcnt(14) lgkmcnt(0)
    s_barrier
    s_branch L_g1_loop_W1
L_cs_25:
    v_mfma_f32_16x16x32_bf16 v[208:211], v[24:27], v[36:39], v[208:211]
    v_mfma_f32_16x16x32_bf16 v[212:215], v[24:27], v[40:43], v[212:215]
    v_mfma_f32_16x16x32_bf16 v[216:219], v[24:27], v[44:47], v[216:219]
    ds_read_b64_tr_b16 v[16:17], v68 offset:20480
    ds_read_b64_tr_b16 v[18:19], v68 offset:20992
    v_mfma_f32_16x16x32_bf16 v[220:223], v[24:27], v[48:51], v[220:223]
    v_mfma_f32_16x16x32_bf16 v[4:7], v[88:91], v[24:27], v[4:7]
    v_mfma_f32_16x16x32_bf16 v[224:227], v[28:31], v[36:39], v[224:227]
    v_mfma_f32_16x16x32_bf16 v[228:231], v[28:31], v[40:43], v[228:231]
    ds_read_b64_tr_b16 v[20:21], v69 offset:20480
    ds_read_b64_tr_b16 v[22:23], v69 offset:20992
    v_mfma_f32_16x16x32_bf16 v[232:235], v[28:31], v[44:47], v[232:235]
    v_mfma_f32_16x16x32_bf16 v[236:239], v[28:31], v[48:51], v[236:239]
    s_add_u32 m0, s44, 0
    s_nop 0
    buffer_load_dwordx4 v82, s[12:15], s36 offen offset:0 lds
    s_add_u32 s36, s36, s40
    v_mfma_f32_16x16x32_bf16 v[8:11], v[88:91], v[28:31], v[8:11]
    v_mfma_f32_16x16x32_bf16 v[240:243], v[32:35], v[36:39], v[240:243]
    v_mfma_f32_16x16x32_bf16 v[244:247], v[32:35], v[40:43], v[244:247]
    ds_read_b64_tr_b16 v[24:25], v70 offset:21504
    ds_read_b64_tr_b16 v[26:27], v70 offset:22016
    v_mfma_f32_16x16x32_bf16 v[248:251], v[32:35], v[44:47], v[248:251]
    v_mfma_f32_16x16x32_bf16 v[252:255], v[32:35], v[48:51], v[252:255]
    buffer_load_dwordx4 v83, s[16:19], s37 offen offset:1024 lds
    v_mfma_f32_16x16x32_bf16 v[12:15], v[88:91], v[32:35], v[12:15]
    s_branch L_cs_25_ret
L_cs_26:
    s_waitcnt lgkmcnt(4)
    v_mfma_f32_16x16x32_bf16 v[96:99], v[52:55], v[16:19], v[96:99]
    v_mfma_f32_16x16x32_bf16 v[100:103], v[56:59], v[16:19], v[100:103]
    ds_read_b64_tr_b16 v[28:29], v70 offset:22528
    ds_read_b64_tr_b16 v[30:31], v70 offset:23040
    v_mfma_f32_16x16x32_bf16 v[104:107], v[60:63], v[16:19], v[104:107]
    v_mfma_f32_16x16x32_bf16 v[108:111], v[64:67], v[16:19], v[108:111]
    buffer_load_dwordx4 v83, s[20:23], s37 offen offset:2048 lds
    s_add_u32 s37, s37, s41
    v_mfma_f32_16x16x32_bf16 v[4:7], v[88:91], v[16:19], v[4:7]
    s_waitcnt lgkmcnt(4)
    v_mfma_f32_16x16x32_bf16 v[112:115], v[52:55], v[20:23], v[112:115]
    v_mfma_f32_16x16x32_bf16 v[116:119], v[56:59], v[20:23], v[116:119]
    ds_read_b64_tr_b16 v[32:33], v71 offset:21504
    ds_read_b64_tr_b16 v[34:35], v71 offset:22016
    v_mfma_f32_16x16x32_bf16 v[120:123], v[60:63], v[20:23], v[120:123]
    v_mfma_f32_16x16x32_bf16 v[124:127], v[64:67], v[20:23], v[124:127]
    buffer_load_dwordx4 v84, s[24:27], s38 offen offset:3072 lds
    v_mfma_f32_16x16x32_bf16 v[8:11], v[88:91], v[20:23], v[8:11]
    s_waitcnt lgkmcnt(4)
    v_mfma_f32_16x16x32_bf16 v[128:131], v[24:27], v[52:55], v[128:131]
    v_mfma_f32_16x16x32_bf16 v[132:135], v[24:27], v[56:59], v[132:135]
    ds_read_b64_tr_b16 v[16:17], v71 offset:22528
    ds_read_b64_tr_b16 v[18:19], v71 offset:23040
    v_mfma_f32_16x16x32_bf16 v[136:139], v[24:27], v[60:63], v[136:139]
    v_mfma_f32_16x16x32_bf16 v[140:143], v[24:27], v[64:67], v[140:143]
    s_add_u32 m0, s44, 4096
    s_nop 0
    buffer_load_dwordx4 v84, s[28:31], s38 offen offset:0 lds
    s_add_u32 s38, s38, s42
    v_mfma_f32_16x16x32_bf16 v[12:15], v[88:91], v[24:27], v[12:15]
    s_branch L_cs_26_ret
L_cs_27:
    s_waitcnt lgkmcnt(4)
    v_mfma_f32_16x16x32_bf16 v[144:147], v[28:31], v[52:55], v[144:147]
    v_mfma_f32_16x16x32_bf16 v[148:151], v[28:31], v[56:59], v[148:151]
    ds_read_b64_tr_b16 v[20:21], v72 offset:21504
    ds_read_b64_tr_b16 v[22:23], v72 offset:22016
    v_mfma_f32_16x16x32_bf16 v[152:155], v[28:31], v[60:63], v[152:155]
    v_mfma_f32_16x16x32_bf16 v[156:159], v[28:31], v[64:67], v[156:159]
    v_mfma_f32_16x16x32_bf16 v[4:7], v[88:91], v[28:31], v[4:7]
    s_waitcnt lgkmcnt(4)
    v_mfma_f32_16x16x32_bf16 v[160:163], v[32:35], v[52:55], v[160:163]
    v_mfma_f32_16x16x32_bf16 v[164:167], v[32:35], v[56:59], v[164:167]
    ds_read_b64_tr_b16 v[24:25], v72 offset:22528
    ds_read_b64_tr_b16 v[26:27], v72 offset:23040
    v_mfma_f32_16x16x32_bf16 v[168:171], v[32:35], v[60:63], v[168:171]
    v_mfma_f32_16x16x32_bf16 v[172:175], v[32:35], v[64:67], v[172:175]
    v_mfma_f32_16x16x32_bf16 v[8:11], v[88:91], v[32:35], v[8:11]
    s_branch L_cs_27_ret
L_cs_28:
    s_waitcnt lgkmcnt(4)
    v_mfma_f32_16x16x32_bf16 v[176:179], v[16:19], v[52:55], v[176:179]
    ds_read_b64_tr_b16 v[28:29], v73 offset:21504
    ds_read_b64_tr_b16 v[30:31], v73 offset:22016
    v_mfma_f32_16x16x32_bf16 v[180:183], v[16:19], v[56:59], v[180:183]
    ds_read_b64_tr_b16 v[32:33], v73 offset:22528
    ds_read_b64_tr_b16 v[34:35], v73 offset:23040
    v_mfma_f32_16x16x32_bf16 v[184:187], v[16:19], v[60:63], v[184:187]
    v_mfma_f32_16x16x32_bf16 v[188:191], v[16:19], v[64:67], v[188:191]
    v_mfma_f32_16x16x32_bf16 v[4:7], v[88:91], v[16:19], v[4:7]
    s_waitcnt lgkmcnt(6)
    v_mfma_f32_16x16x32_bf16 v[192:195], v[20:23], v[52:55], v[192:195]
    v_mfma_f32_16x16x32_bf16 v[196:199], v[20:23], v[56:59], v[196:199]
    v_mfma_f32_16x16x32_bf16 v[200:203], v[20:23], v[60:63], v[200:203]
    v_mfma_f32_16x16x32_bf16 v[204:207], v[20:23], v[64:67], v[204:207]
    v_mfma_f32_16x16x32_bf16 v[8:11], v[88:91], v[20:23], v[8:11]
    s_branch L_cs_28_ret
L_cs_29:
    v_mfma_f32_16x16x32_bf16 v[208:211], v[24:27], v[52:55], v[208:211]
    ds_read_b128 v[36:39], v80 offset:32768
    ds_read_b128 v[40:43], v80 offset:34816
    v_lshlrev_b32 v74, 16, v76
    v_mfma_f32_16x16x32_bf16 v[212:215], v[24:27], v[56:59], v[212:215]
    ds_read_b128 v[44:47], v80 offset:36864
    ds_read_b128 v[48:51], v80 offset:38912
    v_and_b32 v75, s87, v76
    v_mfma_f32_16x16x32_bf16 v[216:219], v[24:27], v[60:63], v[216:219]
    ds_read_b64_tr_b16 v[16:17], v68 offset:40960
    ds_read_b64_tr_b16 v[18:19], v68 offset:41472
    v_lshlrev_b32 v2, 16, v77
    v_mfma_f32_16x16x32_bf16 v[220:223], v[24:27], v[64:67], v[220:223]
    v_mfma_f32_16x16x32_bf16 v[4:7], v[88:91], v[24:27], v[4:7]
    v_and_b32 v3, s87, v77
    v_mfma_f32_16x16x32_bf16 v[224:227], v[28:31], v[52:55], v[224:227]
    v_add_f32 v74, v74, v2
    v_mfma_f32_16x16x32_bf16 v[228:231], v[28:31], v[56:59], v[228:231]
    ds_read_b64_tr_b16 v[20:21], v69 offset:40960
    ds_read_b64_tr_b16 v[22:23], v69 offset:41472
    v_add_f32 v75, v75, v3
    v_mfma_f32_16x16x32_bf16 v[232:235], v[28:31], v[60:63], v[232:235]
    v_lshlrev_b32 v2, 16, v78
    v_mfma_f32_16x16x32_bf16 v[236:239], v[28:31], v[64:67], v[236:239]
    s_add_u32 m0, s44, 20480
    s_nop 0
    buffer_load_dwordx4 v82, s[12:15], s36 offen offset:0 lds
    s_add_u32 s36, s36, s40
    v_mfma_f32_16x16x32_bf16 v[8:11], v[88:91], v[28:31], v[8:11]
    v_and_b32 v3, s87, v78
    v_mfma_f32_16x16x32_bf16 v[240:243], v[32:35], v[52:55], v[240:243]
    v_add_f32 v74, v74, v2
    v_mfma_f32_16x16x32_bf16 v[244:247], v[32:35], v[56:59], v[244:247]
    ds_read_b64_tr_b16 v[24:25], v70 offset:41984
    ds_read_b64_tr_b16 v[26:27], v70 offset:42496
    v_add_f32 v75, v75, v3
    v_mfma_f32_16x16x32_bf16 v[248:251], v[32:35], v[60:63], v[248:251]
    v_lshlrev_b32 v2, 16, v79
    v_mfma_f32_16x16x32_bf16 v[252:255], v[32:35], v[64:67], v[252:255]
    buffer_load_dwordx4 v83, s[16:19], s37 offen offset:1024 lds
    v_mfma_f32_16x16x32_bf16 v[12:15], v[88:91], v[32:35], v[12:15]
    v_and_b32 v3, s87, v79
    s_branch L_cs_29_ret
L_cs_30:
    s_waitcnt lgkmcnt(4)
    v_mfma_f32_16x16x32_bf16 v[96:99], v[36:39], v[16:19], v[96:99]
    ds_read_b128 v[52:55], v81 offset:32768
    ds_read_b128 v[56:59], v81 offset:34816
    v_add_f32 v74, v74, v2
    v_mfma_f32_16x16x32_bf16 v[100:103], v[40:43], v[16:19], v[100:103]
    ds_read_b64_tr_b16 v[28:29], v70 offset:43008
    ds_read_b64_tr_b16 v[30:31], v70 offset:43520
    v_add_f32 v75, v75, v3
    v_mfma_f32_16x16x32_bf16 v[104:107], v[44:47], v[16:19], v[104:107]
    ds_read_b128 v[60:63], v81 offset:36864
    ds_read_b128 v[64:67], v81 offset:38912
    v_lshlrev_b32 v2, 16, v92
    v_mfma_f32_16x16x32_bf16 v[108:111], v[48:51], v[16:19], v[108:111]
    buffer_load_dwordx4 v83, s[20:23], s37 offen offset:2048 lds
    s_add_u32 s37, s37, s41
    v_mfma_f32_16x16x32_bf16 v[4:7], v[88:91], v[16:19], v[4:7]
    v_and_b32 v3, s87, v92
    s_waitcnt lgkmcnt(8)
    v_mfma_f32_16x16x32_bf16 v[112:115], v[36:39], v[20:23], v[112:115]
    v_add_f32 v74, v74, v2
    v_mfma_f32_16x16x32_bf16 v[116:119], v[40:43], v[20:23], v[116:119]
    ds_read_b64_tr_b16 v[32:33], v71 offset:41984
    ds_read_b64_tr_b16 v[34:35], v71 offset:42496
    v_add_f32 v75, v75, v3
    v_mfma_f32_16x16x32_bf16 v[120:123], v[44:47], v[20:23], v[120:123]
    v_lshlrev_b32 v2, 16, v93
    v_mfma_f32_16x16x32_bf16 v[124:127], v[48:51], v[20:23], v[124:127]
    buffer_load_dwordx4 v84, s[24:27], s38 offen offset:3072 lds
    v_mfma_f32_16x16x32_bf16 v[8:11], v[88:91], v[20:23], v[8:11]
    v_and_b32 v3, s87, v93
    s_waitcnt lgkmcnt(8)
    v_mfma_f32_16x16x32_bf16 v[128:131], v[24:27], v[36:39], v[128:131]
    v_add_f32 v74, v74, v2
    v_mfma_f32_16x16x32_bf16 v[132:135], v[24:27], v[40:43], v[132:135]
    ds_read_b64_tr_b16 v[16:17], v71 offset:43008
    ds_read_b64_tr_b16 v[18:19], v71 offset:43520
    v_add_f32 v75, v75, v3
    v_mfma_f32_16x16x32_bf16 v[136:139], v[24:27], v[44:47], v[136:139]
    v_lshlrev_b32 v2, 16, v94
    v_mfma_f32_16x16x32_bf16 v[140:143], v[24:27], v[48:51], v[140:143]
    s_add_u32 m0, s44, 24576
    s_nop 0
    buffer_load_dwordx4 v84, s[28:31], s38 offen offset:0 lds
    s_add_u32 s38, s38, s42
    v_mfma_f32_16x16x32_bf16 v[12:15], v[88:91], v[24:27], v[12:15]
    v_and_b32 v3, s87, v94
    s_branch L_cs_30_ret
L_cs_31:
    s_waitcnt lgkmcnt(6)
    v_mfma_f32_16x16x32_bf16 v[144:147], v[28:31], v[36:39], v[144:147]
    v_add_f32 v74, v74, v2
    v_mfma_f32_16x16x32_bf16 v[148:151], v[28:31], v[40:43], v[148:151]
    ds_read_b64_tr_b16 v[20:21], v72 offset:41984
    ds_read_b64_tr_b16 v[22:23], v72 offset:42496
    v_add_f32 v75, v75, v3
    v_mfma_f32_16x16x32_bf16 v[152:155], v[28:31], v[44:47], v[152:155]
    v_lshlrev_b32 v2, 16, v95
    v_mfma_f32_16x16x32_bf16 v[156:159], v[28:31], v[48:51], v[156:159]
    v_mfma_f32_16x16x32_bf16 v[4:7], v[88:91], v[28:31], v[4:7]
    v_and_b32 v3, s87, v95
    s_waitcnt lgkmcnt(4)
    v_mfma_f32_16x16x32_bf16 v[160:163], v[32:35], v[36:39], v[160:163]
    v_add_f32 v74, v74, v2
    v_mfma_f32_16x16x32_bf16 v[164:167], v[32:35], v[40:43], v[164:167]
    ds_read_b64_tr_b16 v[24:25], v72 offset:43008
    ds_read_b64_tr_b16 v[26:27], v72 offset:43520
    v_add_f32 v75, v75, v3
    v_mfma_f32_16x16x32_bf16 v[168:171], v[32:35], v[44:47], v[168:171]
    v_add_f32 v74, v74, v75
    v_mfma_f32_16x16x32_bf16 v[172:175], v[32:35], v[48:51], v[172:175]
    v_mfma_f32_16x16x32_bf16 v[8:11], v[88:91], v[32:35], v[8:11]
    s_nop 1
    v_add_f32_dpp v74, v74, v74 row_ror:8 row_mask:0xf bank_mask:0xf
    s_branch L_cs_31_ret
L_cs_32:
    s_waitcnt lgkmcnt(4)
    v_mfma_f32_16x16x32_bf16 v[176:179], v[16:19], v[36:39], v[176:179]
    ds_read_b64_tr_b16 v[28:29], v73 offset:41984
    ds_read_b64_tr_b16 v[30:31], v73 offset:42496
    s_nop 1
    v_add_f32_dpp v74, v74, v74 row_ror:4 row_mask:0xf bank_mask:0xf
    v_mfma_f32_16x16x32_bf16 v[180:183], v[16:19], v[40:43], v[180:183]
    ds_read_b64_tr_b16 v[32:33], v73 offset:43008
    ds_read_b64_tr_b16 v[34:35], v73 offset:43520
    s_nop 1
    v_add_f32_dpp v74, v74, v74 row_ror:2 row_mask:0xf bank_mask:0xf
    v_mfma_f32_16x16x32_bf16 v[184:187], v[16:19], v[44:47], v[184:187]
    s_nop 1
    v_add_f32_dpp v74, v74, v74 row_ror:1 row_mask:0xf bank_mask:0xf
    v_mfma_f32_16x16x32_bf16 v[188:191], v[16:19], v[48:51], v[188:191]
    v_mfma_f32_16x16x32_bf16 v[4:7], v[88:91], v[16:19], v[4:7]
    v_mov_b32 v2, v74
    s_waitcnt lgkmcnt(6)
    v_mfma_f32_16x16x32_bf16 v[192:195], v[20:23], v[36:39], v[192:195]
    s_nop 1
    v_permlane16_swap_b32 v74, v2
    v_mfma_f32_16x16x32_bf16 v[196:199], v[20:23], v[40:43], v[196:199]
    s_nop 1
    v_add_f32 v74, v74, v2
    v_mfma_f32_16x16x32_bf16 v[200:203], v[20:23], v[44:47], v[200:203]
    v_mov_b32 v2, v74
    v_mfma_f32_16x16x32_bf16 v[204:207], v[20:23], v[48:51], v[204:207]
    v_mfma_f32_16x16x32_bf16 v[8:11], v[88:91], v[20:23], v[8:11]
    s_nop 1
    v_permlane32_swap_b32 v74, v2
    s_branch L_cs_32_ret
L_cs_33:
    v_mfma_f32_16x16x32_bf16 v[208:211], v[24:27], v[36:39], v[208:211]
    s_nop 1
    v_add_f32 v74, v74, v2
    v_mfma_f32_16x16x32_bf16 v[212:215], v[24:27], v[40:43], v[212:215]
    v_mul_f32 v74, 0x3a800000, v74
    v_mfma_f32_16x16x32_bf16 v[216:219], v[24:27], v[44:47], v[216:219]
    ds_read_b64_tr_b16 v[16:17], v68 offset:61440
    ds_read_b64_tr_b16 v[18:19], v68 offset:61952
    v_mov_b32 v75, 0
    v_mfma_f32_16x16x32_bf16 v[220:223], v[24:27], v[48:51], v[220:223]
    v_mfma_f32_16x16x32_bf16 v[4:7], v[88:91], v[24:27], v[4:7]
    v_lshlrev_b32 v2, 16, v76
    v_mfma_f32_16x16x32_bf16 v[224:227], v[28:31], v[36:39], v[224:227]
    v_and_b32 v3, s87, v76
    v_mfma_f32_16x16x32_bf16 v[228:231], v[28:31], v[40:43], v[228:231]
    ds_read_b64_tr_b16 v[20:21], v69 offset:61440
    ds_read_b64_tr_b16 v[22:23], v69 offset:61952
    v_sub_f32 v2, v2, v74
    v_mfma_f32_16x16x32_bf16 v[232:235], v[28:31], v[44:47], v[232:235]
    v_sub_f32 v3, v3, v74
    v_mfma_f32_16x16x32_bf16 v[236:239], v[28:31], v[48:51], v[236:239]
    s_add_u32 m0, s44, 40960
    s_nop 0
    buffer_load_dwordx4 v82, s[12:15], s36 offen offset:0 lds
    s_add_u32 s36, s36, s40
    v_mfma_f32_16x16x32_bf16 v[8:11], v[88:91], v[28:31], v[8:11]
    v_fma_f32 v75, v2, v2, v75
    v_mfma_f32_16x16x32_bf16 v[240:243], v[32:35], v[36:39], v[240:243]
    v_fma_f32 v75, v3, v3, v75
    v_mfma_f32_16x16x32_bf16 v[244:247], v[32:35], v[40:43], v[244:247]
    ds_read_b64_tr_b16 v[24:25], v70 offset:62464
    ds_read_b64_tr_b16 v[26:27], v70 offset:62976
    v_lshlrev_b32 v2, 16, v77
    v_mfma_f32_16x16x32_bf16 v[248:251], v[32:35], v[44:47], v[248:251]
    v_and_b32 v3, s87, v77
    v_mfma_f32_16x16x32_bf16 v[252:255], v[32:35], v[48:51], v[252:255]
    buffer_load_dwordx4 v83, s[16:19], s37 offen offset:1024 lds
    v_mfma_f32_16x16x32_bf16 v[12:15], v[88:91], v[32:35], v[12:15]
    v_sub_f32 v2, v2, v74
    s_branch L_cs_33_ret
L_cs_34:
    s_waitcnt lgkmcnt(4)
    v_mfma_f32_16x16x32_bf16 v[96:99], v[52:55], v[16:19], v[96:99]
    v_sub_f32 v3, v3, v74
    v_mfma_f32_16x16x32_bf16 v[100:103], v[56:59], v[16:19], v[100:103]
    ds_read_b64_tr_b16 v[28:29], v70 offset:63488
    ds_read_b64_tr_b16 v[30:31], v70 offset:64000
    v_fma_f32 v75, v2, v2, v75
    v_mfma_f32_16x16x32_bf16 v[104:107], v[60:63], v[16:19], v[104:107]
    v_fma_f32 v75, v3, v3, v75
    v_mfma_f32_16x16x32_bf16 v[108:111], v[64:67], v[16:19], v[108:111]
    buffer_load_dwordx4 v83, s[20:23], s37 offen offset:2048 lds
    s_add_u32 s37, s37, s41
    v_mfma_f32_16x16x32_bf16 v[4:7], v[88:91], v[16:19], v[4:7]
    v_lshlrev_b32 v2, 16, v78
    s_waitcnt lgkmcnt(4)
    v_mfma_f32_16x16x32_bf16 v[112:115], v[52:55], v[20:23], v[112:115]
    v_and_b32 v3, s87, v78
    v_mfma_f32_16x16x32_bf16 v[116:119], v[56:59], v[20:23], v[116:119]
    ds_read_b64_tr_b16 v[32:33], v71 offset:62464
    ds_read_b64_tr_b16 v[34:35], v71 offset:62976
    v_sub_f32 v2, v2, v74
    v_mfma_f32_16x16x32_bf16 v[120:123], v[60:63], v[20:23], v[120:123]
    v_sub_f32 v3, v3, v74
    v_mfma_f32_16x16x32_bf16 v[124:127], v[64:67], v[20:23], v[124:127]
    buffer_load_dwordx4 v84, s[24:27], s38 offen offset:3072 lds
    v_mfma_f32_16x16x32_bf16 v[8:11], v[88:91], v[20:23], v[8:11]
    v_fma_f32 v75, v2, v2, v75
    s_waitcnt lgkmcnt(4)
    v_mfma_f32_16x16x32_bf16 v[128:131], v[24:27], v[52:55], v[128:131]
    v_fma_f32 v75, v3, v3, v75
    v_mfma_f32_16x16x32_bf16 v[132:135], v[24:27], v[56:59], v[132:135]
    ds_read_b64_tr_b16 v[16:17], v71 offset:63488
    ds_read_b64_tr_b16 v[18:19], v71 offset:64000
    v_lshlrev_b32 v2, 16, v79
    v_mfma_f32_16x16x32_bf16 v[136:139], v[24:27], v[60:63], v[136:139]
    v_and_b32 v3, s87, v79
    v_mfma_f32_16x16x32_bf16 v[140:143], v[24:27], v[64:67], v[140:143]
    s_add_u32 m0, s44, 45056
    s_nop 0
    buffer_load_dwordx4 v84, s[28:31], s38 offen offset:0 lds
    s_add_u32 s38, s38, s42
    v_mfma_f32_16x16x32_bf16 v[12:15], v[88:91], v[24:27], v[12:15]
    v_sub_f32 v2, v2, v74
    s_branch L_cs_34_ret
L_cs_35:
    s_waitcnt lgkmcnt(4)
    v_mfma_f32_16x16x32_bf16 v[144:147], v[28:31], v[52:55], v[144:147]
    v_sub_f32 v3, v3, v74
    v_mfma_f32_16x16x32_bf16 v[148:151], v[28:31], v[56:59], v[148:151]
    ds_read_b64_tr_b16 v[20:21], v72 offset:62464
    ds_read_b64_tr_b16 v[22:23], v72 offset:62976
    v_fma_f32 v75, v2, v2, v75
    v_mfma_f32_16x16x32_bf16 v[152:155], v[28:31], v[60:63], v[152:155]
    v_fma_f32 v75, v3, v3, v75
    v_mfma_f32_16x16x32_bf16 v[156:159], v[28:31], v[64:67], v[156:159]
    v_mfma_f32_16x16x32_bf16 v[4:7], v[88:91], v[28:31], v[4:7]
    v_lshlrev_b32 v2, 16, v92
    s_waitcnt lgkmcnt(4)
    v_mfma_f32_16x16x32_bf16 v[160:163], v[32:35], v[52:55], v[160:163]
    v_and_b32 v3, s87, v92
    v_mfma_f32_16x16x32_bf16 v[164:167], v[32:35], v[56:59], v[164:167]
    ds_read_b64_tr_b16 v[24:25], v72 offset:63488
    ds_read_b64_tr_b16 v[26:27], v72 offset:64000
    v_sub_f32 v2, v2, v74
    v_mfma_f32_16x16x32_bf16 v[168:171], v[32:35], v[60:63], v[168:171]
    v_sub_f32 v3, v3, v74
    v_mfma_f32_16x16x32_bf16 v[172:175], v[32:35], v[64:67], v[172:175]
    v_mfma_f32_16x16x32_bf16 v[8:11], v[88:91], v[32:35], v[8:11]
    v_fma_f32 v75, v2, v2, v75
    s_branch L_cs_35_ret
L_cs_36:
    s_waitcnt lgkmcnt(4)
    v_mfma_f32_16x16x32_bf16 v[176:179], v[16:19], v[52:55], v[176:179]
    ds_read_b64_tr_b16 v[28:29], v73 offset:62464
    ds_read_b64_tr_b16 v[30:31], v73 offset:62976
    v_fma_f32 v75, v3, v3, v75
    v_mfma_f32_16x16x32_bf16 v[180:183], v[16:19], v[56:59], v[180:183]
    ds_read_b64_tr_b16 v[32:33], v73 offset:63488
    ds_read_b64_tr_b16 v[34:35], v73 offset:64000
    v_lshlrev_b32 v2, 16, v93
    v_mfma_f32_16x16x32_bf16 v[184:187], v[16:19], v[60:63], v[184:187]
    v_and_b32 v3, s87, v93
    v_mfma_f32_16x16x32_bf16 v[188:191], v[16:19], v[64:67], v[188:191]
    v_mfma_f32_16x16x32_bf16 v[4:7], v[88:91], v[16:19], v[4:7]
    v_sub_f32 v2, v2, v74
    s_waitcnt lgkmcnt(6)
    v_mfma_f32_16x16x32_bf16 v[192:195], v[20:23], v[52:55], v[192:195]
    v_sub_f32 v3, v3, v74
    v_mfma_f32_16x16x32_bf16 v[196:199], v[20:23], v[56:59], v[196:199]
    v_fma_f32 v75, v2, v2, v75
    v_mfma_f32_16x16x32_bf16 v[200:203], v[20:23], v[60:63], v[200:203]
    v_fma_f32 v75, v3, v3, v75
    v_mfma_f32_16x16x32_bf16 v[204:207], v[20:23], v[64:67], v[204:207]
    v_mfma_f32_16x16x32_bf16 v[8:11], v[88:91], v[20:23], v[8:11]
    v_lshlrev_b32 v2, 16, v94
    s_branch L_cs_36_ret
L_cs_37:
    v_mfma_f32_16x16x32_bf16 v[208:211], v[24:27], v[52:55], v[208:211]
    ds_read_b128 v[36:39], v80 offset:0
    ds_read_b128 v[40:43], v80 offset:2048
    v_and_b32 v3, s87, v94
    v_mfma_f32_16x16x32_bf16 v[212:215], v[24:27], v[56:59], v[212:215]
    ds_read_b128 v[44:47], v80 offset:4096
    ds_read_b128 v[48:51], v80 offset:6144
    v_sub_f32 v2, v2, v74
    v_mfma_f32_16x16x32_bf16 v[216:219], v[24:27], v[60:63], v[216:219]
    ds_read_b64_tr_b16 v[16:17], v68 offset:0
    ds_read_b64_tr_b16 v[18:19], v68 offset:512
    v_sub_f32 v3, v3, v74
    v_mfma_f32_16x16x32_bf16 v[220:223], v[24:27], v[64:67], v[220:223]
    v_mfma_f32_16x16x32_bf16 v[4:7], v[88:91], v[24:27], v[4:7]
    v_fma_f32 v75, v2, v2, v75
    v_mfma_f32_16x16x32_bf16 v[224:227], v[28:31], v[52:55], v[224:227]
    v_fma_f32 v75, v3, v3, v75
    v_mfma_f32_16x16x32_bf16 v[228:231], v[28:31], v[56:59], v[228:231]
    ds_read_b64_tr_b16 v[20:21], v69 offset:0
    ds_read_b64_tr_b16 v[22:23], v69 offset:512
    v_lshlrev_b32 v2, 16, v95
    v_mfma_f32_16x16x32_bf16 v[232:235], v[28:31], v[60:63], v[232:235]
    v_and_b32 v3, s87, v95
    v_mfma_f32_16x16x32_bf16 v[236:239], v[28:31], v[64:67], v[236:239]
    s_add_u32 m0, s44, 61440
    s_nop 0
    buffer_load_dwordx4 v82, s[12:15], s36 offen offset:0 lds
    s_add_u32 s36, s36, s40
    v_mfma_f32_16x16x32_bf16 v[8:11], v[88:91], v[28:31], v[8:11]
    v_sub_f32 v2, v2, v74
    v_mfma_f32_16x16x32_bf16 v[240:243], v[32:35], v[52:55], v[240:243]
    v_sub_f32 v3, v3, v74
    v_mfma_f32_16x16x32_bf16 v[244:247], v[32:35], v[56:59], v[244:247]
    ds_read_b64_tr_b16 v[24:25], v70 offset:1024
    ds_read_b64_tr_b16 v[26:27], v70 offset:1536
    v_fma_f32 v75, v2, v2, v75
    v_mfma_f32_16x16x32_bf16 v[248:251], v[32:35], v[60:63], v[248:251]
    v_fma_f32 v75, v3, v3, v75
    v_mfma_f32_16x16x32_bf16 v[252:255], v[32:35], v[64:67], v[252:255]
    buffer_load_dwordx4 v83, s[16:19], s37 offen offset:1024 lds
    v_mfma_f32_16x16x32_bf16 v[12:15], v[88:91], v[32:35], v[12:15]
    s_nop 1
    v_add_f32_dpp v75, v75, v75 row_ror:8 row_mask:0xf bank_mask:0xf
    s_branch L_cs_37_ret
L_cs_38:
    s_waitcnt lgkmcnt(4)
    v_mfma_f32_16x16x32_bf16 v[96:99], v[36:39], v[16:19], v[96:99]
    ds_read_b128 v[52:55], v81 offset:0
    ds_read_b128 v[56:59], v81 offset:2048
    s_nop 1
    v_add_f32_dpp v75, v75, v75 row_ror:4 row_mask:0xf bank_mask:0xf
    v_mfma_f32_16x16x32_bf16 v[100:103], v[40:43], v[16:19], v[100:103]
    ds_read_b64_tr_b16 v[28:29], v70 offset:2048
    ds_read_b64_tr_b16 v[30:31], v70 offset:2560
    s_nop 1
    v_add_f32_dpp v75, v75, v75 row_ror:2 row_mask:0xf bank_mask:0xf
    v_mfma_f32_16x16x32_bf16 v[104:107], v[44:47], v[16:19], v[104:107]
    ds_read_b128 v[60:63], v81 offset:4096
    ds_read_b128 v[64:67], v81 offset:6144
    s_nop 1
    v_add_f32_dpp v75, v75, v75 row_ror:1 row_mask:0xf bank_mask:0xf
    v_mfma_f32_16x16x32_bf16 v[108:111], v[48:51], v[16:19], v[108:111]
    buffer_load_dwordx4 v83, s[20:23], s37 offen offset:2048 lds
    s_add_u32 s37, s37, s41
    v_mfma_f32_16x16x32_bf16 v[4:7], v[88:91], v[16:19], v[4:7]
    v_mov_b32 v2, v75
    s_waitcnt lgkmcnt(8)
    v_mfma_f32_16x16x32_bf16 v[112:115], v[36:39], v[20:23], v[112:115]
    s_nop 1
    v_permlane16_swap_b32 v75, v2
    v_mfma_f32_16x16x32_bf16 v[116:119], v[40:43], v[20:23], v[116:119]
    ds_read_b64_tr_b16 v[32:33], v71 offset:1024
    ds_read_b64_tr_b16 v[34:35], v71 offset:1536
    s_nop 1
    v_add_f32 v75, v75, v2
    v_mfma_f32_16x16x32_bf16 v[120:123], v[44:47], v[20:23], v[120:123]
    v_mov_b32 v2, v75
    v_mfma_f32_16x16x32_bf16 v[124:127], v[48:51], v[20:23], v[124:127]
    buffer_load_dwordx4 v84, s[24:27], s38 offen offset:3072 lds
    v_mfma_f32_16x16x32_bf16 v[8:11], v[88:91], v[20:23], v[8:11]
    s_nop 1
    v_permlane32_swap_b32 v75, v2
    s_waitcnt lgkmcnt(8)
    v_mfma_f32_16x16x32_bf16 v[128:131], v[24:27], v[36:39], v[128:131]
    s_nop 1
    v_add_f32 v75, v75, v2
    v_mfma_f32_16x16x32_bf16 v[132:135], v[24:27], v[40:43], v[132:135]
    ds_read_b64_tr_b16 v[16:17], v71 offset:2048
    ds_read_b64_tr_b16 v[18:19], v71 offset:2560
    v_mov_b32 v2, 0x3727c5ac
    v_mfma_f32_16x16x32_bf16 v[136:139], v[24:27], v[44:47], v[136:139]
    v_mov_b32 v3, 0x3a800000
    v_mfma_f32_16x16x32_bf16 v[140:143], v[24:27], v[48:51], v[140:143]
    s_add_u32 m0, s44, 65536
    s_nop 0
    buffer_load_dwordx4 v84, s[28:31], s38 offen offset:0 lds
    s_add_u32 s38, s38, s42
    v_mfma_f32_16x16x32_bf16 v[12:15], v[88:91], v[24:27], v[12:15]
    v_fma_f32 v75, v75, v3, v2
    s_branch L_cs_38_ret
L_cs_39:
    s_waitcnt lgkmcnt(6)
    v_mfma_f32_16x16x32_bf16 v[144:147], v[28:31], v[36:39], v[144:147]
    s_nop 0
    v_rsq_f32 v75, v75
    v_mfma_f32_16x16x32_bf16 v[148:151], v[28:31], v[40:43], v[148:151]
    ds_read_b64_tr_b16 v[20:21], v72 offset:1024
    ds_read_b64_tr_b16 v[22:23], v72 offset:1536
    s_nop 0
    s_lshl_b32 s52, s51, 2
    s_lshr_b32 s52, 0x5307, s52
    s_and_b32 s52, s52, 15
    s_lshr_b32 s53, s51, 1
    s_sub_u32 s53, 3, s53
    v_lshrrev_b32 v76, 4, v1
    v_mfma_f32_16x16x32_bf16 v[152:155], v[28:31], v[44:47], v[152:155]
    v_cmp_gt_u32 vcc, s53, v76
    v_mfma_f32_16x16x32_bf16 v[156:159], v[28:31], v[48:51], v[156:159]
    v_mfma_f32_16x16x32_bf16 v[4:7], v[88:91], v[28:31], v[4:7]
    v_add_u32 v76, s52, v76
    s_waitcnt lgkmcnt(4)
    v_mfma_f32_16x16x32_bf16 v[160:163], v[32:35], v[36:39], v[160:163]
    v_and_b32 v77, 15, v1
    v_mfma_f32_16x16x32_bf16 v[164:167], v[32:35], v[40:43], v[164:167]
    ds_read_b64_tr_b16 v[24:25], v72 offset:2048
    ds_read_b64_tr_b16 v[26:27], v72 offset:2560
    v_lshlrev_b32 v77, 2, v77
    v_mfma_f32_16x16x32_bf16 v[168:171], v[32:35], v[44:47], v[168:171]
    v_lshl_add_u32 v76, v76, 6, v77
    v_mfma_f32_16x16x32_bf16 v[172:175], v[32:35], v[48:51], v[172:175]
    v_mfma_f32_16x16x32_bf16 v[8:11], v[88:91], v[32:35], v[8:11]
    v_mov_b32 v77, 2147418112
    s_branch L_cs_39_ret
L_cs_40:
    s_waitcnt lgkmcnt(4)
    v_mfma_f32_16x16x32_bf16 v[176:179], v[16:19], v[36:39], v[176:179]
    ds_read_b64_tr_b16 v[28:29], v73 offset:1024
    ds_read_b64_tr_b16 v[30:31], v73 offset:1536
    v_cndmask_b32 v76, v77, v76, vcc
    v_mfma_f32_16x16x32_bf16 v[180:183], v[16:19], v[40:43], v[180:183]
    ds_read_b64_tr_b16 v[32:33], v73 offset:2048
    ds_read_b64_tr_b16 v[34:35], v73 offset:2560
    v_cmp_eq_u32 vcc, 0, v1
    v_mfma_f32_16x16x32_bf16 v[184:187], v[16:19], v[44:47], v[184:187]
    s_and_b32 s52, s2, 31
    s_mul_i32 s52, s52, 10240
    s_mul_i32 s53, s48, 1280
    s_add_u32 s52, s52, s53
    s_mul_i32 s53, s50, 640
    s_add_u32 s52, s52, s53
    s_add_u32 s54, s52, 52498432
    v_cndmask_b32 v77, v77, v1, vcc
    v_mfma_f32_16x16x32_bf16 v[188:191], v[16:19], v[48:51], v[188:191]
    v_mfma_f32_16x16x32_bf16 v[4:7], v[88:91], v[16:19], v[4:7]
    s_lshl_b32 s55, s2, 7
    s_lshl_b32 s53, s49, 3
    s_add_u32 s55, s55, s53
    s_add_u32 s55, s55, 52465664
    s_waitcnt lgkmcnt(6)
    v_mfma_f32_16x16x32_bf16 v[192:195], v[20:23], v[36:39], v[192:195]
    v_mfma_f32_16x16x32_bf16 v[196:199], v[20:23], v[40:43], v[196:199]
    v_mfma_f32_16x16x32_bf16 v[200:203], v[20:23], v[44:47], v[200:203]
    v_mfma_f32_16x16x32_bf16 v[204:207], v[20:23], v[48:51], v[204:207]
    v_mfma_f32_16x16x32_bf16 v[8:11], v[88:91], v[20:23], v[8:11]
    s_branch L_cs_40_ret
L_g1_roleX:
    s_sub_u32 s52, s49, 4
    s_lshl_b32 s44, s52, 13
    s_add_u32 s44, s44, 81920
    s_lshl_b32 s52, s52, 6
    s_lshl_b32 s53, s48, 8
    s_add_u32 s52, s52, s53
    s_lshl_b32 s36, s52, 11
    v_lshrrev_b32 v2, 3, v1
    v_and_b32 v3, 7, v1
    v_lshrrev_b32 v4, 1, v2
    v_xor_b32 v3, v3, v4
    v_lshlrev_b32 v3, 4, v3
    v_lshl_add_u32 v82, v2, 11, v3
    v_xor_b32 v3, 64, v82
    v_add_u32 v83, 15360, v3
    v_add_u32 v84, 30720, v82
    v_add_u32 v85, 46080, v3
    s_waitcnt lgkmcnt(0)
    s_mov_b32 s12, s100
    s_mov_b32 s13, s101
    s_mov_b32 s14, 4194304
    s_mov_b32 s15, 0x20000
    s_mov_b32 s32, s6
    s_mov_b32 s33, s7
    s_mov_b32 s34, 52826112
    s_mov_b32 s35, 0x20000
    s_cmp_eq_u32 s47, 0
    s_cbranch_scc1 L_g1_roleXV
    s_cmp_eq_u32 s47, 3
    s_cbranch_scc1 L_g1_roleXV
    s_and_b32 s52, s48, 1
    s_lshl_b32 s60, s52, 11
    s_lshr_b32 s53, s60, 1
    s_add_u32 s36, s36, s53
    s_add_u32 s37, s36, 65536
    s_add_u32 m0, s44, 0
    s_nop 0
    buffer_load_dwordx4 v82, s[12:15], s36 offen offset:0 lds
    buffer_load_dwordx4 v83, s[12:15], s36 offen offset:1024 lds
    buffer_load_dwordx4 v84, s[12:15], s36 offen offset:2048 lds
    buffer_load_dwordx4 v85, s[12:15], s36 offen offset:3072 lds
    s_add_u32 s36, s36, 128
    s_add_u32 m0, s44, 4096
    s_nop 0
    buffer_load_dwordx4 v82, s[12:15], s37 offen offset:0 lds
    buffer_load_dwordx4 v83, s[12:15], s37 offen offset:1024 lds
    buffer_load_dwordx4 v84, s[12:15], s37 offen offset:2048 lds
    buffer_load_dwordx4 v85, s[12:15], s37 offen offset:3072 lds
    s_add_u32 s37, s37, 128
    s_barrier
    s_add_u32 m0, s44, 32768
    s_nop 0
    buffer_load_dwordx4 v82, s[12:15], s36 offen offset:0 lds
    buffer_load_dwordx4 v83, s[12:15], s36 offen offset:1024 lds
    buffer_load_dwordx4 v84, s[12:15], s36 offen offset:2048 lds
    buffer_load_dwordx4 v85, s[12:15], s36 offen offset:3072 lds
    s_add_u32 s36, s36, 128
    s_add_u32 m0, s44, 36864
    s_nop 0
    buffer_load_dwordx4 v82, s[12:15], s37 offen offset:0 lds
    buffer_load_dwordx4 v83, s[12:15], s37 offen offset:1024 lds
    buffer_load_dwordx4 v84, s[12:15], s37 offen offset:2048 lds
    buffer_load_dwordx4 v85, s[12:15], s37 offen offset:3072 lds
    s_add_u32 s37, s37, 128
    s_lshl_b32 s52, s2, 2
    s_add_u32 s53, s52, 52429824
    s_add_u32 s52, s52, 52428800
    s_and_b32 s54, s2, 7
    s_lshl_b32 s54, s54, 7
    s_lshr_b32 s55, s2, 3
    s_lshl_b32 s55, s55, 2
    s_add_u32 s54, s54, s55
    s_add_u32 s54, s54, 52430848
    v_mov_b32 v8, s52
    v_mov_b32 v9, 0
    s_cmp_eq_u32 s49, 4
    s_cselect_b32 s55, 0, 2147418112
    v_writelane_b32 v8, s53, 1
    s_nop 1
    v_writelane_b32 v8, s54, 2
    s_nop 1
    s_mov_b64 exec, 7
    buffer_store_dword v9, v8, s[32:35], s55 offen sc0 sc1
    s_mov_b64 exec, -1
    s_mov_b32 s52, s100
    s_mov_b32 s53, s101
    s_mov_b32 s54, 4194304
    s_mov_b32 s55, 0x20000
    s_lshl_b32 s59, s2, 3
    s_add_u32 s59, s59, s49
    s_lshl_b32 s59, s59, 11
    buffer_load_dwordx4 v[76:79], v86, s[52:55], s59 offen
    buffer_load_dwordx4 v[92:95], v86, s[52:55], s59 offen offset:1024
    v_lshrrev_b32 v3, 4, v1
    v_bfe_u32 v4, v1, 2, 2
    v_and_b32 v5, 3, v1
    v_mul_u32_u24 v6, 5120, v3
    v_lshl_add_u32 v6, v4, 7, v6
    v_lshl_add_u32 v6, v5, 3, v6
    v_lshrrev_b32 v7, 1, v4
    v_lshlrev_b32 v7, 5, v7
    v_and_b32 v8, 1, v3
    v_lshl_or_b32 v7, v8, 6, v7
    s_lshl_b32 s52, s50, 6
    v_xor_b32 v8, s52, v7
    v_add_u32 v68, v6, v8
    v_xor_b32 v8, 32, v8
    v_add_u32 v69, v6, v8
    s_cmp_eq_u32 s47, 0
    s_cbranch_scc1 L_g1_taB_41
    s_lshl_b32 s52, s50, 11
    v_add_u32 v9, s52, v6
    v_xor_b32 v8, 0, v7
    v_add_u32 v70, v9, v8
    v_xor_b32 v8, 32, v7
    v_add_u32 v71, v9, v8
    v_xor_b32 v8, 64, v7
    v_add_u32 v72, v9, v8
    v_xor_b32 v8, 96, v7
    v_add_u32 v73, v9, v8
    s_branch L_g1_ta_done_42
L_g1_taB_41:
    v_mov_b32 v70, v68
    v_mov_b32 v71, v69
    v_add_u32 v72, 2048, v68
    v_add_u32 v73, 2048, v69
L_g1_ta_done_42:
    s_and_b32 s52, s49, 3
    s_lshl_b32 s53, s52, 13
    s_add_u32 s53, s53, 81920
    v_and_b32 v4, 15, v1
    v_lshrrev_b32 v5, 1, v4
    v_xor_b32 v5, v5, v3
    v_lshlrev_b32 v5, 4, v5
    v_lshl_add_u32 v5, v4, 7, v5
    v_add_u32 v80, s53, v5
    v_xor_b32 v81, 64, v80
    s_mov_b32 s51, s52
    s_lshr_b32 s52, s48, 1
    s_sub_u32 s63, 7, s52
    s_sub_u32 s64, 6, s52
    s_mov_b32 s86, 2147418112
    s_mov_b32 s87, 0xffff0000
    s_mov_b32 s65, 2147418112
    s_mov_b32 s66, 2147418112
    s_lshl_b32 s52, s48, 5
    s_cmp_eq_u32 s49, 0
    s_cselect_b32 s67, s52, s86
    s_cselect_b32 s92, 0, s86
    s_mov_b32 s88, s98
    s_mov_b32 s89, s99
    s_mov_b32 s90, 256
    s_mov_b32 s91, 0x20000
    v_and_b32 v87, 7, v1
    v_lshlrev_b32 v87, 5, v87
    v_mov_b32 v208, 0
    v_mov_b32 v209, 0
    v_mov_b32 v210, 0
    v_mov_b32 v211, 0
    v_mov_b32 v212, 0
    v_mov_b32 v213, 0
    v_mov_b32 v214, 0
    v_mov_b32 v215, 0
    v_mov_b32 v216, 0
    v_mov_b32 v217, 0
    v_mov_b32 v218, 0
    v_mov_b32 v219, 0
    v_mov_b32 v220, 0
    v_mov_b32 v221, 0
    v_mov_b32 v222, 0
    v_mov_b32 v223, 0
    v_mov_b32 v224, 0
    v_mov_b32 v225, 0
    v_mov_b32 v226, 0
    v_mov_b32 v227, 0
    v_mov_b32 v228, 0
    v_mov_b32 v229, 0
    v_mov_b32 v230, 0
    v_mov_b32 v231, 0
    v_mov_b32 v232, 0
    v_mov_b32 v233, 0
    v_mov_b32 v234, 0
    v_mov_b32 v235, 0
    v_mov_b32 v236, 0
    v_mov_b32 v237, 0
    v_mov_b32 v238, 0
    v_mov_b32 v239, 0
    v_mov_b32 v240, 0
    v_mov_b32 v241, 0
    v_mov_b32 v242, 0
    v_mov_b32 v243, 0
    v_mov_b32 v244, 0
    v_mov_b32 v245, 0
    v_mov_b32 v246, 0
    v_mov_b32 v247, 0
    v_mov_b32 v248, 0
    v_mov_b32 v249, 0
    v_mov_b32 v250, 0
    v_mov_b32 v251, 0
    v_mov_b32 v252, 0
    v_mov_b32 v253, 0
    v_mov_b32 v254, 0
    v_mov_b32 v255, 0
    v_mov_b32 v86, 1
    v_mov_b32 v4, 0
    v_mov_b32 v5, 0
    v_mov_b32 v6, 0
    v_mov_b32 v7, 0
    v_mov_b32 v8, 0
    v_mov_b32 v9, 0
    v_mov_b32 v10, 0
    v_mov_b32 v11, 0
    v_mov_b32 v12, 0
    v_mov_b32 v13, 0
    v_mov_b32 v14, 0
    v_mov_b32 v15, 0
    v_mov_b32 v88, 0x3f803f80
    v_mov_b32 v89, 0x3f803f80
    v_mov_b32 v90, 0x3f803f80
    v_mov_b32 v91, 0x3f803f80
    s_waitcnt vmcnt(11)
    s_barrier
    ds_read_b128 v[36:39], v80 offset:0
    ds_read_b128 v[40:43], v80 offset:2048
    ds_read_b128 v[44:47], v80 offset:4096
    ds_read_b128 v[48:51], v80 offset:6144
    ds_read_b64_tr_b16 v[16:17], v68 offset:0
    ds_read_b64_tr_b16 v[18:19], v68 offset:512
    ds_read_b64_tr_b16 v[20:21], v69 offset:0
    ds_read_b64_tr_b16 v[22:23], v69 offset:512
    ds_read_b64_tr_b16 v[24:25], v70 offset:1024
    ds_read_b64_tr_b16 v[26:27], v70 offset:1536
    s_waitcnt lgkmcnt(4)
    v_mfma_f32_16x16x32_bf16 v[96:99], v[16:19], v[36:39], 0
    ds_read_b128 v[52:55], v81 offset:0
    ds_read_b128 v[56:59], v81 offset:2048
    v_mfma_f32_16x16x32_bf16 v[100:103], v[16:19], v[40:43], 0
    ds_read_b64_tr_b16 v[28:29], v70 offset:2048
    ds_read_b64_tr_b16 v[30:31], v70 offset:2560
    v_mfma_f32_16x16x32_bf16 v[104:107], v[16:19], v[44:47], 0
    ds_read_b128 v[60:63], v81 offset:4096
    ds_read_b128 v[64:67], v81 offset:6144
    v_mfma_f32_16x16x32_bf16 v[108:111], v[16:19], v[48:51], 0
    s_waitcnt lgkmcnt(8)
    v_mfma_f32_16x16x32_bf16 v[112:115], v[20:23], v[36:39], 0
    v_mfma_f32_16x16x32_bf16 v[116:119], v[20:23], v[40:43], 0
    ds_read_b64_tr_b16 v[32:33], v71 offset:1024
    ds_read_b64_tr_b16 v[34:35], v71 offset:1536
    v_mfma_f32_16x16x32_bf16 v[120:123], v[20:23], v[44:47], 0
    v_mfma_f32_16x16x32_bf16 v[124:127], v[20:23], v[48:51], 0
    s_waitcnt lgkmcnt(8)
    v_mfma_f32_16x16x32_bf16 v[128:131], v[24:27], v[36:39], 0
    v_mfma_f32_16x16x32_bf16 v[132:135], v[24:27], v[40:43], 0
    ds_read_b64_tr_b16 v[16:17], v71 offset:2048
    ds_read_b64_tr_b16 v[18:19], v71 offset:2560
    v_mfma_f32_16x16x32_bf16 v[136:139], v[24:27], v[44:47], 0
    v_mfma_f32_16x16x32_bf16 v[140:143], v[24:27], v[48:51], 0
    s_waitcnt lgkmcnt(6)
    v_mfma_f32_16x16x32_bf16 v[144:147], v[28:31], v[36:39], 0
    v_mfma_f32_16x16x32_bf16 v[148:151], v[28:31], v[40:43], 0
    ds_read_b64_tr_b16 v[20:21], v72 offset:1024
    ds_read_b64_tr_b16 v[22:23], v72 offset:1536
    v_mfma_f32_16x16x32_bf16 v[152:155], v[28:31], v[44:47], 0
    v_mfma_f32_16x16x32_bf16 v[156:159], v[28:31], v[48:51], 0
    s_waitcnt lgkmcnt(4)
    v_mfma_f32_16x16x32_bf16 v[160:163], v[32:35], v[36:39], 0
    v_mfma_f32_16x16x32_bf16 v[164:167], v[32:35], v[40:43], 0
    ds_read_b64_tr_b16 v[24:25], v72 offset:2048
    ds_read_b64_tr_b16 v[26:27], v72 offset:2560
    v_mfma_f32_16x16x32_bf16 v[168:171], v[32:35], v[44:47], 0
    v_mfma_f32_16x16x32_bf16 v[172:175], v[32:35], v[48:51], 0
    s_waitcnt lgkmcnt(4)
    v_mfma_f32_16x16x32_bf16 v[176:179], v[16:19], v[36:39], 0
    ds_read_b64_tr_b16 v[28:29], v73 offset:1024
    ds_read_b64_tr_b16 v[30:31], v73 offset:1536
    v_mfma_f32_16x16x32_bf16 v[180:183], v[16:19], v[40:43], 0
    ds_read_b64_tr_b16 v[32:33], v73 offset:2048
    ds_read_b64_tr_b16 v[34:35], v73 offset:2560
    v_mfma_f32_16x16x32_bf16 v[184:187], v[16:19], v[44:47], 0
    v_mfma_f32_16x16x32_bf16 v[188:191], v[16:19], v[48:51], 0
    s_waitcnt lgkmcnt(6)
    v_mfma_f32_16x16x32_bf16 v[192:195], v[20:23], v[36:39], 0
    v_mfma_f32_16x16x32_bf16 v[196:199], v[20:23], v[40:43], 0
    v_mfma_f32_16x16x32_bf16 v[200:203], v[20:23], v[44:47], 0
    v_mfma_f32_16x16x32_bf16 v[204:207], v[20:23], v[48:51], 0
    buffer_store_dword v1, v1, s[32:35], s86 offen
    buffer_store_dword v1, v1, s[32:35], s86 offen
    s_waitcnt lgkmcnt(0)
    s_barrier
    s_mov_b32 s45, 7
    .p2align 6
L_g1_loop_X0:
    s_cmp_eq_u32 s45, s63
    s_cbranch_scc1 L_g1_spec_X0
    v_mfma_f32_16x16x32_bf16 v[208:211], v[24:27], v[36:39], v[208:211]
    v_mfma_f32_16x16x32_bf16 v[212:215], v[24:27], v[40:43], v[212:215]
    v_mfma_f32_16x16x32_bf16 v[216:219], v[24:27], v[44:47], v[216:219]
    ds_read_b64_tr_b16 v[16:17], v68 offset:20480
    ds_read_b64_tr_b16 v[18:19], v68 offset:20992
    v_mfma_f32_16x16x32_bf16 v[220:223], v[24:27], v[48:51], v[220:223]
    v_mfma_f32_16x16x32_bf16 v[224:227], v[28:31], v[36:39], v[224:227]
    v_mfma_f32_16x16x32_bf16 v[228:231], v[28:31], v[40:43], v[228:231]
    ds_read_b64_tr_b16 v[20:21], v69 offset:20480
    ds_read_b64_tr_b16 v[22:23], v69 offset:20992
    v_mfma_f32_16x16x32_bf16 v[232:235], v[28:31], v[44:47], v[232:235]
    v_mfma_f32_16x16x32_bf16 v[236:239], v[28:31], v[48:51], v[236:239]
    s_add_u32 m0, s44, 0
    s_nop 0
    buffer_load_dwordx4 v82, s[12:15], s36 offen offset:0 lds
    v_mfma_f32_16x16x32_bf16 v[240:243], v[32:35], v[36:39], v[240:243]
    v_mfma_f32_16x16x32_bf16 v[244:247], v[32:35], v[40:43], v[244:247]
    ds_read_b64_tr_b16 v[24:25], v70 offset:21504
    ds_read_b64_tr_b16 v[26:27], v70 offset:22016
    v_mfma_f32_16x16x32_bf16 v[248:251], v[32:35], v[44:47], v[248:251]
    v_mfma_f32_16x16x32_bf16 v[252:255], v[32:35], v[48:51], v[252:255]
    buffer_load_dwordx4 v83, s[12:15], s36 offen offset:1024 lds
    s_waitcnt lgkmcnt(4)
    v_mfma_f32_16x16x32_bf16 v[96:99], v[16:19], v[52:55], v[96:99]
    v_mfma_f32_16x16x32_bf16 v[100:103], v[16:19], v[56:59], v[100:103]
    ds_read_b64_tr_b16 v[28:29], v70 offset:22528
    ds_read_b64_tr_b16 v[30:31], v70 offset:23040
    v_mfma_f32_16x16x32_bf16 v[104:107], v[16:19], v[60:63], v[104:107]
    v_mfma_f32_16x16x32_bf16 v[108:111], v[16:19], v[64:67], v[108:111]
    buffer_load_dwordx4 v84, s[12:15], s36 offen offset:2048 lds
    s_waitcnt lgkmcnt(4)
    v_mfma_f32_16x16x32_bf16 v[112:115], v[20:23], v[52:55], v[112:115]
    v_mfma_f32_16x16x32_bf16 v[116:119], v[20:23], v[56:59], v[116:119]
    ds_read_b64_tr_b16 v[32:33], v71 offset:21504
    ds_read_b64_tr_b16 v[34:35], v71 offset:22016
    v_mfma_f32_16x16x32_bf16 v[120:123], v[20:23], v[60:63], v[120:123]
    v_mfma_f32_16x16x32_bf16 v[124:127], v[20:23], v[64:67], v[124:127]
    buffer_load_dwordx4 v85, s[12:15], s36 offen offset:3072 lds
    s_add_u32 s36, s36, 128
    s_waitcnt lgkmcnt(4)
    v_mfma_f32_16x16x32_bf16 v[128:131], v[24:27], v[52:55], v[128:131]
    v_mfma_f32_16x16x32_bf16 v[132:135], v[24:27], v[56:59], v[132:135]
    ds_read_b64_tr_b16 v[16:17], v71 offset:22528
    ds_read_b64_tr_b16 v[18:19], v71 offset:23040
    v_mfma_f32_16x16x32_bf16 v[136:139], v[24:27], v[60:63], v[136:139]
    v_mfma_f32_16x16x32_bf16 v[140:143], v[24:27], v[64:67], v[140:143]
    s_add_u32 m0, s44, 4096
    s_nop 0
    buffer_load_dwordx4 v82, s[12:15], s37 offen offset:0 lds
    s_waitcnt lgkmcnt(4)
    v_mfma_f32_16x16x32_bf16 v[144:147], v[28:31], v[52:55], v[144:147]
    v_mfma_f32_16x16x32_bf16 v[148:151], v[28:31], v[56:59], v[148:151]
    ds_read_b64_tr_b16 v[20:21], v72 offset:21504
    ds_read_b64_tr_b16 v[22:23], v72 offset:22016
    v_mfma_f32_16x16x32_bf16 v[152:155], v[28:31], v[60:63], v[152:155]
    v_mfma_f32_16x16x32_bf16 v[156:159], v[28:31], v[64:67], v[156:159]
    buffer_load_dwordx4 v83, s[12:15], s37 offen offset:1024 lds
    s_waitcnt lgkmcnt(4)
    v_mfma_f32_16x16x32_bf16 v[160:163], v[32:35], v[52:55], v[160:163]
    v_mfma_f32_16x16x32_bf16 v[164:167], v[32:35], v[56:59], v[164:167]
    ds_read_b64_tr_b16 v[24:25], v72 offset:22528
    ds_read_b64_tr_b16 v[26:27], v72 offset:23040
    v_mfma_f32_16x16x32_bf16 v[168:171], v[32:35], v[60:63], v[168:171]
    v_mfma_f32_16x16x32_bf16 v[172:175], v[32:35], v[64:67], v[172:175]
    buffer_load_dwordx4 v84, s[12:15], s37 offen offset:2048 lds
    s_waitcnt lgkmcnt(4)
    v_mfma_f32_16x16x32_bf16 v[176:179], v[16:19], v[52:55], v[176:179]
    ds_read_b64_tr_b16 v[28:29], v73 offset:21504
    ds_read_b64_tr_b16 v[30:31], v73 offset:22016
    v_mfma_f32_16x16x32_bf16 v[180:183], v[16:19], v[56:59], v[180:183]
    ds_read_b64_tr_b16 v[32:33], v73 offset:22528
    ds_read_b64_tr_b16 v[34:35], v73 offset:23040
    v_mfma_f32_16x16x32_bf16 v[184:187], v[16:19], v[60:63], v[184:187]
    v_mfma_f32_16x16x32_bf16 v[188:191], v[16:19], v[64:67], v[188:191]
    buffer_load_dwordx4 v85, s[12:15], s37 offen offset:3072 lds
    s_add_u32 s37, s37, 128
    s_waitcnt lgkmcnt(6)
    v_mfma_f32_16x16x32_bf16 v[192:195], v[20:23], v[52:55], v[192:195]
    v_mfma_f32_16x16x32_bf16 v[196:199], v[20:23], v[56:59], v[196:199]
    v_mfma_f32_16x16x32_bf16 v[200:203], v[20:23], v[60:63], v[200:203]
    v_mfma_f32_16x16x32_bf16 v[204:207], v[20:23], v[64:67], v[204:207]
    s_waitcnt vmcnt(10) lgkmcnt(0)
    s_barrier
    v_mfma_f32_16x16x32_bf16 v[208:211], v[24:27], v[52:55], v[208:211]
    ds_read_b128 v[36:39], v80 offset:32768
    ds_read_b128 v[40:43], v80 offset:34816
    v_mfma_f32_16x16x32_bf16 v[212:215], v[24:27], v[56:59], v[212:215]
    ds_read_b128 v[44:47], v80 offset:36864
    ds_read_b128 v[48:51], v80 offset:38912
    v_mfma_f32_16x16x32_bf16 v[216:219], v[24:27], v[60:63], v[216:219]
    ds_read_b64_tr_b16 v[16:17], v68 offset:40960
    ds_read_b64_tr_b16 v[18:19], v68 offset:41472
    v_mfma_f32_16x16x32_bf16 v[220:223], v[24:27], v[64:67], v[220:223]
    v_mfma_f32_16x16x32_bf16 v[224:227], v[28:31], v[52:55], v[224:227]
    v_mfma_f32_16x16x32_bf16 v[228:231], v[28:31], v[56:59], v[228:231]
    ds_read_b64_tr_b16 v[20:21], v69 offset:40960
    ds_read_b64_tr_b16 v[22:23], v69 offset:41472
    v_mfma_f32_16x16x32_bf16 v[232:235], v[28:31], v[60:63], v[232:235]
    v_mfma_f32_16x16x32_bf16 v[236:239], v[28:31], v[64:67], v[236:239]
    v_mfma_f32_16x16x32_bf16 v[240:243], v[32:35], v[52:55], v[240:243]
    v_mfma_f32_16x16x32_bf16 v[244:247], v[32:35], v[56:59], v[244:247]
    ds_read_b64_tr_b16 v[24:25], v70 offset:41984
    ds_read_b64_tr_b16 v[26:27], v70 offset:42496
    v_mfma_f32_16x16x32_bf16 v[248:251], v[32:35], v[60:63], v[248:251]
    v_mfma_f32_16x16x32_bf16 v[252:255], v[32:35], v[64:67], v[252:255]
    s_waitcnt lgkmcnt(4)
    v_mfma_f32_16x16x32_bf16 v[96:99], v[16:19], v[36:39], v[96:99]
    ds_read_b128 v[52:55], v81 offset:32768
    ds_read_b128 v[56:59], v81 offset:34816
    v_mfma_f32_16x16x32_bf16 v[100:103], v[16:19], v[40:43], v[100:103]
    ds_read_b64_tr_b16 v[28:29], v70 offset:43008
    ds_read_b64_tr_b16 v[30:31], v70 offset:43520
    v_mfma_f32_16x16x32_bf16 v[104:107], v[16:19], v[44:47], v[104:107]
    ds_read_b128 v[60:63], v81 offset:36864
    ds_read_b128 v[64:67], v81 offset:38912
    v_mfma_f32_16x16x32_bf16 v[108:111], v[16:19], v[48:51], v[108:111]
    s_waitcnt lgkmcnt(8)
    v_mfma_f32_16x16x32_bf16 v[112:115], v[20:23], v[36:39], v[112:115]
    v_mfma_f32_16x16x32_bf16 v[116:119], v[20:23], v[40:43], v[116:119]
    ds_read_b64_tr_b16 v[32:33], v71 offset:41984
    ds_read_b64_tr_b16 v[34:35], v71 offset:42496
    v_mfma_f32_16x16x32_bf16 v[120:123], v[20:23], v[44:47], v[120:123]
    v_mfma_f32_16x16x32_bf16 v[124:127], v[20:23], v[48:51], v[124:127]
    s_waitcnt lgkmcnt(8)
    v_mfma_f32_16x16x32_bf16 v[128:131], v[24:27], v[36:39], v[128:131]
    v_mfma_f32_16x16x32_bf16 v[132:135], v[24:27], v[40:43], v[132:135]
    ds_read_b64_tr_b16 v[16:17], v71 offset:43008
    ds_read_b64_tr_b16 v[18:19], v71 offset:43520
    v_mfma_f32_16x16x32_bf16 v[136:139], v[24:27], v[44:47], v[136:139]
    v_mfma_f32_16x16x32_bf16 v[140:143], v[24:27], v[48:51], v[140:143]
    s_waitcnt lgkmcnt(6)
    v_mfma_f32_16x16x32_bf16 v[144:147], v[28:31], v[36:39], v[144:147]
    v_mfma_f32_16x16x32_bf16 v[148:151], v[28:31], v[40:43], v[148:151]
    ds_read_b64_tr_b16 v[20:21], v72 offset:41984
    ds_read_b64_tr_b16 v[22:23], v72 offset:42496
    v_mfma_f32_16x16x32_bf16 v[152:155], v[28:31], v[44:47], v[152:155]
    v_mfma_f32_16x16x32_bf16 v[156:159], v[28:31], v[48:51], v[156:159]
    s_waitcnt lgkmcnt(4)
    v_mfma_f32_16x16x32_bf16 v[160:163], v[32:35], v[36:39], v[160:163]
    v_mfma_f32_16x16x32_bf16 v[164:167], v[32:35], v[40:43], v[164:167]
    ds_read_b64_tr_b16 v[24:25], v72 offset:43008
    ds_read_b64_tr_b16 v[26:27], v72 offset:43520
    v_mfma_f32_16x16x32_bf16 v[168:171], v[32:35], v[44:47], v[168:171]
    v_mfma_f32_16x16x32_bf16 v[172:175], v[32:35], v[48:51], v[172:175]
    s_waitcnt lgkmcnt(4)
    v_mfma_f32_16x16x32_bf16 v[176:179], v[16:19], v[36:39], v[176:179]
    ds_read_b64_tr_b16 v[28:29], v73 offset:41984
    ds_read_b64_tr_b16 v[30:31], v73 offset:42496
    v_mfma_f32_16x16x32_bf16 v[180:183], v[16:19], v[40:43], v[180:183]
    ds_read_b64_tr_b16 v[32:33], v73 offset:43008
    ds_read_b64_tr_b16 v[34:35], v73 offset:43520
    v_mfma_f32_16x16x32_bf16 v[184:187], v[16:19], v[44:47], v[184:187]
    v_mfma_f32_16x16x32_bf16 v[188:191], v[16:19], v[48:51], v[188:191]
    s_waitcnt lgkmcnt(6)
    v_mfma_f32_16x16x32_bf16 v[192:195], v[20:23], v[36:39], v[192:195]
    v_mfma_f32_16x16x32_bf16 v[196:199], v[20:23], v[40:43], v[196:199]
    v_mfma_f32_16x16x32_bf16 v[200:203], v[20:23], v[44:47], v[200:203]
    v_mfma_f32_16x16x32_bf16 v[204:207], v[20:23], v[48:51], v[204:207]
    s_waitcnt vmcnt(10) lgkmcnt(0)
    s_barrier
    v_mfma_f32_16x16x32_bf16 v[208:211], v[24:27], v[36:39], v[208:211]
    v_mfma_f32_16x16x32_bf16 v[212:215], v[24:27], v[40:43], v[212:215]
    v_mfma_f32_16x16x32_bf16 v[216:219], v[24:27], v[44:47], v[216:219]
    ds_read_b64_tr_b16 v[16:17], v68 offset:61440
    ds_read_b64_tr_b16 v[18:19], v68 offset:61952
    v_mfma_f32_16x16x32_bf16 v[220:223], v[24:27], v[48:51], v[220:223]
    v_mfma_f32_16x16x32_bf16 v[224:227], v[28:31], v[36:39], v[224:227]
    v_mfma_f32_16x16x32_bf16 v[228:231], v[28:31], v[40:43], v[228:231]
    ds_read_b64_tr_b16 v[20:21], v69 offset:61440
    ds_read_b64_tr_b16 v[22:23], v69 offset:61952
    v_mfma_f32_16x16x32_bf16 v[232:235], v[28:31], v[44:47], v[232:235]
    v_mfma_f32_16x16x32_bf16 v[236:239], v[28:31], v[48:51], v[236:239]
    s_add_u32 m0, s44, 32768
    s_nop 0
    buffer_load_dwordx4 v82, s[12:15], s36 offen offset:0 lds
    v_mfma_f32_16x16x32_bf16 v[240:243], v[32:35], v[36:39], v[240:243]
    v_mfma_f32_16x16x32_bf16 v[244:247], v[32:35], v[40:43], v[244:247]
    ds_read_b64_tr_b16 v[24:25], v70 offset:62464
    ds_read_b64_tr_b16 v[26:27], v70 offset:62976
    v_mfma_f32_16x16x32_bf16 v[248:251], v[32:35], v[44:47], v[248:251]
    v_mfma_f32_16x16x32_bf16 v[252:255], v[32:35], v[48:51], v[252:255]
    buffer_load_dwordx4 v83, s[12:15], s36 offen offset:1024 lds
    s_waitcnt lgkmcnt(4)
    v_mfma_f32_16x16x32_bf16 v[96:99], v[16:19], v[52:55], v[96:99]
    v_mfma_f32_16x16x32_bf16 v[100:103], v[16:19], v[56:59], v[100:103]
    ds_read_b64_tr_b16 v[28:29], v70 offset:63488
    ds_read_b64_tr_b16 v[30:31], v70 offset:64000
    v_mfma_f32_16x16x32_bf16 v[104:107], v[16:19], v[60:63], v[104:107]
    v_mfma_f32_16x16x32_bf16 v[108:111], v[16:19], v[64:67], v[108:111]
    buffer_load_dwordx4 v84, s[12:15], s36 offen offset:2048 lds
    s_waitcnt lgkmcnt(4)
    v_mfma_f32_16x16x32_bf16 v[112:115], v[20:23], v[52:55], v[112:115]
    v_mfma_f32_16x16x32_bf16 v[116:119], v[20:23], v[56:59], v[116:119]
    ds_read_b64_tr_b16 v[32:33], v71 offset:62464
    ds_read_b64_tr_b16 v[34:35], v71 offset:62976
    v_mfma_f32_16x16x32_bf16 v[120:123], v[20:23], v[60:63], v[120:123]
    v_mfma_f32_16x16x32_bf16 v[124:127], v[20:23], v[64:67], v[124:127]
    buffer_load_dwordx4 v85, s[12:15], s36 offen offset:3072 lds
    s_add_u32 s36, s36, 128
    s_waitcnt lgkmcnt(4)
    v_mfma_f32_16x16x32_bf16 v[128:131], v[24:27], v[52:55], v[128:131]
    v_mfma_f32_16x16x32_bf16 v[132:135], v[24:27], v[56:59], v[132:135]
    ds_read_b64_tr_b16 v[16:17], v71 offset:63488
    ds_read_b64_tr_b16 v[18:19], v71 offset:64000
    v_mfma_f32_16x16x32_bf16 v[136:139], v[24:27], v[60:63], v[136:139]
    v_mfma_f32_16x16x32_bf16 v[140:143], v[24:27], v[64:67], v[140:143]
    s_add_u32 m0, s44, 36864
    s_nop 0
    buffer_load_dwordx4 v82, s[12:15], s37 offen offset:0 lds
    s_waitcnt lgkmcnt(4)
    v_mfma_f32_16x16x32_bf16 v[144:147], v[28:31], v[52:55], v[144:147]
    v_mfma_f32_16x16x32_bf16 v[148:151], v[28:31], v[56:59], v[148:151]
    ds_read_b64_tr_b16 v[20:21], v72 offset:62464
    ds_read_b64_tr_b16 v[22:23], v72 offset:62976
    v_mfma_f32_16x16x32_bf16 v[152:155], v[28:31], v[60:63], v[152:155]
    v_mfma_f32_16x16x32_bf16 v[156:159], v[28:31], v[64:67], v[156:159]
    buffer_load_dwordx4 v83, s[12:15], s37 offen offset:1024 lds
    s_waitcnt lgkmcnt(4)
    v_mfma_f32_16x16x32_bf16 v[160:163], v[32:35], v[52:55], v[160:163]
    v_mfma_f32_16x16x32_bf16 v[164:167], v[32:35], v[56:59], v[164:167]
    ds_read_b64_tr_b16 v[24:25], v72 offset:63488
    ds_read_b64_tr_b16 v[26:27], v72 offset:64000
    v_mfma_f32_16x16x32_bf16 v[168:171], v[32:35], v[60:63], v[168:171]
    v_mfma_f32_16x16x32_bf16 v[172:175], v[32:35], v[64:67], v[172:175]
    buffer_load_dwordx4 v84, s[12:15], s37 offen offset:2048 lds
    s_waitcnt lgkmcnt(4)
    v_mfma_f32_16x16x32_bf16 v[176:179], v[16:19], v[52:55], v[176:179]
    ds_read_b64_tr_b16 v[28:29], v73 offset:62464
    ds_read_b64_tr_b16 v[30:31], v73 offset:62976
    v_mfma_f32_16x16x32_bf16 v[180:183], v[16:19], v[56:59], v[180:183]
    ds_read_b64_tr_b16 v[32:33], v73 offset:63488
    ds_read_b64_tr_b16 v[34:35], v73 offset:64000
    v_mfma_f32_16x16x32_bf16 v[184:187], v[16:19], v[60:63], v[184:187]
    v_mfma_f32_16x16x32_bf16 v[188:191], v[16:19], v[64:67], v[188:191]
    buffer_load_dwordx4 v85, s[12:15], s37 offen offset:3072 lds
    s_add_u32 s37, s37, 128
    s_waitcnt lgkmcnt(6)
    v_mfma_f32_16x16x32_bf16 v[192:195], v[20:23], v[52:55], v[192:195]
    v_mfma_f32_16x16x32_bf16 v[196:199], v[20:23], v[56:59], v[196:199]
    v_mfma_f32_16x16x32_bf16 v[200:203], v[20:23], v[60:63], v[200:203]
    v_mfma_f32_16x16x32_bf16 v[204:207], v[20:23], v[64:67], v[204:207]
    s_waitcnt vmcnt(8) lgkmcnt(0)
    s_barrier
    v_mfma_f32_16x16x32_bf16 v[208:211], v[24:27], v[52:55], v[208:211]
    ds_read_b128 v[36:39], v80 offset:0
    ds_read_b128 v[40:43], v80 offset:2048
    v_mfma_f32_16x16x32_bf16 v[212:215], v[24:27], v[56:59], v[212:215]
    ds_read_b128 v[44:47], v80 offset:4096
    ds_read_b128 v[48:51], v80 offset:6144
    v_mfma_f32_16x16x32_bf16 v[216:219], v[24:27], v[60:63], v[216:219]
    ds_read_b64_tr_b16 v[16:17], v68 offset:0
    ds_read_b64_tr_b16 v[18:19], v68 offset:512
    v_mfma_f32_16x16x32_bf16 v[220:223], v[24:27], v[64:67], v[220:223]
    v_mfma_f32_16x16x32_bf16 v[224:227], v[28:31], v[52:55], v[224:227]
    v_mfma_f32_16x16x32_bf16 v[228:231], v[28:31], v[56:59], v[228:231]
    ds_read_b64_tr_b16 v[20:21], v69 offset:0
    ds_read_b64_tr_b16 v[22:23], v69 offset:512
    v_mfma_f32_16x16x32_bf16 v[232:235], v[28:31], v[60:63], v[232:235]
    v_mfma_f32_16x16x32_bf16 v[236:239], v[28:31], v[64:67], v[236:239]
    v_mfma_f32_16x16x32_bf16 v[240:243], v[32:35], v[52:55], v[240:243]
    v_mfma_f32_16x16x32_bf16 v[244:247], v[32:35], v[56:59], v[244:247]
    ds_read_b64_tr_b16 v[24:25], v70 offset:1024
    ds_read_b64_tr_b16 v[26:27], v70 offset:1536
    v_mfma_f32_16x16x32_bf16 v[248:251], v[32:35], v[60:63], v[248:251]
    v_mfma_f32_16x16x32_bf16 v[252:255], v[32:35], v[64:67], v[252:255]
    s_waitcnt lgkmcnt(4)
    v_mfma_f32_16x16x32_bf16 v[96:99], v[16:19], v[36:39], v[96:99]
    ds_read_b128 v[52:55], v81 offset:0
    ds_read_b128 v[56:59], v81 offset:2048
    v_mfma_f32_16x16x32_bf16 v[100:103], v[16:19], v[40:43], v[100:103]
    ds_read_b64_tr_b16 v[28:29], v70 offset:2048
    ds_read_b64_tr_b16 v[30:31], v70 offset:2560
    v_mfma_f32_16x16x32_bf16 v[104:107], v[16:19], v[44:47], v[104:107]
    ds_read_b128 v[60:63], v81 offset:4096
    ds_read_b128 v[64:67], v81 offset:6144
    v_mfma_f32_16x16x32_bf16 v[108:111], v[16:19], v[48:51], v[108:111]
    s_waitcnt lgkmcnt(8)
    v_mfma_f32_16x16x32_bf16 v[112:115], v[20:23], v[36:39], v[112:115]
    v_mfma_f32_16x16x32_bf16 v[116:119], v[20:23], v[40:43], v[116:119]
    ds_read_b64_tr_b16 v[32:33], v71 offset:1024
    ds_read_b64_tr_b16 v[34:35], v71 offset:1536
    v_mfma_f32_16x16x32_bf16 v[120:123], v[20:23], v[44:47], v[120:123]
    v_mfma_f32_16x16x32_bf16 v[124:127], v[20:23], v[48:51], v[124:127]
    s_waitcnt lgkmcnt(8)
    v_mfma_f32_16x16x32_bf16 v[128:131], v[24:27], v[36:39], v[128:131]
    v_mfma_f32_16x16x32_bf16 v[132:135], v[24:27], v[40:43], v[132:135]
    ds_read_b64_tr_b16 v[16:17], v71 offset:2048
    ds_read_b64_tr_b16 v[18:19], v71 offset:2560
    v_mfma_f32_16x16x32_bf16 v[136:139], v[24:27], v[44:47], v[136:139]
    v_mfma_f32_16x16x32_bf16 v[140:143], v[24:27], v[48:51], v[140:143]
    s_waitcnt lgkmcnt(6)
    v_mfma_f32_16x16x32_bf16 v[144:147], v[28:31], v[36:39], v[144:147]
    v_mfma_f32_16x16x32_bf16 v[148:151], v[28:31], v[40:43], v[148:151]
    ds_read_b64_tr_b16 v[20:21], v72 offset:1024
    ds_read_b64_tr_b16 v[22:23], v72 offset:1536
    v_mfma_f32_16x16x32_bf16 v[152:155], v[28:31], v[44:47], v[152:155]
    v_mfma_f32_16x16x32_bf16 v[156:159], v[28:31], v[48:51], v[156:159]
    s_waitcnt lgkmcnt(4)
    v_mfma_f32_16x16x32_bf16 v[160:163], v[32:35], v[36:39], v[160:163]
    v_mfma_f32_16x16x32_bf16 v[164:167], v[32:35], v[40:43], v[164:167]
    ds_read_b64_tr_b16 v[24:25], v72 offset:2048
    ds_read_b64_tr_b16 v[26:27], v72 offset:2560
    v_mfma_f32_16x16x32_bf16 v[168:171], v[32:35], v[44:47], v[168:171]
    v_mfma_f32_16x16x32_bf16 v[172:175], v[32:35], v[48:51], v[172:175]
    s_waitcnt lgkmcnt(4)
    v_mfma_f32_16x16x32_bf16 v[176:179], v[16:19], v[36:39], v[176:179]
    ds_read_b64_tr_b16 v[28:29], v73 offset:1024
    ds_read_b64_tr_b16 v[30:31], v73 offset:1536
    v_mfma_f32_16x16x32_bf16 v[180:183], v[16:19], v[40:43], v[180:183]
    ds_read_b64_tr_b16 v[32:33], v73 offset:2048
    ds_read_b64_tr_b16 v[34:35], v73 offset:2560
    v_mfma_f32_16x16x32_bf16 v[184:187], v[16:19], v[44:47], v[184:187]
    v_mfma_f32_16x16x32_bf16 v[188:191], v[16:19], v[48:51], v[188:191]
    s_waitcnt lgkmcnt(6)
    v_mfma_f32_16x16x32_bf16 v[192:195], v[20:23], v[36:39], v[192:195]
    v_mfma_f32_16x16x32_bf16 v[196:199], v[20:23], v[40:43], v[196:199]
    v_mfma_f32_16x16x32_bf16 v[200:203], v[20:23], v[44:47], v[200:203]
    v_mfma_f32_16x16x32_bf16 v[204:207], v[20:23], v[48:51], v[204:207]
    buffer_store_dword v1, v1, s[32:35], s86 offen
    buffer_store_dword v1, v1, s[32:35], s86 offen
    s_cmp_eq_u32 s45, 5
    s_cselect_b32 s52, s60, 0
    s_sub_u32 s36, s36, s52
    s_cmp_eq_u32 s45, 5
    s_cselect_b32 s52, s60, 0
    s_sub_u32 s37, s37, s52
    s_cmp_eq_u32 s45, 5
    s_sub_u32 s45, s45, 1
    s_cmp_lg_u32 s45, 1
    s_waitcnt vmcnt(10) lgkmcnt(0)
    s_barrier
    s_cbranch_scc1 L_g1_loop_X0
L_g1_lastit_X0:
    v_mfma_f32_16x16x32_bf16 v[208:211], v[24:27], v[36:39], v[208:211]
    v_mfma_f32_16x16x32_bf16 v[212:215], v[24:27], v[40:43], v[212:215]
    v_mfma_f32_16x16x32_bf16 v[216:219], v[24:27], v[44:47], v[216:219]
    ds_read_b64_tr_b16 v[16:17], v68 offset:20480
    ds_read_b64_tr_b16 v[18:19], v68 offset:20992
    v_mfma_f32_16x16x32_bf16 v[220:223], v[24:27], v[48:51], v[220:223]
    v_mfma_f32_16x16x32_bf16 v[224:227], v[28:31], v[36:39], v[224:227]
    v_mfma_f32_16x16x32_bf16 v[228:231], v[28:31], v[40:43], v[228:231]
    ds_read_b64_tr_b16 v[20:21], v69 offset:20480
    ds_read_b64_tr_b16 v[22:23], v69 offset:20992
    v_mfma_f32_16x16x32_bf16 v[232:235], v[28:31], v[44:47], v[232:235]
    v_mfma_f32_16x16x32_bf16 v[236:239], v[28:31], v[48:51], v[236:239]
    s_add_u32 m0, s44, 0
    s_nop 0
    buffer_load_dwordx4 v82, s[12:15], s36 offen offset:0 lds
    v_mfma_f32_16x16x32_bf16 v[240:243], v[32:35], v[36:39], v[240:243]
    v_mfma_f32_16x16x32_bf16 v[244:247], v[32:35], v[40:43], v[244:247]
    ds_read_b64_tr_b16 v[24:25], v70 offset:21504
    ds_read_b64_tr_b16 v[26:27], v70 offset:22016
    v_mfma_f32_16x16x32_bf16 v[248:251], v[32:35], v[44:47], v[248:251]
    v_mfma_f32_16x16x32_bf16 v[252:255], v[32:35], v[48:51], v[252:255]
    buffer_load_dwordx4 v83, s[12:15], s36 offen offset:1024 lds
    s_waitcnt lgkmcnt(4)
    v_mfma_f32_16x16x32_bf16 v[96:99], v[16:19], v[52:55], v[96:99]
    v_mfma_f32_16x16x32_bf16 v[100:103], v[16:19], v[56:59], v[100:103]
    ds_read_b64_tr_b16 v[28:29], v70 offset:22528
    ds_read_b64_tr_b16 v[30:31], v70 offset:23040
    v_mfma_f32_16x16x32_bf16 v[104:107], v[16:19], v[60:63], v[104:107]
    v_mfma_f32_16x16x32_bf16 v[108:111], v[16:19], v[64:67], v[108:111]
    buffer_load_dwordx4 v84, s[12:15], s36 offen offset:2048 lds
    s_waitcnt lgkmcnt(4)
    v_mfma_f32_16x16x32_bf16 v[112:115], v[20:23], v[52:55], v[112:115]
    v_mfma_f32_16x16x32_bf16 v[116:119], v[20:23], v[56:59], v[116:119]
    ds_read_b64_tr_b16 v[32:33], v71 offset:21504
    ds_read_b64_tr_b16 v[34:35], v71 offset:22016
    v_mfma_f32_16x16x32_bf16 v[120:123], v[20:23], v[60:63], v[120:123]
    v_mfma_f32_16x16x32_bf16 v[124:127], v[20:23], v[64:67], v[124:127]
    buffer_load_dwordx4 v85, s[12:15], s36 offen offset:3072 lds
    s_add_u32 s36, s36, 128
    s_waitcnt lgkmcnt(4)
    v_mfma_f32_16x16x32_bf16 v[128:131], v[24:27], v[52:55], v[128:131]
    v_mfma_f32_16x16x32_bf16 v[132:135], v[24:27], v[56:59], v[132:135]
    ds_read_b64_tr_b16 v[16:17], v71 offset:22528
    ds_read_b64_tr_b16 v[18:19], v71 offset:23040
    v_mfma_f32_16x16x32_bf16 v[136:139], v[24:27], v[60:63], v[136:139]
    v_mfma_f32_16x16x32_bf16 v[140:143], v[24:27], v[64:67], v[140:143]
    s_add_u32 m0, s44, 4096
    s_nop 0
    buffer_load_dwordx4 v82, s[12:15], s37 offen offset:0 lds
    s_waitcnt lgkmcnt(4)
    v_mfma_f32_16x16x32_bf16 v[144:147], v[28:31], v[52:55], v[144:147]
    v_mfma_f32_16x16x32_bf16 v[148:151], v[28:31], v[56:59], v[148:151]
    ds_read_b64_tr_b16 v[20:21], v72 offset:21504
    ds_read_b64_tr_b16 v[22:23], v72 offset:22016
    v_mfma_f32_16x16x32_bf16 v[152:155], v[28:31], v[60:63], v[152:155]
    v_mfma_f32_16x16x32_bf16 v[156:159], v[28:31], v[64:67], v[156:159]
    buffer_load_dwordx4 v83, s[12:15], s37 offen offset:1024 lds
    s_waitcnt lgkmcnt(4)
    v_mfma_f32_16x16x32_bf16 v[160:163], v[32:35], v[52:55], v[160:163]
    v_mfma_f32_16x16x32_bf16 v[164:167], v[32:35], v[56:59], v[164:167]
    ds_read_b64_tr_b16 v[24:25], v72 offset:22528
    ds_read_b64_tr_b16 v[26:27], v72 offset:23040
    v_mfma_f32_16x16x32_bf16 v[168:171], v[32:35], v[60:63], v[168:171]
    v_mfma_f32_16x16x32_bf16 v[172:175], v[32:35], v[64:67], v[172:175]
    buffer_load_dwordx4 v84, s[12:15], s37 offen offset:2048 lds
    s_waitcnt lgkmcnt(4)
    v_mfma_f32_16x16x32_bf16 v[176:179], v[16:19], v[52:55], v[176:179]
    ds_read_b64_tr_b16 v[28:29], v73 offset:21504
    ds_read_b64_tr_b16 v[30:31], v73 offset:22016
    v_mfma_f32_16x16x32_bf16 v[180:183], v[16:19], v[56:59], v[180:183]
    ds_read_b64_tr_b16 v[32:33], v73 offset:22528
    ds_read_b64_tr_b16 v[34:35], v73 offset:23040
    v_mfma_f32_16x16x32_bf16 v[184:187], v[16:19], v[60:63], v[184:187]
    v_mfma_f32_16x16x32_bf16 v[188:191], v[16:19], v[64:67], v[188:191]
    buffer_load_dwordx4 v85, s[12:15], s37 offen offset:3072 lds
    s_add_u32 s37, s37, 128
    s_waitcnt lgkmcnt(6)
    v_mfma_f32_16x16x32_bf16 v[192:195], v[20:23], v[52:55], v[192:195]
    v_mfma_f32_16x16x32_bf16 v[196:199], v[20:23], v[56:59], v[196:199]
    v_mfma_f32_16x16x32_bf16 v[200:203], v[20:23], v[60:63], v[200:203]
    v_mfma_f32_16x16x32_bf16 v[204:207], v[20:23], v[64:67], v[204:207]
    s_waitcnt vmcnt(10) lgkmcnt(0)
    s_barrier
    v_mfma_f32_16x16x32_bf16 v[208:211], v[24:27], v[52:55], v[208:211]
    ds_read_b128 v[36:39], v80 offset:32768
    ds_read_b128 v[40:43], v80 offset:34816
    s_lshl_b32 s52, s49, 6
    v_add_u32 v4, s52, v1
    v_mfma_f32_16x16x32_bf16 v[212:215], v[24:27], v[56:59], v[212:215]
    ds_read_b128 v[44:47], v80 offset:36864
    ds_read_b128 v[48:51], v80 offset:38912
    v_lshrrev_b32 v5, 3, v4
    v_mfma_f32_16x16x32_bf16 v[216:219], v[24:27], v[60:63], v[216:219]
    ds_read_b64_tr_b16 v[16:17], v68 offset:40960
    ds_read_b64_tr_b16 v[18:19], v68 offset:41472
    v_lshlrev_b32 v5, 7, v5
    v_mfma_f32_16x16x32_bf16 v[220:223], v[24:27], v[64:67], v[220:223]
    v_and_b32 v6, 7, v1
    v_mfma_f32_16x16x32_bf16 v[224:227], v[28:31], v[52:55], v[224:227]
    v_lshl_add_u32 v5, v6, 3, v5
    v_mfma_f32_16x16x32_bf16 v[228:231], v[28:31], v[56:59], v[228:231]
    ds_read_b64_tr_b16 v[20:21], v69 offset:40960
    ds_read_b64_tr_b16 v[22:23], v69 offset:41472
    v_cmp_gt_u32 vcc, 256, v4
    v_mfma_f32_16x16x32_bf16 v[232:235], v[28:31], v[60:63], v[232:235]
    v_mov_b32 v6, 2147418112
    v_mfma_f32_16x16x32_bf16 v[236:239], v[28:31], v[64:67], v[236:239]
    v_cndmask_b32 v5, v6, v5, vcc
    v_mfma_f32_16x16x32_bf16 v[240:243], v[32:35], v[52:55], v[240:243]
    v_cmp_gt_u32 vcc, 320, v4
    v_mfma_f32_16x16x32_bf16 v[244:247], v[32:35], v[56:59], v[244:247]
    ds_read_b64_tr_b16 v[24:25], v70 offset:41984
    ds_read_b64_tr_b16 v[26:27], v70 offset:42496
    v_lshlrev_b32 v4, 2, v4
    v_mfma_f32_16x16x32_bf16 v[248:251], v[32:35], v[60:63], v[248:251]
    v_cndmask_b32 v7, v6, v4, vcc
    v_mfma_f32_16x16x32_bf16 v[252:255], v[32:35], v[64:67], v[252:255]
    s_and_b32 s52, s2, 31
    s_mul_i32 s52, s52, 10240
    s_add_u32 s52, s52, 52498432
    s_add_u32 s53, s52, 5120
    buffer_load_dword v88, v7, s[32:35], s52 offen offset:0 sc0 sc1
    s_waitcnt lgkmcnt(4)
    v_mfma_f32_16x16x32_bf16 v[96:99], v[16:19], v[36:39], v[96:99]
    ds_read_b128 v[52:55], v81 offset:32768
    ds_read_b128 v[56:59], v81 offset:34816
    buffer_load_dword v89, v7, s[32:35], s52 offen offset:1280 sc0 sc1
    v_mfma_f32_16x16x32_bf16 v[100:103], v[16:19], v[40:43], v[100:103]
    ds_read_b64_tr_b16 v[28:29], v70 offset:43008
    ds_read_b64_tr_b16 v[30:31], v70 offset:43520
    buffer_load_dword v90, v7, s[32:35], s52 offen offset:2560 sc0 sc1
    v_mfma_f32_16x16x32_bf16 v[104:107], v[16:19], v[44:47], v[104:107]
    ds_read_b128 v[60:63], v81 offset:36864
    ds_read_b128 v[64:67], v81 offset:38912
    buffer_load_dword v91, v7, s[32:35], s52 offen offset:3840 sc0 sc1
    v_mfma_f32_16x16x32_bf16 v[108:111], v[16:19], v[48:51], v[108:111]
    buffer_load_dword v92, v7, s[32:35], s53 offen offset:0 sc0 sc1
    s_waitcnt lgkmcnt(8)
    v_mfma_f32_16x16x32_bf16 v[112:115], v[20:23], v[36:39], v[112:115]
    buffer_load_dword v93, v7, s[32:35], s53 offen offset:1280 sc0 sc1
    v_mfma_f32_16x16x32_bf16 v[116:119], v[20:23], v[40:43], v[116:119]
    ds_read_b64_tr_b16 v[32:33], v71 offset:41984
    ds_read_b64_tr_b16 v[34:35], v71 offset:42496
    buffer_load_dword v94, v7, s[32:35], s53 offen offset:2560 sc0 sc1
    v_mfma_f32_16x16x32_bf16 v[120:123], v[20:23], v[44:47], v[120:123]
    buffer_load_dword v95, v7, s[32:35], s53 offen offset:3840 sc0 sc1
    v_mfma_f32_16x16x32_bf16 v[124:127], v[20:23], v[48:51], v[124:127]
    s_lshl_b32 s52, s48, 12
    s_add_u32 s52, s52, 52465664
    buffer_load_dwordx2 v[74:75], v5, s[32:35], s52 offen sc0 sc1
    s_waitcnt lgkmcnt(8)
    v_mfma_f32_16x16x32_bf16 v[128:131], v[24:27], v[36:39], v[128:131]
    v_mfma_f32_16x16x32_bf16 v[132:135], v[24:27], v[40:43], v[132:135]
    ds_read_b64_tr_b16 v[16:17], v71 offset:43008
    ds_read_b64_tr_b16 v[18:19], v71 offset:43520
    v_mfma_f32_16x16x32_bf16 v[136:139], v[24:27], v[44:47], v[136:139]
    v_mfma_f32_16x16x32_bf16 v[140:143], v[24:27], v[48:51], v[140:143]
    s_waitcnt lgkmcnt(6)
    v_mfma_f32_16x16x32_bf16 v[144:147], v[28:31], v[36:39], v[144:147]
    v_mfma_f32_16x16x32_bf16 v[148:151], v[28:31], v[40:43], v[148:151]
    ds_read_b64_tr_b16 v[20:21], v72 offset:41984
    ds_read_b64_tr_b16 v[22:23], v72 offset:42496
    v_mfma_f32_16x16x32_bf16 v[152:155], v[28:31], v[44:47], v[152:155]
    v_mfma_f32_16x16x32_bf16 v[156:159], v[28:31], v[48:51], v[156:159]
    s_waitcnt lgkmcnt(4)
    v_mfma_f32_16x16x32_bf16 v[160:163], v[32:35], v[36:39], v[160:163]
    v_mfma_f32_16x16x32_bf16 v[164:167], v[32:35], v[40:43], v[164:167]
    ds_read_b64_tr_b16 v[24:25], v72 offset:43008
    ds_read_b64_tr_b16 v[26:27], v72 offset:43520
    v_mfma_f32_16x16x32_bf16 v[168:171], v[32:35], v[44:47], v[168:171]
    v_mfma_f32_16x16x32_bf16 v[172:175], v[32:35], v[48:51], v[172:175]
    s_waitcnt lgkmcnt(4)
    v_mfma_f32_16x16x32_bf16 v[176:179], v[16:19], v[36:39], v[176:179]
    ds_read_b64_tr_b16 v[28:29], v73 offset:41984
    ds_read_b64_tr_b16 v[30:31], v73 offset:42496
    v_mfma_f32_16x16x32_bf16 v[180:183], v[16:19], v[40:43], v[180:183]
    ds_read_b64_tr_b16 v[32:33], v73 offset:43008
    ds_read_b64_tr_b16 v[34:35], v73 offset:43520
    v_mfma_f32_16x16x32_bf16 v[184:187], v[16:19], v[44:47], v[184:187]
    v_mfma_f32_16x16x32_bf16 v[188:191], v[16:19], v[48:51], v[188:191]
    s_waitcnt lgkmcnt(6)
    v_mfma_f32_16x16x32_bf16 v[192:195], v[20:23], v[36:39], v[192:195]
    v_mfma_f32_16x16x32_bf16 v[196:199], v[20:23], v[40:43], v[196:199]
    v_mfma_f32_16x16x32_bf16 v[200:203], v[20:23], v[44:47], v[200:203]
    v_mfma_f32_16x16x32_bf16 v[204:207], v[20:23], v[48:51], v[204:207]
    s_waitcnt vmcnt(19) lgkmcnt(0)
    s_barrier
    v_mfma_f32_16x16x32_bf16 v[208:211], v[24:27], v[36:39], v[208:211]
    v_mfma_f32_16x16x32_bf16 v[212:215], v[24:27], v[40:43], v[212:215]
    v_mfma_f32_16x16x32_bf16 v[216:219], v[24:27], v[44:47], v[216:219]
    ds_read_b64_tr_b16 v[16:17], v68 offset:61440
    ds_read_b64_tr_b16 v[18:19], v68 offset:61952
    v_mfma_f32_16x16x32_bf16 v[220:223], v[24:27], v[48:51], v[220:223]
    v_mfma_f32_16x16x32_bf16 v[224:227], v[28:31], v[36:39], v[224:227]
    v_mfma_f32_16x16x32_bf16 v[228:231], v[28:31], v[40:43], v[228:231]
    ds_read_b64_tr_b16 v[20:21], v69 offset:61440
    ds_read_b64_tr_b16 v[22:23], v69 offset:61952
    v_mfma_f32_16x16x32_bf16 v[232:235], v[28:31], v[44:47], v[232:235]
    v_mfma_f32_16x16x32_bf16 v[236:239], v[28:31], v[48:51], v[236:239]
    s_add_u32 m0, s44, 32768
    s_nop 0
    buffer_load_dwordx4 v82, s[12:15], s36 offen offset:0 lds
    v_mfma_f32_16x16x32_bf16 v[240:243], v[32:35], v[36:39], v[240:243]
    v_mfma_f32_16x16x32_bf16 v[244:247], v[32:35], v[40:43], v[244:247]
    ds_read_b64_tr_b16 v[24:25], v70 offset:62464
    ds_read_b64_tr_b16 v[26:27], v70 offset:62976
    v_mfma_f32_16x16x32_bf16 v[248:251], v[32:35], v[44:47], v[248:251]
    v_mfma_f32_16x16x32_bf16 v[252:255], v[32:35], v[48:51], v[252:255]
    buffer_load_dwordx4 v83, s[12:15], s36 offen offset:1024 lds
    s_waitcnt lgkmcnt(4)
    v_mfma_f32_16x16x32_bf16 v[96:99], v[16:19], v[52:55], v[96:99]
    v_mfma_f32_16x16x32_bf16 v[100:103], v[16:19], v[56:59], v[100:103]
    ds_read_b64_tr_b16 v[28:29], v70 offset:63488
    ds_read_b64_tr_b16 v[30:31], v70 offset:64000
    v_mfma_f32_16x16x32_bf16 v[104:107], v[16:19], v[60:63], v[104:107]
    v_mfma_f32_16x16x32_bf16 v[108:111], v[16:19], v[64:67], v[108:111]
    buffer_load_dwordx4 v84, s[12:15], s36 offen offset:2048 lds
    s_waitcnt lgkmcnt(4)
    v_mfma_f32_16x16x32_bf16 v[112:115], v[20:23], v[52:55], v[112:115]
    v_mfma_f32_16x16x32_bf16 v[116:119], v[20:23], v[56:59], v[116:119]
    ds_read_b64_tr_b16 v[32:33], v71 offset:62464
    ds_read_b64_tr_b16 v[34:35], v71 offset:62976
    v_mfma_f32_16x16x32_bf16 v[120:123], v[20:23], v[60:63], v[120:123]
    v_mfma_f32_16x16x32_bf16 v[124:127], v[20:23], v[64:67], v[124:127]
    buffer_load_dwordx4 v85, s[12:15], s36 offen offset:3072 lds
    s_add_u32 s36, s36, 128
    s_waitcnt lgkmcnt(4)
    v_mfma_f32_16x16x32_bf16 v[128:131], v[24:27], v[52:55], v[128:131]
    v_mfma_f32_16x16x32_bf16 v[132:135], v[24:27], v[56:59], v[132:135]
    ds_read_b64_tr_b16 v[16:17], v71 offset:63488
    ds_read_b64_tr_b16 v[18:19], v71 offset:64000
    v_mfma_f32_16x16x32_bf16 v[136:139], v[24:27], v[60:63], v[136:139]
    v_mfma_f32_16x16x32_bf16 v[140:143], v[24:27], v[64:67], v[140:143]
    s_add_u32 m0, s44, 36864
    s_nop 0
    buffer_load_dwordx4 v82, s[12:15], s37 offen offset:0 lds
    s_waitcnt lgkmcnt(4)
    v_mfma_f32_16x16x32_bf16 v[144:147], v[28:31], v[52:55], v[144:147]
    v_mfma_f32_16x16x32_bf16 v[148:151], v[28:31], v[56:59], v[148:151]
    ds_read_b64_tr_b16 v[20:21], v72 offset:62464
    ds_read_b64_tr_b16 v[22:23], v72 offset:62976
    v_mfma_f32_16x16x32_bf16 v[152:155], v[28:31], v[60:63], v[152:155]
    v_mfma_f32_16x16x32_bf16 v[156:159], v[28:31], v[64:67], v[156:159]
    buffer_load_dwordx4 v83, s[12:15], s37 offen offset:1024 lds
    s_waitcnt lgkmcnt(4)
    v_mfma_f32_16x16x32_bf16 v[160:163], v[32:35], v[52:55], v[160:163]
    v_mfma_f32_16x16x32_bf16 v[164:167], v[32:35], v[56:59], v[164:167]
    ds_read_b64_tr_b16 v[24:25], v72 offset:63488
    ds_read_b64_tr_b16 v[26:27], v72 offset:64000
    v_mfma_f32_16x16x32_bf16 v[168:171], v[32:35], v[60:63], v[168:171]
    v_mfma_f32_16x16x32_bf16 v[172:175], v[32:35], v[64:67], v[172:175]
    buffer_load_dwordx4 v84, s[12:15], s37 offen offset:2048 lds
    s_waitcnt lgkmcnt(4)
    v_mfma_f32_16x16x32_bf16 v[176:179], v[16:19], v[52:55], v[176:179]
    ds_read_b64_tr_b16 v[28:29], v73 offset:62464
    ds_read_b64_tr_b16 v[30:31], v73 offset:62976
    v_mfma_f32_16x16x32_bf16 v[180:183], v[16:19], v[56:59], v[180:183]
    ds_read_b64_tr_b16 v[32:33], v73 offset:63488
    ds_read_b64_tr_b16 v[34:35], v73 offset:64000
    v_mfma_f32_16x16x32_bf16 v[184:187], v[16:19], v[60:63], v[184:187]
    v_mfma_f32_16x16x32_bf16 v[188:191], v[16:19], v[64:67], v[188:191]
    buffer_load_dwordx4 v85, s[12:15], s37 offen offset:3072 lds
    s_add_u32 s37, s37, 128
    s_waitcnt lgkmcnt(6)
    v_mfma_f32_16x16x32_bf16 v[192:195], v[20:23], v[52:55], v[192:195]
    v_mfma_f32_16x16x32_bf16 v[196:199], v[20:23], v[56:59], v[196:199]
    v_mfma_f32_16x16x32_bf16 v[200:203], v[20:23], v[60:63], v[200:203]
    v_mfma_f32_16x16x32_bf16 v[204:207], v[20:23], v[64:67], v[204:207]
    s_waitcnt vmcnt(17) lgkmcnt(0)
    s_barrier
    v_mfma_f32_16x16x32_bf16 v[208:211], v[24:27], v[52:55], v[208:211]
    ds_read_b128 v[36:39], v80 offset:0
    ds_read_b128 v[40:43], v80 offset:2048
    v_mfma_f32_16x16x32_bf16 v[212:215], v[24:27], v[56:59], v[212:215]
    ds_read_b128 v[44:47], v80 offset:4096
    ds_read_b128 v[48:51], v80 offset:6144
    v_mfma_f32_16x16x32_bf16 v[216:219], v[24:27], v[60:63], v[216:219]
    ds_read_b64_tr_b16 v[16:17], v68 offset:0
    ds_read_b64_tr_b16 v[18:19], v68 offset:512
    v_mfma_f32_16x16x32_bf16 v[220:223], v[24:27], v[64:67], v[220:223]
    v_mfma_f32_16x16x32_bf16 v[224:227], v[28:31], v[52:55], v[224:227]
    v_mfma_f32_16x16x32_bf16 v[228:231], v[28:31], v[56:59], v[228:231]
    ds_read_b64_tr_b16 v[20:21], v69 offset:0
    ds_read_b64_tr_b16 v[22:23], v69 offset:512
    v_mfma_f32_16x16x32_bf16 v[232:235], v[28:31], v[60:63], v[232:235]
    v_mfma_f32_16x16x32_bf16 v[236:239], v[28:31], v[64:67], v[236:239]
    v_mfma_f32_16x16x32_bf16 v[240:243], v[32:35], v[52:55], v[240:243]
    v_mfma_f32_16x16x32_bf16 v[244:247], v[32:35], v[56:59], v[244:247]
    ds_read_b64_tr_b16 v[24:25], v70 offset:1024
    ds_read_b64_tr_b16 v[26:27], v70 offset:1536
    v_mfma_f32_16x16x32_bf16 v[248:251], v[32:35], v[60:63], v[248:251]
    v_mfma_f32_16x16x32_bf16 v[252:255], v[32:35], v[64:67], v[252:255]
    s_waitcnt lgkmcnt(4)
    v_mfma_f32_16x16x32_bf16 v[96:99], v[16:19], v[36:39], v[96:99]
    ds_read_b128 v[52:55], v81 offset:0
    ds_read_b128 v[56:59], v81 offset:2048
    v_mfma_f32_16x16x32_bf16 v[100:103], v[16:19], v[40:43], v[100:103]
    ds_read_b64_tr_b16 v[28:29], v70 offset:2048
    ds_read_b64_tr_b16 v[30:31], v70 offset:2560
    v_mfma_f32_16x16x32_bf16 v[104:107], v[16:19], v[44:47], v[104:107]
    ds_read_b128 v[60:63], v81 offset:4096
    ds_read_b128 v[64:67], v81 offset:6144
    v_mfma_f32_16x16x32_bf16 v[108:111], v[16:19], v[48:51], v[108:111]
    s_waitcnt lgkmcnt(8)
    v_mfma_f32_16x16x32_bf16 v[112:115], v[20:23], v[36:39], v[112:115]
    v_mfma_f32_16x16x32_bf16 v[116:119], v[20:23], v[40:43], v[116:119]
    ds_read_b64_tr_b16 v[32:33], v71 offset:1024
    ds_read_b64_tr_b16 v[34:35], v71 offset:1536
    v_mfma_f32_16x16x32_bf16 v[120:123], v[20:23], v[44:47], v[120:123]
    v_mfma_f32_16x16x32_bf16 v[124:127], v[20:23], v[48:51], v[124:127]
    s_waitcnt lgkmcnt(8)
    v_mfma_f32_16x16x32_bf16 v[128:131], v[24:27], v[36:39], v[128:131]
    v_mfma_f32_16x16x32_bf16 v[132:135], v[24:27], v[40:43], v[132:135]
    ds_read_b64_tr_b16 v[16:17], v71 offset:2048
    ds_read_b64_tr_b16 v[18:19], v71 offset:2560
    v_mfma_f32_16x16x32_bf16 v[136:139], v[24:27], v[44:47], v[136:139]
    v_mfma_f32_16x16x32_bf16 v[140:143], v[24:27], v[48:51], v[140:143]
    s_waitcnt lgkmcnt(6)
    v_mfma_f32_16x16x32_bf16 v[144:147], v[28:31], v[36:39], v[144:147]
    v_mfma_f32_16x16x32_bf16 v[148:151], v[28:31], v[40:43], v[148:151]
    ds_read_b64_tr_b16 v[20:21], v72 offset:1024
    ds_read_b64_tr_b16 v[22:23], v72 offset:1536
    v_mfma_f32_16x16x32_bf16 v[152:155], v[28:31], v[44:47], v[152:155]
    v_mfma_f32_16x16x32_bf16 v[156:159], v[28:31], v[48:51], v[156:159]
    s_waitcnt lgkmcnt(4)
    v_mfma_f32_16x16x32_bf16 v[160:163], v[32:35], v[36:39], v[160:163]
    v_mfma_f32_16x16x32_bf16 v[164:167], v[32:35], v[40:43], v[164:167]
    ds_read_b64_tr_b16 v[24:25], v72 offset:2048
    ds_read_b64_tr_b16 v[26:27], v72 offset:2560
    v_mfma_f32_16x16x32_bf16 v[168:171], v[32:35], v[44:47], v[168:171]
    v_mfma_f32_16x16x32_bf16 v[172:175], v[32:35], v[48:51], v[172:175]
    s_waitcnt lgkmcnt(4)
    v_mfma_f32_16x16x32_bf16 v[176:179], v[16:19], v[36:39], v[176:179]
    ds_read_b64_tr_b16 v[28:29], v73 offset:1024
    ds_read_b64_tr_b16 v[30:31], v73 offset:1536
    v_mfma_f32_16x16x32_bf16 v[180:183], v[16:19], v[40:43], v[180:183]
    ds_read_b64_tr_b16 v[32:33], v73 offset:2048
    ds_read_b64_tr_b16 v[34:35], v73 offset:2560
    v_mfma_f32_16x16x32_bf16 v[184:187], v[16:19], v[44:47], v[184:187]
    v_mfma_f32_16x16x32_bf16 v[188:191], v[16:19], v[48:51], v[188:191]
    s_waitcnt lgkmcnt(6)
    v_mfma_f32_16x16x32_bf16 v[192:195], v[20:23], v[36:39], v[192:195]
    v_mfma_f32_16x16x32_bf16 v[196:199], v[20:23], v[40:43], v[196:199]
    v_mfma_f32_16x16x32_bf16 v[200:203], v[20:23], v[44:47], v[200:203]
    v_mfma_f32_16x16x32_bf16 v[204:207], v[20:23], v[48:51], v[204:207]
    s_waitcnt vmcnt(8)
    v_add_f32 v88, v88, v89
    v_add_f32 v90, v90, v91
    v_add_f32 v92, v92, v93
    v_add_f32 v94, v94, v95
    v_add_f32 v88, v88, v90
    v_add_f32 v92, v92, v94
    v_add_f32 v88, v88, v92
    v_add_u32 v4, 147456, v4
    s_lshl_b32 s52, s49, 9
    s_add_u32 s52, s52, 149504
    v_lshl_add_u32 v5, v1, 2, s52
    ds_write_b32 v4, v88
    ds_write2_b32 v5, v74, v75 offset0:0 offset1:64
    s_waitcnt lgkmcnt(0)
    s_barrier
    s_branch L_g1_tail
L_g1_spec_X0:
    s_cmp_eq_u32 s51, 0
    s_cbranch_scc1 L_cs_43
    v_mfma_f32_16x16x32_bf16 v[208:211], v[24:27], v[36:39], v[208:211]
    v_mfma_f32_16x16x32_bf16 v[212:215], v[24:27], v[40:43], v[212:215]
    v_mfma_f32_16x16x32_bf16 v[216:219], v[24:27], v[44:47], v[216:219]
    ds_read_b64_tr_b16 v[16:17], v68 offset:20480
    ds_read_b64_tr_b16 v[18:19], v68 offset:20992
    v_mfma_f32_16x16x32_bf16 v[220:223], v[24:27], v[48:51], v[220:223]
    v_mfma_f32_16x16x32_bf16 v[224:227], v[28:31], v[36:39], v[224:227]
    v_mfma_f32_16x16x32_bf16 v[228:231], v[28:31], v[40:43], v[228:231]
    ds_read_b64_tr_b16 v[20:21], v69 offset:20480
    ds_read_b64_tr_b16 v[22:23], v69 offset:20992
    v_mfma_f32_16x16x32_bf16 v[232:235], v[28:31], v[44:47], v[232:235]
    v_mfma_f32_16x16x32_bf16 v[236:239], v[28:31], v[48:51], v[236:239]
    s_add_u32 m0, s44, 0
    s_nop 0
    buffer_load_dwordx4 v82, s[12:15], s36 offen offset:0 lds
    v_mfma_f32_16x16x32_bf16 v[240:243], v[32:35], v[36:39], v[240:243]
    v_mfma_f32_16x16x32_bf16 v[244:247], v[32:35], v[40:43], v[244:247]
    ds_read_b64_tr_b16 v[24:25], v70 offset:21504
    ds_read_b64_tr_b16 v[26:27], v70 offset:22016
    v_mfma_f32_16x16x32_bf16 v[248:251], v[32:35], v[44:47], v[248:251]
    v_mfma_f32_16x16x32_bf16 v[252:255], v[32:35], v[48:51], v[252:255]
    buffer_load_dwordx4 v83, s[12:15], s36 offen offset:1024 lds
L_cs_43_ret:
    s_cmp_eq_u32 s51, 1
    s_cbranch_scc1 L_cs_44
    s_waitcnt lgkmcnt(4)
    v_mfma_f32_16x16x32_bf16 v[96:99], v[16:19], v[52:55], v[96:99]
    v_mfma_f32_16x16x32_bf16 v[100:103], v[16:19], v[56:59], v[100:103]
    ds_read_b64_tr_b16 v[28:29], v70 offset:22528
    ds_read_b64_tr_b16 v[30:31], v70 offset:23040
    v_mfma_f32_16x16x32_bf16 v[104:107], v[16:19], v[60:63], v[104:107]
    v_mfma_f32_16x16x32_bf16 v[108:111], v[16:19], v[64:67], v[108:111]
    buffer_load_dwordx4 v84, s[12:15], s36 offen offset:2048 lds
    s_waitcnt lgkmcnt(4)
    v_mfma_f32_16x16x32_bf16 v[112:115], v[20:23], v[52:55], v[112:115]
    v_mfma_f32_16x16x32_bf16 v[116:119], v[20:23], v[56:59], v[116:119]
    ds_read_b64_tr_b16 v[32:33], v71 offset:21504
    ds_read_b64_tr_b16 v[34:35], v71 offset:22016
    v_mfma_f32_16x16x32_bf16 v[120:123], v[20:23], v[60:63], v[120:123]
    v_mfma_f32_16x16x32_bf16 v[124:127], v[20:23], v[64:67], v[124:127]
    buffer_load_dwordx4 v85, s[12:15], s36 offen offset:3072 lds
    s_add_u32 s36, s36, 128
    s_waitcnt lgkmcnt(4)
    v_mfma_f32_16x16x32_bf16 v[128:131], v[24:27], v[52:55], v[128:131]
    v_mfma_f32_16x16x32_bf16 v[132:135], v[24:27], v[56:59], v[132:135]
    ds_read_b64_tr_b16 v[16:17], v71 offset:22528
    ds_read_b64_tr_b16 v[18:19], v71 offset:23040
    v_mfma_f32_16x16x32_bf16 v[136:139], v[24:27], v[60:63], v[136:139]
    v_mfma_f32_16x16x32_bf16 v[140:143], v[24:27], v[64:67], v[140:143]
    s_add_u32 m0, s44, 4096
    s_nop 0
    buffer_load_dwordx4 v82, s[12:15], s37 offen offset:0 lds
L_cs_44_ret:
    s_cmp_eq_u32 s51, 2
    s_cbranch_scc1 L_cs_45
    s_waitcnt lgkmcnt(4)
    v_mfma_f32_16x16x32_bf16 v[144:147], v[28:31], v[52:55], v[144:147]
    v_mfma_f32_16x16x32_bf16 v[148:151], v[28:31], v[56:59], v[148:151]
    ds_read_b64_tr_b16 v[20:21], v72 offset:21504
    ds_read_b64_tr_b16 v[22:23], v72 offset:22016
    v_mfma_f32_16x16x32_bf16 v[152:155], v[28:31], v[60:63], v[152:155]
    v_mfma_f32_16x16x32_bf16 v[156:159], v[28:31], v[64:67], v[156:159]
    buffer_load_dwordx4 v83, s[12:15], s37 offen offset:1024 lds
    s_waitcnt lgkmcnt(4)
    v_mfma_f32_16x16x32_bf16 v[160:163], v[32:35], v[52:55], v[160:163]
    v_mfma_f32_16x16x32_bf16 v[164:167], v[32:35], v[56:59], v[164:167]
    ds_read_b64_tr_b16 v[24:25], v72 offset:22528
    ds_read_b64_tr_b16 v[26:27], v72 offset:23040
    v_mfma_f32_16x16x32_bf16 v[168:171], v[32:35], v[60:63], v[168:171]
    v_mfma_f32_16x16x32_bf16 v[172:175], v[32:35], v[64:67], v[172:175]
    buffer_load_dwordx4 v84, s[12:15], s37 offen offset:2048 lds
L_cs_45_ret:
    s_cmp_eq_u32 s51, 3
    s_cbranch_scc1 L_cs_46
    s_waitcnt lgkmcnt(4)
    v_mfma_f32_16x16x32_bf16 v[176:179], v[16:19], v[52:55], v[176:179]
    ds_read_b64_tr_b16 v[28:29], v73 offset:21504
    ds_read_b64_tr_b16 v[30:31], v73 offset:22016
    v_mfma_f32_16x16x32_bf16 v[180:183], v[16:19], v[56:59], v[180:183]
    ds_read_b64_tr_b16 v[32:33], v73 offset:22528
    ds_read_b64_tr_b16 v[34:35], v73 offset:23040
    v_mfma_f32_16x16x32_bf16 v[184:187], v[16:19], v[60:63], v[184:187]
    v_mfma_f32_16x16x32_bf16 v[188:191], v[16:19], v[64:67], v[188:191]
    buffer_load_dwordx4 v85, s[12:15], s37 offen offset:3072 lds
    s_add_u32 s37, s37, 128
    s_waitcnt lgkmcnt(6)
    v_mfma_f32_16x16x32_bf16 v[192:195], v[20:23], v[52:55], v[192:195]
    v_mfma_f32_16x16x32_bf16 v[196:199], v[20:23], v[56:59], v[196:199]
    v_mfma_f32_16x16x32_bf16 v[200:203], v[20:23], v[60:63], v[200:203]
    v_mfma_f32_16x16x32_bf16 v[204:207], v[20:23], v[64:67], v[204:207]
L_cs_46_ret:
    s_waitcnt vmcnt(10) lgkmcnt(0)
    s_barrier
    s_cmp_eq_u32 s51, 0
    s_cbranch_scc1 L_cs_47
    v_mfma_f32_16x16x32_bf16 v[208:211], v[24:27], v[52:55], v[208:211]
    ds_read_b128 v[36:39], v80 offset:32768
    ds_read_b128 v[40:43], v80 offset:34816
    v_lshlrev_b32 v74, 16, v76
    v_mfma_f32_16x16x32_bf16 v[212:215], v[24:27], v[56:59], v[212:215]
    ds_read_b128 v[44:47], v80 offset:36864
    ds_read_b128 v[48:51], v80 offset:38912
    v_and_b32 v75, s87, v76
    v_mfma_f32_16x16x32_bf16 v[216:219], v[24:27], v[60:63], v[216:219]
    ds_read_b64_tr_b16 v[16:17], v68 offset:40960
    ds_read_b64_tr_b16 v[18:19], v68 offset:41472
    v_lshlrev_b32 v2, 16, v77
    v_mfma_f32_16x16x32_bf16 v[220:223], v[24:27], v[64:67], v[220:223]
    v_and_b32 v3, s87, v77
    v_mfma_f32_16x16x32_bf16 v[224:227], v[28:31], v[52:55], v[224:227]
    v_add_f32 v74, v74, v2
    v_mfma_f32_16x16x32_bf16 v[228:231], v[28:31], v[56:59], v[228:231]
    ds_read_b64_tr_b16 v[20:21], v69 offset:40960
    ds_read_b64_tr_b16 v[22:23], v69 offset:41472
    v_add_f32 v75, v75, v3
    v_mfma_f32_16x16x32_bf16 v[232:235], v[28:31], v[60:63], v[232:235]
    v_lshlrev_b32 v2, 16, v78
    v_mfma_f32_16x16x32_bf16 v[236:239], v[28:31], v[64:67], v[236:239]
    v_and_b32 v3, s87, v78
    v_mfma_f32_16x16x32_bf16 v[240:243], v[32:35], v[52:55], v[240:243]
    v_add_f32 v74, v74, v2
    v_mfma_f32_16x16x32_bf16 v[244:247], v[32:35], v[56:59], v[244:247]
    ds_read_b64_tr_b16 v[24:25], v70 offset:41984
    ds_read_b64_tr_b16 v[26:27], v70 offset:42496
    v_add_f32 v75, v75, v3
    v_mfma_f32_16x16x32_bf16 v[248:251], v[32:35], v[60:63], v[248:251]
    v_lshlrev_b32 v2, 16, v79
    v_mfma_f32_16x16x32_bf16 v[252:255], v[32:35], v[64:67], v[252:255]
    v_and_b32 v3, s87, v79
L_cs_47_ret:
    s_cmp_eq_u32 s51, 1
    s_cbranch_scc1 L_cs_48
    s_waitcnt lgkmcnt(4)
    v_mfma_f32_16x16x32_bf16 v[96:99], v[16:19], v[36:39], v[96:99]
    ds_read_b128 v[52:55], v81 offset:32768
    ds_read_b128 v[56:59], v81 offset:34816
    v_add_f32 v74, v74, v2
    v_mfma_f32_16x16x32_bf16 v[100:103], v[16:19], v[40:43], v[100:103]
    ds_read_b64_tr_b16 v[28:29], v70 offset:43008
    ds_read_b64_tr_b16 v[30:31], v70 offset:43520
    v_add_f32 v75, v75, v3
    v_mfma_f32_16x16x32_bf16 v[104:107], v[16:19], v[44:47], v[104:107]
    ds_read_b128 v[60:63], v81 offset:36864
    ds_read_b128 v[64:67], v81 offset:38912
    v_lshlrev_b32 v2, 16, v92
    v_mfma_f32_16x16x32_bf16 v[108:111], v[16:19], v[48:51], v[108:111]
    v_and_b32 v3, s87, v92
    s_waitcnt lgkmcnt(8)
    v_mfma_f32_16x16x32_bf16 v[112:115], v[20:23], v[36:39], v[112:115]
    v_add_f32 v74, v74, v2
    v_mfma_f32_16x16x32_bf16 v[116:119], v[20:23], v[40:43], v[116:119]
    ds_read_b64_tr_b16 v[32:33], v71 offset:41984
    ds_read_b64_tr_b16 v[34:35], v71 offset:42496
    v_add_f32 v75, v75, v3
    v_mfma_f32_16x16x32_bf16 v[120:123], v[20:23], v[44:47], v[120:123]
    v_lshlrev_b32 v2, 16, v93
    v_mfma_f32_16x16x32_bf16 v[124:127], v[20:23], v[48:51], v[124:127]
    v_and_b32 v3, s87, v93
    s_waitcnt lgkmcnt(8)
    v_mfma_f32_16x16x32_bf16 v[128:131], v[24:27], v[36:39], v[128:131]
    v_add_f32 v74, v74, v2
    v_mfma_f32_16x16x32_bf16 v[132:135], v[24:27], v[40:43], v[132:135]
    ds_read_b64_tr_b16 v[16:17], v71 offset:43008
    ds_read_b64_tr_b16 v[18:19], v71 offset:43520
    v_add_f32 v75, v75, v3
    v_mfma_f32_16x16x32_bf16 v[136:139], v[24:27], v[44:47], v[136:139]
    v_lshlrev_b32 v2, 16, v94
    v_mfma_f32_16x16x32_bf16 v[140:143], v[24:27], v[48:51], v[140:143]
    v_and_b32 v3, s87, v94
L_cs_48_ret:
    s_cmp_eq_u32 s51, 2
    s_cbranch_scc1 L_cs_49
    s_waitcnt lgkmcnt(6)
    v_mfma_f32_16x16x32_bf16 v[144:147], v[28:31], v[36:39], v[144:147]
    v_add_f32 v74, v74, v2
    v_mfma_f32_16x16x32_bf16 v[148:151], v[28:31], v[40:43], v[148:151]
    ds_read_b64_tr_b16 v[20:21], v72 offset:41984
    ds_read_b64_tr_b16 v[22:23], v72 offset:42496
    v_add_f32 v75, v75, v3
    v_mfma_f32_16x16x32_bf16 v[152:155], v[28:31], v[44:47], v[152:155]
    v_lshlrev_b32 v2, 16, v95
    v_mfma_f32_16x16x32_bf16 v[156:159], v[28:31], v[48:51], v[156:159]
    v_and_b32 v3, s87, v95
    s_waitcnt lgkmcnt(4)
    v_mfma_f32_16x16x32_bf16 v[160:163], v[32:35], v[36:39], v[160:163]
    v_add_f32 v74, v74, v2
    v_mfma_f32_16x16x32_bf16 v[164:167], v[32:35], v[40:43], v[164:167]
    ds_read_b64_tr_b16 v[24:25], v72 offset:43008
    ds_read_b64_tr_b16 v[26:27], v72 offset:43520
    v_add_f32 v75, v75, v3
    v_mfma_f32_16x16x32_bf16 v[168:171], v[32:35], v[44:47], v[168:171]
    v_add_f32 v74, v74, v75
    v_mfma_f32_16x16x32_bf16 v[172:175], v[32:35], v[48:51], v[172:175]
    s_nop 1
    v_add_f32_dpp v74, v74, v74 row_ror:8 row_mask:0xf bank_mask:0xf
L_cs_49_ret:
    s_cmp_eq_u32 s51, 3
    s_cbranch_scc1 L_cs_50
    s_waitcnt lgkmcnt(4)
    v_mfma_f32_16x16x32_bf16 v[176:179], v[16:19], v[36:39], v[176:179]
    ds_read_b64_tr_b16 v[28:29], v73 offset:41984
    ds_read_b64_tr_b16 v[30:31], v73 offset:42496
    s_nop 1
    v_add_f32_dpp v74, v74, v74 row_ror:4 row_mask:0xf bank_mask:0xf
    v_mfma_f32_16x16x32_bf16 v[180:183], v[16:19], v[40:43], v[180:183]
    ds_read_b64_tr_b16 v[32:33], v73 offset:43008
    ds_read_b64_tr_b16 v[34:35], v73 offset:43520
    s_nop 1
    v_add_f32_dpp v74, v74, v74 row_ror:2 row_mask:0xf bank_mask:0xf
    v_mfma_f32_16x16x32_bf16 v[184:187], v[16:19], v[44:47], v[184:187]
    s_nop 1
    v_add_f32_dpp v74, v74, v74 row_ror:1 row_mask:0xf bank_mask:0xf
    v_mfma_f32_16x16x32_bf16 v[188:191], v[16:19], v[48:51], v[188:191]
    v_mov_b32 v2, v74
    s_waitcnt lgkmcnt(6)
    v_mfma_f32_16x16x32_bf16 v[192:195], v[20:23], v[36:39], v[192:195]
    s_nop 1
    v_permlane16_swap_b32 v74, v2
    v_mfma_f32_16x16x32_bf16 v[196:199], v[20:23], v[40:43], v[196:199]
    s_nop 1
    v_add_f32 v74, v74, v2
    v_mfma_f32_16x16x32_bf16 v[200:203], v[20:23], v[44:47], v[200:203]
    v_mov_b32 v2, v74
    v_mfma_f32_16x16x32_bf16 v[204:207], v[20:23], v[48:51], v[204:207]
    s_nop 1
    v_permlane32_swap_b32 v74, v2
L_cs_50_ret:
    s_waitcnt vmcnt(10) lgkmcnt(0)
    s_barrier
    s_cmp_eq_u32 s51, 0
    s_cbranch_scc1 L_cs_51
    v_mfma_f32_16x16x32_bf16 v[208:211], v[24:27], v[36:39], v[208:211]
    s_nop 1
    v_add_f32 v74, v74, v2
    v_mfma_f32_16x16x32_bf16 v[212:215], v[24:27], v[40:43], v[212:215]
    v_mul_f32 v74, 0x3a800000, v74
    v_mfma_f32_16x16x32_bf16 v[216:219], v[24:27], v[44:47], v[216:219]
    ds_read_b64_tr_b16 v[16:17], v68 offset:61440
    ds_read_b64_tr_b16 v[18:19], v68 offset:61952
    v_mov_b32 v75, 0
    v_mfma_f32_16x16x32_bf16 v[220:223], v[24:27], v[48:51], v[220:223]
    v_lshlrev_b32 v2, 16, v76
    v_mfma_f32_16x16x32_bf16 v[224:227], v[28:31], v[36:39], v[224:227]
    v_and_b32 v3, s87, v76
    v_mfma_f32_16x16x32_bf16 v[228:231], v[28:31], v[40:43], v[228:231]
    ds_read_b64_tr_b16 v[20:21], v69 offset:61440
    ds_read_b64_tr_b16 v[22:23], v69 offset:61952
    v_sub_f32 v2, v2, v74
    v_mfma_f32_16x16x32_bf16 v[232:235], v[28:31], v[44:47], v[232:235]
    v_sub_f32 v3, v3, v74
    v_mfma_f32_16x16x32_bf16 v[236:239], v[28:31], v[48:51], v[236:239]
    s_add_u32 m0, s44, 32768
    s_nop 0
    buffer_load_dwordx4 v82, s[12:15], s36 offen offset:0 lds
    v_fma_f32 v75, v2, v2, v75
    v_mfma_f32_16x16x32_bf16 v[240:243], v[32:35], v[36:39], v[240:243]
    v_fma_f32 v75, v3, v3, v75
    v_mfma_f32_16x16x32_bf16 v[244:247], v[32:35], v[40:43], v[244:247]
    ds_read_b64_tr_b16 v[24:25], v70 offset:62464
    ds_read_b64_tr_b16 v[26:27], v70 offset:62976
    v_lshlrev_b32 v2, 16, v77
    v_mfma_f32_16x16x32_bf16 v[248:251], v[32:35], v[44:47], v[248:251]
    v_and_b32 v3, s87, v77
    v_mfma_f32_16x16x32_bf16 v[252:255], v[32:35], v[48:51], v[252:255]
    buffer_load_dwordx4 v83, s[12:15], s36 offen offset:1024 lds
    v_sub_f32 v2, v2, v74
L_cs_51_ret:
    s_cmp_eq_u32 s51, 1
    s_cbranch_scc1 L_cs_52
    s_waitcnt lgkmcnt(4)
    v_mfma_f32_16x16x32_bf16 v[96:99], v[16:19], v[52:55], v[96:99]
    v_sub_f32 v3, v3, v74
    v_mfma_f32_16x16x32_bf16 v[100:103], v[16:19], v[56:59], v[100:103]
    ds_read_b64_tr_b16 v[28:29], v70 offset:63488
    ds_read_b64_tr_b16 v[30:31], v70 offset:64000
    v_fma_f32 v75, v2, v2, v75
    v_mfma_f32_16x16x32_bf16 v[104:107], v[16:19], v[60:63], v[104:107]
    v_fma_f32 v75, v3, v3, v75
    v_mfma_f32_16x16x32_bf16 v[108:111], v[16:19], v[64:67], v[108:111]
    buffer_load_dwordx4 v84, s[12:15], s36 offen offset:2048 lds
    v_lshlrev_b32 v2, 16, v78
    s_waitcnt lgkmcnt(4)
    v_mfma_f32_16x16x32_bf16 v[112:115], v[20:23], v[52:55], v[112:115]
    v_and_b32 v3, s87, v78
    v_mfma_f32_16x16x32_bf16 v[116:119], v[20:23], v[56:59], v[116:119]
    ds_read_b64_tr_b16 v[32:33], v71 offset:62464
    ds_read_b64_tr_b16 v[34:35], v71 offset:62976
    v_sub_f32 v2, v2, v74
    v_mfma_f32_16x16x32_bf16 v[120:123], v[20:23], v[60:63], v[120:123]
    v_sub_f32 v3, v3, v74
    v_mfma_f32_16x16x32_bf16 v[124:127], v[20:23], v[64:67], v[124:127]
    buffer_load_dwordx4 v85, s[12:15], s36 offen offset:3072 lds
    s_add_u32 s36, s36, 128
    v_fma_f32 v75, v2, v2, v75
    s_waitcnt lgkmcnt(4)
    v_mfma_f32_16x16x32_bf16 v[128:131], v[24:27], v[52:55], v[128:131]
    v_fma_f32 v75, v3, v3, v75
    v_mfma_f32_16x16x32_bf16 v[132:135], v[24:27], v[56:59], v[132:135]
    ds_read_b64_tr_b16 v[16:17], v71 offset:63488
    ds_read_b64_tr_b16 v[18:19], v71 offset:64000
    v_lshlrev_b32 v2, 16, v79
    v_mfma_f32_16x16x32_bf16 v[136:139], v[24:27], v[60:63], v[136:139]
    v_and_b32 v3, s87, v79
    v_mfma_f32_16x16x32_bf16 v[140:143], v[24:27], v[64:67], v[140:143]
    s_add_u32 m0, s44, 36864
    s_nop 0
    buffer_load_dwordx4 v82, s[12:15], s37 offen offset:0 lds
    v_sub_f32 v2, v2, v74
L_cs_52_ret:
    s_cmp_eq_u32 s51, 2
    s_cbranch_scc1 L_cs_53
    s_waitcnt lgkmcnt(4)
    v_mfma_f32_16x16x32_bf16 v[144:147], v[28:31], v[52:55], v[144:147]
    v_sub_f32 v3, v3, v74
    v_mfma_f32_16x16x32_bf16 v[148:151], v[28:31], v[56:59], v[148:151]
    ds_read_b64_tr_b16 v[20:21], v72 offset:62464
    ds_read_b64_tr_b16 v[22:23], v72 offset:62976
    v_fma_f32 v75, v2, v2, v75
    v_mfma_f32_16x16x32_bf16 v[152:155], v[28:31], v[60:63], v[152:155]
    v_fma_f32 v75, v3, v3, v75
    v_mfma_f32_16x16x32_bf16 v[156:159], v[28:31], v[64:67], v[156:159]
    buffer_load_dwordx4 v83, s[12:15], s37 offen offset:1024 lds
    v_lshlrev_b32 v2, 16, v92
    s_waitcnt lgkmcnt(4)
    v_mfma_f32_16x16x32_bf16 v[160:163], v[32:35], v[52:55], v[160:163]
    v_and_b32 v3, s87, v92
    v_mfma_f32_16x16x32_bf16 v[164:167], v[32:35], v[56:59], v[164:167]
    ds_read_b64_tr_b16 v[24:25], v72 offset:63488
    ds_read_b64_tr_b16 v[26:27], v72 offset:64000
    v_sub_f32 v2, v2, v74
    v_mfma_f32_16x16x32_bf16 v[168:171], v[32:35], v[60:63], v[168:171]
    v_sub_f32 v3, v3, v74
    v_mfma_f32_16x16x32_bf16 v[172:175], v[32:35], v[64:67], v[172:175]
    buffer_load_dwordx4 v84, s[12:15], s37 offen offset:2048 lds
    v_fma_f32 v75, v2, v2, v75
L_cs_53_ret:
    s_cmp_eq_u32 s51, 3
    s_cbranch_scc1 L_cs_54
    s_waitcnt lgkmcnt(4)
    v_mfma_f32_16x16x32_bf16 v[176:179], v[16:19], v[52:55], v[176:179]
    ds_read_b64_tr_b16 v[28:29], v73 offset:62464
    ds_read_b64_tr_b16 v[30:31], v73 offset:62976
    v_fma_f32 v75, v3, v3, v75
    v_mfma_f32_16x16x32_bf16 v[180:183], v[16:19], v[56:59], v[180:183]
    ds_read_b64_tr_b16 v[32:33], v73 offset:63488
    ds_read_b64_tr_b16 v[34:35], v73 offset:64000
    v_lshlrev_b32 v2, 16, v93
    v_mfma_f32_16x16x32_bf16 v[184:187], v[16:19], v[60:63], v[184:187]
    v_and_b32 v3, s87, v93
    v_mfma_f32_16x16x32_bf16 v[188:191], v[16:19], v[64:67], v[188:191]
    buffer_load_dwordx4 v85, s[12:15], s37 offen offset:3072 lds
    s_add_u32 s37, s37, 128
    v_sub_f32 v2, v2, v74
    s_waitcnt lgkmcnt(6)
    v_mfma_f32_16x16x32_bf16 v[192:195], v[20:23], v[52:55], v[192:195]
    v_sub_f32 v3, v3, v74
    v_mfma_f32_16x16x32_bf16 v[196:199], v[20:23], v[56:59], v[196:199]
    v_fma_f32 v75, v2, v2, v75
    v_mfma_f32_16x16x32_bf16 v[200:203], v[20:23], v[60:63], v[200:203]
    v_fma_f32 v75, v3, v3, v75
    v_mfma_f32_16x16x32_bf16 v[204:207], v[20:23], v[64:67], v[204:207]
    v_lshlrev_b32 v2, 16, v94
L_cs_54_ret:
    s_waitcnt vmcnt(8) lgkmcnt(0)
    s_barrier
    s_cmp_eq_u32 s51, 0
    s_cbranch_scc1 L_cs_55
    v_mfma_f32_16x16x32_bf16 v[208:211], v[24:27], v[52:55], v[208:211]
    ds_read_b128 v[36:39], v80 offset:0
    ds_read_b128 v[40:43], v80 offset:2048
    v_and_b32 v3, s87, v94
    v_mfma_f32_16x16x32_bf16 v[212:215], v[24:27], v[56:59], v[212:215]
    ds_read_b128 v[44:47], v80 offset:4096
    ds_read_b128 v[48:51], v80 offset:6144
    v_sub_f32 v2, v2, v74
    v_mfma_f32_16x16x32_bf16 v[216:219], v[24:27], v[60:63], v[216:219]
    ds_read_b64_tr_b16 v[16:17], v68 offset:0
    ds_read_b64_tr_b16 v[18:19], v68 offset:512
    v_sub_f32 v3, v3, v74
    v_mfma_f32_16x16x32_bf16 v[220:223], v[24:27], v[64:67], v[220:223]
    v_fma_f32 v75, v2, v2, v75
    v_mfma_f32_16x16x32_bf16 v[224:227], v[28:31], v[52:55], v[224:227]
    v_fma_f32 v75, v3, v3, v75
    v_mfma_f32_16x16x32_bf16 v[228:231], v[28:31], v[56:59], v[228:231]
    ds_read_b64_tr_b16 v[20:21], v69 offset:0
    ds_read_b64_tr_b16 v[22:23], v69 offset:512
    v_lshlrev_b32 v2, 16, v95
    v_mfma_f32_16x16x32_bf16 v[232:235], v[28:31], v[60:63], v[232:235]
    v_and_b32 v3, s87, v95
    v_mfma_f32_16x16x32_bf16 v[236:239], v[28:31], v[64:67], v[236:239]
    v_sub_f32 v2, v2, v74
    v_mfma_f32_16x16x32_bf16 v[240:243], v[32:35], v[52:55], v[240:243]
    v_sub_f32 v3, v3, v74
    v_mfma_f32_16x16x32_bf16 v[244:247], v[32:35], v[56:59], v[244:247]
    ds_read_b64_tr_b16 v[24:25], v70 offset:1024
    ds_read_b64_tr_b16 v[26:27], v70 offset:1536
    v_fma_f32 v75, v2, v2, v75
    v_mfma_f32_16x16x32_bf16 v[248:251], v[32:35], v[60:63], v[248:251]
    v_fma_f32 v75, v3, v3, v75
    v_mfma_f32_16x16x32_bf16 v[252:255], v[32:35], v[64:67], v[252:255]
    s_nop 1
    v_add_f32_dpp v75, v75, v75 row_ror:8 row_mask:0xf bank_mask:0xf
L_cs_55_ret:
    s_cmp_eq_u32 s51, 1
    s_cbranch_scc1 L_cs_56
    s_waitcnt lgkmcnt(4)
    v_mfma_f32_16x16x32_bf16 v[96:99], v[16:19], v[36:39], v[96:99]
    ds_read_b128 v[52:55], v81 offset:0
    ds_read_b128 v[56:59], v81 offset:2048
    s_nop 1
    v_add_f32_dpp v75, v75, v75 row_ror:4 row_mask:0xf bank_mask:0xf
    v_mfma_f32_16x16x32_bf16 v[100:103], v[16:19], v[40:43], v[100:103]
    ds_read_b64_tr_b16 v[28:29], v70 offset:2048
    ds_read_b64_tr_b16 v[30:31], v70 offset:2560
    s_nop 1
    v_add_f32_dpp v75, v75, v75 row_ror:2 row_mask:0xf bank_mask:0xf
    v_mfma_f32_16x16x32_bf16 v[104:107], v[16:19], v[44:47], v[104:107]
    ds_read_b128 v[60:63], v81 offset:4096
    ds_read_b128 v[64:67], v81 offset:6144
    s_nop 1
    v_add_f32_dpp v75, v75, v75 row_ror:1 row_mask:0xf bank_mask:0xf
    v_mfma_f32_16x16x32_bf16 v[108:111], v[16:19], v[48:51], v[108:111]
    v_mov_b32 v2, v75
    s_waitcnt lgkmcnt(8)
    v_mfma_f32_16x16x32_bf16 v[112:115], v[20:23], v[36:39], v[112:115]
    s_nop 1
    v_permlane16_swap_b32 v75, v2
    v_mfma_f32_16x16x32_bf16 v[116:119], v[20:23], v[40:43], v[116:119]
    ds_read_b64_tr_b16 v[32:33], v71 offset:1024
    ds_read_b64_tr_b16 v[34:35], v71 offset:1536
    s_nop 1
    v_add_f32 v75, v75, v2
    v_mfma_f32_16x16x32_bf16 v[120:123], v[20:23], v[44:47], v[120:123]
    v_mov_b32 v2, v75
    v_mfma_f32_16x16x32_bf16 v[124:127], v[20:23], v[48:51], v[124:127]
    s_nop 1
    v_permlane32_swap_b32 v75, v2
    s_waitcnt lgkmcnt(8)
    v_mfma_f32_16x16x32_bf16 v[128:131], v[24:27], v[36:39], v[128:131]
    s_nop 1
    v_add_f32 v75, v75, v2
    v_mfma_f32_16x16x32_bf16 v[132:135], v[24:27], v[40:43], v[132:135]
    ds_read_b64_tr_b16 v[16:17], v71 offset:2048
    ds_read_b64_tr_b16 v[18:19], v71 offset:2560
    v_mov_b32 v2, 0x3727c5ac
    v_mfma_f32_16x16x32_bf16 v[136:139], v[24:27], v[44:47], v[136:139]
    v_mov_b32 v3, 0x3a800000
    v_mfma_f32_16x16x32_bf16 v[140:143], v[24:27], v[48:51], v[140:143]
    v_fma_f32 v75, v75, v3, v2
L_cs_56_ret:
    s_cmp_eq_u32 s51, 2
    s_cbranch_scc1 L_cs_57
    s_waitcnt lgkmcnt(6)
    v_mfma_f32_16x16x32_bf16 v[144:147], v[28:31], v[36:39], v[144:147]
    s_nop 0
    v_rsq_f32 v75, v75
    v_mfma_f32_16x16x32_bf16 v[148:151], v[28:31], v[40:43], v[148:151]
    ds_read_b64_tr_b16 v[20:21], v72 offset:1024
    ds_read_b64_tr_b16 v[22:23], v72 offset:1536
    s_nop 0
    s_lshl_b32 s52, s51, 2
    s_lshr_b32 s52, 0x5307, s52
    s_and_b32 s52, s52, 15
    s_lshr_b32 s53, s51, 1
    s_sub_u32 s53, 3, s53
    v_lshrrev_b32 v76, 4, v1
    v_mfma_f32_16x16x32_bf16 v[152:155], v[28:31], v[44:47], v[152:155]
    v_cmp_gt_u32 vcc, s53, v76
    v_mfma_f32_16x16x32_bf16 v[156:159], v[28:31], v[48:51], v[156:159]
    v_add_u32 v76, s52, v76
    s_waitcnt lgkmcnt(4)
    v_mfma_f32_16x16x32_bf16 v[160:163], v[32:35], v[36:39], v[160:163]
    v_and_b32 v77, 15, v1
    v_mfma_f32_16x16x32_bf16 v[164:167], v[32:35], v[40:43], v[164:167]
    ds_read_b64_tr_b16 v[24:25], v72 offset:2048
    ds_read_b64_tr_b16 v[26:27], v72 offset:2560
    v_lshlrev_b32 v77, 2, v77
    v_mfma_f32_16x16x32_bf16 v[168:171], v[32:35], v[44:47], v[168:171]
    v_lshl_add_u32 v76, v76, 6, v77
    v_mfma_f32_16x16x32_bf16 v[172:175], v[32:35], v[48:51], v[172:175]
    v_mov_b32 v77, 2147418112
L_cs_57_ret:
    s_cmp_eq_u32 s51, 3
    s_cbranch_scc1 L_cs_58
    s_waitcnt lgkmcnt(4)
    v_mfma_f32_16x16x32_bf16 v[176:179], v[16:19], v[36:39], v[176:179]
    ds_read_b64_tr_b16 v[28:29], v73 offset:1024
    ds_read_b64_tr_b16 v[30:31], v73 offset:1536
    v_cndmask_b32 v76, v77, v76, vcc
    v_mfma_f32_16x16x32_bf16 v[180:183], v[16:19], v[40:43], v[180:183]
    ds_read_b64_tr_b16 v[32:33], v73 offset:2048
    ds_read_b64_tr_b16 v[34:35], v73 offset:2560
    v_cmp_eq_u32 vcc, 0, v1
    v_mfma_f32_16x16x32_bf16 v[184:187], v[16:19], v[44:47], v[184:187]
    s_and_b32 s52, s2, 31
    s_mul_i32 s52, s52, 10240
    s_mul_i32 s53, s48, 1280
    s_add_u32 s52, s52, s53
    s_mul_i32 s53, s50, 640
    s_add_u32 s52, s52, s53
    s_add_u32 s54, s52, 52498432
    v_cndmask_b32 v77, v77, v1, vcc
    v_mfma_f32_16x16x32_bf16 v[188:191], v[16:19], v[48:51], v[188:191]
    s_lshl_b32 s55, s2, 7
    s_lshl_b32 s53, s49, 3
    s_add_u32 s55, s55, s53
    s_add_u32 s55, s55, 52465664
    s_waitcnt lgkmcnt(6)
    v_mfma_f32_16x16x32_bf16 v[192:195], v[20:23], v[36:39], v[192:195]
    v_mfma_f32_16x16x32_bf16 v[196:199], v[20:23], v[40:43], v[196:199]
    v_mfma_f32_16x16x32_bf16 v[200:203], v[20:23], v[44:47], v[200:203]
    v_mfma_f32_16x16x32_bf16 v[204:207], v[20:23], v[48:51], v[204:207]
L_cs_58_ret:
    s_nop 7
    s_nop 7
    v_mov_b32_dpp v4, v8 quad_perm:[0,1,2,3] row_mask:0x2 bank_mask:0xf
    v_mov_b32_dpp v4, v12 quad_perm:[0,1,2,3] row_mask:0x4 bank_mask:0xf
    buffer_store_dwordx2 v[74:75], v77, s[32:35], s55 offen sc0 sc1
    buffer_store_dword v4, v76, s[32:35], s54 offen sc0 sc1
    s_cmp_eq_u32 s45, 5
    s_cselect_b32 s52, s60, 0
    s_sub_u32 s36, s36, s52
    s_cmp_eq_u32 s45, 5
    s_cselect_b32 s52, s60, 0
    s_sub_u32 s37, s37, s52
    s_cmp_eq_u32 s45, 5
    s_sub_u32 s45, s45, 1
    s_cmp_lg_u32 s45, 1
    s_waitcnt vmcnt(10) lgkmcnt(0)
    s_barrier
    s_branch L_g1_loop_X0
L_cs_43:
    v_mfma_f32_16x16x32_bf16 v[208:211], v[24:27], v[36:39], v[208:211]
    v_mfma_f32_16x16x32_bf16 v[212:215], v[24:27], v[40:43], v[212:215]
    v_mfma_f32_16x16x32_bf16 v[216:219], v[24:27], v[44:47], v[216:219]
    ds_read_b64_tr_b16 v[16:17], v68 offset:20480
    ds_read_b64_tr_b16 v[18:19], v68 offset:20992
    v_mfma_f32_16x16x32_bf16 v[220:223], v[24:27], v[48:51], v[220:223]
    v_mfma_f32_16x16x32_bf16 v[4:7], v[88:91], v[24:27], v[4:7]
    v_mfma_f32_16x16x32_bf16 v[224:227], v[28:31], v[36:39], v[224:227]
    v_mfma_f32_16x16x32_bf16 v[228:231], v[28:31], v[40:43], v[228:231]
    ds_read_b64_tr_b16 v[20:21], v69 offset:20480
    ds_read_b64_tr_b16 v[22:23], v69 offset:20992
    v_mfma_f32_16x16x32_bf16 v[232:235], v[28:31], v[44:47], v[232:235]
    v_mfma_f32_16x16x32_bf16 v[236:239], v[28:31], v[48:51], v[236:239]
    s_add_u32 m0, s44, 0
    s_nop 0
    buffer_load_dwordx4 v82, s[12:15], s36 offen offset:0 lds
    v_mfma_f32_16x16x32_bf16 v[8:11], v[88:91], v[28:31], v[8:11]
    v_mfma_f32_16x16x32_bf16 v[240:243], v[32:35], v[36:39], v[240:243]
    v_mfma_f32_16x16x32_bf16 v[244:247], v[32:35], v[40:43], v[244:247]
    ds_read_b64_tr_b16 v[24:25], v70 offset:21504
    ds_read_b64_tr_b16 v[26:27], v70 offset:22016
    v_mfma_f32_16x16x32_bf16 v[248:251], v[32:35], v[44:47], v[248:251]
    v_mfma_f32_16x16x32_bf16 v[252:255], v[32:35], v[48:51], v[252:255]
    buffer_load_dwordx4 v83, s[12:15], s36 offen offset:1024 lds
    v_mfma_f32_16x16x32_bf16 v[12:15], v[88:91], v[32:35], v[12:15]
    s_branch L_cs_43_ret
L_cs_44:
    s_waitcnt lgkmcnt(4)
    v_mfma_f32_16x16x32_bf16 v[96:99], v[16:19], v[52:55], v[96:99]
    v_mfma_f32_16x16x32_bf16 v[100:103], v[16:19], v[56:59], v[100:103]
    ds_read_b64_tr_b16 v[28:29], v70 offset:22528
    ds_read_b64_tr_b16 v[30:31], v70 offset:23040
    v_mfma_f32_16x16x32_bf16 v[104:107], v[16:19], v[60:63], v[104:107]
    v_mfma_f32_16x16x32_bf16 v[108:111], v[16:19], v[64:67], v[108:111]
    buffer_load_dwordx4 v84, s[12:15], s36 offen offset:2048 lds
    v_mfma_f32_16x16x32_bf16 v[4:7], v[88:91], v[16:19], v[4:7]
    s_waitcnt lgkmcnt(4)
    v_mfma_f32_16x16x32_bf16 v[112:115], v[20:23], v[52:55], v[112:115]
    v_mfma_f32_16x16x32_bf16 v[116:119], v[20:23], v[56:59], v[116:119]
    ds_read_b64_tr_b16 v[32:33], v71 offset:21504
    ds_read_b64_tr_b16 v[34:35], v71 offset:22016
    v_mfma_f32_16x16x32_bf16 v[120:123], v[20:23], v[60:63], v[120:123]
    v_mfma_f32_16x16x32_bf16 v[124:127], v[20:23], v[64:67], v[124:127]
    buffer_load_dwordx4 v85, s[12:15], s36 offen offset:3072 lds
    s_add_u32 s36, s36, 128
    v_mfma_f32_16x16x32_bf16 v[8:11], v[88:91], v[20:23], v[8:11]
    s_waitcnt lgkmcnt(4)
    v_mfma_f32_16x16x32_bf16 v[128:131], v[24:27], v[52:55], v[128:131]
    v_mfma_f32_16x16x32_bf16 v[132:135], v[24:27], v[56:59], v[132:135]
    ds_read_b64_tr_b16 v[16:17], v71 offset:22528
    ds_read_b64_tr_b16 v[18:19], v71 offset:23040
    v_mfma_f32_16x16x32_bf16 v[136:139], v[24:27], v[60:63], v[136:139]
    v_mfma_f32_16x16x32_bf16 v[140:143], v[24:27], v[64:67], v[140:143]
    s_add_u32 m0, s44, 4096
    s_nop 0
    buffer_load_dwordx4 v82, s[12:15], s37 offen offset:0 lds
    v_mfma_f32_16x16x32_bf16 v[12:15], v[88:91], v[24:27], v[12:15]
    s_branch L_cs_44_ret
L_cs_45:
    s_waitcnt lgkmcnt(4)
    v_mfma_f32_16x16x32_bf16 v[144:147], v[28:31], v[52:55], v[144:147]
    v_mfma_f32_16x16x32_bf16 v[148:151], v[28:31], v[56:59], v[148:151]
    ds_read_b64_tr_b16 v[20:21], v72 offset:21504
    ds_read_b64_tr_b16 v[22:23], v72 offset:22016
    v_mfma_f32_16x16x32_bf16 v[152:155], v[28:31], v[60:63], v[152:155]
    v_mfma_f32_16x16x32_bf16 v[156:159], v[28:31], v[64:67], v[156:159]
    buffer_load_dwordx4 v83, s[12:15], s37 offen offset:1024 lds
    v_mfma_f32_16x16x32_bf16 v[4:7], v[88:91], v[28:31], v[4:7]
    s_waitcnt lgkmcnt(4)
    v_mfma_f32_16x16x32_bf16 v[160:163], v[32:35], v[52:55], v[160:163]
    v_mfma_f32_16x16x32_bf16 v[164:167], v[32:35], v[56:59], v[164:167]
    ds_read_b64_tr_b16 v[24:25], v72 offset:22528
    ds_read_b64_tr_b16 v[26:27], v72 offset:23040
    v_mfma_f32_16x16x32_bf16 v[168:171], v[32:35], v[60:63], v[168:171]
    v_mfma_f32_16x16x32_bf16 v[172:175], v[32:35], v[64:67], v[172:175]
    buffer_load_dwordx4 v84, s[12:15], s37 offen offset:2048 lds
    v_mfma_f32_16x16x32_bf16 v[8:11], v[88:91], v[32:35], v[8:11]
    s_branch L_cs_45_ret
L_cs_46:
    s_waitcnt lgkmcnt(4)
    v_mfma_f32_16x16x32_bf16 v[176:179], v[16:19], v[52:55], v[176:179]
    ds_read_b64_tr_b16 v[28:29], v73 offset:21504
    ds_read_b64_tr_b16 v[30:31], v73 offset:22016
    v_mfma_f32_16x16x32_bf16 v[180:183], v[16:19], v[56:59], v[180:183]
    ds_read_b64_tr_b16 v[32:33], v73 offset:22528
    ds_read_b64_tr_b16 v[34:35], v73 offset:23040
    v_mfma_f32_16x16x32_bf16 v[184:187], v[16:19], v[60:63], v[184:187]
    v_mfma_f32_16x16x32_bf16 v[188:191], v[16:19], v[64:67], v[188:191]
    buffer_load_dwordx4 v85, s[12:15], s37 offen offset:3072 lds
    s_add_u32 s37, s37, 128
    v_mfma_f32_16x16x32_bf16 v[4:7], v[88:91], v[16:19], v[4:7]
    s_waitcnt lgkmcnt(6)
    v_mfma_f32_16x16x32_bf16 v[192:195], v[20:23], v[52:55], v[192:195]
    v_mfma_f32_16x16x32_bf16 v[196:199], v[20:23], v[56:59], v[196:199]
    v_mfma_f32_16x16x32_bf16 v[200:203], v[20:23], v[60:63], v[200:203]
    v_mfma_f32_16x16x32_bf16 v[204:207], v[20:23], v[64:67], v[204:207]
    v_mfma_f32_16x16x32_bf16 v[8:11], v[88:91], v[20:23], v[8:11]
    s_branch L_cs_46_ret
L_cs_47:
    v_mfma_f32_16x16x32_bf16 v[208:211], v[24:27], v[52:55], v[208:211]
    ds_read_b128 v[36:39], v80 offset:32768
    ds_read_b128 v[40:43], v80 offset:34816
    v_lshlrev_b32 v74, 16, v76
    v_mfma_f32_16x16x32_bf16 v[212:215], v[24:27], v[56:59], v[212:215]
    ds_read_b128 v[44:47], v80 offset:36864
    ds_read_b128 v[48:51], v80 offset:38912
    v_and_b32 v75, s87, v76
    v_mfma_f32_16x16x32_bf16 v[216:219], v[24:27], v[60:63], v[216:219]
    ds_read_b64_tr_b16 v[16:17], v68 offset:40960
    ds_read_b64_tr_b16 v[18:19], v68 offset:41472
    v_lshlrev_b32 v2, 16, v77
    v_mfma_f32_16x16x32_bf16 v[220:223], v[24:27], v[64:67], v[220:223]
    v_mfma_f32_16x16x32_bf16 v[4:7], v[88:91], v[24:27], v[4:7]
    v_and_b32 v3, s87, v77
    v_mfma_f32_16x16x32_bf16 v[224:227], v[28:31], v[52:55], v[224:227]
    v_add_f32 v74, v74, v2
    v_mfma_f32_16x16x32_bf16 v[228:231], v[28:31], v[56:59], v[228:231]
    ds_read_b64_tr_b16 v[20:21], v69 offset:40960
    ds_read_b64_tr_b16 v[22:23], v69 offset:41472
    v_add_f32 v75, v75, v3
    v_mfma_f32_16x16x32_bf16 v[232:235], v[28:31], v[60:63], v[232:235]
    v_lshlrev_b32 v2, 16, v78
    v_mfma_f32_16x16x32_bf16 v[236:239], v[28:31], v[64:67], v[236:239]
    v_mfma_f32_16x16x32_bf16 v[8:11], v[88:91], v[28:31], v[8:11]
    v_and_b32 v3, s87, v78
    v_mfma_f32_16x16x32_bf16 v[240:243], v[32:35], v[52:55], v[240:243]
    v_add_f32 v74, v74, v2
    v_mfma_f32_16x16x32_bf16 v[244:247], v[32:35], v[56:59], v[244:247]
    ds_read_b64_tr_b16 v[24:25], v70 offset:41984
    ds_read_b64_tr_b16 v[26:27], v70 offset:42496
    v_add_f32 v75, v75, v3
    v_mfma_f32_16x16x32_bf16 v[248:251], v[32:35], v[60:63], v[248:251]
    v_lshlrev_b32 v2, 16, v79
    v_mfma_f32_16x16x32_bf16 v[252:255], v[32:35], v[64:67], v[252:255]
    v_mfma_f32_16x16x32_bf16 v[12:15], v[88:91], v[32:35], v[12:15]
    v_and_b32 v3, s87, v79
    s_branch L_cs_47_ret
L_cs_48:
    s_waitcnt lgkmcnt(4)
    v_mfma_f32_16x16x32_bf16 v[96:99], v[16:19], v[36:39], v[96:99]
    ds_read_b128 v[52:55], v81 offset:32768
    ds_read_b128 v[56:59], v81 offset:34816
    v_add_f32 v74, v74, v2
    v_mfma_f32_16x16x32_bf16 v[100:103], v[16:19], v[40:43], v[100:103]
    ds_read_b64_tr_b16 v[28:29], v70 offset:43008
    ds_read_b64_tr_b16 v[30:31], v70 offset:43520
    v_add_f32 v75, v75, v3
    v_mfma_f32_16x16x32_bf16 v[104:107], v[16:19], v[44:47], v[104:107]
    ds_read_b128 v[60:63], v81 offset:36864
    ds_read_b128 v[64:67], v81 offset:38912
    v_lshlrev_b32 v2, 16, v92
    v_mfma_f32_16x16x32_bf16 v[108:111], v[16:19], v[48:51], v[108:111]
    v_mfma_f32_16x16x32_bf16 v[4:7], v[88:91], v[16:19], v[4:7]
    v_and_b32 v3, s87, v92
    s_waitcnt lgkmcnt(8)
    v_mfma_f32_16x16x32_bf16 v[112:115], v[20:23], v[36:39], v[112:115]
    v_add_f32 v74, v74, v2
    v_mfma_f32_16x16x32_bf16 v[116:119], v[20:23], v[40:43], v[116:119]
    ds_read_b64_tr_b16 v[32:33], v71 offset:41984
    ds_read_b64_tr_b16 v[34:35], v71 offset:42496
    v_add_f32 v75, v75, v3
    v_mfma_f32_16x16x32_bf16 v[120:123], v[20:23], v[44:47], v[120:123]
    v_lshlrev_b32 v2, 16, v93
    v_mfma_f32_16x16x32_bf16 v[124:127], v[20:23], v[48:51], v[124:127]
    v_mfma_f32_16x16x32_bf16 v[8:11], v[88:91], v[20:23], v[8:11]
    v_and_b32 v3, s87, v93
    s_waitcnt lgkmcnt(8)
    v_mfma_f32_16x16x32_bf16 v[128:131], v[24:27], v[36:39], v[128:131]
    v_add_f32 v74, v74, v2
    v_mfma_f32_16x16x32_bf16 v[132:135], v[24:27], v[40:43], v[132:135]
    ds_read_b64_tr_b16 v[16:17], v71 offset:43008
    ds_read_b64_tr_b16 v[18:19], v71 offset:43520
    v_add_f32 v75, v75, v3
    v_mfma_f32_16x16x32_bf16 v[136:139], v[24:27], v[44:47], v[136:139]
    v_lshlrev_b32 v2, 16, v94
    v_mfma_f32_16x16x32_bf16 v[140:143], v[24:27], v[48:51], v[140:143]
    v_mfma_f32_16x16x32_bf16 v[12:15], v[88:91], v[24:27], v[12:15]
    v_and_b32 v3, s87, v94
    s_branch L_cs_48_ret
L_cs_49:
    s_waitcnt lgkmcnt(6)
    v_mfma_f32_16x16x32_bf16 v[144:147], v[28:31], v[36:39], v[144:147]
    v_add_f32 v74, v74, v2
    v_mfma_f32_16x16x32_bf16 v[148:151], v[28:31], v[40:43], v[148:151]
    ds_read_b64_tr_b16 v[20:21], v72 offset:41984
    ds_read_b64_tr_b16 v[22:23], v72 offset:42496
    v_add_f32 v75, v75, v3
    v_mfma_f32_16x16x32_bf16 v[152:155], v[28:31], v[44:47], v[152:155]
    v_lshlrev_b32 v2, 16, v95
    v_mfma_f32_16x16x32_bf16 v[156:159], v[28:31], v[48:51], v[156:159]
    v_mfma_f32_16x16x32_bf16 v[4:7], v[88:91], v[28:31], v[4:7]
    v_and_b32 v3, s87, v95
    s_waitcnt lgkmcnt(4)
    v_mfma_f32_16x16x32_bf16 v[160:163], v[32:35], v[36:39], v[160:163]
    v_add_f32 v74, v74, v2
    v_mfma_f32_16x16x32_bf16 v[164:167], v[32:35], v[40:43], v[164:167]
    ds_read_b64_tr_b16 v[24:25], v72 offset:43008
    ds_read_b64_tr_b16 v[26:27], v72 offset:43520
    v_add_f32 v75, v75, v3
    v_mfma_f32_16x16x32_bf16 v[168:171], v[32:35], v[44:47], v[168:171]
    v_add_f32 v74, v74, v75
    v_mfma_f32_16x16x32_bf16 v[172:175], v[32:35], v[48:51], v[172:175]
    v_mfma_f32_16x16x32_bf16 v[8:11], v[88:91], v[32:35], v[8:11]
    s_nop 1
    v_add_f32_dpp v74, v74, v74 row_ror:8 row_mask:0xf bank_mask:0xf
    s_branch L_cs_49_ret
L_cs_50:
    s_waitcnt lgkmcnt(4)
    v_mfma_f32_16x16x32_bf16 v[176:179], v[16:19], v[36:39], v[176:179]
    ds_read_b64_tr_b16 v[28:29], v73 offset:41984
    ds_read_b64_tr_b16 v[30:31], v73 offset:42496
    s_nop 1
    v_add_f32_dpp v74, v74, v74 row_ror:4 row_mask:0xf bank_mask:0xf
    v_mfma_f32_16x16x32_bf16 v[180:183], v[16:19], v[40:43], v[180:183]
    ds_read_b64_tr_b16 v[32:33], v73 offset:43008
    ds_read_b64_tr_b16 v[34:35], v73 offset:43520
    s_nop 1
    v_add_f32_dpp v74, v74, v74 row_ror:2 row_mask:0xf bank_mask:0xf
    v_mfma_f32_16x16x32_bf16 v[184:187], v[16:19], v[44:47], v[184:187]
    s_nop 1
    v_add_f32_dpp v74, v74, v74 row_ror:1 row_mask:0xf bank_mask:0xf
    v_mfma_f32_16x16x32_bf16 v[188:191], v[16:19], v[48:51], v[188:191]
    v_mfma_f32_16x16x32_bf16 v[4:7], v[88:91], v[16:19], v[4:7]
    v_mov_b32 v2, v74
    s_waitcnt lgkmcnt(6)
    v_mfma_f32_16x16x32_bf16 v[192:195], v[20:23], v[36:39], v[192:195]
    s_nop 1
    v_permlane16_swap_b32 v74, v2
    v_mfma_f32_16x16x32_bf16 v[196:199], v[20:23], v[40:43], v[196:199]
    s_nop 1
    v_add_f32 v74, v74, v2
    v_mfma_f32_16x16x32_bf16 v[200:203], v[20:23], v[44:47], v[200:203]
    v_mov_b32 v2, v74
    v_mfma_f32_16x16x32_bf16 v[204:207], v[20:23], v[48:51], v[204:207]
    v_mfma_f32_16x16x32_bf16 v[8:11], v[88:91], v[20:23], v[8:11]
    s_nop 1
    v_permlane32_swap_b32 v74, v2
    s_branch L_cs_50_ret
L_cs_51:
    v_mfma_f32_16x16x32_bf16 v[208:211], v[24:27], v[36:39], v[208:211]
    s_nop 1
    v_add_f32 v74, v74, v2
    v_mfma_f32_16x16x32_bf16 v[212:215], v[24:27], v[40:43], v[212:215]
    v_mul_f32 v74, 0x3a800000, v74
    v_mfma_f32_16x16x32_bf16 v[216:219], v[24:27], v[44:47], v[216:219]
    ds_read_b64_tr_b16 v[16:17], v68 offset:61440
    ds_read_b64_tr_b16 v[18:19], v68 offset:61952
    v_mov_b32 v75, 0
    v_mfma_f32_16x16x32_bf16 v[220:223], v[24:27], v[48:51], v[220:223]
    v_mfma_f32_16x16x32_bf16 v[4:7], v[88:91], v[24:27], v[4:7]
    v_lshlrev_b32 v2, 16, v76
    v_mfma_f32_16x16x32_bf16 v[224:227], v[28:31], v[36:39], v[224:227]
    v_and_b32 v3, s87, v76
    v_mfma_f32_16x16x32_bf16 v[228:231], v[28:31], v[40:43], v[228:231]
    ds_read_b64_tr_b16 v[20:21], v69 offset:61440
    ds_read_b64_tr_b16 v[22:23], v69 offset:61952
    v_sub_f32 v2, v2, v74
    v_mfma_f32_16x16x32_bf16 v[232:235], v[28:31], v[44:47], v[232:235]
    v_sub_f32 v3, v3, v74
    v_mfma_f32_16x16x32_bf16 v[236:239], v[28:31], v[48:51], v[236:239]
    s_add_u32 m0, s44, 32768
    s_nop 0
    buffer_load_dwordx4 v82, s[12:15], s36 offen offset:0 lds
    v_mfma_f32_16x16x32_bf16 v[8:11], v[88:91], v[28:31], v[8:11]
    v_fma_f32 v75, v2, v2, v75
    v_mfma_f32_16x16x32_bf16 v[240:243], v[32:35], v[36:39], v[240:243]
    v_fma_f32 v75, v3, v3, v75
    v_mfma_f32_16x16x32_bf16 v[244:247], v[32:35], v[40:43], v[244:247]
    ds_read_b64_tr_b16 v[24:25], v70 offset:62464
    ds_read_b64_tr_b16 v[26:27], v70 offset:62976
    v_lshlrev_b32 v2, 16, v77
    v_mfma_f32_16x16x32_bf16 v[248:251], v[32:35], v[44:47], v[248:251]
    v_and_b32 v3, s87, v77
    v_mfma_f32_16x16x32_bf16 v[252:255], v[32:35], v[48:51], v[252:255]
    buffer_load_dwordx4 v83, s[12:15], s36 offen offset:1024 lds
    v_mfma_f32_16x16x32_bf16 v[12:15], v[88:91], v[32:35], v[12:15]
    v_sub_f32 v2, v2, v74
    s_branch L_cs_51_ret
L_cs_52:
    s_waitcnt lgkmcnt(4)
    v_mfma_f32_16x16x32_bf16 v[96:99], v[16:19], v[52:55], v[96:99]
    v_sub_f32 v3, v3, v74
    v_mfma_f32_16x16x32_bf16 v[100:103], v[16:19], v[56:59], v[100:103]
    ds_read_b64_tr_b16 v[28:29], v70 offset:63488
    ds_read_b64_tr_b16 v[30:31], v70 offset:64000
    v_fma_f32 v75, v2, v2, v75
    v_mfma_f32_16x16x32_bf16 v[104:107], v[16:19], v[60:63], v[104:107]
    v_fma_f32 v75, v3, v3, v75
    v_mfma_f32_16x16x32_bf16 v[108:111], v[16:19], v[64:67], v[108:111]
    buffer_load_dwordx4 v84, s[12:15], s36 offen offset:2048 lds
    v_mfma_f32_16x16x32_bf16 v[4:7], v[88:91], v[16:19], v[4:7]
    v_lshlrev_b32 v2, 16, v78
    s_waitcnt lgkmcnt(4)
    v_mfma_f32_16x16x32_bf16 v[112:115], v[20:23], v[52:55], v[112:115]
    v_and_b32 v3, s87, v78
    v_mfma_f32_16x16x32_bf16 v[116:119], v[20:23], v[56:59], v[116:119]
    ds_read_b64_tr_b16 v[32:33], v71 offset:62464
    ds_read_b64_tr_b16 v[34:35], v71 offset:62976
    v_sub_f32 v2, v2, v74
    v_mfma_f32_16x16x32_bf16 v[120:123], v[20:23], v[60:63], v[120:123]
    v_sub_f32 v3, v3, v74
    v_mfma_f32_16x16x32_bf16 v[124:127], v[20:23], v[64:67], v[124:127]
    buffer_load_dwordx4 v85, s[12:15], s36 offen offset:3072 lds
    s_add_u32 s36, s36, 128
    v_mfma_f32_16x16x32_bf16 v[8:11], v[88:91], v[20:23], v[8:11]
    v_fma_f32 v75, v2, v2, v75
    s_waitcnt lgkmcnt(4)
    v_mfma_f32_16x16x32_bf16 v[128:131], v[24:27], v[52:55], v[128:131]
    v_fma_f32 v75, v3, v3, v75
    v_mfma_f32_16x16x32_bf16 v[132:135], v[24:27], v[56:59], v[132:135]
    ds_read_b64_tr_b16 v[16:17], v71 offset:63488
    ds_read_b64_tr_b16 v[18:19], v71 offset:64000
    v_lshlrev_b32 v2, 16, v79
    v_mfma_f32_16x16x32_bf16 v[136:139], v[24:27], v[60:63], v[136:139]
    v_and_b32 v3, s87, v79
    v_mfma_f32_16x16x32_bf16 v[140:143], v[24:27], v[64:67], v[140:143]
    s_add_u32 m0, s44, 36864
    s_nop 0
    buffer_load_dwordx4 v82, s[12:15], s37 offen offset:0 lds
    v_mfma_f32_16x16x32_bf16 v[12:15], v[88:91], v[24:27], v[12:15]
    v_sub_f32 v2, v2, v74
    s_branch L_cs_52_ret
L_cs_53:
    s_waitcnt lgkmcnt(4)
    v_mfma_f32_16x16x32_bf16 v[144:147], v[28:31], v[52:55], v[144:147]
    v_sub_f32 v3, v3, v74
    v_mfma_f32_16x16x32_bf16 v[148:151], v[28:31], v[56:59], v[148:151]
    ds_read_b64_tr_b16 v[20:21], v72 offset:62464
    ds_read_b64_tr_b16 v[22:23], v72 offset:62976
    v_fma_f32 v75, v2, v2, v75
    v_mfma_f32_16x16x32_bf16 v[152:155], v[28:31], v[60:63], v[152:155]
    v_fma_f32 v75, v3, v3, v75
    v_mfma_f32_16x16x32_bf16 v[156:159], v[28:31], v[64:67], v[156:159]
    buffer_load_dwordx4 v83, s[12:15], s37 offen offset:1024 lds
    v_mfma_f32_16x16x32_bf16 v[4:7], v[88:91], v[28:31], v[4:7]
    v_lshlrev_b32 v2, 16, v92
    s_waitcnt lgkmcnt(4)
    v_mfma_f32_16x16x32_bf16 v[160:163], v[32:35], v[52:55], v[160:163]
    v_and_b32 v3, s87, v92
    v_mfma_f32_16x16x32_bf16 v[164:167], v[32:35], v[56:59], v[164:167]
    ds_read_b64_tr_b16 v[24:25], v72 offset:63488
    ds_read_b64_tr_b16 v[26:27], v72 offset:64000
    v_sub_f32 v2, v2, v74
    v_mfma_f32_16x16x32_bf16 v[168:171], v[32:35], v[60:63], v[168:171]
    v_sub_f32 v3, v3, v74
    v_mfma_f32_16x16x32_bf16 v[172:175], v[32:35], v[64:67], v[172:175]
    buffer_load_dwordx4 v84, s[12:15], s37 offen offset:2048 lds
    v_mfma_f32_16x16x32_bf16 v[8:11], v[88:91], v[32:35], v[8:11]
    v_fma_f32 v75, v2, v2, v75
    s_branch L_cs_53_ret
L_cs_54:
    s_waitcnt lgkmcnt(4)
    v_mfma_f32_16x16x32_bf16 v[176:179], v[16:19], v[52:55], v[176:179]
    ds_read_b64_tr_b16 v[28:29], v73 offset:62464
    ds_read_b64_tr_b16 v[30:31], v73 offset:62976
    v_fma_f32 v75, v3, v3, v75
    v_mfma_f32_16x16x32_bf16 v[180:183], v[16:19], v[56:59], v[180:183]
    ds_read_b64_tr_b16 v[32:33], v73 offset:63488
    ds_read_b64_tr_b16 v[34:35], v73 offset:64000
    v_lshlrev_b32 v2, 16, v93
    v_mfma_f32_16x16x32_bf16 v[184:187], v[16:19], v[60:63], v[184:187]
    v_and_b32 v3, s87, v93
    v_mfma_f32_16x16x32_bf16 v[188:191], v[16:19], v[64:67], v[188:191]
    buffer_load_dwordx4 v85, s[12:15], s37 offen offset:3072 lds
    s_add_u32 s37, s37, 128
    v_mfma_f32_16x16x32_bf16 v[4:7], v[88:91], v[16:19], v[4:7]
    v_sub_f32 v2, v2, v74
    s_waitcnt lgkmcnt(6)
    v_mfma_f32_16x16x32_bf16 v[192:195], v[20:23], v[52:55], v[192:195]
    v_sub_f32 v3, v3, v74
    v_mfma_f32_16x16x32_bf16 v[196:199], v[20:23], v[56:59], v[196:199]
    v_fma_f32 v75, v2, v2, v75
    v_mfma_f32_16x16x32_bf16 v[200:203], v[20:23], v[60:63], v[200:203]
    v_fma_f32 v75, v3, v3, v75
    v_mfma_f32_16x16x32_bf16 v[204:207], v[20:23], v[64:67], v[204:207]
    v_mfma_f32_16x16x32_bf16 v[8:11], v[88:91], v[20:23], v[8:11]
    v_lshlrev_b32 v2, 16, v94
    s_branch L_cs_54_ret
L_cs_55:
    v_mfma_f32_16x16x32_bf16 v[208:211], v[24:27], v[52:55], v[208:211]
    ds_read_b128 v[36:39], v80 offset:0
    ds_read_b128 v[40:43], v80 offset:2048
    v_and_b32 v3, s87, v94
    v_mfma_f32_16x16x32_bf16 v[212:215], v[24:27], v[56:59], v[212:215]
    ds_read_b128 v[44:47], v80 offset:4096
    ds_read_b128 v[48:51], v80 offset:6144
    v_sub_f32 v2, v2, v74
    v_mfma_f32_16x16x32_bf16 v[216:219], v[24:27], v[60:63], v[216:219]
    ds_read_b64_tr_b16 v[16:17], v68 offset:0
    ds_read_b64_tr_b16 v[18:19], v68 offset:512
    v_sub_f32 v3, v3, v74
    v_mfma_f32_16x16x32_bf16 v[220:223], v[24:27], v[64:67], v[220:223]
    v_mfma_f32_16x16x32_bf16 v[4:7], v[88:91], v[24:27], v[4:7]
    v_fma_f32 v75, v2, v2, v75
    v_mfma_f32_16x16x32_bf16 v[224:227], v[28:31], v[52:55], v[224:227]
    v_fma_f32 v75, v3, v3, v75
    v_mfma_f32_16x16x32_bf16 v[228:231], v[28:31], v[56:59], v[228:231]
    ds_read_b64_tr_b16 v[20:21], v69 offset:0
    ds_read_b64_tr_b16 v[22:23], v69 offset:512
    v_lshlrev_b32 v2, 16, v95
    v_mfma_f32_16x16x32_bf16 v[232:235], v[28:31], v[60:63], v[232:235]
    v_and_b32 v3, s87, v95
    v_mfma_f32_16x16x32_bf16 v[236:239], v[28:31], v[64:67], v[236:239]
    v_mfma_f32_16x16x32_bf16 v[8:11], v[88:91], v[28:31], v[8:11]
    v_sub_f32 v2, v2, v74
    v_mfma_f32_16x16x32_bf16 v[240:243], v[32:35], v[52:55], v[240:243]
    v_sub_f32 v3, v3, v74
    v_mfma_f32_16x16x32_bf16 v[244:247], v[32:35], v[56:59], v[244:247]
    ds_read_b64_tr_b16 v[24:25], v70 offset:1024
    ds_read_b64_tr_b16 v[26:27], v70 offset:1536
    v_fma_f32 v75, v2, v2, v75
    v_mfma_f32_16x16x32_bf16 v[248:251], v[32:35], v[60:63], v[248:251]
    v_fma_f32 v75, v3, v3, v75
    v_mfma_f32_16x16x32_bf16 v[252:255], v[32:35], v[64:67], v[252:255]
    v_mfma_f32_16x16x32_bf16 v[12:15], v[88:91], v[32:35], v[12:15]
    s_nop 1
    v_add_f32_dpp v75, v75, v75 row_ror:8 row_mask:0xf bank_mask:0xf
    s_branch L_cs_55_ret
L_cs_56:
    s_waitcnt lgkmcnt(4)
    v_mfma_f32_16x16x32_bf16 v[96:99], v[16:19], v[36:39], v[96:99]
    ds_read_b128 v[52:55], v81 offset:0
    ds_read_b128 v[56:59], v81 offset:2048
    s_nop 1
    v_add_f32_dpp v75, v75, v75 row_ror:4 row_mask:0xf bank_mask:0xf
    v_mfma_f32_16x16x32_bf16 v[100:103], v[16:19], v[40:43], v[100:103]
    ds_read_b64_tr_b16 v[28:29], v70 offset:2048
    ds_read_b64_tr_b16 v[30:31], v70 offset:2560
    s_nop 1
    v_add_f32_dpp v75, v75, v75 row_ror:2 row_mask:0xf bank_mask:0xf
    v_mfma_f32_16x16x32_bf16 v[104:107], v[16:19], v[44:47], v[104:107]
    ds_read_b128 v[60:63], v81 offset:4096
    ds_read_b128 v[64:67], v81 offset:6144
    s_nop 1
    v_add_f32_dpp v75, v75, v75 row_ror:1 row_mask:0xf bank_mask:0xf
    v_mfma_f32_16x16x32_bf16 v[108:111], v[16:19], v[48:51], v[108:111]
    v_mfma_f32_16x16x32_bf16 v[4:7], v[88:91], v[16:19], v[4:7]
    v_mov_b32 v2, v75
    s_waitcnt lgkmcnt(8)
    v_mfma_f32_16x16x32_bf16 v[112:115], v[20:23], v[36:39], v[112:115]
    s_nop 1
    v_permlane16_swap_b32 v75, v2
    v_mfma_f32_16x16x32_bf16 v[116:119], v[20:23], v[40:43], v[116:119]
    ds_read_b64_tr_b16 v[32:33], v71 offset:1024
    ds_read_b64_tr_b16 v[34:35], v71 offset:1536
    s_nop 1
    v_add_f32 v75, v75, v2
    v_mfma_f32_16x16x32_bf16 v[120:123], v[20:23], v[44:47], v[120:123]
    v_mov_b32 v2, v75
    v_mfma_f32_16x16x32_bf16 v[124:127], v[20:23], v[48:51], v[124:127]
    v_mfma_f32_16x16x32_bf16 v[8:11], v[88:91], v[20:23], v[8:11]
    s_nop 1
    v_permlane32_swap_b32 v75, v2
    s_waitcnt lgkmcnt(8)
    v_mfma_f32_16x16x32_bf16 v[128:131], v[24:27], v[36:39], v[128:131]
    s_nop 1
    v_add_f32 v75, v75, v2
    v_mfma_f32_16x16x32_bf16 v[132:135], v[24:27], v[40:43], v[132:135]
    ds_read_b64_tr_b16 v[16:17], v71 offset:2048
    ds_read_b64_tr_b16 v[18:19], v71 offset:2560
    v_mov_b32 v2, 0x3727c5ac
    v_mfma_f32_16x16x32_bf16 v[136:139], v[24:27], v[44:47], v[136:139]
    v_mov_b32 v3, 0x3a800000
    v_mfma_f32_16x16x32_bf16 v[140:143], v[24:27], v[48:51], v[140:143]
    v_mfma_f32_16x16x32_bf16 v[12:15], v[88:91], v[24:27], v[12:15]
    v_fma_f32 v75, v75, v3, v2
    s_branch L_cs_56_ret
L_cs_57:
    s_waitcnt lgkmcnt(6)
    v_mfma_f32_16x16x32_bf16 v[144:147], v[28:31], v[36:39], v[144:147]
    s_nop 0
    v_rsq_f32 v75, v75
    v_mfma_f32_16x16x32_bf16 v[148:151], v[28:31], v[40:43], v[148:151]
    ds_read_b64_tr_b16 v[20:21], v72 offset:1024
    ds_read_b64_tr_b16 v[22:23], v72 offset:1536
    s_nop 0
    s_lshl_b32 s52, s51, 2
    s_lshr_b32 s52, 0x5307, s52
    s_and_b32 s52, s52, 15
    s_lshr_b32 s53, s51, 1
    s_sub_u32 s53, 3, s53
    v_lshrrev_b32 v76, 4, v1
    v_mfma_f32_16x16x32_bf16 v[152:155], v[28:31], v[44:47], v[152:155]
    v_cmp_gt_u32 vcc, s53, v76
    v_mfma_f32_16x16x32_bf16 v[156:159], v[28:31], v[48:51], v[156:159]
    v_mfma_f32_16x16x32_bf16 v[4:7], v[88:91], v[28:31], v[4:7]
    v_add_u32 v76, s52, v76
    s_waitcnt lgkmcnt(4)
    v_mfma_f32_16x16x32_bf16 v[160:163], v[32:35], v[36:39], v[160:163]
    v_and_b32 v77, 15, v1
    v_mfma_f32_16x16x32_bf16 v[164:167], v[32:35], v[40:43], v[164:167]
    ds_read_b64_tr_b16 v[24:25], v72 offset:2048
    ds_read_b64_tr_b16 v[26:27], v72 offset:2560
    v_lshlrev_b32 v77, 2, v77
    v_mfma_f32_16x16x32_bf16 v[168:171], v[32:35], v[44:47], v[168:171]
    v_lshl_add_u32 v76, v76, 6, v77
    v_mfma_f32_16x16x32_bf16 v[172:175], v[32:35], v[48:51], v[172:175]
    v_mfma_f32_16x16x32_bf16 v[8:11], v[88:91], v[32:35], v[8:11]
    v_mov_b32 v77, 2147418112
    s_branch L_cs_57_ret
L_cs_58:
    s_waitcnt lgkmcnt(4)
    v_mfma_f32_16x16x32_bf16 v[176:179], v[16:19], v[36:39], v[176:179]
    ds_read_b64_tr_b16 v[28:29], v73 offset:1024
    ds_read_b64_tr_b16 v[30:31], v73 offset:1536
    v_cndmask_b32 v76, v77, v76, vcc
    v_mfma_f32_16x16x32_bf16 v[180:183], v[16:19], v[40:43], v[180:183]
    ds_read_b64_tr_b16 v[32:33], v73 offset:2048
    ds_read_b64_tr_b16 v[34:35], v73 offset:2560
    v_cmp_eq_u32 vcc, 0, v1
    v_mfma_f32_16x16x32_bf16 v[184:187], v[16:19], v[44:47], v[184:187]
    s_and_b32 s52, s2, 31
    s_mul_i32 s52, s52, 10240
    s_mul_i32 s53, s48, 1280
    s_add_u32 s52, s52, s53
    s_mul_i32 s53, s50, 640
    s_add_u32 s52, s52, s53
    s_add_u32 s54, s52, 52498432
    v_cndmask_b32 v77, v77, v1, vcc
    v_mfma_f32_16x16x32_bf16 v[188:191], v[16:19], v[48:51], v[188:191]
    v_mfma_f32_16x16x32_bf16 v[4:7], v[88:91], v[16:19], v[4:7]
    s_lshl_b32 s55, s2, 7
    s_lshl_b32 s53, s49, 3
    s_add_u32 s55, s55, s53
    s_add_u32 s55, s55, 52465664
    s_waitcnt lgkmcnt(6)
    v_mfma_f32_16x16x32_bf16 v[192:195], v[20:23], v[36:39], v[192:195]
    v_mfma_f32_16x16x32_bf16 v[196:199], v[20:23], v[40:43], v[196:199]
    v_mfma_f32_16x16x32_bf16 v[200:203], v[20:23], v[44:47], v[200:203]
    v_mfma_f32_16x16x32_bf16 v[204:207], v[20:23], v[48:51], v[204:207]
    v_mfma_f32_16x16x32_bf16 v[8:11], v[88:91], v[20:23], v[8:11]
    s_branch L_cs_58_ret
L_g1_roleXV:
    s_and_b32 s52, s48, 1
    s_lshl_b32 s60, s52, 11
    s_lshr_b32 s53, s60, 1
    s_add_u32 s36, s36, s53
    s_add_u32 s37, s36, 65536
    s_add_u32 m0, s44, 0
    s_nop 0
    buffer_load_dwordx4 v82, s[12:15], s36 offen offset:0 lds
    buffer_load_dwordx4 v83, s[12:15], s36 offen offset:1024 lds
    buffer_load_dwordx4 v84, s[12:15], s36 offen offset:2048 lds
    buffer_load_dwordx4 v85, s[12:15], s36 offen offset:3072 lds
    s_add_u32 s36, s36, 128
    s_add_u32 m0, s44, 4096
    s_nop 0
    buffer_load_dwordx4 v82, s[12:15], s37 offen offset:0 lds
    buffer_load_dwordx4 v83, s[12:15], s37 offen offset:1024 lds
    buffer_load_dwordx4 v84, s[12:15], s37 offen offset:2048 lds
    buffer_load_dwordx4 v85, s[12:15], s37 offen offset:3072 lds
    s_add_u32 s37, s37, 128
    s_barrier
    s_add_u32 m0, s44, 32768
    s_nop 0
    buffer_load_dwordx4 v82, s[12:15], s36 offen offset:0 lds
    buffer_load_dwordx4 v83, s[12:15], s36 offen offset:1024 lds
    buffer_load_dwordx4 v84, s[12:15], s36 offen offset:2048 lds
    buffer_load_dwordx4 v85, s[12:15], s36 offen offset:3072 lds
    s_add_u32 s36, s36, 128
    s_add_u32 m0, s44, 36864
    s_nop 0
    buffer_load_dwordx4 v82, s[12:15], s37 offen offset:0 lds
    buffer_load_dwordx4 v83, s[12:15], s37 offen offset:1024 lds
    buffer_load_dwordx4 v84, s[12:15], s37 offen offset:2048 lds
    buffer_load_dwordx4 v85, s[12:15], s37 offen offset:3072 lds
    s_add_u32 s37, s37, 128
    s_lshl_b32 s52, s2, 2
    s_add_u32 s53, s52, 52429824
    s_add_u32 s52, s52, 52428800
    s_and_b32 s54, s2, 7
    s_lshl_b32 s54, s54, 7
    s_lshr_b32 s55, s2, 3
    s_lshl_b32 s55, s55, 2
    s_add_u32 s54, s54, s55
    s_add_u32 s54, s54, 52430848
    v_mov_b32 v8, s52
    v_mov_b32 v9, 0
    s_cmp_eq_u32 s49, 4
    s_cselect_b32 s55, 0, 2147418112
    v_writelane_b32 v8, s53, 1
    s_nop 1
    v_writelane_b32 v8, s54, 2
    s_nop 1
    s_mov_b64 exec, 7
    buffer_store_dword v9, v8, s[32:35], s55 offen sc0 sc1
    s_mov_b64 exec, -1
    s_mov_b32 s52, s100
    s_mov_b32 s53, s101
    s_mov_b32 s54, 4194304
    s_mov_b32 s55, 0x20000
    s_lshl_b32 s59, s2, 3
    s_add_u32 s59, s59, s49
    s_lshl_b32 s59, s59, 11
    buffer_load_dwordx4 v[76:79], v86, s[52:55], s59 offen
    buffer_load_dwordx4 v[92:95], v86, s[52:55], s59 offen offset:1024
    v_lshrrev_b32 v3, 4, v1
    v_bfe_u32 v4, v1, 2, 2
    v_and_b32 v5, 3, v1
    v_mul_u32_u24 v6, 5120, v3
    v_lshl_add_u32 v6, v4, 7, v6
    v_lshl_add_u32 v6, v5, 3, v6
    v_lshrrev_b32 v7, 1, v4
    v_lshlrev_b32 v7, 5, v7
    v_and_b32 v8, 1, v3
    v_lshl_or_b32 v7, v8, 6, v7
    s_lshl_b32 s52, s50, 6
    v_xor_b32 v8, s52, v7
    v_add_u32 v68, v6, v8
    v_xor_b32 v8, 32, v8
    v_add_u32 v69, v6, v8
    s_cmp_eq_u32 s47, 0
    s_cbranch_scc1 L_g1_taB_59
    s_lshl_b32 s52, s50, 11
    v_add_u32 v9, s52, v6
    v_xor_b32 v8, 0, v7
    v_add_u32 v70, v9, v8
    v_xor_b32 v8, 32, v7
    v_add_u32 v71, v9, v8
    v_xor_b32 v8, 64, v7
    v_add_u32 v72, v9, v8
    v_xor_b32 v8, 96, v7
    v_add_u32 v73, v9, v8
    s_branch L_g1_ta_done_60
L_g1_taB_59:
    v_mov_b32 v70, v68
    v_mov_b32 v71, v69
    v_add_u32 v72, 2048, v68
    v_add_u32 v73, 2048, v69
L_g1_ta_done_60:
    s_and_b32 s52, s49, 3
    s_lshl_b32 s53, s52, 13
    s_add_u32 s53, s53, 81920
    v_and_b32 v4, 15, v1
    v_lshrrev_b32 v5, 1, v4
    v_xor_b32 v5, v5, v3
    v_lshlrev_b32 v5, 4, v5
    v_lshl_add_u32 v5, v4, 7, v5
    v_add_u32 v80, s53, v5
    v_xor_b32 v81, 64, v80
    s_mov_b32 s51, s52
    s_lshr_b32 s52, s48, 1
    s_sub_u32 s63, 7, s52
    s_sub_u32 s64, 6, s52
    s_mov_b32 s86, 2147418112
    s_mov_b32 s87, 0xffff0000
    s_mov_b32 s65, 2147418112
    s_mov_b32 s66, 2147418112
    s_lshl_b32 s52, s48, 5
    s_cmp_eq_u32 s49, 0
    s_cselect_b32 s67, s52, s86
    s_cselect_b32 s92, 0, s86
    s_mov_b32 s88, s98
    s_mov_b32 s89, s99
    s_mov_b32 s90, 256
    s_mov_b32 s91, 0x20000
    v_and_b32 v87, 7, v1
    v_lshlrev_b32 v87, 5, v87
    v_mov_b32 v208, 0
    v_mov_b32 v209, 0
    v_mov_b32 v210, 0
    v_mov_b32 v211, 0
    v_mov_b32 v212, 0
    v_mov_b32 v213, 0
    v_mov_b32 v214, 0
    v_mov_b32 v215, 0
    v_mov_b32 v216, 0
    v_mov_b32 v217, 0
    v_mov_b32 v218, 0
    v_mov_b32 v219, 0
    v_mov_b32 v220, 0
    v_mov_b32 v221, 0
    v_mov_b32 v222, 0
    v_mov_b32 v223, 0
    v_mov_b32 v224, 0
    v_mov_b32 v225, 0
    v_mov_b32 v226, 0
    v_mov_b32 v227, 0
    v_mov_b32 v228, 0
    v_mov_b32 v229, 0
    v_mov_b32 v230, 0
    v_mov_b32 v231, 0
    v_mov_b32 v232, 0
    v_mov_b32 v233, 0
    v_mov_b32 v234, 0
    v_mov_b32 v235, 0
    v_mov_b32 v236, 0
    v_mov_b32 v237, 0
    v_mov_b32 v238, 0
    v_mov_b32 v239, 0
    v_mov_b32 v240, 0
    v_mov_b32 v241, 0
    v_mov_b32 v242, 0
    v_mov_b32 v243, 0
    v_mov_b32 v244, 0
    v_mov_b32 v245, 0
    v_mov_b32 v246, 0
    v_mov_b32 v247, 0
    v_mov_b32 v248, 0
    v_mov_b32 v249, 0
    v_mov_b32 v250, 0
    v_mov_b32 v251, 0
    v_mov_b32 v252, 0
    v_mov_b32 v253, 0
    v_mov_b32 v254, 0
    v_mov_b32 v255, 0
    v_mov_b32 v86, 1
    v_mov_b32 v4, 0
    v_mov_b32 v5, 0
    v_mov_b32 v6, 0
    v_mov_b32 v7, 0
    v_mov_b32 v8, 0
    v_mov_b32 v9, 0
    v_mov_b32 v10, 0
    v_mov_b32 v11, 0
    v_mov_b32 v12, 0
    v_mov_b32 v13, 0
    v_mov_b32 v14, 0
    v_mov_b32 v15, 0
    v_mov_b32 v88, 0x3f803f80
    v_mov_b32 v89, 0x3f803f80
    v_mov_b32 v90, 0x3f803f80
    v_mov_b32 v91, 0x3f803f80
    s_waitcnt vmcnt(11)
    s_barrier
    ds_read_b128 v[36:39], v80 offset:0
    ds_read_b128 v[40:43], v80 offset:2048
    ds_read_b128 v[44:47], v80 offset:4096
    ds_read_b128 v[48:51], v80 offset:6144
    ds_read_b64_tr_b16 v[16:17], v68 offset:0
    ds_read_b64_tr_b16 v[18:19], v68 offset:512
    ds_read_b64_tr_b16 v[20:21], v69 offset:0
    ds_read_b64_tr_b16 v[22:23], v69 offset:512
    ds_read_b64_tr_b16 v[24:25], v70 offset:1024
    ds_read_b64_tr_b16 v[26:27], v70 offset:1536
    s_waitcnt lgkmcnt(4)
    v_mfma_f32_16x16x32_bf16 v[96:99], v[36:39], v[16:19], 0
    ds_read_b128 v[52:55], v81 offset:0
    ds_read_b128 v[56:59], v81 offset:2048
    v_mfma_f32_16x16x32_bf16 v[100:103], v[40:43], v[16:19], 0
    ds_read_b64_tr_b16 v[28:29], v70 offset:2048
    ds_read_b64_tr_b16 v[30:31], v70 offset:2560
    v_mfma_f32_16x16x32_bf16 v[104:107], v[44:47], v[16:19], 0
    ds_read_b128 v[60:63], v81 offset:4096
    ds_read_b128 v[64:67], v81 offset:6144
    v_mfma_f32_16x16x32_bf16 v[108:111], v[48:51], v[16:19], 0
    s_waitcnt lgkmcnt(8)
    v_mfma_f32_16x16x32_bf16 v[112:115], v[36:39], v[20:23], 0
    v_mfma_f32_16x16x32_bf16 v[116:119], v[40:43], v[20:23], 0
    ds_read_b64_tr_b16 v[32:33], v71 offset:1024
    ds_read_b64_tr_b16 v[34:35], v71 offset:1536
    v_mfma_f32_16x16x32_bf16 v[120:123], v[44:47], v[20:23], 0
    v_mfma_f32_16x16x32_bf16 v[124:127], v[48:51], v[20:23], 0
    s_waitcnt lgkmcnt(8)
    v_mfma_f32_16x16x32_bf16 v[128:131], v[24:27], v[36:39], 0
    v_mfma_f32_16x16x32_bf16 v[132:135], v[24:27], v[40:43], 0
    ds_read_b64_tr_b16 v[16:17], v71 offset:2048
    ds_read_b64_tr_b16 v[18:19], v71 offset:2560
    v_mfma_f32_16x16x32_bf16 v[136:139], v[24:27], v[44:47], 0
    v_mfma_f32_16x16x32_bf16 v[140:143], v[24:27], v[48:51], 0
    s_waitcnt lgkmcnt(6)
    v_mfma_f32_16x16x32_bf16 v[144:147], v[28:31], v[36:39], 0
    v_mfma_f32_16x16x32_bf16 v[148:151], v[28:31], v[40:43], 0
    ds_read_b64_tr_b16 v[20:21], v72 offset:1024
    ds_read_b64_tr_b16 v[22:23], v72 offset:1536
    v_mfma_f32_16x16x32_bf16 v[152:155], v[28:31], v[44:47], 0
    v_mfma_f32_16x16x32_bf16 v[156:159], v[28:31], v[48:51], 0
    s_waitcnt lgkmcnt(4)
    v_mfma_f32_16x16x32_bf16 v[160:163], v[32:35], v[36:39], 0
    v_mfma_f32_16x16x32_bf16 v[164:167], v[32:35], v[40:43], 0
    ds_read_b64_tr_b16 v[24:25], v72 offset:2048
    ds_read_b64_tr_b16 v[26:27], v72 offset:2560
    v_mfma_f32_16x16x32_bf16 v[168:171], v[32:35], v[44:47], 0
    v_mfma_f32_16x16x32_bf16 v[172:175], v[32:35], v[48:51], 0
    s_waitcnt lgkmcnt(4)
    v_mfma_f32_16x16x32_bf16 v[176:179], v[16:19], v[36:39], 0
    ds_read_b64_tr_b16 v[28:29], v73 offset:1024
    ds_read_b64_tr_b16 v[30:31], v73 offset:1536
    v_mfma_f32_16x16x32_bf16 v[180:183], v[16:19], v[40:43], 0
    ds_read_b64_tr_b16 v[32:33], v73 offset:2048
    ds_read_b64_tr_b16 v[34:35], v73 offset:2560
    v_mfma_f32_16x16x32_bf16 v[184:187], v[16:19], v[44:47], 0
    v_mfma_f32_16x16x32_bf16 v[188:191], v[16:19], v[48:51], 0
    s_waitcnt lgkmcnt(6)
    v_mfma_f32_16x16x32_bf16 v[192:195], v[20:23], v[36:39], 0
    v_mfma_f32_16x16x32_bf16 v[196:199], v[20:23], v[40:43], 0
    v_mfma_f32_16x16x32_bf16 v[200:203], v[20:23], v[44:47], 0
    v_mfma_f32_16x16x32_bf16 v[204:207], v[20:23], v[48:51], 0
    buffer_store_dword v1, v1, s[32:35], s86 offen
    buffer_store_dword v1, v1, s[32:35], s86 offen
    s_waitcnt lgkmcnt(0)
    s_barrier
    s_mov_b32 s45, 7
    .p2align 6
L_g1_loop_X1:
    s_cmp_eq_u32 s45, s63
    s_cbranch_scc1 L_g1_spec_X1
    v_mfma_f32_16x16x32_bf16 v[208:211], v[24:27], v[36:39], v[208:211]
    v_mfma_f32_16x16x32_bf16 v[212:215], v[24:27], v[40:43], v[212:215]
    v_mfma_f32_16x16x32_bf16 v[216:219], v[24:27], v[44:47], v[216:219]
    ds_read_b64_tr_b16 v[16:17], v68 offset:20480
    ds_read_b64_tr_b16 v[18:19], v68 offset:20992
    v_mfma_f32_16x16x32_bf16 v[220:223], v[24:27], v[48:51], v[220:223]
    v_mfma_f32_16x16x32_bf16 v[224:227], v[28:31], v[36:39], v[224:227]
    v_mfma_f32_16x16x32_bf16 v[228:231], v[28:31], v[40:43], v[228:231]
    ds_read_b64_tr_b16 v[20:21], v69 offset:20480
    ds_read_b64_tr_b16 v[22:23], v69 offset:20992
    v_mfma_f32_16x16x32_bf16 v[232:235], v[28:31], v[44:47], v[232:235]
    v_mfma_f32_16x16x32_bf16 v[236:239], v[28:31], v[48:51], v[236:239]
    s_add_u32 m0, s44, 0
    s_nop 0
    buffer_load_dwordx4 v82, s[12:15], s36 offen offset:0 lds
    v_mfma_f32_16x16x32_bf16 v[240:243], v[32:35], v[36:39], v[240:243]
    v_mfma_f32_16x16x32_bf16 v[244:247], v[32:35], v[40:43], v[244:247]
    ds_read_b64_tr_b16 v[24:25], v70 offset:21504
    ds_read_b64_tr_b16 v[26:27], v70 offset:22016
    v_mfma_f32_16x16x32_bf16 v[248:251], v[32:35], v[44:47], v[248:251]
    v_mfma_f32_16x16x32_bf16 v[252:255], v[32:35], v[48:51], v[252:255]
    buffer_load_dwordx4 v83, s[12:15], s36 offen offset:1024 lds
    s_waitcnt lgkmcnt(4)
    v_mfma_f32_16x16x32_bf16 v[96:99], v[52:55], v[16:19], v[96:99]
    v_mfma_f32_16x16x32_bf16 v[100:103], v[56:59], v[16:19], v[100:103]
    ds_read_b64_tr_b16 v[28:29], v70 offset:22528
    ds_read_b64_tr_b16 v[30:31], v70 offset:23040
    v_mfma_f32_16x16x32_bf16 v[104:107], v[60:63], v[16:19], v[104:107]
    v_mfma_f32_16x16x32_bf16 v[108:111], v[64:67], v[16:19], v[108:111]
    buffer_load_dwordx4 v84, s[12:15], s36 offen offset:2048 lds
    s_waitcnt lgkmcnt(4)
    v_mfma_f32_16x16x32_bf16 v[112:115], v[52:55], v[20:23], v[112:115]
    v_mfma_f32_16x16x32_bf16 v[116:119], v[56:59], v[20:23], v[116:119]
    ds_read_b64_tr_b16 v[32:33], v71 offset:21504
    ds_read_b64_tr_b16 v[34:35], v71 offset:22016
    v_mfma_f32_16x16x32_bf16 v[120:123], v[60:63], v[20:23], v[120:123]
    v_mfma_f32_16x16x32_bf16 v[124:127], v[64:67], v[20:23], v[124:127]
    buffer_load_dwordx4 v85, s[12:15], s36 offen offset:3072 lds
    s_add_u32 s36, s36, 128
    s_waitcnt lgkmcnt(4)
    v_mfma_f32_16x16x32_bf16 v[128:131], v[24:27], v[52:55], v[128:131]
    v_mfma_f32_16x16x32_bf16 v[132:135], v[24:27], v[56:59], v[132:135]
    ds_read_b64_tr_b16 v[16:17], v71 offset:22528
    ds_read_b64_tr_b16 v[18:19], v71 offset:23040
    v_mfma_f32_16x16x32_bf16 v[136:139], v[24:27], v[60:63], v[136:139]
    v_mfma_f32_16x16x32_bf16 v[140:143], v[24:27], v[64:67], v[140:143]
    s_add_u32 m0, s44, 4096
    s_nop 0
    buffer_load_dwordx4 v82, s[12:15], s37 offen offset:0 lds
    s_waitcnt lgkmcnt(4)
    v_mfma_f32_16x16x32_bf16 v[144:147], v[28:31], v[52:55], v[144:147]
    v_mfma_f32_16x16x32_bf16 v[148:151], v[28:31], v[56:59], v[148:151]
    ds_read_b64_tr_b16 v[20:21], v72 offset:21504
    ds_read_b64_tr_b16 v[22:23], v72 offset:22016
    v_mfma_f32_16x16x32_bf16 v[152:155], v[28:31], v[60:63], v[152:155]
    v_mfma_f32_16x16x32_bf16 v[156:159], v[28:31], v[64:67], v[156:159]
    buffer_load_dwordx4 v83, s[12:15], s37 offen offset:1024 lds
    s_waitcnt lgkmcnt(4)
    v_mfma_f32_16x16x32_bf16 v[160:163], v[32:35], v[52:55], v[160:163]
    v_mfma_f32_16x16x32_bf16 v[164:167], v[32:35], v[56:59], v[164:167]
    ds_read_b64_tr_b16 v[24:25], v72 offset:22528
    ds_read_b64_tr_b16 v[26:27], v72 offset:23040
    v_mfma_f32_16x16x32_bf16 v[168:171], v[32:35], v[60:63], v[168:171]
    v_mfma_f32_16x16x32_bf16 v[172:175], v[32:35], v[64:67], v[172:175]
    buffer_load_dwordx4 v84, s[12:15], s37 offen offset:2048 lds
    s_waitcnt lgkmcnt(4)
    v_mfma_f32_16x16x32_bf16 v[176:179], v[16:19], v[52:55], v[176:179]
    ds_read_b64_tr_b16 v[28:29], v73 offset:21504
    ds_read_b64_tr_b16 v[30:31], v73 offset:22016
    v_mfma_f32_16x16x32_bf16 v[180:183], v[16:19], v[56:59], v[180:183]
    ds_read_b64_tr_b16 v[32:33], v73 offset:22528
    ds_read_b64_tr_b16 v[34:35], v73 offset:23040
    v_mfma_f32_16x16x32_bf16 v[184:187], v[16:19], v[60:63], v[184:187]
    v_mfma_f32_16x16x32_bf16 v[188:191], v[16:19], v[64:67], v[188:191]
    buffer_load_dwordx4 v85, s[12:15], s37 offen offset:3072 lds
    s_add_u32 s37, s37, 128
    s_waitcnt lgkmcnt(6)
    v_mfma_f32_16x16x32_bf16 v[192:195], v[20:23], v[52:55], v[192:195]
    v_mfma_f32_16x16x32_bf16 v[196:199], v[20:23], v[56:59], v[196:199]
    v_mfma_f32_16x16x32_bf16 v[200:203], v[20:23], v[60:63], v[200:203]
    v_mfma_f32_16x16x32_bf16 v[204:207], v[20:23], v[64:67], v[204:207]
    s_waitcnt vmcnt(10) lgkmcnt(0)
    s_barrier
    v_mfma_f32_16x16x32_bf16 v[208:211], v[24:27], v[52:55], v[208:211]
    ds_read_b128 v[36:39], v80 offset:32768
    ds_read_b128 v[40:43], v80 offset:34816
    v_mfma_f32_16x16x32_bf16 v[212:215], v[24:27], v[56:59], v[212:215]
    ds_read_b128 v[44:47], v80 offset:36864
    ds_read_b128 v[48:51], v80 offset:38912
    v_mfma_f32_16x16x32_bf16 v[216:219], v[24:27], v[60:63], v[216:219]
    ds_read_b64_tr_b16 v[16:17], v68 offset:40960
    ds_read_b64_tr_b16 v[18:19], v68 offset:41472
    v_mfma_f32_16x16x32_bf16 v[220:223], v[24:27], v[64:67], v[220:223]
    v_mfma_f32_16x16x32_bf16 v[224:227], v[28:31], v[52:55], v[224:227]
    v_mfma_f32_16x16x32_bf16 v[228:231], v[28:31], v[56:59], v[228:231]
    ds_read_b64_tr_b16 v[20:21], v69 offset:40960
    ds_read_b64_tr_b16 v[22:23], v69 offset:41472
    v_mfma_f32_16x16x32_bf16 v[232:235], v[28:31], v[60:63], v[232:235]
    v_mfma_f32_16x16x32_bf16 v[236:239], v[28:31], v[64:67], v[236:239]
    v_mfma_f32_16x16x32_bf16 v[240:243], v[32:35], v[52:55], v[240:243]
    v_mfma_f32_16x16x32_bf16 v[244:247], v[32:35], v[56:59], v[244:247]
    ds_read_b64_tr_b16 v[24:25], v70 offset:41984
    ds_read_b64_tr_b16 v[26:27], v70 offset:42496
    v_mfma_f32_16x16x32_bf16 v[248:251], v[32:35], v[60:63], v[248:251]
    v_mfma_f32_16x16x32_bf16 v[252:255], v[32:35], v[64:67], v[252:255]
    s_waitcnt lgkmcnt(4)
    v_mfma_f32_16x16x32_bf16 v[96:99], v[36:39], v[16:19], v[96:99]
    ds_read_b128 v[52:55], v81 offset:32768
    ds_read_b128 v[56:59], v81 offset:34816
    v_mfma_f32_16x16x32_bf16 v[100:103], v[40:43], v[16:19], v[100:103]
    ds_read_b64_tr_b16 v[28:29], v70 offset:43008
    ds_read_b64_tr_b16 v[30:31], v70 offset:43520
    v_mfma_f32_16x16x32_bf16 v[104:107], v[44:47], v[16:19], v[104:107]
    ds_read_b128 v[60:63], v81 offset:36864
    ds_read_b128 v[64:67], v81 offset:38912
    v_mfma_f32_16x16x32_bf16 v[108:111], v[48:51], v[16:19], v[108:111]
    s_waitcnt lgkmcnt(8)
    v_mfma_f32_16x16x32_bf16 v[112:115], v[36:39], v[20:23], v[112:115]
    v_mfma_f32_16x16x32_bf16 v[116:119], v[40:43], v[20:23], v[116:119]
    ds_read_b64_tr_b16 v[32:33], v71 offset:41984
    ds_read_b64_tr_b16 v[34:35], v71 offset:42496
    v_mfma_f32_16x16x32_bf16 v[120:123], v[44:47], v[20:23], v[120:123]
    v_mfma_f32_16x16x32_bf16 v[124:127], v[48:51], v[20:23], v[124:127]
    s_waitcnt lgkmcnt(8)
    v_mfma_f32_16x16x32_bf16 v[128:131], v[24:27], v[36:39], v[128:131]
    v_mfma_f32_16x16x32_bf16 v[132:135], v[24:27], v[40:43], v[132:135]
    ds_read_b64_tr_b16 v[16:17], v71 offset:43008
    ds_read_b64_tr_b16 v[18:19], v71 offset:43520
    v_mfma_f32_16x16x32_bf16 v[136:139], v[24:27], v[44:47], v[136:139]
    v_mfma_f32_16x16x32_bf16 v[140:143], v[24:27], v[48:51], v[140:143]
    s_waitcnt lgkmcnt(6)
    v_mfma_f32_16x16x32_bf16 v[144:147], v[28:31], v[36:39], v[144:147]
    v_mfma_f32_16x16x32_bf16 v[148:151], v[28:31], v[40:43], v[148:151]
    ds_read_b64_tr_b16 v[20:21], v72 offset:41984
    ds_read_b64_tr_b16 v[22:23], v72 offset:42496
    v_mfma_f32_16x16x32_bf16 v[152:155], v[28:31], v[44:47], v[152:155]
    v_mfma_f32_16x16x32_bf16 v[156:159], v[28:31], v[48:51], v[156:159]
    s_waitcnt lgkmcnt(4)
    v_mfma_f32_16x16x32_bf16 v[160:163], v[32:35], v[36:39], v[160:163]
    v_mfma_f32_16x16x32_bf16 v[164:167], v[32:35], v[40:43], v[164:167]
    ds_read_b64_tr_b16 v[24:25], v72 offset:43008
    ds_read_b64_tr_b16 v[26:27], v72 offset:43520
    v_mfma_f32_16x16x32_bf16 v[168:171], v[32:35], v[44:47], v[168:171]
    v_mfma_f32_16x16x32_bf16 v[172:175], v[32:35], v[48:51], v[172:175]
    s_waitcnt lgkmcnt(4)
    v_mfma_f32_16x16x32_bf16 v[176:179], v[16:19], v[36:39], v[176:179]
    ds_read_b64_tr_b16 v[28:29], v73 offset:41984
    ds_read_b64_tr_b16 v[30:31], v73 offset:42496
    v_mfma_f32_16x16x32_bf16 v[180:183], v[16:19], v[40:43], v[180:183]
    ds_read_b64_tr_b16 v[32:33], v73 offset:43008
    ds_read_b64_tr_b16 v[34:35], v73 offset:43520
    v_mfma_f32_16x16x32_bf16 v[184:187], v[16:19], v[44:47], v[184:187]
    v_mfma_f32_16x16x32_bf16 v[188:191], v[16:19], v[48:51], v[188:191]
    s_waitcnt lgkmcnt(6)
    v_mfma_f32_16x16x32_bf16 v[192:195], v[20:23], v[36:39], v[192:195]
    v_mfma_f32_16x16x32_bf16 v[196:199], v[20:23], v[40:43], v[196:199]
    v_mfma_f32_16x16x32_bf16 v[200:203], v[20:23], v[44:47], v[200:203]
    v_mfma_f32_16x16x32_bf16 v[204:207], v[20:23], v[48:51], v[204:207]
    s_waitcnt vmcnt(10) lgkmcnt(0)
    s_barrier
    v_mfma_f32_16x16x32_bf16 v[208:211], v[24:27], v[36:39], v[208:211]
    v_mfma_f32_16x16x32_bf16 v[212:215], v[24:27], v[40:43], v[212:215]
    v_mfma_f32_16x16x32_bf16 v[216:219], v[24:27], v[44:47], v[216:219]
    ds_read_b64_tr_b16 v[16:17], v68 offset:61440
    ds_read_b64_tr_b16 v[18:19], v68 offset:61952
    v_mfma_f32_16x16x32_bf16 v[220:223], v[24:27], v[48:51], v[220:223]
    v_mfma_f32_16x16x32_bf16 v[224:227], v[28:31], v[36:39], v[224:227]
    v_mfma_f32_16x16x32_bf16 v[228:231], v[28:31], v[40:43], v[228:231]
    ds_read_b64_tr_b16 v[20:21], v69 offset:61440
    ds_read_b64_tr_b16 v[22:23], v69 offset:61952
    v_mfma_f32_16x16x32_bf16 v[232:235], v[28:31], v[44:47], v[232:235]
    v_mfma_f32_16x16x32_bf16 v[236:239], v[28:31], v[48:51], v[236:239]
    s_add_u32 m0, s44, 32768
    s_nop 0
    buffer_load_dwordx4 v82, s[12:15], s36 offen offset:0 lds
    v_mfma_f32_16x16x32_bf16 v[240:243], v[32:35], v[36:39], v[240:243]
    v_mfma_f32_16x16x32_bf16 v[244:247], v[32:35], v[40:43], v[244:247]
    ds_read_b64_tr_b16 v[24:25], v70 offset:62464
    ds_read_b64_tr_b16 v[26:27], v70 offset:62976
    v_mfma_f32_16x16x32_bf16 v[248:251], v[32:35], v[44:47], v[248:251]
    v_mfma_f32_16x16x32_bf16 v[252:255], v[32:35], v[48:51], v[252:255]
    buffer_load_dwordx4 v83, s[12:15], s36 offen offset:1024 lds
    s_waitcnt lgkmcnt(4)
    v_mfma_f32_16x16x32_bf16 v[96:99], v[52:55], v[16:19], v[96:99]
    v_mfma_f32_16x16x32_bf16 v[100:103], v[56:59], v[16:19], v[100:103]
    ds_read_b64_tr_b16 v[28:29], v70 offset:63488
    ds_read_b64_tr_b16 v[30:31], v70 offset:64000
    v_mfma_f32_16x16x32_bf16 v[104:107], v[60:63], v[16:19], v[104:107]
    v_mfma_f32_16x16x32_bf16 v[108:111], v[64:67], v[16:19], v[108:111]
    buffer_load_dwordx4 v84, s[12:15], s36 offen offset:2048 lds
    s_waitcnt lgkmcnt(4)
    v_mfma_f32_16x16x32_bf16 v[112:115], v[52:55], v[20:23], v[112:115]
    v_mfma_f32_16x16x32_bf16 v[116:119], v[56:59], v[20:23], v[116:119]
    ds_read_b64_tr_b16 v[32:33], v71 offset:62464
    ds_read_b64_tr_b16 v[34:35], v71 offset:62976
    v_mfma_f32_16x16x32_bf16 v[120:123], v[60:63], v[20:23], v[120:123]
    v_mfma_f32_16x16x32_bf16 v[124:127], v[64:67], v[20:23], v[124:127]
    buffer_load_dwordx4 v85, s[12:15], s36 offen offset:3072 lds
    s_add_u32 s36, s36, 128
    s_waitcnt lgkmcnt(4)
    v_mfma_f32_16x16x32_bf16 v[128:131], v[24:27], v[52:55], v[128:131]
    v_mfma_f32_16x16x32_bf16 v[132:135], v[24:27], v[56:59], v[132:135]
    ds_read_b64_tr_b16 v[16:17], v71 offset:63488
    ds_read_b64_tr_b16 v[18:19], v71 offset:64000
    v_mfma_f32_16x16x32_bf16 v[136:139], v[24:27], v[60:63], v[136:139]
    v_mfma_f32_16x16x32_bf16 v[140:143], v[24:27], v[64:67], v[140:143]
    s_add_u32 m0, s44, 36864
    s_nop 0
    buffer_load_dwordx4 v82, s[12:15], s37 offen offset:0 lds
    s_waitcnt lgkmcnt(4)
    v_mfma_f32_16x16x32_bf16 v[144:147], v[28:31], v[52:55], v[144:147]
    v_mfma_f32_16x16x32_bf16 v[148:151], v[28:31], v[56:59], v[148:151]
    ds_read_b64_tr_b16 v[20:21], v72 offset:62464
    ds_read_b64_tr_b16 v[22:23], v72 offset:62976
    v_mfma_f32_16x16x32_bf16 v[152:155], v[28:31], v[60:63], v[152:155]
    v_mfma_f32_16x16x32_bf16 v[156:159], v[28:31], v[64:67], v[156:159]
    buffer_load_dwordx4 v83, s[12:15], s37 offen offset:1024 lds
    s_waitcnt lgkmcnt(4)
    v_mfma_f32_16x16x32_bf16 v[160:163], v[32:35], v[52:55], v[160:163]
    v_mfma_f32_16x16x32_bf16 v[164:167], v[32:35], v[56:59], v[164:167]
    ds_read_b64_tr_b16 v[24:25], v72 offset:63488
    ds_read_b64_tr_b16 v[26:27], v72 offset:64000
    v_mfma_f32_16x16x32_bf16 v[168:171], v[32:35], v[60:63], v[168:171]
    v_mfma_f32_16x16x32_bf16 v[172:175], v[32:35], v[64:67], v[172:175]
    buffer_load_dwordx4 v84, s[12:15], s37 offen offset:2048 lds
    s_waitcnt lgkmcnt(4)
    v_mfma_f32_16x16x32_bf16 v[176:179], v[16:19], v[52:55], v[176:179]
    ds_read_b64_tr_b16 v[28:29], v73 offset:62464
    ds_read_b64_tr_b16 v[30:31], v73 offset:62976
    v_mfma_f32_16x16x32_bf16 v[180:183], v[16:19], v[56:59], v[180:183]
    ds_read_b64_tr_b16 v[32:33], v73 offset:63488
    ds_read_b64_tr_b16 v[34:35], v73 offset:64000
    v_mfma_f32_16x16x32_bf16 v[184:187], v[16:19], v[60:63], v[184:187]
    v_mfma_f32_16x16x32_bf16 v[188:191], v[16:19], v[64:67], v[188:191]
    buffer_load_dwordx4 v85, s[12:15], s37 offen offset:3072 lds
    s_add_u32 s37, s37, 128
    s_waitcnt lgkmcnt(6)
    v_mfma_f32_16x16x32_bf16 v[192:195], v[20:23], v[52:55], v[192:195]
    v_mfma_f32_16x16x32_bf16 v[196:199], v[20:23], v[56:59], v[196:199]
    v_mfma_f32_16x16x32_bf16 v[200:203], v[20:23], v[60:63], v[200:203]
    v_mfma_f32_16x16x32_bf16 v[204:207], v[20:23], v[64:67], v[204:207]
    s_waitcnt vmcnt(8) lgkmcnt(0)
    s_barrier
    v_mfma_f32_16x16x32_bf16 v[208:211], v[24:27], v[52:55], v[208:211]
    ds_read_b128 v[36:39], v80 offset:0
    ds_read_b128 v[40:43], v80 offset:2048
    v_mfma_f32_16x16x32_bf16 v[212:215], v[24:27], v[56:59], v[212:215]
    ds_read_b128 v[44:47], v80 offset:4096
    ds_read_b128 v[48:51], v80 offset:6144
    v_mfma_f32_16x16x32_bf16 v[216:219], v[24:27], v[60:63], v[216:219]
    ds_read_b64_tr_b16 v[16:17], v68 offset:0
    ds_read_b64_tr_b16 v[18:19], v68 offset:512
    v_mfma_f32_16x16x32_bf16 v[220:223], v[24:27], v[64:67], v[220:223]
    v_mfma_f32_16x16x32_bf16 v[224:227], v[28:31], v[52:55], v[224:227]
    v_mfma_f32_16x16x32_bf16 v[228:231], v[28:31], v[56:59], v[228:231]
    ds_read_b64_tr_b16 v[20:21], v69 offset:0
    ds_read_b64_tr_b16 v[22:23], v69 offset:512
    v_mfma_f32_16x16x32_bf16 v[232:235], v[28:31], v[60:63], v[232:235]
    v_mfma_f32_16x16x32_bf16 v[236:239], v[28:31], v[64:67], v[236:239]
    v_mfma_f32_16x16x32_bf16 v[240:243], v[32:35], v[52:55], v[240:243]
    v_mfma_f32_16x16x32_bf16 v[244:247], v[32:35], v[56:59], v[244:247]
    ds_read_b64_tr_b16 v[24:25], v70 offset:1024
    ds_read_b64_tr_b16 v[26:27], v70 offset:1536
    v_mfma_f32_16x16x32_bf16 v[248:251], v[32:35], v[60:63], v[248:251]
    v_mfma_f32_16x16x32_bf16 v[252:255], v[32:35], v[64:67], v[252:255]
    s_waitcnt lgkmcnt(4)
    v_mfma_f32_16x16x32_bf16 v[96:99], v[36:39], v[16:19], v[96:99]
    ds_read_b128 v[52:55], v81 offset:0
    ds_read_b128 v[56:59], v81 offset:2048
    v_mfma_f32_16x16x32_bf16 v[100:103], v[40:43], v[16:19], v[100:103]
    ds_read_b64_tr_b16 v[28:29], v70 offset:2048
    ds_read_b64_tr_b16 v[30:31], v70 offset:2560
    v_mfma_f32_16x16x32_bf16 v[104:107], v[44:47], v[16:19], v[104:107]
    ds_read_b128 v[60:63], v81 offset:4096
    ds_read_b128 v[64:67], v81 offset:6144
    v_mfma_f32_16x16x32_bf16 v[108:111], v[48:51], v[16:19], v[108:111]
    s_waitcnt lgkmcnt(8)
    v_mfma_f32_16x16x32_bf16 v[112:115], v[36:39], v[20:23], v[112:115]
    v_mfma_f32_16x16x32_bf16 v[116:119], v[40:43], v[20:23], v[116:119]
    ds_read_b64_tr_b16 v[32:33], v71 offset:1024
    ds_read_b64_tr_b16 v[34:35], v71 offset:1536
    v_mfma_f32_16x16x32_bf16 v[120:123], v[44:47], v[20:23], v[120:123]
    v_mfma_f32_16x16x32_bf16 v[124:127], v[48:51], v[20:23], v[124:127]
    s_waitcnt lgkmcnt(8)
    v_mfma_f32_16x16x32_bf16 v[128:131], v[24:27], v[36:39], v[128:131]
    v_mfma_f32_16x16x32_bf16 v[132:135], v[24:27], v[40:43], v[132:135]
    ds_read_b64_tr_b16 v[16:17], v71 offset:2048
    ds_read_b64_tr_b16 v[18:19], v71 offset:2560
    v_mfma_f32_16x16x32_bf16 v[136:139], v[24:27], v[44:47], v[136:139]
    v_mfma_f32_16x16x32_bf16 v[140:143], v[24:27], v[48:51], v[140:143]
    s_waitcnt lgkmcnt(6)
    v_mfma_f32_16x16x32_bf16 v[144:147], v[28:31], v[36:39], v[144:147]
    v_mfma_f32_16x16x32_bf16 v[148:151], v[28:31], v[40:43], v[148:151]
    ds_read_b64_tr_b16 v[20:21], v72 offset:1024
    ds_read_b64_tr_b16 v[22:23], v72 offset:1536
    v_mfma_f32_16x16x32_bf16 v[152:155], v[28:31], v[44:47], v[152:155]
    v_mfma_f32_16x16x32_bf16 v[156:159], v[28:31], v[48:51], v[156:159]
    s_waitcnt lgkmcnt(4)
    v_mfma_f32_16x16x32_bf16 v[160:163], v[32:35], v[36:39], v[160:163]
    v_mfma_f32_16x16x32_bf16 v[164:167], v[32:35], v[40:43], v[164:167]
    ds_read_b64_tr_b16 v[24:25], v72 offset:2048
    ds_read_b64_tr_b16 v[26:27], v72 offset:2560
    v_mfma_f32_16x16x32_bf16 v[168:171], v[32:35], v[44:47], v[168:171]
    v_mfma_f32_16x16x32_bf16 v[172:175], v[32:35], v[48:51], v[172:175]
    s_waitcnt lgkmcnt(4)
    v_mfma_f32_16x16x32_bf16 v[176:179], v[16:19], v[36:39], v[176:179]
    ds_read_b64_tr_b16 v[28:29], v73 offset:1024
    ds_read_b64_tr_b16 v[30:31], v73 offset:1536
    v_mfma_f32_16x16x32_bf16 v[180:183], v[16:19], v[40:43], v[180:183]
    ds_read_b64_tr_b16 v[32:33], v73 offset:2048
    ds_read_b64_tr_b16 v[34:35], v73 offset:2560
    v_mfma_f32_16x16x32_bf16 v[184:187], v[16:19], v[44:47], v[184:187]
    v_mfma_f32_16x16x32_bf16 v[188:191], v[16:19], v[48:51], v[188:191]
    s_waitcnt lgkmcnt(6)
    v_mfma_f32_16x16x32_bf16 v[192:195], v[20:23], v[36:39], v[192:195]
    v_mfma_f32_16x16x32_bf16 v[196:199], v[20:23], v[40:43], v[196:199]
    v_mfma_f32_16x16x32_bf16 v[200:203], v[20:23], v[44:47], v[200:203]
    v_mfma_f32_16x16x32_bf16 v[204:207], v[20:23], v[48:51], v[204:207]
    buffer_store_dword v1, v1, s[32:35], s86 offen
    buffer_store_dword v1, v1, s[32:35], s86 offen
    s_cmp_eq_u32 s45, 5
    s_cselect_b32 s52, s60, 0
    s_sub_u32 s36, s36, s52
    s_cmp_eq_u32 s45, 5
    s_cselect_b32 s52, s60, 0
    s_sub_u32 s37, s37, s52
    s_cmp_eq_u32 s45, 5
    s_sub_u32 s45, s45, 1
    s_cmp_lg_u32 s45, 1
    s_waitcnt vmcnt(10) lgkmcnt(0)
    s_barrier
    s_cbranch_scc1 L_g1_loop_X1
L_g1_lastit_X1:
    v_mfma_f32_16x16x32_bf16 v[208:211], v[24:27], v[36:39], v[208:211]
    v_mfma_f32_16x16x32_bf16 v[212:215], v[24:27], v[40:43], v[212:215]
    v_mfma_f32_16x16x32_bf16 v[216:219], v[24:27], v[44:47], v[216:219]
    ds_read_b64_tr_b16 v[16:17], v68 offset:20480
    ds_read_b64_tr_b16 v[18:19], v68 offset:20992
    v_mfma_f32_16x16x32_bf16 v[220:223], v[24:27], v[48:51], v[220:223]
    v_mfma_f32_16x16x32_bf16 v[224:227], v[28:31], v[36:39], v[224:227]
    v_mfma_f32_16x16x32_bf16 v[228:231], v[28:31], v[40:43], v[228:231]
    ds_read_b64_tr_b16 v[20:21], v69 offset:20480
    ds_read_b64_tr_b16 v[22:23], v69 offset:20992
    v_mfma_f32_16x16x32_bf16 v[232:235], v[28:31], v[44:47], v[232:235]
    v_mfma_f32_16x16x32_bf16 v[236:239], v[28:31], v[48:51], v[236:239]
    s_add_u32 m0, s44, 0
    s_nop 0
    buffer_load_dwordx4 v82, s[12:15], s36 offen offset:0 lds
    v_mfma_f32_16x16x32_bf16 v[240:243], v[32:35], v[36:39], v[240:243]
    v_mfma_f32_16x16x32_bf16 v[244:247], v[32:35], v[40:43], v[244:247]
    ds_read_b64_tr_b16 v[24:25], v70 offset:21504
    ds_read_b64_tr_b16 v[26:27], v70 offset:22016
    v_mfma_f32_16x16x32_bf16 v[248:251], v[32:35], v[44:47], v[248:251]
    v_mfma_f32_16x16x32_bf16 v[252:255], v[32:35], v[48:51], v[252:255]
    buffer_load_dwordx4 v83, s[12:15], s36 offen offset:1024 lds
    s_waitcnt lgkmcnt(4)
    v_mfma_f32_16x16x32_bf16 v[96:99], v[52:55], v[16:19], v[96:99]
    v_mfma_f32_16x16x32_bf16 v[100:103], v[56:59], v[16:19], v[100:103]
    ds_read_b64_tr_b16 v[28:29], v70 offset:22528
    ds_read_b64_tr_b16 v[30:31], v70 offset:23040
    v_mfma_f32_16x16x32_bf16 v[104:107], v[60:63], v[16:19], v[104:107]
    v_mfma_f32_16x16x32_bf16 v[108:111], v[64:67], v[16:19], v[108:111]
    buffer_load_dwordx4 v84, s[12:15], s36 offen offset:2048 lds
    s_waitcnt lgkmcnt(4)
    v_mfma_f32_16x16x32_bf16 v[112:115], v[52:55], v[20:23], v[112:115]
    v_mfma_f32_16x16x32_bf16 v[116:119], v[56:59], v[20:23], v[116:119]
    ds_read_b64_tr_b16 v[32:33], v71 offset:21504
    ds_read_b64_tr_b16 v[34:35], v71 offset:22016
    v_mfma_f32_16x16x32_bf16 v[120:123], v[60:63], v[20:23], v[120:123]
    v_mfma_f32_16x16x32_bf16 v[124:127], v[64:67], v[20:23], v[124:127]
    buffer_load_dwordx4 v85, s[12:15], s36 offen offset:3072 lds
    s_add_u32 s36, s36, 128
    s_waitcnt lgkmcnt(4)
    v_mfma_f32_16x16x32_bf16 v[128:131], v[24:27], v[52:55], v[128:131]
    v_mfma_f32_16x16x32_bf16 v[132:135], v[24:27], v[56:59], v[132:135]
    ds_read_b64_tr_b16 v[16:17], v71 offset:22528
    ds_read_b64_tr_b16 v[18:19], v71 offset:23040
    v_mfma_f32_16x16x32_bf16 v[136:139], v[24:27], v[60:63], v[136:139]
    v_mfma_f32_16x16x32_bf16 v[140:143], v[24:27], v[64:67], v[140:143]
    s_add_u32 m0, s44, 4096
    s_nop 0
    buffer_load_dwordx4 v82, s[12:15], s37 offen offset:0 lds
    s_waitcnt lgkmcnt(4)
    v_mfma_f32_16x16x32_bf16 v[144:147], v[28:31], v[52:55], v[144:147]
    v_mfma_f32_16x16x32_bf16 v[148:151], v[28:31], v[56:59], v[148:151]
    ds_read_b64_tr_b16 v[20:21], v72 offset:21504
    ds_read_b64_tr_b16 v[22:23], v72 offset:22016
    v_mfma_f32_16x16x32_bf16 v[152:155], v[28:31], v[60:63], v[152:155]
    v_mfma_f32_16x16x32_bf16 v[156:159], v[28:31], v[64:67], v[156:159]
    buffer_load_dwordx4 v83, s[12:15], s37 offen offset:1024 lds
    s_waitcnt lgkmcnt(4)
    v_mfma_f32_16x16x32_bf16 v[160:163], v[32:35], v[52:55], v[160:163]
    v_mfma_f32_16x16x32_bf16 v[164:167], v[32:35], v[56:59], v[164:167]
    ds_read_b64_tr_b16 v[24:25], v72 offset:22528
    ds_read_b64_tr_b16 v[26:27], v72 offset:23040
    v_mfma_f32_16x16x32_bf16 v[168:171], v[32:35], v[60:63], v[168:171]
    v_mfma_f32_16x16x32_bf16 v[172:175], v[32:35], v[64:67], v[172:175]
    buffer_load_dwordx4 v84, s[12:15], s37 offen offset:2048 lds
    s_waitcnt lgkmcnt(4)
    v_mfma_f32_16x16x32_bf16 v[176:179], v[16:19], v[52:55], v[176:179]
    ds_read_b64_tr_b16 v[28:29], v73 offset:21504
    ds_read_b64_tr_b16 v[30:31], v73 offset:22016
    v_mfma_f32_16x16x32_bf16 v[180:183], v[16:19], v[56:59], v[180:183]
    ds_read_b64_tr_b16 v[32:33], v73 offset:22528
    ds_read_b64_tr_b16 v[34:35], v73 offset:23040
    v_mfma_f32_16x16x32_bf16 v[184:187], v[16:19], v[60:63], v[184:187]
    v_mfma_f32_16x16x32_bf16 v[188:191], v[16:19], v[64:67], v[188:191]
    buffer_load_dwordx4 v85, s[12:15], s37 offen offset:3072 lds
    s_add_u32 s37, s37, 128
    s_waitcnt lgkmcnt(6)
    v_mfma_f32_16x16x32_bf16 v[192:195], v[20:23], v[52:55], v[192:195]
    v_mfma_f32_16x16x32_bf16 v[196:199], v[20:23], v[56:59], v[196:199]
    v_mfma_f32_16x16x32_bf16 v[200:203], v[20:23], v[60:63], v[200:203]
    v_mfma_f32_16x16x32_bf16 v[204:207], v[20:23], v[64:67], v[204:207]
    s_waitcnt vmcnt(10) lgkmcnt(0)
    s_barrier
    v_mfma_f32_16x16x32_bf16 v[208:211], v[24:27], v[52:55], v[208:211]
    ds_read_b128 v[36:39], v80 offset:32768
    ds_read_b128 v[40:43], v80 offset:34816
    s_lshl_b32 s52, s49, 6
    v_add_u32 v4, s52, v1
    v_mfma_f32_16x16x32_bf16 v[212:215], v[24:27], v[56:59], v[212:215]
    ds_read_b128 v[44:47], v80 offset:36864
    ds_read_b128 v[48:51], v80 offset:38912
    v_lshrrev_b32 v5, 3, v4
    v_mfma_f32_16x16x32_bf16 v[216:219], v[24:27], v[60:63], v[216:219]
    ds_read_b64_tr_b16 v[16:17], v68 offset:40960
    ds_read_b64_tr_b16 v[18:19], v68 offset:41472
    v_lshlrev_b32 v5, 7, v5
    v_mfma_f32_16x16x32_bf16 v[220:223], v[24:27], v[64:67], v[220:223]
    v_and_b32 v6, 7, v1
    v_mfma_f32_16x16x32_bf16 v[224:227], v[28:31], v[52:55], v[224:227]
    v_lshl_add_u32 v5, v6, 3, v5
    v_mfma_f32_16x16x32_bf16 v[228:231], v[28:31], v[56:59], v[228:231]
    ds_read_b64_tr_b16 v[20:21], v69 offset:40960
    ds_read_b64_tr_b16 v[22:23], v69 offset:41472
    v_cmp_gt_u32 vcc, 256, v4
    v_mfma_f32_16x16x32_bf16 v[232:235], v[28:31], v[60:63], v[232:235]
    v_mov_b32 v6, 2147418112
    v_mfma_f32_16x16x32_bf16 v[236:239], v[28:31], v[64:67], v[236:239]
    v_cndmask_b32 v5, v6, v5, vcc
    v_mfma_f32_16x16x32_bf16 v[240:243], v[32:35], v[52:55], v[240:243]
    v_cmp_gt_u32 vcc, 320, v4
    v_mfma_f32_16x16x32_bf16 v[244:247], v[32:35], v[56:59], v[244:247]
    ds_read_b64_tr_b16 v[24:25], v70 offset:41984
    ds_read_b64_tr_b16 v[26:27], v70 offset:42496
    v_lshlrev_b32 v4, 2, v4
    v_mfma_f32_16x16x32_bf16 v[248:251], v[32:35], v[60:63], v[248:251]
    v_cndmask_b32 v7, v6, v4, vcc
    v_mfma_f32_16x16x32_bf16 v[252:255], v[32:35], v[64:67], v[252:255]
    s_and_b32 s52, s2, 31
    s_mul_i32 s52, s52, 10240
    s_add_u32 s52, s52, 52498432
    s_add_u32 s53, s52, 5120
    buffer_load_dword v88, v7, s[32:35], s52 offen offset:0 sc0 sc1
    s_waitcnt lgkmcnt(4)
    v_mfma_f32_16x16x32_bf16 v[96:99], v[36:39], v[16:19], v[96:99]
    ds_read_b128 v[52:55], v81 offset:32768
    ds_read_b128 v[56:59], v81 offset:34816
    buffer_load_dword v89, v7, s[32:35], s52 offen offset:1280 sc0 sc1
    v_mfma_f32_16x16x32_bf16 v[100:103], v[40:43], v[16:19], v[100:103]
    ds_read_b64_tr_b16 v[28:29], v70 offset:43008
    ds_read_b64_tr_b16 v[30:31], v70 offset:43520
    buffer_load_dword v90, v7, s[32:35], s52 offen offset:2560 sc0 sc1
    v_mfma_f32_16x16x32_bf16 v[104:107], v[44:47], v[16:19], v[104:107]
    ds_read_b128 v[60:63], v81 offset:36864
    ds_read_b128 v[64:67], v81 offset:38912
    buffer_load_dword v91, v7, s[32:35], s52 offen offset:3840 sc0 sc1
    v_mfma_f32_16x16x32_bf16 v[108:111], v[48:51], v[16:19], v[108:111]
    buffer_load_dword v92, v7, s[32:35], s53 offen offset:0 sc0 sc1
    s_waitcnt lgkmcnt(8)
    v_mfma_f32_16x16x32_bf16 v[112:115], v[36:39], v[20:23], v[112:115]
    buffer_load_dword v93, v7, s[32:35], s53 offen offset:1280 sc0 sc1
    v_mfma_f32_16x16x32_bf16 v[116:119], v[40:43], v[20:23], v[116:119]
    ds_read_b64_tr_b16 v[32:33], v71 offset:41984
    ds_read_b64_tr_b16 v[34:35], v71 offset:42496
    buffer_load_dword v94, v7, s[32:35], s53 offen offset:2560 sc0 sc1
    v_mfma_f32_16x16x32_bf16 v[120:123], v[44:47], v[20:23], v[120:123]
    buffer_load_dword v95, v7, s[32:35], s53 offen offset:3840 sc0 sc1
    v_mfma_f32_16x16x32_bf16 v[124:127], v[48:51], v[20:23], v[124:127]
    s_lshl_b32 s52, s48, 12
    s_add_u32 s52, s52, 52465664
    buffer_load_dwordx2 v[74:75], v5, s[32:35], s52 offen sc0 sc1
    s_waitcnt lgkmcnt(8)
    v_mfma_f32_16x16x32_bf16 v[128:131], v[24:27], v[36:39], v[128:131]
    v_mfma_f32_16x16x32_bf16 v[132:135], v[24:27], v[40:43], v[132:135]
    ds_read_b64_tr_b16 v[16:17], v71 offset:43008
    ds_read_b64_tr_b16 v[18:19], v71 offset:43520
    v_mfma_f32_16x16x32_bf16 v[136:139], v[24:27], v[44:47], v[136:139]
    v_mfma_f32_16x16x32_bf16 v[140:143], v[24:27], v[48:51], v[140:143]
    s_waitcnt lgkmcnt(6)
    v_mfma_f32_16x16x32_bf16 v[144:147], v[28:31], v[36:39], v[144:147]
    v_mfma_f32_16x16x32_bf16 v[148:151], v[28:31], v[40:43], v[148:151]
    ds_read_b64_tr_b16 v[20:21], v72 offset:41984
    ds_read_b64_tr_b16 v[22:23], v72 offset:42496
    v_mfma_f32_16x16x32_bf16 v[152:155], v[28:31], v[44:47], v[152:155]
    v_mfma_f32_16x16x32_bf16 v[156:159], v[28:31], v[48:51], v[156:159]
    s_waitcnt lgkmcnt(4)
    v_mfma_f32_16x16x32_bf16 v[160:163], v[32:35], v[36:39], v[160:163]
    v_mfma_f32_16x16x32_bf16 v[164:167], v[32:35], v[40:43], v[164:167]
    ds_read_b64_tr_b16 v[24:25], v72 offset:43008
    ds_read_b64_tr_b16 v[26:27], v72 offset:43520
    v_mfma_f32_16x16x32_bf16 v[168:171], v[32:35], v[44:47], v[168:171]
    v_mfma_f32_16x16x32_bf16 v[172:175], v[32:35], v[48:51], v[172:175]
    s_waitcnt lgkmcnt(4)
    v_mfma_f32_16x16x32_bf16 v[176:179], v[16:19], v[36:39], v[176:179]
    ds_read_b64_tr_b16 v[28:29], v73 offset:41984
    ds_read_b64_tr_b16 v[30:31], v73 offset:42496
    v_mfma_f32_16x16x32_bf16 v[180:183], v[16:19], v[40:43], v[180:183]
    ds_read_b64_tr_b16 v[32:33], v73 offset:43008
    ds_read_b64_tr_b16 v[34:35], v73 offset:43520
    v_mfma_f32_16x16x32_bf16 v[184:187], v[16:19], v[44:47], v[184:187]
    v_mfma_f32_16x16x32_bf16 v[188:191], v[16:19], v[48:51], v[188:191]
    s_waitcnt lgkmcnt(6)
    v_mfma_f32_16x16x32_bf16 v[192:195], v[20:23], v[36:39], v[192:195]
    v_mfma_f32_16x16x32_bf16 v[196:199], v[20:23], v[40:43], v[196:199]
    v_mfma_f32_16x16x32_bf16 v[200:203], v[20:23], v[44:47], v[200:203]
    v_mfma_f32_16x16x32_bf16 v[204:207], v[20:23], v[48:51], v[204:207]
    s_waitcnt vmcnt(19) lgkmcnt(0)
    s_barrier
    v_mfma_f32_16x16x32_bf16 v[208:211], v[24:27], v[36:39], v[208:211]
    v_mfma_f32_16x16x32_bf16 v[212:215], v[24:27], v[40:43], v[212:215]
    v_mfma_f32_16x16x32_bf16 v[216:219], v[24:27], v[44:47], v[216:219]
    ds_read_b64_tr_b16 v[16:17], v68 offset:61440
    ds_read_b64_tr_b16 v[18:19], v68 offset:61952
    v_mfma_f32_16x16x32_bf16 v[220:223], v[24:27], v[48:51], v[220:223]
    v_mfma_f32_16x16x32_bf16 v[224:227], v[28:31], v[36:39], v[224:227]
    v_mfma_f32_16x16x32_bf16 v[228:231], v[28:31], v[40:43], v[228:231]
    ds_read_b64_tr_b16 v[20:21], v69 offset:61440
    ds_read_b64_tr_b16 v[22:23], v69 offset:61952
    v_mfma_f32_16x16x32_bf16 v[232:235], v[28:31], v[44:47], v[232:235]
    v_mfma_f32_16x16x32_bf16 v[236:239], v[28:31], v[48:51], v[236:239]
    s_add_u32 m0, s44, 32768
    s_nop 0
    buffer_load_dwordx4 v82, s[12:15], s36 offen offset:0 lds
    v_mfma_f32_16x16x32_bf16 v[240:243], v[32:35], v[36:39], v[240:243]
    v_mfma_f32_16x16x32_bf16 v[244:247], v[32:35], v[40:43], v[244:247]
    ds_read_b64_tr_b16 v[24:25], v70 offset:62464
    ds_read_b64_tr_b16 v[26:27], v70 offset:62976
    v_mfma_f32_16x16x32_bf16 v[248:251], v[32:35], v[44:47], v[248:251]
    v_mfma_f32_16x16x32_bf16 v[252:255], v[32:35], v[48:51], v[252:255]
    buffer_load_dwordx4 v83, s[12:15], s36 offen offset:1024 lds
    s_waitcnt lgkmcnt(4)
    v_mfma_f32_16x16x32_bf16 v[96:99], v[52:55], v[16:19], v[96:99]
    v_mfma_f32_16x16x32_bf16 v[100:103], v[56:59], v[16:19], v[100:103]
    ds_read_b64_tr_b16 v[28:29], v70 offset:63488
    ds_read_b64_tr_b16 v[30:31], v70 offset:64000
    v_mfma_f32_16x16x32_bf16 v[104:107], v[60:63], v[16:19], v[104:107]
    v_mfma_f32_16x16x32_bf16 v[108:111], v[64:67], v[16:19], v[108:111]
    buffer_load_dwordx4 v84, s[12:15], s36 offen offset:2048 lds
    s_waitcnt lgkmcnt(4)
    v_mfma_f32_16x16x32_bf16 v[112:115], v[52:55], v[20:23], v[112:115]
    v_mfma_f32_16x16x32_bf16 v[116:119], v[56:59], v[20:23], v[116:119]
    ds_read_b64_tr_b16 v[32:33], v71 offset:62464
    ds_read_b64_tr_b16 v[34:35], v71 offset:62976
    v_mfma_f32_16x16x32_bf16 v[120:123], v[60:63], v[20:23], v[120:123]
    v_mfma_f32_16x16x32_bf16 v[124:127], v[64:67], v[20:23], v[124:127]
    buffer_load_dwordx4 v85, s[12:15], s36 offen offset:3072 lds
    s_add_u32 s36, s36, 128
    s_waitcnt lgkmcnt(4)
    v_mfma_f32_16x16x32_bf16 v[128:131], v[24:27], v[52:55], v[128:131]
    v_mfma_f32_16x16x32_bf16 v[132:135], v[24:27], v[56:59], v[132:135]
    ds_read_b64_tr_b16 v[16:17], v71 offset:63488
    ds_read_b64_tr_b16 v[18:19], v71 offset:64000
    v_mfma_f32_16x16x32_bf16 v[136:139], v[24:27], v[60:63], v[136:139]
    v_mfma_f32_16x16x32_bf16 v[140:143], v[24:27], v[64:67], v[140:143]
    s_add_u32 m0, s44, 36864
    s_nop 0
    buffer_load_dwordx4 v82, s[12:15], s37 offen offset:0 lds
    s_waitcnt lgkmcnt(4)
    v_mfma_f32_16x16x32_bf16 v[144:147], v[28:31], v[52:55], v[144:147]
    v_mfma_f32_16x16x32_bf16 v[148:151], v[28:31], v[56:59], v[148:151]
    ds_read_b64_tr_b16 v[20:21], v72 offset:62464
    ds_read_b64_tr_b16 v[22:23], v72 offset:62976
    v_mfma_f32_16x16x32_bf16 v[152:155], v[28:31], v[60:63], v[152:155]
    v_mfma_f32_16x16x32_bf16 v[156:159], v[28:31], v[64:67], v[156:159]
    buffer_load_dwordx4 v83, s[12:15], s37 offen offset:1024 lds
    s_waitcnt lgkmcnt(4)
    v_mfma_f32_16x16x32_bf16 v[160:163], v[32:35], v[52:55], v[160:163]
    v_mfma_f32_16x16x32_bf16 v[164:167], v[32:35], v[56:59], v[164:167]
    ds_read_b64_tr_b16 v[24:25], v72 offset:63488
    ds_read_b64_tr_b16 v[26:27], v72 offset:64000
    v_mfma_f32_16x16x32_bf16 v[168:171], v[32:35], v[60:63], v[168:171]
    v_mfma_f32_16x16x32_bf16 v[172:175], v[32:35], v[64:67], v[172:175]
    buffer_load_dwordx4 v84, s[12:15], s37 offen offset:2048 lds
    s_waitcnt lgkmcnt(4)
    v_mfma_f32_16x16x32_bf16 v[176:179], v[16:19], v[52:55], v[176:179]
    ds_read_b64_tr_b16 v[28:29], v73 offset:62464
    ds_read_b64_tr_b16 v[30:31], v73 offset:62976
    v_mfma_f32_16x16x32_bf16 v[180:183], v[16:19], v[56:59], v[180:183]
    ds_read_b64_tr_b16 v[32:33], v73 offset:63488
    ds_read_b64_tr_b16 v[34:35], v73 offset:64000
    v_mfma_f32_16x16x32_bf16 v[184:187], v[16:19], v[60:63], v[184:187]
    v_mfma_f32_16x16x32_bf16 v[188:191], v[16:19], v[64:67], v[188:191]
    buffer_load_dwordx4 v85, s[12:15], s37 offen offset:3072 lds
    s_add_u32 s37, s37, 128
    s_waitcnt lgkmcnt(6)
    v_mfma_f32_16x16x32_bf16 v[192:195], v[20:23], v[52:55], v[192:195]
    v_mfma_f32_16x16x32_bf16 v[196:199], v[20:23], v[56:59], v[196:199]
    v_mfma_f32_16x16x32_bf16 v[200:203], v[20:23], v[60:63], v[200:203]
    v_mfma_f32_16x16x32_bf16 v[204:207], v[20:23], v[64:67], v[204:207]
    s_waitcnt vmcnt(17) lgkmcnt(0)
    s_barrier
    v_mfma_f32_16x16x32_bf16 v[208:211], v[24:27], v[52:55], v[208:211]
    ds_read_b128 v[36:39], v80 offset:0
    ds_read_b128 v[40:43], v80 offset:2048
    v_mfma_f32_16x16x32_bf16 v[212:215], v[24:27], v[56:59], v[212:215]
    ds_read_b128 v[44:47], v80 offset:4096
    ds_read_b128 v[48:51], v80 offset:6144
    v_mfma_f32_16x16x32_bf16 v[216:219], v[24:27], v[60:63], v[216:219]
    ds_read_b64_tr_b16 v[16:17], v68 offset:0
    ds_read_b64_tr_b16 v[18:19], v68 offset:512
    v_mfma_f32_16x16x32_bf16 v[220:223], v[24:27], v[64:67], v[220:223]
    v_mfma_f32_16x16x32_bf16 v[224:227], v[28:31], v[52:55], v[224:227]
    v_mfma_f32_16x16x32_bf16 v[228:231], v[28:31], v[56:59], v[228:231]
    ds_read_b64_tr_b16 v[20:21], v69 offset:0
    ds_read_b64_tr_b16 v[22:23], v69 offset:512
    v_mfma_f32_16x16x32_bf16 v[232:235], v[28:31], v[60:63], v[232:235]
    v_mfma_f32_16x16x32_bf16 v[236:239], v[28:31], v[64:67], v[236:239]
    v_mfma_f32_16x16x32_bf16 v[240:243], v[32:35], v[52:55], v[240:243]
    v_mfma_f32_16x16x32_bf16 v[244:247], v[32:35], v[56:59], v[244:247]
    ds_read_b64_tr_b16 v[24:25], v70 offset:1024
    ds_read_b64_tr_b16 v[26:27], v70 offset:1536
    v_mfma_f32_16x16x32_bf16 v[248:251], v[32:35], v[60:63], v[248:251]
    v_mfma_f32_16x16x32_bf16 v[252:255], v[32:35], v[64:67], v[252:255]
    s_waitcnt lgkmcnt(4)
    v_mfma_f32_16x16x32_bf16 v[96:99], v[36:39], v[16:19], v[96:99]
    ds_read_b128 v[52:55], v81 offset:0
    ds_read_b128 v[56:59], v81 offset:2048
    v_mfma_f32_16x16x32_bf16 v[100:103], v[40:43], v[16:19], v[100:103]
    ds_read_b64_tr_b16 v[28:29], v70 offset:2048
    ds_read_b64_tr_b16 v[30:31], v70 offset:2560
    v_mfma_f32_16x16x32_bf16 v[104:107], v[44:47], v[16:19], v[104:107]
    ds_read_b128 v[60:63], v81 offset:4096
    ds_read_b128 v[64:67], v81 offset:6144
    v_mfma_f32_16x16x32_bf16 v[108:111], v[48:51], v[16:19], v[108:111]
    s_waitcnt lgkmcnt(8)
    v_mfma_f32_16x16x32_bf16 v[112:115], v[36:39], v[20:23], v[112:115]
    v_mfma_f32_16x16x32_bf16 v[116:119], v[40:43], v[20:23], v[116:119]
    ds_read_b64_tr_b16 v[32:33], v71 offset:1024
    ds_read_b64_tr_b16 v[34:35], v71 offset:1536
    v_mfma_f32_16x16x32_bf16 v[120:123], v[44:47], v[20:23], v[120:123]
    v_mfma_f32_16x16x32_bf16 v[124:127], v[48:51], v[20:23], v[124:127]
    s_waitcnt lgkmcnt(8)
    v_mfma_f32_16x16x32_bf16 v[128:131], v[24:27], v[36:39], v[128:131]
    v_mfma_f32_16x16x32_bf16 v[132:135], v[24:27], v[40:43], v[132:135]
    ds_read_b64_tr_b16 v[16:17], v71 offset:2048
    ds_read_b64_tr_b16 v[18:19], v71 offset:2560
    v_mfma_f32_16x16x32_bf16 v[136:139], v[24:27], v[44:47], v[136:139]
    v_mfma_f32_16x16x32_bf16 v[140:143], v[24:27], v[48:51], v[140:143]
    s_waitcnt lgkmcnt(6)
    v_mfma_f32_16x16x32_bf16 v[144:147], v[28:31], v[36:39], v[144:147]
    v_mfma_f32_16x16x32_bf16 v[148:151], v[28:31], v[40:43], v[148:151]
    ds_read_b64_tr_b16 v[20:21], v72 offset:1024
    ds_read_b64_tr_b16 v[22:23], v72 offset:1536
    v_mfma_f32_16x16x32_bf16 v[152:155], v[28:31], v[44:47], v[152:155]
    v_mfma_f32_16x16x32_bf16 v[156:159], v[28:31], v[48:51], v[156:159]
    s_waitcnt lgkmcnt(4)
    v_mfma_f32_16x16x32_bf16 v[160:163], v[32:35], v[36:39], v[160:163]
    v_mfma_f32_16x16x32_bf16 v[164:167], v[32:35], v[40:43], v[164:167]
    ds_read_b64_tr_b16 v[24:25], v72 offset:2048
    ds_read_b64_tr_b16 v[26:27], v72 offset:2560
    v_mfma_f32_16x16x32_bf16 v[168:171], v[32:35], v[44:47], v[168:171]
    v_mfma_f32_16x16x32_bf16 v[172:175], v[32:35], v[48:51], v[172:175]
    s_waitcnt lgkmcnt(4)
    v_mfma_f32_16x16x32_bf16 v[176:179], v[16:19], v[36:39], v[176:179]
    ds_read_b64_tr_b16 v[28:29], v73 offset:1024
    ds_read_b64_tr_b16 v[30:31], v73 offset:1536
    v_mfma_f32_16x16x32_bf16 v[180:183], v[16:19], v[40:43], v[180:183]
    ds_read_b64_tr_b16 v[32:33], v73 offset:2048
    ds_read_b64_tr_b16 v[34:35], v73 offset:2560
    v_mfma_f32_16x16x32_bf16 v[184:187], v[16:19], v[44:47], v[184:187]
    v_mfma_f32_16x16x32_bf16 v[188:191], v[16:19], v[48:51], v[188:191]
    s_waitcnt lgkmcnt(6)
    v_mfma_f32_16x16x32_bf16 v[192:195], v[20:23], v[36:39], v[192:195]
    v_mfma_f32_16x16x32_bf16 v[196:199], v[20:23], v[40:43], v[196:199]
    v_mfma_f32_16x16x32_bf16 v[200:203], v[20:23], v[44:47], v[200:203]
    v_mfma_f32_16x16x32_bf16 v[204:207], v[20:23], v[48:51], v[204:207]
    s_waitcnt vmcnt(8)
    v_add_f32 v88, v88, v89
    v_add_f32 v90, v90, v91
    v_add_f32 v92, v92, v93
    v_add_f32 v94, v94, v95
    v_add_f32 v88, v88, v90
    v_add_f32 v92, v92, v94
    v_add_f32 v88, v88, v92
    v_add_u32 v4, 147456, v4
    s_lshl_b32 s52, s49, 9
    s_add_u32 s52, s52, 149504
    v_lshl_add_u32 v5, v1, 2, s52
    ds_write_b32 v4, v88
    ds_write2_b32 v5, v74, v75 offset0:0 offset1:64
    s_waitcnt lgkmcnt(0)
    s_barrier
    s_branch L_g1_tail
L_g1_spec_X1:
    s_cmp_eq_u32 s51, 0
    s_cbranch_scc1 L_cs_61
    v_mfma_f32_16x16x32_bf16 v[208:211], v[24:27], v[36:39], v[208:211]
    v_mfma_f32_16x16x32_bf16 v[212:215], v[24:27], v[40:43], v[212:215]
    v_mfma_f32_16x16x32_bf16 v[216:219], v[24:27], v[44:47], v[216:219]
    ds_read_b64_tr_b16 v[16:17], v68 offset:20480
    ds_read_b64_tr_b16 v[18:19], v68 offset:20992
    v_mfma_f32_16x16x32_bf16 v[220:223], v[24:27], v[48:51], v[220:223]
    v_mfma_f32_16x16x32_bf16 v[224:227], v[28:31], v[36:39], v[224:227]
    v_mfma_f32_16x16x32_bf16 v[228:231], v[28:31], v[40:43], v[228:231]
    ds_read_b64_tr_b16 v[20:21], v69 offset:20480
    ds_read_b64_tr_b16 v[22:23], v69 offset:20992
    v_mfma_f32_16x16x32_bf16 v[232:235], v[28:31], v[44:47], v[232:235]
    v_mfma_f32_16x16x32_bf16 v[236:239], v[28:31], v[48:51], v[236:239]
    s_add_u32 m0, s44, 0
    s_nop 0
    buffer_load_dwordx4 v82, s[12:15], s36 offen offset:0 lds
    v_mfma_f32_16x16x32_bf16 v[240:243], v[32:35], v[36:39], v[240:243]
    v_mfma_f32_16x16x32_bf16 v[244:247], v[32:35], v[40:43], v[244:247]
    ds_read_b64_tr_b16 v[24:25], v70 offset:21504
    ds_read_b64_tr_b16 v[26:27], v70 offset:22016
    v_mfma_f32_16x16x32_bf16 v[248:251], v[32:35], v[44:47], v[248:251]
    v_mfma_f32_16x16x32_bf16 v[252:255], v[32:35], v[48:51], v[252:255]
    buffer_load_dwordx4 v83, s[12:15], s36 offen offset:1024 lds
L_cs_61_ret:
    s_cmp_eq_u32 s51, 1
    s_cbranch_scc1 L_cs_62
    s_waitcnt lgkmcnt(4)
    v_mfma_f32_16x16x32_bf16 v[96:99], v[52:55], v[16:19], v[96:99]
    v_mfma_f32_16x16x32_bf16 v[100:103], v[56:59], v[16:19], v[100:103]
    ds_read_b64_tr_b16 v[28:29], v70 offset:22528
    ds_read_b64_tr_b16 v[30:31], v70 offset:23040
    v_mfma_f32_16x16x32_bf16 v[104:107], v[60:63], v[16:19], v[104:107]
    v_mfma_f32_16x16x32_bf16 v[108:111], v[64:67], v[16:19], v[108:111]
    buffer_load_dwordx4 v84, s[12:15], s36 offen offset:2048 lds
    s_waitcnt lgkmcnt(4)
    v_mfma_f32_16x16x32_bf16 v[112:115], v[52:55], v[20:23], v[112:115]
    v_mfma_f32_16x16x32_bf16 v[116:119], v[56:59], v[20:23], v[116:119]
    ds_read_b64_tr_b16 v[32:33], v71 offset:21504
    ds_read_b64_tr_b16 v[34:35], v71 offset:22016
    v_mfma_f32_16x16x32_bf16 v[120:123], v[60:63], v[20:23], v[120:123]
    v_mfma_f32_16x16x32_bf16 v[124:127], v[64:67], v[20:23], v[124:127]
    buffer_load_dwordx4 v85, s[12:15], s36 offen offset:3072 lds
    s_add_u32 s36, s36, 128
    s_waitcnt lgkmcnt(4)
    v_mfma_f32_16x16x32_bf16 v[128:131], v[24:27], v[52:55], v[128:131]
    v_mfma_f32_16x16x32_bf16 v[132:135], v[24:27], v[56:59], v[132:135]
    ds_read_b64_tr_b16 v[16:17], v71 offset:22528
    ds_read_b64_tr_b16 v[18:19], v71 offset:23040
    v_mfma_f32_16x16x32_bf16 v[136:139], v[24:27], v[60:63], v[136:139]
    v_mfma_f32_16x16x32_bf16 v[140:143], v[24:27], v[64:67], v[140:143]
    s_add_u32 m0, s44, 4096
    s_nop 0
    buffer_load_dwordx4 v82, s[12:15], s37 offen offset:0 lds
L_cs_62_ret:
    s_cmp_eq_u32 s51, 2
    s_cbranch_scc1 L_cs_63
    s_waitcnt lgkmcnt(4)
    v_mfma_f32_16x16x32_bf16 v[144:147], v[28:31], v[52:55], v[144:147]
    v_mfma_f32_16x16x32_bf16 v[148:151], v[28:31], v[56:59], v[148:151]
    ds_read_b64_tr_b16 v[20:21], v72 offset:21504
    ds_read_b64_tr_b16 v[22:23], v72 offset:22016
    v_mfma_f32_16x16x32_bf16 v[152:155], v[28:31], v[60:63], v[152:155]
    v_mfma_f32_16x16x32_bf16 v[156:159], v[28:31], v[64:67], v[156:159]
    buffer_load_dwordx4 v83, s[12:15], s37 offen offset:1024 lds
    s_waitcnt lgkmcnt(4)
    v_mfma_f32_16x16x32_bf16 v[160:163], v[32:35], v[52:55], v[160:163]
    v_mfma_f32_16x16x32_bf16 v[164:167], v[32:35], v[56:59], v[164:167]
    ds_read_b64_tr_b16 v[24:25], v72 offset:22528
    ds_read_b64_tr_b16 v[26:27], v72 offset:23040
    v_mfma_f32_16x16x32_bf16 v[168:171], v[32:35], v[60:63], v[168:171]
    v_mfma_f32_16x16x32_bf16 v[172:175], v[32:35], v[64:67], v[172:175]
    buffer_load_dwordx4 v84, s[12:15], s37 offen offset:2048 lds
L_cs_63_ret:
    s_cmp_eq_u32 s51, 3
    s_cbranch_scc1 L_cs_64
    s_waitcnt lgkmcnt(4)
    v_mfma_f32_16x16x32_bf16 v[176:179], v[16:19], v[52:55], v[176:179]
    ds_read_b64_tr_b16 v[28:29], v73 offset:21504
    ds_read_b64_tr_b16 v[30:31], v73 offset:22016
    v_mfma_f32_16x16x32_bf16 v[180:183], v[16:19], v[56:59], v[180:183]
    ds_read_b64_tr_b16 v[32:33], v73 offset:22528
    ds_read_b64_tr_b16 v[34:35], v73 offset:23040
    v_mfma_f32_16x16x32_bf16 v[184:187], v[16:19], v[60:63], v[184:187]
    v_mfma_f32_16x16x32_bf16 v[188:191], v[16:19], v[64:67], v[188:191]
    buffer_load_dwordx4 v85, s[12:15], s37 offen offset:3072 lds
    s_add_u32 s37, s37, 128
    s_waitcnt lgkmcnt(6)
    v_mfma_f32_16x16x32_bf16 v[192:195], v[20:23], v[52:55], v[192:195]
    v_mfma_f32_16x16x32_bf16 v[196:199], v[20:23], v[56:59], v[196:199]
    v_mfma_f32_16x16x32_bf16 v[200:203], v[20:23], v[60:63], v[200:203]
    v_mfma_f32_16x16x32_bf16 v[204:207], v[20:23], v[64:67], v[204:207]
L_cs_64_ret:
    s_waitcnt vmcnt(10) lgkmcnt(0)
    s_barrier
    s_cmp_eq_u32 s51, 0
    s_cbranch_scc1 L_cs_65
    v_mfma_f32_16x16x32_bf16 v[208:211], v[24:27], v[52:55], v[208:211]
    ds_read_b128 v[36:39], v80 offset:32768
    ds_read_b128 v[40:43], v80 offset:34816
    v_lshlrev_b32 v74, 16, v76
    v_mfma_f32_16x16x32_bf16 v[212:215], v[24:27], v[56:59], v[212:215]
    ds_read_b128 v[44:47], v80 offset:36864
    ds_read_b128 v[48:51], v80 offset:38912
    v_and_b32 v75, s87, v76
    v_mfma_f32_16x16x32_bf16 v[216:219], v[24:27], v[60:63], v[216:219]
    ds_read_b64_tr_b16 v[16:17], v68 offset:40960
    ds_read_b64_tr_b16 v[18:19], v68 offset:41472
    v_lshlrev_b32 v2, 16, v77
    v_mfma_f32_16x16x32_bf16 v[220:223], v[24:27], v[64:67], v[220:223]
    v_and_b32 v3, s87, v77
    v_mfma_f32_16x16x32_bf16 v[224:227], v[28:31], v[52:55], v[224:227]
    v_add_f32 v74, v74, v2
    v_mfma_f32_16x16x32_bf16 v[228:231], v[28:31], v[56:59], v[228:231]
    ds_read_b64_tr_b16 v[20:21], v69 offset:40960
    ds_read_b64_tr_b16 v[22:23], v69 offset:41472
    v_add_f32 v75, v75, v3
    v_mfma_f32_16x16x32_bf16 v[232:235], v[28:31], v[60:63], v[232:235]
    v_lshlrev_b32 v2, 16, v78
    v_mfma_f32_16x16x32_bf16 v[236:239], v[28:31], v[64:67], v[236:239]
    v_and_b32 v3, s87, v78
    v_mfma_f32_16x16x32_bf16 v[240:243], v[32:35], v[52:55], v[240:243]
    v_add_f32 v74, v74, v2
    v_mfma_f32_16x16x32_bf16 v[244:247], v[32:35], v[56:59], v[244:247]
    ds_read_b64_tr_b16 v[24:25], v70 offset:41984
    ds_read_b64_tr_b16 v[26:27], v70 offset:42496
    v_add_f32 v75, v75, v3
    v_mfma_f32_16x16x32_bf16 v[248:251], v[32:35], v[60:63], v[248:251]
    v_lshlrev_b32 v2, 16, v79
    v_mfma_f32_16x16x32_bf16 v[252:255], v[32:35], v[64:67], v[252:255]
    v_and_b32 v3, s87, v79
L_cs_65_ret:
    s_cmp_eq_u32 s51, 1
    s_cbranch_scc1 L_cs_66
    s_waitcnt lgkmcnt(4)
    v_mfma_f32_16x16x32_bf16 v[96:99], v[36:39], v[16:19], v[96:99]
    ds_read_b128 v[52:55], v81 offset:32768
    ds_read_b128 v[56:59], v81 offset:34816
    v_add_f32 v74, v74, v2
    v_mfma_f32_16x16x32_bf16 v[100:103], v[40:43], v[16:19], v[100:103]
    ds_read_b64_tr_b16 v[28:29], v70 offset:43008
    ds_read_b64_tr_b16 v[30:31], v70 offset:43520
    v_add_f32 v75, v75, v3
    v_mfma_f32_16x16x32_bf16 v[104:107], v[44:47], v[16:19], v[104:107]
    ds_read_b128 v[60:63], v81 offset:36864
    ds_read_b128 v[64:67], v81 offset:38912
    v_lshlrev_b32 v2, 16, v92
    v_mfma_f32_16x16x32_bf16 v[108:111], v[48:51], v[16:19], v[108:111]
    v_and_b32 v3, s87, v92
    s_waitcnt lgkmcnt(8)
    v_mfma_f32_16x16x32_bf16 v[112:115], v[36:39], v[20:23], v[112:115]
    v_add_f32 v74, v74, v2
    v_mfma_f32_16x16x32_bf16 v[116:119], v[40:43], v[20:23], v[116:119]
    ds_read_b64_tr_b16 v[32:33], v71 offset:41984
    ds_read_b64_tr_b16 v[34:35], v71 offset:42496
    v_add_f32 v75, v75, v3
    v_mfma_f32_16x16x32_bf16 v[120:123], v[44:47], v[20:23], v[120:123]
    v_lshlrev_b32 v2, 16, v93
    v_mfma_f32_16x16x32_bf16 v[124:127], v[48:51], v[20:23], v[124:127]
    v_and_b32 v3, s87, v93
    s_waitcnt lgkmcnt(8)
    v_mfma_f32_16x16x32_bf16 v[128:131], v[24:27], v[36:39], v[128:131]
    v_add_f32 v74, v74, v2
    v_mfma_f32_16x16x32_bf16 v[132:135], v[24:27], v[40:43], v[132:135]
    ds_read_b64_tr_b16 v[16:17], v71 offset:43008
    ds_read_b64_tr_b16 v[18:19], v71 offset:43520
    v_add_f32 v75, v75, v3
    v_mfma_f32_16x16x32_bf16 v[136:139], v[24:27], v[44:47], v[136:139]
    v_lshlrev_b32 v2, 16, v94
    v_mfma_f32_16x16x32_bf16 v[140:143], v[24:27], v[48:51], v[140:143]
    v_and_b32 v3, s87, v94
L_cs_66_ret:
    s_cmp_eq_u32 s51, 2
    s_cbranch_scc1 L_cs_67
    s_waitcnt lgkmcnt(6)
    v_mfma_f32_16x16x32_bf16 v[144:147], v[28:31], v[36:39], v[144:147]
    v_add_f32 v74, v74, v2
    v_mfma_f32_16x16x32_bf16 v[148:151], v[28:31], v[40:43], v[148:151]
    ds_read_b64_tr_b16 v[20:21], v72 offset:41984
    ds_read_b64_tr_b16 v[22:23], v72 offset:42496
    v_add_f32 v75, v75, v3
    v_mfma_f32_16x16x32_bf16 v[152:155], v[28:31], v[44:47], v[152:155]
    v_lshlrev_b32 v2, 16, v95
    v_mfma_f32_16x16x32_bf16 v[156:159], v[28:31], v[48:51], v[156:159]
    v_and_b32 v3, s87, v95
    s_waitcnt lgkmcnt(4)
    v_mfma_f32_16x16x32_bf16 v[160:163], v[32:35], v[36:39], v[160:163]
    v_add_f32 v74, v74, v2
    v_mfma_f32_16x16x32_bf16 v[164:167], v[32:35], v[40:43], v[164:167]
    ds_read_b64_tr_b16 v[24:25], v72 offset:43008
    ds_read_b64_tr_b16 v[26:27], v72 offset:43520
    v_add_f32 v75, v75, v3
    v_mfma_f32_16x16x32_bf16 v[168:171], v[32:35], v[44:47], v[168:171]
    v_add_f32 v74, v74, v75
    v_mfma_f32_16x16x32_bf16 v[172:175], v[32:35], v[48:51], v[172:175]
    s_nop 1
    v_add_f32_dpp v74, v74, v74 row_ror:8 row_mask:0xf bank_mask:0xf
L_cs_67_ret:
    s_cmp_eq_u32 s51, 3
    s_cbranch_scc1 L_cs_68
    s_waitcnt lgkmcnt(4)
    v_mfma_f32_16x16x32_bf16 v[176:179], v[16:19], v[36:39], v[176:179]
    ds_read_b64_tr_b16 v[28:29], v73 offset:41984
    ds_read_b64_tr_b16 v[30:31], v73 offset:42496
    s_nop 1
    v_add_f32_dpp v74, v74, v74 row_ror:4 row_mask:0xf bank_mask:0xf
    v_mfma_f32_16x16x32_bf16 v[180:183], v[16:19], v[40:43], v[180:183]
    ds_read_b64_tr_b16 v[32:33], v73 offset:43008
    ds_read_b64_tr_b16 v[34:35], v73 offset:43520
    s_nop 1
    v_add_f32_dpp v74, v74, v74 row_ror:2 row_mask:0xf bank_mask:0xf
    v_mfma_f32_16x16x32_bf16 v[184:187], v[16:19], v[44:47], v[184:187]
    s_nop 1
    v_add_f32_dpp v74, v74, v74 row_ror:1 row_mask:0xf bank_mask:0xf
    v_mfma_f32_16x16x32_bf16 v[188:191], v[16:19], v[48:51], v[188:191]
    v_mov_b32 v2, v74
    s_waitcnt lgkmcnt(6)
    v_mfma_f32_16x16x32_bf16 v[192:195], v[20:23], v[36:39], v[192:195]
    s_nop 1
    v_permlane16_swap_b32 v74, v2
    v_mfma_f32_16x16x32_bf16 v[196:199], v[20:23], v[40:43], v[196:199]
    s_nop 1
    v_add_f32 v74, v74, v2
    v_mfma_f32_16x16x32_bf16 v[200:203], v[20:23], v[44:47], v[200:203]
    v_mov_b32 v2, v74
    v_mfma_f32_16x16x32_bf16 v[204:207], v[20:23], v[48:51], v[204:207]
    s_nop 1
    v_permlane32_swap_b32 v74, v2
L_cs_68_ret:
    s_waitcnt vmcnt(10) lgkmcnt(0)
    s_barrier
    s_cmp_eq_u32 s51, 0
    s_cbranch_scc1 L_cs_69
    v_mfma_f32_16x16x32_bf16 v[208:211], v[24:27], v[36:39], v[208:211]
    s_nop 1
    v_add_f32 v74, v74, v2
    v_mfma_f32_16x16x32_bf16 v[212:215], v[24:27], v[40:43], v[212:215]
    v_mul_f32 v74, 0x3a800000, v74
    v_mfma_f32_16x16x32_bf16 v[216:219], v[24:27], v[44:47], v[216:219]
    ds_read_b64_tr_b16 v[16:17], v68 offset:61440
    ds_read_b64_tr_b16 v[18:19], v68 offset:61952
    v_mov_b32 v75, 0
    v_mfma_f32_16x16x32_bf16 v[220:223], v[24:27], v[48:51], v[220:223]
    v_lshlrev_b32 v2, 16, v76
    v_mfma_f32_16x16x32_bf16 v[224:227], v[28:31], v[36:39], v[224:227]
    v_and_b32 v3, s87, v76
    v_mfma_f32_16x16x32_bf16 v[228:231], v[28:31], v[40:43], v[228:231]
    ds_read_b64_tr_b16 v[20:21], v69 offset:61440
    ds_read_b64_tr_b16 v[22:23], v69 offset:61952
    v_sub_f32 v2, v2, v74
    v_mfma_f32_16x16x32_bf16 v[232:235], v[28:31], v[44:47], v[232:235]
    v_sub_f32 v3, v3, v74
    v_mfma_f32_16x16x32_bf16 v[236:239], v[28:31], v[48:51], v[236:239]
    s_add_u32 m0, s44, 32768
    s_nop 0
    buffer_load_dwordx4 v82, s[12:15], s36 offen offset:0 lds
    v_fma_f32 v75, v2, v2, v75
    v_mfma_f32_16x16x32_bf16 v[240:243], v[32:35], v[36:39], v[240:243]
    v_fma_f32 v75, v3, v3, v75
    v_mfma_f32_16x16x32_bf16 v[244:247], v[32:35], v[40:43], v[244:247]
    ds_read_b64_tr_b16 v[24:25], v70 offset:62464
    ds_read_b64_tr_b16 v[26:27], v70 offset:62976
    v_lshlrev_b32 v2, 16, v77
    v_mfma_f32_16x16x32_bf16 v[248:251], v[32:35], v[44:47], v[248:251]
    v_and_b32 v3, s87, v77
    v_mfma_f32_16x16x32_bf16 v[252:255], v[32:35], v[48:51], v[252:255]
    buffer_load_dwordx4 v83, s[12:15], s36 offen offset:1024 lds
    v_sub_f32 v2, v2, v74
L_cs_69_ret:
    s_cmp_eq_u32 s51, 1
    s_cbranch_scc1 L_cs_70
    s_waitcnt lgkmcnt(4)
    v_mfma_f32_16x16x32_bf16 v[96:99], v[52:55], v[16:19], v[96:99]
    v_sub_f32 v3, v3, v74
    v_mfma_f32_16x16x32_bf16 v[100:103], v[56:59], v[16:19], v[100:103]
    ds_read_b64_tr_b16 v[28:29], v70 offset:63488
    ds_read_b64_tr_b16 v[30:31], v70 offset:64000
    v_fma_f32 v75, v2, v2, v75
    v_mfma_f32_16x16x32_bf16 v[104:107], v[60:63], v[16:19], v[104:107]
    v_fma_f32 v75, v3, v3, v75
    v_mfma_f32_16x16x32_bf16 v[108:111], v[64:67], v[16:19], v[108:111]
    buffer_load_dwordx4 v84, s[12:15], s36 offen offset:2048 lds
    v_lshlrev_b32 v2, 16, v78
    s_waitcnt lgkmcnt(4)
    v_mfma_f32_16x16x32_bf16 v[112:115], v[52:55], v[20:23], v[112:115]
    v_and_b32 v3, s87, v78
    v_mfma_f32_16x16x32_bf16 v[116:119], v[56:59], v[20:23], v[116:119]
    ds_read_b64_tr_b16 v[32:33], v71 offset:62464
    ds_read_b64_tr_b16 v[34:35], v71 offset:62976
    v_sub_f32 v2, v2, v74
    v_mfma_f32_16x16x32_bf16 v[120:123], v[60:63], v[20:23], v[120:123]
    v_sub_f32 v3, v3, v74
    v_mfma_f32_16x16x32_bf16 v[124:127], v[64:67], v[20:23], v[124:127]
    buffer_load_dwordx4 v85, s[12:15], s36 offen offset:3072 lds
    s_add_u32 s36, s36, 128
    v_fma_f32 v75, v2, v2, v75
    s_waitcnt lgkmcnt(4)
    v_mfma_f32_16x16x32_bf16 v[128:131], v[24:27], v[52:55], v[128:131]
    v_fma_f32 v75, v3, v3, v75
    v_mfma_f32_16x16x32_bf16 v[132:135], v[24:27], v[56:59], v[132:135]
    ds_read_b64_tr_b16 v[16:17], v71 offset:63488
    ds_read_b64_tr_b16 v[18:19], v71 offset:64000
    v_lshlrev_b32 v2, 16, v79
    v_mfma_f32_16x16x32_bf16 v[136:139], v[24:27], v[60:63], v[136:139]
    v_and_b32 v3, s87, v79
    v_mfma_f32_16x16x32_bf16 v[140:143], v[24:27], v[64:67], v[140:143]
    s_add_u32 m0, s44, 36864
    s_nop 0
    buffer_load_dwordx4 v82, s[12:15], s37 offen offset:0 lds
    v_sub_f32 v2, v2, v74
L_cs_70_ret:
    s_cmp_eq_u32 s51, 2
    s_cbranch_scc1 L_cs_71
    s_waitcnt lgkmcnt(4)
    v_mfma_f32_16x16x32_bf16 v[144:147], v[28:31], v[52:55], v[144:147]
    v_sub_f32 v3, v3, v74
    v_mfma_f32_16x16x32_bf16 v[148:151], v[28:31], v[56:59], v[148:151]
    ds_read_b64_tr_b16 v[20:21], v72 offset:62464
    ds_read_b64_tr_b16 v[22:23], v72 offset:62976
    v_fma_f32 v75, v2, v2, v75
    v_mfma_f32_16x16x32_bf16 v[152:155], v[28:31], v[60:63], v[152:155]
    v_fma_f32 v75, v3, v3, v75
    v_mfma_f32_16x16x32_bf16 v[156:159], v[28:31], v[64:67], v[156:159]
    buffer_load_dwordx4 v83, s[12:15], s37 offen offset:1024 lds
    v_lshlrev_b32 v2, 16, v92
    s_waitcnt lgkmcnt(4)
    v_mfma_f32_16x16x32_bf16 v[160:163], v[32:35], v[52:55], v[160:163]
    v_and_b32 v3, s87, v92
    v_mfma_f32_16x16x32_bf16 v[164:167], v[32:35], v[56:59], v[164:167]
    ds_read_b64_tr_b16 v[24:25], v72 offset:63488
    ds_read_b64_tr_b16 v[26:27], v72 offset:64000
    v_sub_f32 v2, v2, v74
    v_mfma_f32_16x16x32_bf16 v[168:171], v[32:35], v[60:63], v[168:171]
    v_sub_f32 v3, v3, v74
    v_mfma_f32_16x16x32_bf16 v[172:175], v[32:35], v[64:67], v[172:175]
    buffer_load_dwordx4 v84, s[12:15], s37 offen offset:2048 lds
    v_fma_f32 v75, v2, v2, v75
L_cs_71_ret:
    s_cmp_eq_u32 s51, 3
    s_cbranch_scc1 L_cs_72
    s_waitcnt lgkmcnt(4)
    v_mfma_f32_16x16x32_bf16 v[176:179], v[16:19], v[52:55], v[176:179]
    ds_read_b64_tr_b16 v[28:29], v73 offset:62464
    ds_read_b64_tr_b16 v[30:31], v73 offset:62976
    v_fma_f32 v75, v3, v3, v75
    v_mfma_f32_16x16x32_bf16 v[180:183], v[16:19], v[56:59], v[180:183]
    ds_read_b64_tr_b16 v[32:33], v73 offset:63488
    ds_read_b64_tr_b16 v[34:35], v73 offset:64000
    v_lshlrev_b32 v2, 16, v93
    v_mfma_f32_16x16x32_bf16 v[184:187], v[16:19], v[60:63], v[184:187]
    v_and_b32 v3, s87, v93
    v_mfma_f32_16x16x32_bf16 v[188:191], v[16:19], v[64:67], v[188:191]
    buffer_load_dwordx4 v85, s[12:15], s37 offen offset:3072 lds
    s_add_u32 s37, s37, 128
    v_sub_f32 v2, v2, v74
    s_waitcnt lgkmcnt(6)
    v_mfma_f32_16x16x32_bf16 v[192:195], v[20:23], v[52:55], v[192:195]
    v_sub_f32 v3, v3, v74
    v_mfma_f32_16x16x32_bf16 v[196:199], v[20:23], v[56:59], v[196:199]
    v_fma_f32 v75, v2, v2, v75
    v_mfma_f32_16x16x32_bf16 v[200:203], v[20:23], v[60:63], v[200:203]
    v_fma_f32 v75, v3, v3, v75
    v_mfma_f32_16x16x32_bf16 v[204:207], v[20:23], v[64:67], v[204:207]
    v_lshlrev_b32 v2, 16, v94
L_cs_72_ret:
    s_waitcnt vmcnt(8) lgkmcnt(0)
    s_barrier
    s_cmp_eq_u32 s51, 0
    s_cbranch_scc1 L_cs_73
    v_mfma_f32_16x16x32_bf16 v[208:211], v[24:27], v[52:55], v[208:211]
    ds_read_b128 v[36:39], v80 offset:0
    ds_read_b128 v[40:43], v80 offset:2048
    v_and_b32 v3, s87, v94
    v_mfma_f32_16x16x32_bf16 v[212:215], v[24:27], v[56:59], v[212:215]
    ds_read_b128 v[44:47], v80 offset:4096
    ds_read_b128 v[48:51], v80 offset:6144
    v_sub_f32 v2, v2, v74
    v_mfma_f32_16x16x32_bf16 v[216:219], v[24:27], v[60:63], v[216:219]
    ds_read_b64_tr_b16 v[16:17], v68 offset:0
    ds_read_b64_tr_b16 v[18:19], v68 offset:512
    v_sub_f32 v3, v3, v74
    v_mfma_f32_16x16x32_bf16 v[220:223], v[24:27], v[64:67], v[220:223]
    v_fma_f32 v75, v2, v2, v75
    v_mfma_f32_16x16x32_bf16 v[224:227], v[28:31], v[52:55], v[224:227]
    v_fma_f32 v75, v3, v3, v75
    v_mfma_f32_16x16x32_bf16 v[228:231], v[28:31], v[56:59], v[228:231]
    ds_read_b64_tr_b16 v[20:21], v69 offset:0
    ds_read_b64_tr_b16 v[22:23], v69 offset:512
    v_lshlrev_b32 v2, 16, v95
    v_mfma_f32_16x16x32_bf16 v[232:235], v[28:31], v[60:63], v[232:235]
    v_and_b32 v3, s87, v95
    v_mfma_f32_16x16x32_bf16 v[236:239], v[28:31], v[64:67], v[236:239]
    v_sub_f32 v2, v2, v74
    v_mfma_f32_16x16x32_bf16 v[240:243], v[32:35], v[52:55], v[240:243]
    v_sub_f32 v3, v3, v74
    v_mfma_f32_16x16x32_bf16 v[244:247], v[32:35], v[56:59], v[244:247]
    ds_read_b64_tr_b16 v[24:25], v70 offset:1024
    ds_read_b64_tr_b16 v[26:27], v70 offset:1536
    v_fma_f32 v75, v2, v2, v75
    v_mfma_f32_16x16x32_bf16 v[248:251], v[32:35], v[60:63], v[248:251]
    v_fma_f32 v75, v3, v3, v75
    v_mfma_f32_16x16x32_bf16 v[252:255], v[32:35], v[64:67], v[252:255]
    s_nop 1
    v_add_f32_dpp v75, v75, v75 row_ror:8 row_mask:0xf bank_mask:0xf
L_cs_73_ret:
    s_cmp_eq_u32 s51, 1
    s_cbranch_scc1 L_cs_74
    s_waitcnt lgkmcnt(4)
    v_mfma_f32_16x16x32_bf16 v[96:99], v[36:39], v[16:19], v[96:99]
    ds_read_b128 v[52:55], v81 offset:0
    ds_read_b128 v[56:59], v81 offset:2048
    s_nop 1
    v_add_f32_dpp v75, v75, v75 row_ror:4 row_mask:0xf bank_mask:0xf
    v_mfma_f32_16x16x32_bf16 v[100:103], v[40:43], v[16:19], v[100:103]
    ds_read_b64_tr_b16 v[28:29], v70 offset:2048
    ds_read_b64_tr_b16 v[30:31], v70 offset:2560
    s_nop 1
    v_add_f32_dpp v75, v75, v75 row_ror:2 row_mask:0xf bank_mask:0xf
    v_mfma_f32_16x16x32_bf16 v[104:107], v[44:47], v[16:19], v[104:107]
    ds_read_b128 v[60:63], v81 offset:4096
    ds_read_b128 v[64:67], v81 offset:6144
    s_nop 1
    v_add_f32_dpp v75, v75, v75 row_ror:1 row_mask:0xf bank_mask:0xf
    v_mfma_f32_16x16x32_bf16 v[108:111], v[48:51], v[16:19], v[108:111]
    v_mov_b32 v2, v75
    s_waitcnt lgkmcnt(8)
    v_mfma_f32_16x16x32_bf16 v[112:115], v[36:39], v[20:23], v[112:115]
    s_nop 1
    v_permlane16_swap_b32 v75, v2
    v_mfma_f32_16x16x32_bf16 v[116:119], v[40:43], v[20:23], v[116:119]
    ds_read_b64_tr_b16 v[32:33], v71 offset:1024
    ds_read_b64_tr_b16 v[34:35], v71 offset:1536
    s_nop 1
    v_add_f32 v75, v75, v2
    v_mfma_f32_16x16x32_bf16 v[120:123], v[44:47], v[20:23], v[120:123]
    v_mov_b32 v2, v75
    v_mfma_f32_16x16x32_bf16 v[124:127], v[48:51], v[20:23], v[124:127]
    s_nop 1
    v_permlane32_swap_b32 v75, v2
    s_waitcnt lgkmcnt(8)
    v_mfma_f32_16x16x32_bf16 v[128:131], v[24:27], v[36:39], v[128:131]
    s_nop 1
    v_add_f32 v75, v75, v2
    v_mfma_f32_16x16x32_bf16 v[132:135], v[24:27], v[40:43], v[132:135]
    ds_read_b64_tr_b16 v[16:17], v71 offset:2048
    ds_read_b64_tr_b16 v[18:19], v71 offset:2560
    v_mov_b32 v2, 0x3727c5ac
    v_mfma_f32_16x16x32_bf16 v[136:139], v[24:27], v[44:47], v[136:139]
    v_mov_b32 v3, 0x3a800000
    v_mfma_f32_16x16x32_bf16 v[140:143], v[24:27], v[48:51], v[140:143]
    v_fma_f32 v75, v75, v3, v2
L_cs_74_ret:
    s_cmp_eq_u32 s51, 2
    s_cbranch_scc1 L_cs_75
    s_waitcnt lgkmcnt(6)
    v_mfma_f32_16x16x32_bf16 v[144:147], v[28:31], v[36:39], v[144:147]
    s_nop 0
    v_rsq_f32 v75, v75
    v_mfma_f32_16x16x32_bf16 v[148:151], v[28:31], v[40:43], v[148:151]
    ds_read_b64_tr_b16 v[20:21], v72 offset:1024
    ds_read_b64_tr_b16 v[22:23], v72 offset:1536
    s_nop 0
    s_lshl_b32 s52, s51, 2
    s_lshr_b32 s52, 0x5307, s52
    s_and_b32 s52, s52, 15
    s_lshr_b32 s53, s51, 1
    s_sub_u32 s53, 3, s53
    v_lshrrev_b32 v76, 4, v1
    v_mfma_f32_16x16x32_bf16 v[152:155], v[28:31], v[44:47], v[152:155]
    v_cmp_gt_u32 vcc, s53, v76
    v_mfma_f32_16x16x32_bf16 v[156:159], v[28:31], v[48:51], v[156:159]
    v_add_u32 v76, s52, v76
    s_waitcnt lgkmcnt(4)
    v_mfma_f32_16x16x32_bf16 v[160:163], v[32:35], v[36:39], v[160:163]
    v_and_b32 v77, 15, v1
    v_mfma_f32_16x16x32_bf16 v[164:167], v[32:35], v[40:43], v[164:167]
    ds_read_b64_tr_b16 v[24:25], v72 offset:2048
    ds_read_b64_tr_b16 v[26:27], v72 offset:2560
    v_lshlrev_b32 v77, 2, v77
    v_mfma_f32_16x16x32_bf16 v[168:171], v[32:35], v[44:47], v[168:171]
    v_lshl_add_u32 v76, v76, 6, v77
    v_mfma_f32_16x16x32_bf16 v[172:175], v[32:35], v[48:51], v[172:175]
    v_mov_b32 v77, 2147418112
L_cs_75_ret:
    s_cmp_eq_u32 s51, 3
    s_cbranch_scc1 L_cs_76
    s_waitcnt lgkmcnt(4)
    v_mfma_f32_16x16x32_bf16 v[176:179], v[16:19], v[36:39], v[176:179]
    ds_read_b64_tr_b16 v[28:29], v73 offset:1024
    ds_read_b64_tr_b16 v[30:31], v73 offset:1536
    v_cndmask_b32 v76, v77, v76, vcc
    v_mfma_f32_16x16x32_bf16 v[180:183], v[16:19], v[40:43], v[180:183]
    ds_read_b64_tr_b16 v[32:33], v73 offset:2048
    ds_read_b64_tr_b16 v[34:35], v73 offset:2560
    v_cmp_eq_u32 vcc, 0, v1
    v_mfma_f32_16x16x32_bf16 v[184:187], v[16:19], v[44:47], v[184:187]
    s_and_b32 s52, s2, 31
    s_mul_i32 s52, s52, 10240
    s_mul_i32 s53, s48, 1280
    s_add_u32 s52, s52, s53
    s_mul_i32 s53, s50, 640
    s_add_u32 s52, s52, s53
    s_add_u32 s54, s52, 52498432
    v_cndmask_b32 v77, v77, v1, vcc
    v_mfma_f32_16x16x32_bf16 v[188:191], v[16:19], v[48:51], v[188:191]
    s_lshl_b32 s55, s2, 7
    s_lshl_b32 s53, s49, 3
    s_add_u32 s55, s55, s53
    s_add_u32 s55, s55, 52465664
    s_waitcnt lgkmcnt(6)
    v_mfma_f32_16x16x32_bf16 v[192:195], v[20:23], v[36:39], v[192:195]
    v_mfma_f32_16x16x32_bf16 v[196:199], v[20:23], v[40:43], v[196:199]
    v_mfma_f32_16x16x32_bf16 v[200:203], v[20:23], v[44:47], v[200:203]
    v_mfma_f32_16x16x32_bf16 v[204:207], v[20:23], v[48:51], v[204:207]
L_cs_76_ret:
    s_nop 7
    s_nop 7
    v_mov_b32_dpp v4, v8 quad_perm:[0,1,2,3] row_mask:0x2 bank_mask:0xf
    v_mov_b32_dpp v4, v12 quad_perm:[0,1,2,3] row_mask:0x4 bank_mask:0xf
    buffer_store_dwordx2 v[74:75], v77, s[32:35], s55 offen sc0 sc1
    buffer_store_dword v4, v76, s[32:35], s54 offen sc0 sc1
    s_cmp_eq_u32 s45, 5
    s_cselect_b32 s52, s60, 0
    s_sub_u32 s36, s36, s52
    s_cmp_eq_u32 s45, 5
    s_cselect_b32 s52, s60, 0
    s_sub_u32 s37, s37, s52
    s_cmp_eq_u32 s45, 5
    s_sub_u32 s45, s45, 1
    s_cmp_lg_u32 s45, 1
    s_waitcnt vmcnt(10) lgkmcnt(0)
    s_barrier
    s_branch L_g1_loop_X1
L_cs_61:
    v_mfma_f32_16x16x32_bf16 v[208:211], v[24:27], v[36:39], v[208:211]
    v_mfma_f32_16x16x32_bf16 v[212:215], v[24:27], v[40:43], v[212:215]
    v_mfma_f32_16x16x32_bf16 v[216:219], v[24:27], v[44:47], v[216:219]
    ds_read_b64_tr_b16 v[16:17], v68 offset:20480
    ds_read_b64_tr_b16 v[18:19], v68 offset:20992
    v_mfma_f32_16x16x32_bf16 v[220:223], v[24:27], v[48:51], v[220:223]
    v_mfma_f32_16x16x32_bf16 v[4:7], v[88:91], v[24:27], v[4:7]
    v_mfma_f32_16x16x32_bf16 v[224:227], v[28:31], v[36:39], v[224:227]
    v_mfma_f32_16x16x32_bf16 v[228:231], v[28:31], v[40:43], v[228:231]
    ds_read_b64_tr_b16 v[20:21], v69 offset:20480
    ds_read_b64_tr_b16 v[22:23], v69 offset:20992
    v_mfma_f32_16x16x32_bf16 v[232:235], v[28:31], v[44:47], v[232:235]
    v_mfma_f32_16x16x32_bf16 v[236:239], v[28:31], v[48:51], v[236:239]
    s_add_u32 m0, s44, 0
    s_nop 0
    buffer_load_dwordx4 v82, s[12:15], s36 offen offset:0 lds
    v_mfma_f32_16x16x32_bf16 v[8:11], v[88:91], v[28:31], v[8:11]
    v_mfma_f32_16x16x32_bf16 v[240:243], v[32:35], v[36:39], v[240:243]
    v_mfma_f32_16x16x32_bf16 v[244:247], v[32:35], v[40:43], v[244:247]
    ds_read_b64_tr_b16 v[24:25], v70 offset:21504
    ds_read_b64_tr_b16 v[26:27], v70 offset:22016
    v_mfma_f32_16x16x32_bf16 v[248:251], v[32:35], v[44:47], v[248:251]
    v_mfma_f32_16x16x32_bf16 v[252:255], v[32:35], v[48:51], v[252:255]
    buffer_load_dwordx4 v83, s[12:15], s36 offen offset:1024 lds
    v_mfma_f32_16x16x32_bf16 v[12:15], v[88:91], v[32:35], v[12:15]
    s_branch L_cs_61_ret
L_cs_62:
    s_waitcnt lgkmcnt(4)
    v_mfma_f32_16x16x32_bf16 v[96:99], v[52:55], v[16:19], v[96:99]
    v_mfma_f32_16x16x32_bf16 v[100:103], v[56:59], v[16:19], v[100:103]
    ds_read_b64_tr_b16 v[28:29], v70 offset:22528
    ds_read_b64_tr_b16 v[30:31], v70 offset:23040
    v_mfma_f32_16x16x32_bf16 v[104:107], v[60:63], v[16:19], v[104:107]
    v_mfma_f32_16x16x32_bf16 v[108:111], v[64:67], v[16:19], v[108:111]
    buffer_load_dwordx4 v84, s[12:15], s36 offen offset:2048 lds
    v_mfma_f32_16x16x32_bf16 v[4:7], v[88:91], v[16:19], v[4:7]
    s_waitcnt lgkmcnt(4)
    v_mfma_f32_16x16x32_bf16 v[112:115], v[52:55], v[20:23], v[112:115]
    v_mfma_f32_16x16x32_bf16 v[116:119], v[56:59], v[20:23], v[116:119]
    ds_read_b64_tr_b16 v[32:33], v71 offset:21504
    ds_read_b64_tr_b16 v[34:35], v71 offset:22016
    v_mfma_f32_16x16x32_bf16 v[120:123], v[60:63], v[20:23], v[120:123]
    v_mfma_f32_16x16x32_bf16 v[124:127], v[64:67], v[20:23], v[124:127]
    buffer_load_dwordx4 v85, s[12:15], s36 offen offset:3072 lds
    s_add_u32 s36, s36, 128
    v_mfma_f32_16x16x32_bf16 v[8:11], v[88:91], v[20:23], v[8:11]
    s_waitcnt lgkmcnt(4)
    v_mfma_f32_16x16x32_bf16 v[128:131], v[24:27], v[52:55], v[128:131]
    v_mfma_f32_16x16x32_bf16 v[132:135], v[24:27], v[56:59], v[132:135]
    ds_read_b64_tr_b16 v[16:17], v71 offset:22528
    ds_read_b64_tr_b16 v[18:19], v71 offset:23040
    v_mfma_f32_16x16x32_bf16 v[136:139], v[24:27], v[60:63], v[136:139]
    v_mfma_f32_16x16x32_bf16 v[140:143], v[24:27], v[64:67], v[140:143]
    s_add_u32 m0, s44, 4096
    s_nop 0
    buffer_load_dwordx4 v82, s[12:15], s37 offen offset:0 lds
    v_mfma_f32_16x16x32_bf16 v[12:15], v[88:91], v[24:27], v[12:15]
    s_branch L_cs_62_ret
L_cs_63:
    s_waitcnt lgkmcnt(4)
    v_mfma_f32_16x16x32_bf16 v[144:147], v[28:31], v[52:55], v[144:147]
    v_mfma_f32_16x16x32_bf16 v[148:151], v[28:31], v[56:59], v[148:151]
    ds_read_b64_tr_b16 v[20:21], v72 offset:21504
    ds_read_b64_tr_b16 v[22:23], v72 offset:22016
    v_mfma_f32_16x16x32_bf16 v[152:155], v[28:31], v[60:63], v[152:155]
    v_mfma_f32_16x16x32_bf16 v[156:159], v[28:31], v[64:67], v[156:159]
    buffer_load_dwordx4 v83, s[12:15], s37 offen offset:1024 lds
    v_mfma_f32_16x16x32_bf16 v[4:7], v[88:91], v[28:31], v[4:7]
    s_waitcnt lgkmcnt(4)
    v_mfma_f32_16x16x32_bf16 v[160:163], v[32:35], v[52:55], v[160:163]
    v_mfma_f32_16x16x32_bf16 v[164:167], v[32:35], v[56:59], v[164:167]
    ds_read_b64_tr_b16 v[24:25], v72 offset:22528
    ds_read_b64_tr_b16 v[26:27], v72 offset:23040
    v_mfma_f32_16x16x32_bf16 v[168:171], v[32:35], v[60:63], v[168:171]
    v_mfma_f32_16x16x32_bf16 v[172:175], v[32:35], v[64:67], v[172:175]
    buffer_load_dwordx4 v84, s[12:15], s37 offen offset:2048 lds
    v_mfma_f32_16x16x32_bf16 v[8:11], v[88:91], v[32:35], v[8:11]
    s_branch L_cs_63_ret
L_cs_64:
    s_waitcnt lgkmcnt(4)
    v_mfma_f32_16x16x32_bf16 v[176:179], v[16:19], v[52:55], v[176:179]
    ds_read_b64_tr_b16 v[28:29], v73 offset:21504
    ds_read_b64_tr_b16 v[30:31], v73 offset:22016
    v_mfma_f32_16x16x32_bf16 v[180:183], v[16:19], v[56:59], v[180:183]
    ds_read_b64_tr_b16 v[32:33], v73 offset:22528
    ds_read_b64_tr_b16 v[34:35], v73 offset:23040
    v_mfma_f32_16x16x32_bf16 v[184:187], v[16:19], v[60:63], v[184:187]
    v_mfma_f32_16x16x32_bf16 v[188:191], v[16:19], v[64:67], v[188:191]
    buffer_load_dwordx4 v85, s[12:15], s37 offen offset:3072 lds
    s_add_u32 s37, s37, 128
    v_mfma_f32_16x16x32_bf16 v[4:7], v[88:91], v[16:19], v[4:7]
    s_waitcnt lgkmcnt(6)
    v_mfma_f32_16x16x32_bf16 v[192:195], v[20:23], v[52:55], v[192:195]
    v_mfma_f32_16x16x32_bf16 v[196:199], v[20:23], v[56:59], v[196:199]
    v_mfma_f32_16x16x32_bf16 v[200:203], v[20:23], v[60:63], v[200:203]
    v_mfma_f32_16x16x32_bf16 v[204:207], v[20:23], v[64:67], v[204:207]
    v_mfma_f32_16x16x32_bf16 v[8:11], v[88:91], v[20:23], v[8:11]
    s_branch L_cs_64_ret
L_cs_65:
    v_mfma_f32_16x16x32_bf16 v[208:211], v[24:27], v[52:55], v[208:211]
    ds_read_b128 v[36:39], v80 offset:32768
    ds_read_b128 v[40:43], v80 offset:34816
    v_lshlrev_b32 v74, 16, v76
    v_mfma_f32_16x16x32_bf16 v[212:215], v[24:27], v[56:59], v[212:215]
    ds_read_b128 v[44:47], v80 offset:36864
    ds_read_b128 v[48:51], v80 offset:38912
    v_and_b32 v75, s87, v76
    v_mfma_f32_16x16x32_bf16 v[216:219], v[24:27], v[60:63], v[216:219]
    ds_read_b64_tr_b16 v[16:17], v68 offset:40960
    ds_read_b64_tr_b16 v[18:19], v68 offset:41472
    v_lshlrev_b32 v2, 16, v77
    v_mfma_f32_16x16x32_bf16 v[220:223], v[24:27], v[64:67], v[220:223]
    v_mfma_f32_16x16x32_bf16 v[4:7], v[88:91], v[24:27], v[4:7]
    v_and_b32 v3, s87, v77
    v_mfma_f32_16x16x32_bf16 v[224:227], v[28:31], v[52:55], v[224:227]
    v_add_f32 v74, v74, v2
    v_mfma_f32_16x16x32_bf16 v[228:231], v[28:31], v[56:59], v[228:231]
    ds_read_b64_tr_b16 v[20:21], v69 offset:40960
    ds_read_b64_tr_b16 v[22:23], v69 offset:41472
    v_add_f32 v75, v75, v3
    v_mfma_f32_16x16x32_bf16 v[232:235], v[28:31], v[60:63], v[232:235]
    v_lshlrev_b32 v2, 16, v78
    v_mfma_f32_16x16x32_bf16 v[236:239], v[28:31], v[64:67], v[236:239]
    v_mfma_f32_16x16x32_bf16 v[8:11], v[88:91], v[28:31], v[8:11]
    v_and_b32 v3, s87, v78
    v_mfma_f32_16x16x32_bf16 v[240:243], v[32:35], v[52:55], v[240:243]
    v_add_f32 v74, v74, v2
    v_mfma_f32_16x16x32_bf16 v[244:247], v[32:35], v[56:59], v[244:247]
    ds_read_b64_tr_b16 v[24:25], v70 offset:41984
    ds_read_b64_tr_b16 v[26:27], v70 offset:42496
    v_add_f32 v75, v75, v3
    v_mfma_f32_16x16x32_bf16 v[248:251], v[32:35], v[60:63], v[248:251]
    v_lshlrev_b32 v2, 16, v79
    v_mfma_f32_16x16x32_bf16 v[252:255], v[32:35], v[64:67], v[252:255]
    v_mfma_f32_16x16x32_bf16 v[12:15], v[88:91], v[32:35], v[12:15]
    v_and_b32 v3, s87, v79
    s_branch L_cs_65_ret
L_cs_66:
    s_waitcnt lgkmcnt(4)
    v_mfma_f32_16x16x32_bf16 v[96:99], v[36:39], v[16:19], v[96:99]
    ds_read_b128 v[52:55], v81 offset:32768
    ds_read_b128 v[56:59], v81 offset:34816
    v_add_f32 v74, v74, v2
    v_mfma_f32_16x16x32_bf16 v[100:103], v[40:43], v[16:19], v[100:103]
    ds_read_b64_tr_b16 v[28:29], v70 offset:43008
    ds_read_b64_tr_b16 v[30:31], v70 offset:43520
    v_add_f32 v75, v75, v3
    v_mfma_f32_16x16x32_bf16 v[104:107], v[44:47], v[16:19], v[104:107]
    ds_read_b128 v[60:63], v81 offset:36864
    ds_read_b128 v[64:67], v81 offset:38912
    v_lshlrev_b32 v2, 16, v92
    v_mfma_f32_16x16x32_bf16 v[108:111], v[48:51], v[16:19], v[108:111]
    v_mfma_f32_16x16x32_bf16 v[4:7], v[88:91], v[16:19], v[4:7]
    v_and_b32 v3, s87, v92
    s_waitcnt lgkmcnt(8)
    v_mfma_f32_16x16x32_bf16 v[112:115], v[36:39], v[20:23], v[112:115]
    v_add_f32 v74, v74, v2
    v_mfma_f32_16x16x32_bf16 v[116:119], v[40:43], v[20:23], v[116:119]
    ds_read_b64_tr_b16 v[32:33], v71 offset:41984
    ds_read_b64_tr_b16 v[34:35], v71 offset:42496
    v_add_f32 v75, v75, v3
    v_mfma_f32_16x16x32_bf16 v[120:123], v[44:47], v[20:23], v[120:123]
    v_lshlrev_b32 v2, 16, v93
    v_mfma_f32_16x16x32_bf16 v[124:127], v[48:51], v[20:23], v[124:127]
    v_mfma_f32_16x16x32_bf16 v[8:11], v[88:91], v[20:23], v[8:11]
    v_and_b32 v3, s87, v93
    s_waitcnt lgkmcnt(8)
    v_mfma_f32_16x16x32_bf16 v[128:131], v[24:27], v[36:39], v[128:131]
    v_add_f32 v74, v74, v2
    v_mfma_f32_16x16x32_bf16 v[132:135], v[24:27], v[40:43], v[132:135]
    ds_read_b64_tr_b16 v[16:17], v71 offset:43008
    ds_read_b64_tr_b16 v[18:19], v71 offset:43520
    v_add_f32 v75, v75, v3
    v_mfma_f32_16x16x32_bf16 v[136:139], v[24:27], v[44:47], v[136:139]
    v_lshlrev_b32 v2, 16, v94
    v_mfma_f32_16x16x32_bf16 v[140:143], v[24:27], v[48:51], v[140:143]
    v_mfma_f32_16x16x32_bf16 v[12:15], v[88:91], v[24:27], v[12:15]
    v_and_b32 v3, s87, v94
    s_branch L_cs_66_ret
L_cs_67:
    s_waitcnt lgkmcnt(6)
    v_mfma_f32_16x16x32_bf16 v[144:147], v[28:31], v[36:39], v[144:147]
    v_add_f32 v74, v74, v2
    v_mfma_f32_16x16x32_bf16 v[148:151], v[28:31], v[40:43], v[148:151]
    ds_read_b64_tr_b16 v[20:21], v72 offset:41984
    ds_read_b64_tr_b16 v[22:23], v72 offset:42496
    v_add_f32 v75, v75, v3
    v_mfma_f32_16x16x32_bf16 v[152:155], v[28:31], v[44:47], v[152:155]
    v_lshlrev_b32 v2, 16, v95
    v_mfma_f32_16x16x32_bf16 v[156:159], v[28:31], v[48:51], v[156:159]
    v_mfma_f32_16x16x32_bf16 v[4:7], v[88:91], v[28:31], v[4:7]
    v_and_b32 v3, s87, v95
    s_waitcnt lgkmcnt(4)
    v_mfma_f32_16x16x32_bf16 v[160:163], v[32:35], v[36:39], v[160:163]
    v_add_f32 v74, v74, v2
    v_mfma_f32_16x16x32_bf16 v[164:167], v[32:35], v[40:43], v[164:167]
    ds_read_b64_tr_b16 v[24:25], v72 offset:43008
    ds_read_b64_tr_b16 v[26:27], v72 offset:43520
    v_add_f32 v75, v75, v3
    v_mfma_f32_16x16x32_bf16 v[168:171], v[32:35], v[44:47], v[168:171]
    v_add_f32 v74, v74, v75
    v_mfma_f32_16x16x32_bf16 v[172:175], v[32:35], v[48:51], v[172:175]
    v_mfma_f32_16x16x32_bf16 v[8:11], v[88:91], v[32:35], v[8:11]
    s_nop 1
    v_add_f32_dpp v74, v74, v74 row_ror:8 row_mask:0xf bank_mask:0xf
    s_branch L_cs_67_ret
L_cs_68:
    s_waitcnt lgkmcnt(4)
    v_mfma_f32_16x16x32_bf16 v[176:179], v[16:19], v[36:39], v[176:179]
    ds_read_b64_tr_b16 v[28:29], v73 offset:41984
    ds_read_b64_tr_b16 v[30:31], v73 offset:42496
    s_nop 1
    v_add_f32_dpp v74, v74, v74 row_ror:4 row_mask:0xf bank_mask:0xf
    v_mfma_f32_16x16x32_bf16 v[180:183], v[16:19], v[40:43], v[180:183]
    ds_read_b64_tr_b16 v[32:33], v73 offset:43008
    ds_read_b64_tr_b16 v[34:35], v73 offset:43520
    s_nop 1
    v_add_f32_dpp v74, v74, v74 row_ror:2 row_mask:0xf bank_mask:0xf
    v_mfma_f32_16x16x32_bf16 v[184:187], v[16:19], v[44:47], v[184:187]
    s_nop 1
    v_add_f32_dpp v74, v74, v74 row_ror:1 row_mask:0xf bank_mask:0xf
    v_mfma_f32_16x16x32_bf16 v[188:191], v[16:19], v[48:51], v[188:191]
    v_mfma_f32_16x16x32_bf16 v[4:7], v[88:91], v[16:19], v[4:7]
    v_mov_b32 v2, v74
    s_waitcnt lgkmcnt(6)
    v_mfma_f32_16x16x32_bf16 v[192:195], v[20:23], v[36:39], v[192:195]
    s_nop 1
    v_permlane16_swap_b32 v74, v2
    v_mfma_f32_16x16x32_bf16 v[196:199], v[20:23], v[40:43], v[196:199]
    s_nop 1
    v_add_f32 v74, v74, v2
    v_mfma_f32_16x16x32_bf16 v[200:203], v[20:23], v[44:47], v[200:203]
    v_mov_b32 v2, v74
    v_mfma_f32_16x16x32_bf16 v[204:207], v[20:23], v[48:51], v[204:207]
    v_mfma_f32_16x16x32_bf16 v[8:11], v[88:91], v[20:23], v[8:11]
    s_nop 1
    v_permlane32_swap_b32 v74, v2
    s_branch L_cs_68_ret
L_cs_69:
    v_mfma_f32_16x16x32_bf16 v[208:211], v[24:27], v[36:39], v[208:211]
    s_nop 1
    v_add_f32 v74, v74, v2
    v_mfma_f32_16x16x32_bf16 v[212:215], v[24:27], v[40:43], v[212:215]
    v_mul_f32 v74, 0x3a800000, v74
    v_mfma_f32_16x16x32_bf16 v[216:219], v[24:27], v[44:47], v[216:219]
    ds_read_b64_tr_b16 v[16:17], v68 offset:61440
    ds_read_b64_tr_b16 v[18:19], v68 offset:61952
    v_mov_b32 v75, 0
    v_mfma_f32_16x16x32_bf16 v[220:223], v[24:27], v[48:51], v[220:223]
    v_mfma_f32_16x16x32_bf16 v[4:7], v[88:91], v[24:27], v[4:7]
    v_lshlrev_b32 v2, 16, v76
    v_mfma_f32_16x16x32_bf16 v[224:227], v[28:31], v[36:39], v[224:227]
    v_and_b32 v3, s87, v76
    v_mfma_f32_16x16x32_bf16 v[228:231], v[28:31], v[40:43], v[228:231]
    ds_read_b64_tr_b16 v[20:21], v69 offset:61440
    ds_read_b64_tr_b16 v[22:23], v69 offset:61952
    v_sub_f32 v2, v2, v74
    v_mfma_f32_16x16x32_bf16 v[232:235], v[28:31], v[44:47], v[232:235]
    v_sub_f32 v3, v3, v74
    v_mfma_f32_16x16x32_bf16 v[236:239], v[28:31], v[48:51], v[236:239]
    s_add_u32 m0, s44, 32768
    s_nop 0
    buffer_load_dwordx4 v82, s[12:15], s36 offen offset:0 lds
    v_mfma_f32_16x16x32_bf16 v[8:11], v[88:91], v[28:31], v[8:11]
    v_fma_f32 v75, v2, v2, v75
    v_mfma_f32_16x16x32_bf16 v[240:243], v[32:35], v[36:39], v[240:243]
    v_fma_f32 v75, v3, v3, v75
    v_mfma_f32_16x16x32_bf16 v[244:247], v[32:35], v[40:43], v[244:247]
    ds_read_b64_tr_b16 v[24:25], v70 offset:62464
    ds_read_b64_tr_b16 v[26:27], v70 offset:62976
    v_lshlrev_b32 v2, 16, v77
    v_mfma_f32_16x16x32_bf16 v[248:251], v[32:35], v[44:47], v[248:251]
    v_and_b32 v3, s87, v77
    v_mfma_f32_16x16x32_bf16 v[252:255], v[32:35], v[48:51], v[252:255]
    buffer_load_dwordx4 v83, s[12:15], s36 offen offset:1024 lds
    v_mfma_f32_16x16x32_bf16 v[12:15], v[88:91], v[32:35], v[12:15]
    v_sub_f32 v2, v2, v74
    s_branch L_cs_69_ret
L_cs_70:
    s_waitcnt lgkmcnt(4)
    v_mfma_f32_16x16x32_bf16 v[96:99], v[52:55], v[16:19], v[96:99]
    v_sub_f32 v3, v3, v74
    v_mfma_f32_16x16x32_bf16 v[100:103], v[56:59], v[16:19], v[100:103]
    ds_read_b64_tr_b16 v[28:29], v70 offset:63488
    ds_read_b64_tr_b16 v[30:31], v70 offset:64000
    v_fma_f32 v75, v2, v2, v75
    v_mfma_f32_16x16x32_bf16 v[104:107], v[60:63], v[16:19], v[104:107]
    v_fma_f32 v75, v3, v3, v75
    v_mfma_f32_16x16x32_bf16 v[108:111], v[64:67], v[16:19], v[108:111]
    buffer_load_dwordx4 v84, s[12:15], s36 offen offset:2048 lds
    v_mfma_f32_16x16x32_bf16 v[4:7], v[88:91], v[16:19], v[4:7]
    v_lshlrev_b32 v2, 16, v78
    s_waitcnt lgkmcnt(4)
    v_mfma_f32_16x16x32_bf16 v[112:115], v[52:55], v[20:23], v[112:115]
    v_and_b32 v3, s87, v78
    v_mfma_f32_16x16x32_bf16 v[116:119], v[56:59], v[20:23], v[116:119]
    ds_read_b64_tr_b16 v[32:33], v71 offset:62464
    ds_read_b64_tr_b16 v[34:35], v71 offset:62976
    v_sub_f32 v2, v2, v74
    v_mfma_f32_16x16x32_bf16 v[120:123], v[60:63], v[20:23], v[120:123]
    v_sub_f32 v3, v3, v74
    v_mfma_f32_16x16x32_bf16 v[124:127], v[64:67], v[20:23], v[124:127]
    buffer_load_dwordx4 v85, s[12:15], s36 offen offset:3072 lds
    s_add_u32 s36, s36, 128
    v_mfma_f32_16x16x32_bf16 v[8:11], v[88:91], v[20:23], v[8:11]
    v_fma_f32 v75, v2, v2, v75
    s_waitcnt lgkmcnt(4)
    v_mfma_f32_16x16x32_bf16 v[128:131], v[24:27], v[52:55], v[128:131]
    v_fma_f32 v75, v3, v3, v75
    v_mfma_f32_16x16x32_bf16 v[132:135], v[24:27], v[56:59], v[132:135]
    ds_read_b64_tr_b16 v[16:17], v71 offset:63488
    ds_read_b64_tr_b16 v[18:19], v71 offset:64000
    v_lshlrev_b32 v2, 16, v79
    v_mfma_f32_16x16x32_bf16 v[136:139], v[24:27], v[60:63], v[136:139]
    v_and_b32 v3, s87, v79
    v_mfma_f32_16x16x32_bf16 v[140:143], v[24:27], v[64:67], v[140:143]
    s_add_u32 m0, s44, 36864
    s_nop 0
    buffer_load_dwordx4 v82, s[12:15], s37 offen offset:0 lds
    v_mfma_f32_16x16x32_bf16 v[12:15], v[88:91], v[24:27], v[12:15]
    v_sub_f32 v2, v2, v74
    s_branch L_cs_70_ret
L_cs_71:
    s_waitcnt lgkmcnt(4)
    v_mfma_f32_16x16x32_bf16 v[144:147], v[28:31], v[52:55], v[144:147]
    v_sub_f32 v3, v3, v74
    v_mfma_f32_16x16x32_bf16 v[148:151], v[28:31], v[56:59], v[148:151]
    ds_read_b64_tr_b16 v[20:21], v72 offset:62464
    ds_read_b64_tr_b16 v[22:23], v72 offset:62976
    v_fma_f32 v75, v2, v2, v75
    v_mfma_f32_16x16x32_bf16 v[152:155], v[28:31], v[60:63], v[152:155]
    v_fma_f32 v75, v3, v3, v75
    v_mfma_f32_16x16x32_bf16 v[156:159], v[28:31], v[64:67], v[156:159]
    buffer_load_dwordx4 v83, s[12:15], s37 offen offset:1024 lds
    v_mfma_f32_16x16x32_bf16 v[4:7], v[88:91], v[28:31], v[4:7]
    v_lshlrev_b32 v2, 16, v92
    s_waitcnt lgkmcnt(4)
    v_mfma_f32_16x16x32_bf16 v[160:163], v[32:35], v[52:55], v[160:163]
    v_and_b32 v3, s87, v92
    v_mfma_f32_16x16x32_bf16 v[164:167], v[32:35], v[56:59], v[164:167]
    ds_read_b64_tr_b16 v[24:25], v72 offset:63488
    ds_read_b64_tr_b16 v[26:27], v72 offset:64000
    v_sub_f32 v2, v2, v74
    v_mfma_f32_16x16x32_bf16 v[168:171], v[32:35], v[60:63], v[168:171]
    v_sub_f32 v3, v3, v74
    v_mfma_f32_16x16x32_bf16 v[172:175], v[32:35], v[64:67], v[172:175]
    buffer_load_dwordx4 v84, s[12:15], s37 offen offset:2048 lds
    v_mfma_f32_16x16x32_bf16 v[8:11], v[88:91], v[32:35], v[8:11]
    v_fma_f32 v75, v2, v2, v75
    s_branch L_cs_71_ret
L_cs_72:
    s_waitcnt lgkmcnt(4)
    v_mfma_f32_16x16x32_bf16 v[176:179], v[16:19], v[52:55], v[176:179]
    ds_read_b64_tr_b16 v[28:29], v73 offset:62464
    ds_read_b64_tr_b16 v[30:31], v73 offset:62976
    v_fma_f32 v75, v3, v3, v75
    v_mfma_f32_16x16x32_bf16 v[180:183], v[16:19], v[56:59], v[180:183]
    ds_read_b64_tr_b16 v[32:33], v73 offset:63488
    ds_read_b64_tr_b16 v[34:35], v73 offset:64000
    v_lshlrev_b32 v2, 16, v93
    v_mfma_f32_16x16x32_bf16 v[184:187], v[16:19], v[60:63], v[184:187]
    v_and_b32 v3, s87, v93
    v_mfma_f32_16x16x32_bf16 v[188:191], v[16:19], v[64:67], v[188:191]
    buffer_load_dwordx4 v85, s[12:15], s37 offen offset:3072 lds
    s_add_u32 s37, s37, 128
    v_mfma_f32_16x16x32_bf16 v[4:7], v[88:91], v[16:19], v[4:7]
    v_sub_f32 v2, v2, v74
    s_waitcnt lgkmcnt(6)
    v_mfma_f32_16x16x32_bf16 v[192:195], v[20:23], v[52:55], v[192:195]
    v_sub_f32 v3, v3, v74
    v_mfma_f32_16x16x32_bf16 v[196:199], v[20:23], v[56:59], v[196:199]
    v_fma_f32 v75, v2, v2, v75
    v_mfma_f32_16x16x32_bf16 v[200:203], v[20:23], v[60:63], v[200:203]
    v_fma_f32 v75, v3, v3, v75
    v_mfma_f32_16x16x32_bf16 v[204:207], v[20:23], v[64:67], v[204:207]
    v_mfma_f32_16x16x32_bf16 v[8:11], v[88:91], v[20:23], v[8:11]
    v_lshlrev_b32 v2, 16, v94
    s_branch L_cs_72_ret
L_cs_73:
    v_mfma_f32_16x16x32_bf16 v[208:211], v[24:27], v[52:55], v[208:211]
    ds_read_b128 v[36:39], v80 offset:0
    ds_read_b128 v[40:43], v80 offset:2048
    v_and_b32 v3, s87, v94
    v_mfma_f32_16x16x32_bf16 v[212:215], v[24:27], v[56:59], v[212:215]
    ds_read_b128 v[44:47], v80 offset:4096
    ds_read_b128 v[48:51], v80 offset:6144
    v_sub_f32 v2, v2, v74
    v_mfma_f32_16x16x32_bf16 v[216:219], v[24:27], v[60:63], v[216:219]
    ds_read_b64_tr_b16 v[16:17], v68 offset:0
    ds_read_b64_tr_b16 v[18:19], v68 offset:512
    v_sub_f32 v3, v3, v74
    v_mfma_f32_16x16x32_bf16 v[220:223], v[24:27], v[64:67], v[220:223]
    v_mfma_f32_16x16x32_bf16 v[4:7], v[88:91], v[24:27], v[4:7]
    v_fma_f32 v75, v2, v2, v75
    v_mfma_f32_16x16x32_bf16 v[224:227], v[28:31], v[52:55], v[224:227]
    v_fma_f32 v75, v3, v3, v75
    v_mfma_f32_16x16x32_bf16 v[228:231], v[28:31], v[56:59], v[228:231]
    ds_read_b64_tr_b16 v[20:21], v69 offset:0
    ds_read_b64_tr_b16 v[22:23], v69 offset:512
    v_lshlrev_b32 v2, 16, v95
    v_mfma_f32_16x16x32_bf16 v[232:235], v[28:31], v[60:63], v[232:235]
    v_and_b32 v3, s87, v95
    v_mfma_f32_16x16x32_bf16 v[236:239], v[28:31], v[64:67], v[236:239]
    v_mfma_f32_16x16x32_bf16 v[8:11], v[88:91], v[28:31], v[8:11]
    v_sub_f32 v2, v2, v74
    v_mfma_f32_16x16x32_bf16 v[240:243], v[32:35], v[52:55], v[240:243]
    v_sub_f32 v3, v3, v74
    v_mfma_f32_16x16x32_bf16 v[244:247], v[32:35], v[56:59], v[244:247]
    ds_read_b64_tr_b16 v[24:25], v70 offset:1024
    ds_read_b64_tr_b16 v[26:27], v70 offset:1536
    v_fma_f32 v75, v2, v2, v75
    v_mfma_f32_16x16x32_bf16 v[248:251], v[32:35], v[60:63], v[248:251]
    v_fma_f32 v75, v3, v3, v75
    v_mfma_f32_16x16x32_bf16 v[252:255], v[32:35], v[64:67], v[252:255]
    v_mfma_f32_16x16x32_bf16 v[12:15], v[88:91], v[32:35], v[12:15]
    s_nop 1
    v_add_f32_dpp v75, v75, v75 row_ror:8 row_mask:0xf bank_mask:0xf
    s_branch L_cs_73_ret
L_cs_74:
    s_waitcnt lgkmcnt(4)
    v_mfma_f32_16x16x32_bf16 v[96:99], v[36:39], v[16:19], v[96:99]
    ds_read_b128 v[52:55], v81 offset:0
    ds_read_b128 v[56:59], v81 offset:2048
    s_nop 1
    v_add_f32_dpp v75, v75, v75 row_ror:4 row_mask:0xf bank_mask:0xf
    v_mfma_f32_16x16x32_bf16 v[100:103], v[40:43], v[16:19], v[100:103]
    ds_read_b64_tr_b16 v[28:29], v70 offset:2048
    ds_read_b64_tr_b16 v[30:31], v70 offset:2560
    s_nop 1
    v_add_f32_dpp v75, v75, v75 row_ror:2 row_mask:0xf bank_mask:0xf
    v_mfma_f32_16x16x32_bf16 v[104:107], v[44:47], v[16:19], v[104:107]
    ds_read_b128 v[60:63], v81 offset:4096
    ds_read_b128 v[64:67], v81 offset:6144
    s_nop 1
    v_add_f32_dpp v75, v75, v75 row_ror:1 row_mask:0xf bank_mask:0xf
    v_mfma_f32_16x16x32_bf16 v[108:111], v[48:51], v[16:19], v[108:111]
    v_mfma_f32_16x16x32_bf16 v[4:7], v[88:91], v[16:19], v[4:7]
    v_mov_b32 v2, v75
    s_waitcnt lgkmcnt(8)
    v_mfma_f32_16x16x32_bf16 v[112:115], v[36:39], v[20:23], v[112:115]
    s_nop 1
    v_permlane16_swap_b32 v75, v2
    v_mfma_f32_16x16x32_bf16 v[116:119], v[40:43], v[20:23], v[116:119]
    ds_read_b64_tr_b16 v[32:33], v71 offset:1024
    ds_read_b64_tr_b16 v[34:35], v71 offset:1536
    s_nop 1
    v_add_f32 v75, v75, v2
    v_mfma_f32_16x16x32_bf16 v[120:123], v[44:47], v[20:23], v[120:123]
    v_mov_b32 v2, v75
    v_mfma_f32_16x16x32_bf16 v[124:127], v[48:51], v[20:23], v[124:127]
    v_mfma_f32_16x16x32_bf16 v[8:11], v[88:91], v[20:23], v[8:11]
    s_nop 1
    v_permlane32_swap_b32 v75, v2
    s_waitcnt lgkmcnt(8)
    v_mfma_f32_16x16x32_bf16 v[128:131], v[24:27], v[36:39], v[128:131]
    s_nop 1
    v_add_f32 v75, v75, v2
    v_mfma_f32_16x16x32_bf16 v[132:135], v[24:27], v[40:43], v[132:135]
    ds_read_b64_tr_b16 v[16:17], v71 offset:2048
    ds_read_b64_tr_b16 v[18:19], v71 offset:2560
    v_mov_b32 v2, 0x3727c5ac
    v_mfma_f32_16x16x32_bf16 v[136:139], v[24:27], v[44:47], v[136:139]
    v_mov_b32 v3, 0x3a800000
    v_mfma_f32_16x16x32_bf16 v[140:143], v[24:27], v[48:51], v[140:143]
    v_mfma_f32_16x16x32_bf16 v[12:15], v[88:91], v[24:27], v[12:15]
    v_fma_f32 v75, v75, v3, v2
    s_branch L_cs_74_ret
L_cs_75:
    s_waitcnt lgkmcnt(6)
    v_mfma_f32_16x16x32_bf16 v[144:147], v[28:31], v[36:39], v[144:147]
    s_nop 0
    v_rsq_f32 v75, v75
    v_mfma_f32_16x16x32_bf16 v[148:151], v[28:31], v[40:43], v[148:151]
    ds_read_b64_tr_b16 v[20:21], v72 offset:1024
    ds_read_b64_tr_b16 v[22:23], v72 offset:1536
    s_nop 0
    s_lshl_b32 s52, s51, 2
    s_lshr_b32 s52, 0x5307, s52
    s_and_b32 s52, s52, 15
    s_lshr_b32 s53, s51, 1
    s_sub_u32 s53, 3, s53
    v_lshrrev_b32 v76, 4, v1
    v_mfma_f32_16x16x32_bf16 v[152:155], v[28:31], v[44:47], v[152:155]
    v_cmp_gt_u32 vcc, s53, v76
    v_mfma_f32_16x16x32_bf16 v[156:159], v[28:31], v[48:51], v[156:159]
    v_mfma_f32_16x16x32_bf16 v[4:7], v[88:91], v[28:31], v[4:7]
    v_add_u32 v76, s52, v76
    s_waitcnt lgkmcnt(4)
    v_mfma_f32_16x16x32_bf16 v[160:163], v[32:35], v[36:39], v[160:163]
    v_and_b32 v77, 15, v1
    v_mfma_f32_16x16x32_bf16 v[164:167], v[32:35], v[40:43], v[164:167]
    ds_read_b64_tr_b16 v[24:25], v72 offset:2048
    ds_read_b64_tr_b16 v[26:27], v72 offset:2560
    v_lshlrev_b32 v77, 2, v77
    v_mfma_f32_16x16x32_bf16 v[168:171], v[32:35], v[44:47], v[168:171]
    v_lshl_add_u32 v76, v76, 6, v77
    v_mfma_f32_16x16x32_bf16 v[172:175], v[32:35], v[48:51], v[172:175]
    v_mfma_f32_16x16x32_bf16 v[8:11], v[88:91], v[32:35], v[8:11]
    v_mov_b32 v77, 2147418112
    s_branch L_cs_75_ret
L_cs_76:
    s_waitcnt lgkmcnt(4)
    v_mfma_f32_16x16x32_bf16 v[176:179], v[16:19], v[36:39], v[176:179]
    ds_read_b64_tr_b16 v[28:29], v73 offset:1024
    ds_read_b64_tr_b16 v[30:31], v73 offset:1536
    v_cndmask_b32 v76, v77, v76, vcc
    v_mfma_f32_16x16x32_bf16 v[180:183], v[16:19], v[40:43], v[180:183]
    ds_read_b64_tr_b16 v[32:33], v73 offset:2048
    ds_read_b64_tr_b16 v[34:35], v73 offset:2560
    v_cmp_eq_u32 vcc, 0, v1
    v_mfma_f32_16x16x32_bf16 v[184:187], v[16:19], v[44:47], v[184:187]
    s_and_b32 s52, s2, 31
    s_mul_i32 s52, s52, 10240
    s_mul_i32 s53, s48, 1280
    s_add_u32 s52, s52, s53
    s_mul_i32 s53, s50, 640
    s_add_u32 s52, s52, s53
    s_add_u32 s54, s52, 52498432
    v_cndmask_b32 v77, v77, v1, vcc
    v_mfma_f32_16x16x32_bf16 v[188:191], v[16:19], v[48:51], v[188:191]
    v_mfma_f32_16x16x32_bf16 v[4:7], v[88:91], v[16:19], v[4:7]
    s_lshl_b32 s55, s2, 7
    s_lshl_b32 s53, s49, 3
    s_add_u32 s55, s55, s53
    s_add_u32 s55, s55, 52465664
    s_waitcnt lgkmcnt(6)
    v_mfma_f32_16x16x32_bf16 v[192:195], v[20:23], v[36:39], v[192:195]
    v_mfma_f32_16x16x32_bf16 v[196:199], v[20:23], v[40:43], v[196:199]
    v_mfma_f32_16x16x32_bf16 v[200:203], v[20:23], v[44:47], v[200:203]
    v_mfma_f32_16x16x32_bf16 v[204:207], v[20:23], v[48:51], v[204:207]
    v_mfma_f32_16x16x32_bf16 v[8:11], v[88:91], v[20:23], v[8:11]
    s_branch L_cs_76_ret
L_g1_tail:
    s_cmp_eq_u32 s47, 0
    s_cbranch_scc1 L_g1_tB
    s_cmp_eq_u32 s47, 3
    s_cbranch_scc1 L_g1_tAV
    v_mfma_f32_16x16x32_bf16 v[208:211], v[24:27], v[36:39], v[208:211]
    s_and_b32 s52, s49, 3
    s_lshl_b32 s52, s52, 1
    s_lshl_b32 s53, s48, 3
    s_add_u32 s60, s52, s53
    s_lshl_b32 s61, s60, 11
    s_mul_i32 s62, s60, 229376
    s_add_u32 s62, s62, 16777216
    s_mul_i32 s63, s46, 7
    s_lshl_b32 s64, s46, 1
    s_add_u32 s64, s64, s50
    v_lshrrev_b32 v8, 4, v1
    v_and_b32 v9, 15, v1
    v_lshrrev_b32 v10, 1, v8
    v_mfma_f32_16x16x32_bf16 v[212:215], v[24:27], v[40:43], v[212:215]
    ds_read_b64_tr_b16 v[16:17], v68 offset:20480
    ds_read_b64_tr_b16 v[18:19], v68 offset:20992
    v_and_b32 v11, 1, v8
    v_lshlrev_b32 v12, 4, v9
    v_lshl_add_u32 v12, v11, 9, v12
    v_mfma_f32_16x16x32_bf16 v[216:219], v[24:27], v[44:47], v[216:219]
    v_lshl_add_u32 v2, v10, 10, v12
    v_lshl_add_u32 v3, v10, 8, v12
    s_mov_b32 s56, 0x3e8293ee
    s_mov_b32 s57, s56
    s_mov_b32 s12, s98
    s_mov_b32 s13, s99
    s_mov_b32 s14, 256
    s_mov_b32 s15, 0x20000
    s_cmp_eq_u32 s49, 0
    s_cselect_b32 s39, 0, 2147418112
    v_and_b32 v13, 7, v1
    v_mfma_f32_16x16x32_bf16 v[220:223], v[24:27], v[48:51], v[220:223]
    v_lshlrev_b32 v13, 5, v13
    s_sub_u32 s52, s47, 1
    s_lshl_b32 s53, s52, 1
    s_add_u32 s53, s53, s63
    s_add_u32 s53, s53, s50
    s_add_u32 s53, s53, 1
    s_lshl_b32 s53, s53, 11
    s_add_u32 s65, s53, s62
    s_lshl_b32 s52, s52, 22
    s_add_u32 s52, s52, 4194304
    s_add_u32 s66, s64, 16
    s_lshl_b32 s66, s66, 17
    s_add_u32 s66, s66, s61
    s_add_u32 s66, s66, s52
    s_mov_b32 s62, s65
    s_add_u32 s65, s65, 1024
    s_cmp_eq_u32 s47, 1
    s_cselect_b32 s56, s56, 1.0
    s_mov_b32 s57, s56
    s_mul_i32 s52, s50, 640
    s_add_u32 s52, s52, 147456
    v_lshrrev_b32 v6, 4, v1
    v_and_b32 v7, 15, v1
    v_mfma_f32_16x16x32_bf16 v[224:227], v[28:31], v[36:39], v[224:227]
    v_lshl_add_u32 v74, v6, 4, s52
    v_lshl_add_u32 v12, v7, 2, s52
    s_and_b32 s53, s49, 3
    s_lshl_b32 s53, s53, 9
    s_add_u32 s53, s53, 149504
    v_lshl_add_u32 v75, v6, 4, s53
    v_mfma_f32_16x16x32_bf16 v[228:231], v[28:31], v[40:43], v[228:231]
    ds_read_b64_tr_b16 v[20:21], v69 offset:20480
    ds_read_b64_tr_b16 v[22:23], v69 offset:20992
    v_lshl_add_u32 v87, v7, 2, s53
    ds_read2_b32 v[88:89], v87 offset0:0 offset1:64
    ds_read2_b32 v[90:91], v87 offset0:16 offset1:80
    v_mfma_f32_16x16x32_bf16 v[232:235], v[28:31], v[44:47], v[232:235]
    ds_read2_b32 v[92:93], v87 offset0:32 offset1:96
    ds_read2_b32 v[94:95], v87 offset0:48 offset1:112
    ds_read_b128 v[4:7], v74 offset:0
    v_mfma_f32_16x16x32_bf16 v[236:239], v[28:31], v[48:51], v[236:239]
    ds_read_b128 v[8:11], v74 offset:64
    v_mfma_f32_16x16x32_bf16 v[240:243], v[32:35], v[36:39], v[240:243]
    v_mfma_f32_16x16x32_bf16 v[244:247], v[32:35], v[40:43], v[244:247]
    ds_read_b64_tr_b16 v[24:25], v70 offset:21504
    ds_read_b64_tr_b16 v[26:27], v70 offset:22016
    v_mfma_f32_16x16x32_bf16 v[248:251], v[32:35], v[44:47], v[248:251]
    v_mfma_f32_16x16x32_bf16 v[252:255], v[32:35], v[48:51], v[252:255]
    s_waitcnt lgkmcnt(10)
    v_mfma_f32_16x16x32_bf16 v[96:99], v[16:19], v[52:55], v[96:99]
    v_mfma_f32_16x16x32_bf16 v[100:103], v[16:19], v[56:59], v[100:103]
    ds_read_b64_tr_b16 v[28:29], v70 offset:22528
    ds_read_b64_tr_b16 v[30:31], v70 offset:23040
    v_mfma_f32_16x16x32_bf16 v[104:107], v[16:19], v[60:63], v[104:107]
    v_mfma_f32_16x16x32_bf16 v[108:111], v[16:19], v[64:67], v[108:111]
    s_waitcnt lgkmcnt(10)
    v_mfma_f32_16x16x32_bf16 v[112:115], v[20:23], v[52:55], v[112:115]
    v_mfma_f32_16x16x32_bf16 v[116:119], v[20:23], v[56:59], v[116:119]
    ds_read_b64_tr_b16 v[32:33], v71 offset:21504
    ds_read_b64_tr_b16 v[34:35], v71 offset:22016
    v_mfma_f32_16x16x32_bf16 v[120:123], v[20:23], v[60:63], v[120:123]
    v_mfma_f32_16x16x32_bf16 v[124:127], v[20:23], v[64:67], v[124:127]
    s_waitcnt lgkmcnt(4)
    v_mfma_f32_16x16x32_bf16 v[128:131], v[24:27], v[52:55], v[128:131]
    v_fma_f32 v96, -v88, v4, v96
    v_fma_f32 v97, -v88, v5, v97
    v_fma_f32 v98, -v88, v6, v98
    v_fma_f32 v99, -v88, v7, v99
    v_mfma_f32_16x16x32_bf16 v[132:135], v[24:27], v[56:59], v[132:135]
    ds_read_b64_tr_b16 v[16:17], v71 offset:22528
    ds_read_b64_tr_b16 v[18:19], v71 offset:23040
    v_fma_f32 v100, -v90, v4, v100
    v_fma_f32 v101, -v90, v5, v101
    v_fma_f32 v102, -v90, v6, v102
    v_fma_f32 v103, -v90, v7, v103
    v_mfma_f32_16x16x32_bf16 v[136:139], v[24:27], v[60:63], v[136:139]
    v_fma_f32 v104, -v92, v4, v104
    v_fma_f32 v105, -v92, v5, v105
    v_fma_f32 v106, -v92, v6, v106
    v_fma_f32 v107, -v92, v7, v107
    v_mfma_f32_16x16x32_bf16 v[140:143], v[24:27], v[64:67], v[140:143]
    v_fma_f32 v108, -v94, v4, v108
    v_fma_f32 v109, -v94, v5, v109
    v_fma_f32 v110, -v94, v6, v110
    v_fma_f32 v111, -v94, v7, v111
    ds_read_b128 v[4:7], v74 offset:128
    s_waitcnt lgkmcnt(5)
    v_mfma_f32_16x16x32_bf16 v[144:147], v[28:31], v[52:55], v[144:147]
    v_fma_f32 v112, -v88, v8, v112
    v_fma_f32 v113, -v88, v9, v113
    v_fma_f32 v114, -v88, v10, v114
    v_fma_f32 v115, -v88, v11, v115
    v_mfma_f32_16x16x32_bf16 v[148:151], v[28:31], v[56:59], v[148:151]
    ds_read_b64_tr_b16 v[20:21], v72 offset:21504
    ds_read_b64_tr_b16 v[22:23], v72 offset:22016
    v_fma_f32 v116, -v90, v8, v116
    v_fma_f32 v117, -v90, v9, v117
    v_fma_f32 v118, -v90, v10, v118
    v_fma_f32 v119, -v90, v11, v119
    v_mfma_f32_16x16x32_bf16 v[152:155], v[28:31], v[60:63], v[152:155]
    v_fma_f32 v120, -v92, v8, v120
    v_fma_f32 v121, -v92, v9, v121
    v_fma_f32 v122, -v92, v10, v122
    v_fma_f32 v123, -v92, v11, v123
    v_mfma_f32_16x16x32_bf16 v[156:159], v[28:31], v[64:67], v[156:159]
    v_fma_f32 v124, -v94, v8, v124
    v_fma_f32 v125, -v94, v9, v125
    v_fma_f32 v126, -v94, v10, v126
    v_fma_f32 v127, -v94, v11, v127
    ds_read_b128 v[8:11], v74 offset:192
    s_waitcnt lgkmcnt(6)
    v_mfma_f32_16x16x32_bf16 v[160:163], v[32:35], v[52:55], v[160:163]
    s_waitcnt lgkmcnt(3)
    v_fma_f32 v128, -v88, v4, v128
    v_fma_f32 v129, -v88, v5, v129
    v_fma_f32 v130, -v88, v6, v130
    v_fma_f32 v131, -v88, v7, v131
    v_mfma_f32_16x16x32_bf16 v[164:167], v[32:35], v[56:59], v[164:167]
    ds_read_b64_tr_b16 v[24:25], v72 offset:22528
    ds_read_b64_tr_b16 v[26:27], v72 offset:23040
    v_fma_f32 v132, -v90, v4, v132
    v_fma_f32 v133, -v90, v5, v133
    v_fma_f32 v134, -v90, v6, v134
    v_fma_f32 v135, -v90, v7, v135
    v_mfma_f32_16x16x32_bf16 v[168:171], v[32:35], v[60:63], v[168:171]
    v_fma_f32 v136, -v92, v4, v136
    v_fma_f32 v137, -v92, v5, v137
    v_fma_f32 v138, -v92, v6, v138
    v_fma_f32 v139, -v92, v7, v139
    v_mfma_f32_16x16x32_bf16 v[172:175], v[32:35], v[64:67], v[172:175]
    v_fma_f32 v140, -v94, v4, v140
    v_fma_f32 v141, -v94, v5, v141
    v_fma_f32 v142, -v94, v6, v142
    v_fma_f32 v143, -v94, v7, v143
    ds_read_b128 v[4:7], v74 offset:256
    v_mfma_f32_16x16x32_bf16 v[176:179], v[16:19], v[52:55], v[176:179]
    s_waitcnt lgkmcnt(3)
    v_fma_f32 v144, -v88, v8, v144
    v_fma_f32 v145, -v88, v9, v145
    v_fma_f32 v146, -v88, v10, v146
    v_fma_f32 v147, -v88, v11, v147
    v_mfma_f32_16x16x32_bf16 v[180:183], v[16:19], v[56:59], v[180:183]
    ds_read_b64_tr_b16 v[28:29], v73 offset:21504
    ds_read_b64_tr_b16 v[30:31], v73 offset:22016
    v_fma_f32 v148, -v90, v8, v148
    v_fma_f32 v149, -v90, v9, v149
    v_fma_f32 v150, -v90, v10, v150
    v_fma_f32 v151, -v90, v11, v151
    v_mfma_f32_16x16x32_bf16 v[184:187], v[16:19], v[60:63], v[184:187]
    v_fma_f32 v152, -v92, v8, v152
    v_fma_f32 v153, -v92, v9, v153
    v_fma_f32 v154, -v92, v10, v154
    v_fma_f32 v155, -v92, v11, v155
    v_mfma_f32_16x16x32_bf16 v[188:191], v[16:19], v[64:67], v[188:191]
    v_fma_f32 v156, -v94, v8, v156
    v_fma_f32 v157, -v94, v9, v157
    v_fma_f32 v158, -v94, v10, v158
    v_fma_f32 v159, -v94, v11, v159
    ds_read_b128 v[8:11], v74 offset:320
    v_mfma_f32_16x16x32_bf16 v[192:195], v[20:23], v[52:55], v[192:195]
    s_waitcnt lgkmcnt(3)
    v_fma_f32 v160, -v88, v4, v160
    v_fma_f32 v161, -v88, v5, v161
    v_fma_f32 v162, -v88, v6, v162
    v_fma_f32 v163, -v88, v7, v163
    v_mfma_f32_16x16x32_bf16 v[196:199], v[20:23], v[56:59], v[196:199]
    ds_read_b64_tr_b16 v[32:33], v73 offset:22528
    ds_read_b64_tr_b16 v[34:35], v73 offset:23040
    v_fma_f32 v164, -v90, v4, v164
    v_fma_f32 v165, -v90, v5, v165
    v_fma_f32 v166, -v90, v6, v166
    v_fma_f32 v167, -v90, v7, v167
    v_mfma_f32_16x16x32_bf16 v[200:203], v[20:23], v[60:63], v[200:203]
    v_fma_f32 v168, -v92, v4, v168
    v_fma_f32 v169, -v92, v5, v169
    v_fma_f32 v170, -v92, v6, v170
    v_fma_f32 v171, -v92, v7, v171
    v_mfma_f32_16x16x32_bf16 v[204:207], v[20:23], v[64:67], v[204:207]
    v_fma_f32 v172, -v94, v4, v172
    v_fma_f32 v173, -v94, v5, v173
    v_fma_f32 v174, -v94, v6, v174
    v_fma_f32 v175, -v94, v7, v175
    ds_read_b128 v[4:7], v74 offset:384
    s_waitcnt vmcnt(0)
    s_barrier
    v_mfma_f32_16x16x32_bf16 v[208:211], v[24:27], v[52:55], v[208:211]
    ds_read_b128 v[36:39], v80 offset:32768
    ds_read_b128 v[40:43], v80 offset:34816
    s_waitcnt lgkmcnt(5)
    v_fma_f32 v176, -v88, v8, v176
    v_fma_f32 v177, -v88, v9, v177
    v_fma_f32 v178, -v88, v10, v178
    v_fma_f32 v179, -v88, v11, v179
    v_mfma_f32_16x16x32_bf16 v[212:215], v[24:27], v[56:59], v[212:215]
    ds_read_b64_tr_b16 v[16:17], v68 offset:40960
    ds_read_b64_tr_b16 v[18:19], v68 offset:41472
    v_fma_f32 v180, -v90, v8, v180
    v_fma_f32 v181, -v90, v9, v181
    v_fma_f32 v182, -v90, v10, v182
    v_fma_f32 v183, -v90, v11, v183
    v_mfma_f32_16x16x32_bf16 v[216:219], v[24:27], v[60:63], v[216:219]
    ds_read_b128 v[44:47], v80 offset:36864
    ds_read_b128 v[48:51], v80 offset:38912
    v_fma_f32 v184, -v92, v8, v184
    v_fma_f32 v185, -v92, v9, v185
    v_fma_f32 v186, -v92, v10, v186
    v_fma_f32 v187, -v92, v11, v187
    v_mfma_f32_16x16x32_bf16 v[220:223], v[24:27], v[64:67], v[220:223]
    v_fma_f32 v188, -v94, v8, v188
    v_fma_f32 v189, -v94, v9, v189
    v_fma_f32 v190, -v94, v10, v190
    v_fma_f32 v191, -v94, v11, v191
    ds_read_b128 v[8:11], v74 offset:448
    v_mfma_f32_16x16x32_bf16 v[224:227], v[28:31], v[52:55], v[224:227]
    s_waitcnt lgkmcnt(7)
    v_fma_f32 v192, -v88, v4, v192
    v_fma_f32 v193, -v88, v5, v193
    v_fma_f32 v194, -v88, v6, v194
    v_fma_f32 v195, -v88, v7, v195
    v_mfma_f32_16x16x32_bf16 v[228:231], v[28:31], v[56:59], v[228:231]
    ds_read_b64_tr_b16 v[20:21], v69 offset:40960
    ds_read_b64_tr_b16 v[22:23], v69 offset:41472
    v_fma_f32 v196, -v90, v4, v196
    v_fma_f32 v197, -v90, v5, v197
    v_fma_f32 v198, -v90, v6, v198
    v_fma_f32 v199, -v90, v7, v199
    v_mfma_f32_16x16x32_bf16 v[232:235], v[28:31], v[60:63], v[232:235]
    v_fma_f32 v200, -v92, v4, v200
    v_fma_f32 v201, -v92, v5, v201
    v_fma_f32 v202, -v92, v6, v202
    v_fma_f32 v203, -v92, v7, v203
    v_mfma_f32_16x16x32_bf16 v[236:239], v[28:31], v[64:67], v[236:239]
    v_fma_f32 v204, -v94, v4, v204
    v_fma_f32 v205, -v94, v5, v205
    v_fma_f32 v206, -v94, v6, v206
    v_fma_f32 v207, -v94, v7, v207
    ds_read_b128 v[4:7], v74 offset:512
    v_mfma_f32_16x16x32_bf16 v[240:243], v[32:35], v[52:55], v[240:243]
    s_waitcnt lgkmcnt(3)
    v_fma_f32 v208, -v88, v8, v208
    v_fma_f32 v209, -v88, v9, v209
    v_fma_f32 v210, -v88, v10, v210
    v_fma_f32 v211, -v88, v11, v211
    v_mfma_f32_16x16x32_bf16 v[244:247], v[32:35], v[56:59], v[244:247]
    ds_read_b64_tr_b16 v[24:25], v68 offset:61440
    ds_read_b64_tr_b16 v[26:27], v68 offset:61952
    v_fma_f32 v212, -v90, v8, v212
    v_fma_f32 v213, -v90, v9, v213
    v_fma_f32 v214, -v90, v10, v214
    v_fma_f32 v215, -v90, v11, v215
    v_mfma_f32_16x16x32_bf16 v[248:251], v[32:35], v[60:63], v[248:251]
    v_fma_f32 v216, -v92, v8, v216
    v_fma_f32 v217, -v92, v9, v217
    v_fma_f32 v218, -v92, v10, v218
    v_fma_f32 v219, -v92, v11, v219
    v_mfma_f32_16x16x32_bf16 v[252:255], v[32:35], v[64:67], v[252:255]
    v_fma_f32 v220, -v94, v8, v220
    v_fma_f32 v221, -v94, v9, v221
    v_fma_f32 v222, -v94, v10, v222
    v_fma_f32 v223, -v94, v11, v223
    ds_read_b128 v[8:11], v74 offset:576
    v_mfma_f32_16x16x32_bf16 v[96:99], v[16:19], v[36:39], v[96:99]
    ds_read_b128 v[52:55], v81 offset:32768
    ds_read_b128 v[56:59], v81 offset:34816
    s_waitcnt lgkmcnt(5)
    v_fma_f32 v224, -v88, v4, v224
    v_fma_f32 v225, -v88, v5, v225
    v_fma_f32 v226, -v88, v6, v226
    v_fma_f32 v227, -v88, v7, v227
    v_mfma_f32_16x16x32_bf16 v[100:103], v[16:19], v[40:43], v[100:103]
    ds_read_b64_tr_b16 v[28:29], v69 offset:61440
    ds_read_b64_tr_b16 v[30:31], v69 offset:61952
    v_fma_f32 v228, -v90, v4, v228
    v_fma_f32 v229, -v90, v5, v229
    v_fma_f32 v230, -v90, v6, v230
    v_fma_f32 v231, -v90, v7, v231
    v_mfma_f32_16x16x32_bf16 v[104:107], v[16:19], v[44:47], v[104:107]
    ds_read_b128 v[60:63], v81 offset:36864
    ds_read_b128 v[64:67], v81 offset:38912
    v_fma_f32 v232, -v92, v4, v232
    v_fma_f32 v233, -v92, v5, v233
    v_fma_f32 v234, -v92, v6, v234
    v_fma_f32 v235, -v92, v7, v235
    v_mfma_f32_16x16x32_bf16 v[108:111], v[16:19], v[48:51], v[108:111]
    v_fma_f32 v236, -v94, v4, v236
    v_fma_f32 v237, -v94, v5, v237
    v_fma_f32 v238, -v94, v6, v238
    v_fma_f32 v239, -v94, v7, v239
    v_mfma_f32_16x16x32_bf16 v[112:115], v[20:23], v[36:39], v[112:115]
    s_waitcnt lgkmcnt(6)
    v_fma_f32 v240, -v88, v8, v240
    v_fma_f32 v241, -v88, v9, v241
    v_fma_f32 v242, -v88, v10, v242
    v_fma_f32 v243, -v88, v11, v243
    v_mfma_f32_16x16x32_bf16 v[116:119], v[20:23], v[40:43], v[116:119]
    ds_read_b64_tr_b16 v[32:33], v72 offset:62464
    ds_read_b64_tr_b16 v[34:35], v72 offset:62976
    v_fma_f32 v244, -v90, v8, v244
    v_fma_f32 v245, -v90, v9, v245
    v_fma_f32 v246, -v90, v10, v246
    v_fma_f32 v247, -v90, v11, v247
    v_mfma_f32_16x16x32_bf16 v[120:123], v[20:23], v[44:47], v[120:123]
    v_fma_f32 v248, -v92, v8, v248
    v_fma_f32 v249, -v92, v9, v249
    v_fma_f32 v250, -v92, v10, v250
    v_fma_f32 v251, -v92, v11, v251
    v_mfma_f32_16x16x32_bf16 v[124:127], v[20:23], v[48:51], v[124:127]
    v_fma_f32 v252, -v94, v8, v252
    v_fma_f32 v253, -v94, v9, v253
    v_fma_f32 v254, -v94, v10, v254
    v_fma_f32 v255, -v94, v11, v255
    s_waitcnt lgkmcnt(2)
    v_mfma_f32_16x16x32_bf16 v[96:99], v[24:27], v[52:55], v[96:99]
    buffer_load_dword v14, v13, s[12:15], s39 offen sc0 sc1
    v_mfma_f32_16x16x32_bf16 v[100:103], v[24:27], v[56:59], v[100:103]
    ds_read_b64_tr_b16 v[16:17], v72 offset:63488
    ds_read_b64_tr_b16 v[18:19], v72 offset:64000
    v_mfma_f32_16x16x32_bf16 v[104:107], v[24:27], v[60:63], v[104:107]
    v_mfma_f32_16x16x32_bf16 v[108:111], v[24:27], v[64:67], v[108:111]
    v_mfma_f32_16x16x32_bf16 v[112:115], v[28:31], v[52:55], v[112:115]
    v_mfma_f32_16x16x32_bf16 v[116:119], v[28:31], v[56:59], v[116:119]
    ds_read_b64_tr_b16 v[20:21], v73 offset:62464
    ds_read_b64_tr_b16 v[22:23], v73 offset:62976
    v_mfma_f32_16x16x32_bf16 v[120:123], v[28:31], v[60:63], v[120:123]
    v_mfma_f32_16x16x32_bf16 v[124:127], v[28:31], v[64:67], v[124:127]
    s_waitcnt lgkmcnt(4)
    v_mfma_f32_16x16x32_bf16 v[192:195], v[32:35], v[52:55], v[192:195]
    v_mfma_f32_16x16x32_bf16 v[196:199], v[32:35], v[56:59], v[196:199]
    ds_read_b64_tr_b16 v[24:25], v73 offset:63488
    ds_read_b64_tr_b16 v[26:27], v73 offset:64000
    v_mfma_f32_16x16x32_bf16 v[200:203], v[32:35], v[60:63], v[200:203]
    v_mfma_f32_16x16x32_bf16 v[204:207], v[32:35], v[64:67], v[204:207]
    s_waitcnt lgkmcnt(4)
    v_mfma_f32_16x16x32_bf16 v[208:211], v[16:19], v[52:55], v[208:211]
    v_mul_f32 v76, s56, v89
    v_mul_f32 v78, s56, v91
    v_mul_f32 v82, s56, v93
    v_mfma_f32_16x16x32_bf16 v[212:215], v[16:19], v[56:59], v[212:215]
    ds_read_b64_tr_b16 v[28:29], v72 offset:41984
    ds_read_b64_tr_b16 v[30:31], v72 offset:42496
    v_mul_f32 v84, s56, v95
    v_mul_f32 v96, v76, v96
    v_mul_f32 v97, v76, v97
    v_mfma_f32_16x16x32_bf16 v[216:219], v[16:19], v[60:63], v[216:219]
    v_mul_f32 v98, v76, v98
    v_mul_f32 v99, v76, v99
    v_mul_f32 v112, v76, v112
    v_mfma_f32_16x16x32_bf16 v[220:223], v[16:19], v[64:67], v[220:223]
    v_mul_f32 v113, v76, v113
    v_mul_f32 v114, v76, v114
    v_mul_f32 v115, v76, v115
    s_waitcnt lgkmcnt(4)
    v_mfma_f32_16x16x32_bf16 v[224:227], v[20:23], v[52:55], v[224:227]
    v_cvt_pk_bf16_f32 v96, v96, v97
    v_cvt_pk_bf16_f32 v97, v98, v99
    v_cvt_pk_bf16_f32 v98, v112, v113
    v_mfma_f32_16x16x32_bf16 v[228:231], v[20:23], v[56:59], v[228:231]
    ds_read_b64_tr_b16 v[32:33], v72 offset:43008
    ds_read_b64_tr_b16 v[34:35], v72 offset:43520
    v_cvt_pk_bf16_f32 v99, v114, v115
    buffer_store_dwordx4 v[96:99], v2, s[32:35], s66 offen offset:0 sc0 sc1
    v_mul_f32 v100, v78, v100
    v_mfma_f32_16x16x32_bf16 v[232:235], v[20:23], v[60:63], v[232:235]
    v_mul_f32 v101, v78, v101
    v_mul_f32 v102, v78, v102
    v_mul_f32 v103, v78, v103
    v_mfma_f32_16x16x32_bf16 v[236:239], v[20:23], v[64:67], v[236:239]
    v_mul_f32 v116, v78, v116
    v_mul_f32 v117, v78, v117
    v_mul_f32 v118, v78, v118
    s_waitcnt lgkmcnt(4)
    v_mfma_f32_16x16x32_bf16 v[240:243], v[24:27], v[52:55], v[240:243]
    v_mul_f32 v119, v78, v119
    v_cvt_pk_bf16_f32 v100, v100, v101
    v_cvt_pk_bf16_f32 v101, v102, v103
    v_mfma_f32_16x16x32_bf16 v[244:247], v[24:27], v[56:59], v[244:247]
    ds_read_b64_tr_b16 v[16:17], v73 offset:41984
    ds_read_b64_tr_b16 v[18:19], v73 offset:42496
    v_cvt_pk_bf16_f32 v102, v116, v117
    v_cvt_pk_bf16_f32 v103, v118, v119
    buffer_store_dwordx4 v[100:103], v2, s[32:35], s66 offen offset:256 sc0 sc1
    v_mfma_f32_16x16x32_bf16 v[248:251], v[24:27], v[60:63], v[248:251]
    v_mul_f32 v104, v82, v104
    v_mul_f32 v105, v82, v105
    v_mul_f32 v106, v82, v106
    v_mfma_f32_16x16x32_bf16 v[252:255], v[24:27], v[64:67], v[252:255]
    v_mul_f32 v107, v82, v107
    v_mul_f32 v120, v82, v120
    v_mul_f32 v121, v82, v121
    s_waitcnt lgkmcnt(4)
    v_mfma_f32_16x16x32_bf16 v[192:195], v[28:31], v[36:39], v[192:195]
    v_mul_f32 v122, v82, v122
    v_mul_f32 v123, v82, v123
    v_cvt_pk_bf16_f32 v104, v104, v105
    v_mfma_f32_16x16x32_bf16 v[196:199], v[28:31], v[40:43], v[196:199]
    ds_read_b64_tr_b16 v[20:21], v73 offset:43008
    ds_read_b64_tr_b16 v[22:23], v73 offset:43520
    v_cvt_pk_bf16_f32 v105, v106, v107
    v_cvt_pk_bf16_f32 v106, v120, v121
    v_cvt_pk_bf16_f32 v107, v122, v123
    v_mfma_f32_16x16x32_bf16 v[200:203], v[28:31], v[44:47], v[200:203]
    buffer_store_dwordx4 v[104:107], v2, s[32:35], s66 offen offset:2048 sc0 sc1
    v_mul_f32 v108, v84, v108
    v_mul_f32 v109, v84, v109
    v_mfma_f32_16x16x32_bf16 v[204:207], v[28:31], v[48:51], v[204:207]
    v_mul_f32 v110, v84, v110
    v_mul_f32 v111, v84, v111
    v_mul_f32 v124, v84, v124
    s_waitcnt lgkmcnt(4)
    v_mfma_f32_16x16x32_bf16 v[208:211], v[32:35], v[36:39], v[208:211]
    v_mul_f32 v125, v84, v125
    v_mul_f32 v126, v84, v126
    v_mul_f32 v127, v84, v127
    v_mfma_f32_16x16x32_bf16 v[212:215], v[32:35], v[40:43], v[212:215]
    ds_read_b64_tr_b16 v[24:25], v70 offset:62464
    ds_read_b64_tr_b16 v[26:27], v70 offset:62976
    v_cvt_pk_bf16_f32 v108, v108, v109
    v_cvt_pk_bf16_f32 v109, v110, v111
    v_cvt_pk_bf16_f32 v110, v124, v125
    v_mfma_f32_16x16x32_bf16 v[216:219], v[32:35], v[44:47], v[216:219]
    v_cvt_pk_bf16_f32 v111, v126, v127
    buffer_store_dwordx4 v[108:111], v2, s[32:35], s66 offen offset:2304 sc0 sc1
    v_mfma_f32_16x16x32_bf16 v[220:223], v[32:35], v[48:51], v[220:223]
    s_waitcnt lgkmcnt(4)
    v_mfma_f32_16x16x32_bf16 v[224:227], v[16:19], v[36:39], v[224:227]
    v_mfma_f32_16x16x32_bf16 v[228:231], v[16:19], v[40:43], v[228:231]
    ds_read_b64_tr_b16 v[28:29], v70 offset:63488
    ds_read_b64_tr_b16 v[30:31], v70 offset:64000
    v_mfma_f32_16x16x32_bf16 v[232:235], v[16:19], v[44:47], v[232:235]
    v_mfma_f32_16x16x32_bf16 v[236:239], v[16:19], v[48:51], v[236:239]
    s_waitcnt lgkmcnt(4)
    v_mfma_f32_16x16x32_bf16 v[240:243], v[20:23], v[36:39], v[240:243]
    v_mfma_f32_16x16x32_bf16 v[244:247], v[20:23], v[40:43], v[244:247]
    ds_read_b64_tr_b16 v[32:33], v71 offset:62464
    ds_read_b64_tr_b16 v[34:35], v71 offset:62976
    v_mfma_f32_16x16x32_bf16 v[248:251], v[20:23], v[44:47], v[248:251]
    v_mfma_f32_16x16x32_bf16 v[252:255], v[20:23], v[48:51], v[252:255]
    s_waitcnt lgkmcnt(4)
    v_mfma_f32_16x16x32_bf16 v[128:131], v[24:27], v[52:55], v[128:131]
    v_mfma_f32_16x16x32_bf16 v[132:135], v[24:27], v[56:59], v[132:135]
    ds_read_b64_tr_b16 v[16:17], v71 offset:63488
    ds_read_b64_tr_b16 v[18:19], v71 offset:64000
    v_mfma_f32_16x16x32_bf16 v[136:139], v[24:27], v[60:63], v[136:139]
    v_mfma_f32_16x16x32_bf16 v[140:143], v[24:27], v[64:67], v[140:143]
    s_waitcnt lgkmcnt(4)
    v_mfma_f32_16x16x32_bf16 v[144:147], v[28:31], v[52:55], v[144:147]
    v_mul_f32 v76, v89, v89
    v_mul_f32 v78, v91, v91
    v_mul_f32 v82, v93, v93
    v_mfma_f32_16x16x32_bf16 v[148:151], v[28:31], v[56:59], v[148:151]
    ds_read_b64_tr_b16 v[20:21], v70 offset:41984
    ds_read_b64_tr_b16 v[22:23], v70 offset:42496
    v_mul_f32 v84, v95, v95
    v_max_f32 v192, 0, v192
    v_max_f32 v193, 0, v193
    v_mfma_f32_16x16x32_bf16 v[152:155], v[28:31], v[60:63], v[152:155]
    v_max_f32 v194, 0, v194
    v_max_f32 v195, 0, v195
    v_mul_f32 v208, v76, v208
    v_mfma_f32_16x16x32_bf16 v[156:159], v[28:31], v[64:67], v[156:159]
    v_mul_f32 v209, v76, v209
    v_mul_f32 v210, v76, v210
    v_mul_f32 v211, v76, v211
    s_waitcnt lgkmcnt(4)
    v_mfma_f32_16x16x32_bf16 v[160:163], v[32:35], v[52:55], v[160:163]
    v_max_f32 v224, 0, v224
    v_max_f32 v225, 0, v225
    v_max_f32 v226, 0, v226
    v_mfma_f32_16x16x32_bf16 v[164:167], v[32:35], v[56:59], v[164:167]
    ds_read_b64_tr_b16 v[24:25], v70 offset:43008
    ds_read_b64_tr_b16 v[26:27], v70 offset:43520
    v_max_f32 v227, 0, v227
    v_mul_f32 v240, v76, v240
    v_mul_f32 v241, v76, v241
    v_mfma_f32_16x16x32_bf16 v[168:171], v[32:35], v[60:63], v[168:171]
    v_mul_f32 v242, v76, v242
    v_mul_f32 v243, v76, v243
    v_mul_f32 v192, v192, v208
    v_mfma_f32_16x16x32_bf16 v[172:175], v[32:35], v[64:67], v[172:175]
    v_mul_f32 v193, v193, v209
    v_mul_f32 v194, v194, v210
    v_mul_f32 v195, v195, v211
    s_waitcnt lgkmcnt(4)
    v_mfma_f32_16x16x32_bf16 v[176:179], v[16:19], v[52:55], v[176:179]
    v_mul_f32 v224, v224, v240
    v_mul_f32 v225, v225, v241
    v_mul_f32 v226, v226, v242
    v_mfma_f32_16x16x32_bf16 v[180:183], v[16:19], v[56:59], v[180:183]
    ds_read_b64_tr_b16 v[28:29], v71 offset:41984
    ds_read_b64_tr_b16 v[30:31], v71 offset:42496
    v_mul_f32 v227, v227, v243
    v_cvt_pk_bf16_f32 v208, v192, v193
    v_cvt_pk_bf16_f32 v209, v194, v195
    v_mfma_f32_16x16x32_bf16 v[184:187], v[16:19], v[60:63], v[184:187]
    v_cvt_pk_bf16_f32 v210, v224, v225
    v_cvt_pk_bf16_f32 v211, v226, v227
    v_max_f32 v196, 0, v196
    v_mfma_f32_16x16x32_bf16 v[188:191], v[16:19], v[64:67], v[188:191]
    v_max_f32 v197, 0, v197
    v_max_f32 v198, 0, v198
    v_max_f32 v199, 0, v199
    s_waitcnt lgkmcnt(4)
    v_mfma_f32_16x16x32_bf16 v[128:131], v[20:23], v[36:39], v[128:131]
    v_mul_f32 v212, v78, v212
    v_mul_f32 v213, v78, v213
    v_mul_f32 v214, v78, v214
    v_mfma_f32_16x16x32_bf16 v[132:135], v[20:23], v[40:43], v[132:135]
    ds_read_b64_tr_b16 v[32:33], v71 offset:43008
    ds_read_b64_tr_b16 v[34:35], v71 offset:43520
    v_mul_f32 v215, v78, v215
    v_max_f32 v228, 0, v228
    v_max_f32 v229, 0, v229
    v_mfma_f32_16x16x32_bf16 v[136:139], v[20:23], v[44:47], v[136:139]
    v_max_f32 v230, 0, v230
    v_max_f32 v231, 0, v231
    v_mul_f32 v244, v78, v244
    v_mfma_f32_16x16x32_bf16 v[140:143], v[20:23], v[48:51], v[140:143]
    v_mul_f32 v245, v78, v245
    v_mul_f32 v246, v78, v246
    v_mul_f32 v247, v78, v247
    s_waitcnt lgkmcnt(4)
    v_mfma_f32_16x16x32_bf16 v[144:147], v[24:27], v[36:39], v[144:147]
    v_mul_f32 v196, v196, v212
    v_mul_f32 v197, v197, v213
    v_mul_f32 v198, v198, v214
    v_mfma_f32_16x16x32_bf16 v[148:151], v[24:27], v[40:43], v[148:151]
    v_mul_f32 v199, v199, v215
    v_mul_f32 v228, v228, v244
    v_mul_f32 v229, v229, v245
    v_mfma_f32_16x16x32_bf16 v[152:155], v[24:27], v[44:47], v[152:155]
    v_mul_f32 v230, v230, v246
    v_mul_f32 v231, v231, v247
    v_cvt_pk_bf16_f32 v212, v196, v197
    v_mfma_f32_16x16x32_bf16 v[156:159], v[24:27], v[48:51], v[156:159]
    v_cvt_pk_bf16_f32 v213, v198, v199
    v_cvt_pk_bf16_f32 v214, v228, v229
    v_cvt_pk_bf16_f32 v215, v230, v231
    s_waitcnt lgkmcnt(2)
    v_mfma_f32_16x16x32_bf16 v[160:163], v[28:31], v[36:39], v[160:163]
    v_max_f32 v200, 0, v200
    v_max_f32 v201, 0, v201
    v_max_f32 v202, 0, v202
    v_mfma_f32_16x16x32_bf16 v[164:167], v[28:31], v[40:43], v[164:167]
    v_max_f32 v203, 0, v203
    v_mul_f32 v216, v82, v216
    v_mul_f32 v217, v82, v217
    v_mfma_f32_16x16x32_bf16 v[168:171], v[28:31], v[44:47], v[168:171]
    v_mul_f32 v218, v82, v218
    v_mul_f32 v219, v82, v219
    v_max_f32 v232, 0, v232
    v_mfma_f32_16x16x32_bf16 v[172:175], v[28:31], v[48:51], v[172:175]
    v_max_f32 v233, 0, v233
    v_max_f32 v234, 0, v234
    v_max_f32 v235, 0, v235
    s_waitcnt lgkmcnt(0)
    v_mfma_f32_16x16x32_bf16 v[176:179], v[32:35], v[36:39], v[176:179]
    v_mul_f32 v248, v82, v248
    v_mul_f32 v249, v82, v249
    v_mul_f32 v250, v82, v250
    v_mfma_f32_16x16x32_bf16 v[180:183], v[32:35], v[40:43], v[180:183]
    v_mul_f32 v251, v82, v251
    v_mul_f32 v200, v200, v216
    v_mul_f32 v201, v201, v217
    v_mfma_f32_16x16x32_bf16 v[184:187], v[32:35], v[44:47], v[184:187]
    v_mul_f32 v202, v202, v218
    v_mul_f32 v203, v203, v219
    v_mul_f32 v232, v232, v248
    v_mfma_f32_16x16x32_bf16 v[188:191], v[32:35], v[48:51], v[188:191]
    v_mul_f32 v233, v233, v249
    v_mul_f32 v234, v234, v250
    v_mul_f32 v235, v235, v251
    s_nop 7
    v_cvt_pk_bf16_f32 v216, v200, v201
    v_cvt_pk_bf16_f32 v217, v202, v203
    v_cvt_pk_bf16_f32 v218, v232, v233
    v_cvt_pk_bf16_f32 v219, v234, v235
    v_max_f32 v204, 0, v204
    v_max_f32 v205, 0, v205
    v_max_f32 v206, 0, v206
    v_max_f32 v207, 0, v207
    v_mul_f32 v220, v84, v220
    v_mul_f32 v221, v84, v221
    v_mul_f32 v222, v84, v222
    v_mul_f32 v223, v84, v223
    v_max_f32 v236, 0, v236
    v_max_f32 v237, 0, v237
    v_max_f32 v238, 0, v238
    v_max_f32 v239, 0, v239
    v_mul_f32 v252, v84, v252
    v_mul_f32 v253, v84, v253
    v_mul_f32 v254, v84, v254
    v_mul_f32 v255, v84, v255
    v_mul_f32 v204, v204, v220
    v_mul_f32 v205, v205, v221
    v_mul_f32 v206, v206, v222
    v_mul_f32 v207, v207, v223
    v_mul_f32 v236, v236, v252
    v_mul_f32 v237, v237, v253
    v_mul_f32 v238, v238, v254
    v_mul_f32 v239, v239, v255
    v_cvt_pk_bf16_f32 v220, v204, v205
    v_cvt_pk_bf16_f32 v221, v206, v207
    v_cvt_pk_bf16_f32 v222, v236, v237
    v_cvt_pk_bf16_f32 v223, v238, v239
    s_and_b32 s52, s2, 7
    s_lshl_b32 s52, s52, 7
    s_lshr_b32 s53, s2, 3
    s_lshl_b32 s53, s53, 2
    s_add_u32 s52, s52, s53
    s_add_u32 s52, s52, 52430848
    s_cmp_eq_u32 s49, 0
    s_cselect_b32 s52, s52, 2147418112
    v_mov_b32 v2, 0
    v_mov_b32 v3, 1
    s_mov_b32 s63, 1879048192
    s_waitcnt vmcnt(0)
    s_barrier
    buffer_store_dword v3, v2, s[32:35], s52 offen sc0 sc1
    v_mul_f32 v76, v89, v89
    v_mul_f32 v78, v91, v91
    v_mul_f32 v82, v93, v93
    v_mul_f32 v84, v95, v95
    v_max_f32 v128, 0, v128
    v_max_f32 v129, 0, v129
    v_max_f32 v130, 0, v130
    v_max_f32 v131, 0, v131
    v_mul_f32 v144, v76, v144
    v_mul_f32 v145, v76, v145
    v_mul_f32 v146, v76, v146
    v_mul_f32 v147, v76, v147
    v_max_f32 v160, 0, v160
    v_max_f32 v161, 0, v161
    v_max_f32 v162, 0, v162
    v_max_f32 v163, 0, v163
    v_mul_f32 v176, v76, v176
    v_mul_f32 v177, v76, v177
    v_mul_f32 v178, v76, v178
    v_mul_f32 v179, v76, v179
    v_mul_f32 v128, v128, v144
    v_mul_f32 v129, v129, v145
    v_mul_f32 v130, v130, v146
    v_mul_f32 v131, v131, v147
    v_mul_f32 v160, v160, v176
    v_mul_f32 v161, v161, v177
    v_mul_f32 v162, v162, v178
    v_mul_f32 v163, v163, v179
    v_cvt_pk_bf16_f32 v196, v128, v129
    v_cvt_pk_bf16_f32 v197, v130, v131
    v_cvt_pk_bf16_f32 v198, v160, v161
    v_cvt_pk_bf16_f32 v199, v162, v163
    v_max_f32 v132, 0, v132
    v_max_f32 v133, 0, v133
    v_max_f32 v134, 0, v134
    v_max_f32 v135, 0, v135
    v_mul_f32 v148, v78, v148
    v_mul_f32 v149, v78, v149
    v_mul_f32 v150, v78, v150
    v_mul_f32 v151, v78, v151
    v_max_f32 v164, 0, v164
    v_max_f32 v165, 0, v165
    v_max_f32 v166, 0, v166
    v_max_f32 v167, 0, v167
    v_mul_f32 v180, v78, v180
    v_mul_f32 v181, v78, v181
    v_mul_f32 v182, v78, v182
    v_mul_f32 v183, v78, v183
    v_mul_f32 v132, v132, v148
    v_mul_f32 v133, v133, v149
    v_mul_f32 v134, v134, v150
    v_mul_f32 v135, v135, v151
    v_mul_f32 v164, v164, v180
    v_mul_f32 v165, v165, v181
    v_mul_f32 v166, v166, v182
    v_mul_f32 v167, v167, v183
    v_cvt_pk_bf16_f32 v200, v132, v133
    v_cvt_pk_bf16_f32 v201, v134, v135
    v_cvt_pk_bf16_f32 v202, v164, v165
    v_cvt_pk_bf16_f32 v203, v166, v167
    v_max_f32 v136, 0, v136
    v_max_f32 v137, 0, v137
    v_max_f32 v138, 0, v138
    v_max_f32 v139, 0, v139
    v_mul_f32 v152, v82, v152
    v_mul_f32 v153, v82, v153
    v_mul_f32 v154, v82, v154
    v_mul_f32 v155, v82, v155
    v_max_f32 v168, 0, v168
    v_max_f32 v169, 0, v169
    v_max_f32 v170, 0, v170
    v_max_f32 v171, 0, v171
    v_mul_f32 v184, v82, v184
    v_mul_f32 v185, v82, v185
    v_mul_f32 v186, v82, v186
    v_mul_f32 v187, v82, v187
    v_mul_f32 v136, v136, v152
    v_mul_f32 v137, v137, v153
    v_mul_f32 v138, v138, v154
    v_mul_f32 v139, v139, v155
    v_mul_f32 v168, v168, v184
    v_mul_f32 v169, v169, v185
    v_mul_f32 v170, v170, v186
    v_mul_f32 v171, v171, v187
    v_cvt_pk_bf16_f32 v204, v136, v137
    v_cvt_pk_bf16_f32 v205, v138, v139
    v_cvt_pk_bf16_f32 v206, v168, v169
    v_cvt_pk_bf16_f32 v207, v170, v171
    v_max_f32 v140, 0, v140
    v_max_f32 v141, 0, v141
    v_max_f32 v142, 0, v142
    v_max_f32 v143, 0, v143
    v_mul_f32 v156, v84, v156
    v_mul_f32 v157, v84, v157
    v_mul_f32 v158, v84, v158
    v_mul_f32 v159, v84, v159
    v_max_f32 v172, 0, v172
    v_max_f32 v173, 0, v173
    v_max_f32 v174, 0, v174
    v_max_f32 v175, 0, v175
    v_mul_f32 v188, v84, v188
    v_mul_f32 v189, v84, v189
    v_mul_f32 v190, v84, v190
    v_mul_f32 v191, v84, v191
    v_mul_f32 v140, v140, v156
    v_mul_f32 v141, v141, v157
    v_mul_f32 v142, v142, v158
    v_mul_f32 v143, v143, v159
    v_mul_f32 v172, v172, v188
    v_mul_f32 v173, v173, v189
    v_mul_f32 v174, v174, v190
    v_mul_f32 v175, v175, v191
    v_cvt_pk_bf16_f32 v224, v140, v141
    v_cvt_pk_bf16_f32 v225, v142, v143
    v_cvt_pk_bf16_f32 v226, v172, v173
    v_cvt_pk_bf16_f32 v227, v174, v175
    s_branch L_g1_fin
L_g1_tAV:
    v_mfma_f32_16x16x32_bf16 v[208:211], v[24:27], v[36:39], v[208:211]
    s_and_b32 s52, s49, 3
    s_lshl_b32 s52, s52, 1
    s_lshl_b32 s53, s48, 3
    s_add_u32 s60, s52, s53
    s_lshl_b32 s61, s60, 11
    s_mul_i32 s62, s60, 229376
    s_add_u32 s62, s62, 16777216
    s_mul_i32 s63, s46, 7
    s_lshl_b32 s64, s46, 1
    s_add_u32 s64, s64, s50
    v_lshrrev_b32 v8, 4, v1
    v_and_b32 v9, 15, v1
    v_lshrrev_b32 v10, 1, v8
    v_mfma_f32_16x16x32_bf16 v[212:215], v[24:27], v[40:43], v[212:215]
    ds_read_b64_tr_b16 v[16:17], v68 offset:20480
    ds_read_b64_tr_b16 v[18:19], v68 offset:20992
    v_and_b32 v11, 1, v8
    v_lshlrev_b32 v12, 4, v9
    v_lshl_add_u32 v12, v11, 9, v12
    v_mfma_f32_16x16x32_bf16 v[216:219], v[24:27], v[44:47], v[216:219]
    v_lshl_add_u32 v2, v10, 10, v12
    v_lshl_add_u32 v3, v10, 8, v12
    s_mov_b32 s56, 0x3e8293ee
    s_mov_b32 s57, s56
    s_mov_b32 s12, s98
    s_mov_b32 s13, s99
    s_mov_b32 s14, 256
    s_mov_b32 s15, 0x20000
    s_cmp_eq_u32 s49, 0
    s_cselect_b32 s39, 0, 2147418112
    v_and_b32 v13, 7, v1
    v_mfma_f32_16x16x32_bf16 v[220:223], v[24:27], v[48:51], v[220:223]
    v_lshlrev_b32 v13, 5, v13
    s_sub_u32 s52, s47, 1
    s_lshl_b32 s53, s52, 1
    s_add_u32 s53, s53, s63
    s_add_u32 s53, s53, s50
    s_add_u32 s53, s53, 1
    s_lshl_b32 s53, s53, 11
    s_add_u32 s65, s53, s62
    s_lshl_b32 s52, s52, 22
    s_add_u32 s52, s52, 4194304
    s_add_u32 s66, s64, 16
    s_lshl_b32 s66, s66, 17
    s_add_u32 s66, s66, s61
    s_add_u32 s66, s66, s52
    s_mov_b32 s62, s65
    s_add_u32 s65, s65, 1024
    s_cmp_eq_u32 s47, 1
    s_cselect_b32 s56, s56, 1.0
    s_mov_b32 s57, s56
    s_mul_i32 s52, s50, 640
    s_add_u32 s52, s52, 147456
    v_lshrrev_b32 v6, 4, v1
    v_and_b32 v7, 15, v1
    v_mfma_f32_16x16x32_bf16 v[224:227], v[28:31], v[36:39], v[224:227]
    v_lshl_add_u32 v74, v6, 4, s52
    v_lshl_add_u32 v12, v7, 2, s52
    s_and_b32 s53, s49, 3
    s_lshl_b32 s53, s53, 9
    s_add_u32 s53, s53, 149504
    v_lshl_add_u32 v75, v6, 4, s53
    v_mfma_f32_16x16x32_bf16 v[228:231], v[28:31], v[40:43], v[228:231]
    ds_read_b64_tr_b16 v[20:21], v69 offset:20480
    ds_read_b64_tr_b16 v[22:23], v69 offset:20992
    v_lshl_add_u32 v87, v7, 2, s53
    ds_read2_b32 v[88:89], v87 offset0:0 offset1:64
    ds_read2_b32 v[90:91], v87 offset0:16 offset1:80
    v_mfma_f32_16x16x32_bf16 v[232:235], v[28:31], v[44:47], v[232:235]
    ds_read2_b32 v[92:93], v87 offset0:32 offset1:96
    ds_read2_b32 v[94:95], v87 offset0:48 offset1:112
    ds_read_b128 v[4:7], v74 offset:128
    v_mfma_f32_16x16x32_bf16 v[236:239], v[28:31], v[48:51], v[236:239]
    ds_read_b128 v[8:11], v74 offset:192
    v_mfma_f32_16x16x32_bf16 v[240:243], v[32:35], v[36:39], v[240:243]
    v_mfma_f32_16x16x32_bf16 v[244:247], v[32:35], v[40:43], v[244:247]
    ds_read_b64_tr_b16 v[24:25], v70 offset:21504
    ds_read_b64_tr_b16 v[26:27], v70 offset:22016
    v_mfma_f32_16x16x32_bf16 v[248:251], v[32:35], v[44:47], v[248:251]
    v_mfma_f32_16x16x32_bf16 v[252:255], v[32:35], v[48:51], v[252:255]
    s_waitcnt lgkmcnt(10)
    v_mfma_f32_16x16x32_bf16 v[96:99], v[52:55], v[16:19], v[96:99]
    v_mfma_f32_16x16x32_bf16 v[100:103], v[56:59], v[16:19], v[100:103]
    ds_read_b64_tr_b16 v[28:29], v70 offset:22528
    ds_read_b64_tr_b16 v[30:31], v70 offset:23040
    v_mfma_f32_16x16x32_bf16 v[104:107], v[60:63], v[16:19], v[104:107]
    v_mfma_f32_16x16x32_bf16 v[108:111], v[64:67], v[16:19], v[108:111]
    s_waitcnt lgkmcnt(10)
    v_mfma_f32_16x16x32_bf16 v[112:115], v[52:55], v[20:23], v[112:115]
    v_mfma_f32_16x16x32_bf16 v[116:119], v[56:59], v[20:23], v[116:119]
    ds_read_b64_tr_b16 v[32:33], v71 offset:21504
    ds_read_b64_tr_b16 v[34:35], v71 offset:22016
    v_mfma_f32_16x16x32_bf16 v[120:123], v[60:63], v[20:23], v[120:123]
    v_mfma_f32_16x16x32_bf16 v[124:127], v[64:67], v[20:23], v[124:127]
    s_waitcnt lgkmcnt(4)
    v_mfma_f32_16x16x32_bf16 v[128:131], v[24:27], v[52:55], v[128:131]
    v_mfma_f32_16x16x32_bf16 v[132:135], v[24:27], v[56:59], v[132:135]
    ds_read_b64_tr_b16 v[16:17], v71 offset:22528
    ds_read_b64_tr_b16 v[18:19], v71 offset:23040
    v_mfma_f32_16x16x32_bf16 v[136:139], v[24:27], v[60:63], v[136:139]
    v_mfma_f32_16x16x32_bf16 v[140:143], v[24:27], v[64:67], v[140:143]
    s_waitcnt lgkmcnt(4)
    v_mfma_f32_16x16x32_bf16 v[144:147], v[28:31], v[52:55], v[144:147]
    v_mfma_f32_16x16x32_bf16 v[148:151], v[28:31], v[56:59], v[148:151]
    ds_read_b64_tr_b16 v[20:21], v72 offset:21504
    ds_read_b64_tr_b16 v[22:23], v72 offset:22016
    v_mfma_f32_16x16x32_bf16 v[152:155], v[28:31], v[60:63], v[152:155]
    v_mfma_f32_16x16x32_bf16 v[156:159], v[28:31], v[64:67], v[156:159]
    s_waitcnt lgkmcnt(4)
    v_mfma_f32_16x16x32_bf16 v[160:163], v[32:35], v[52:55], v[160:163]
    v_fma_f32 v128, -v88, v4, v128
    v_fma_f32 v129, -v88, v5, v129
    v_fma_f32 v130, -v88, v6, v130
    v_fma_f32 v131, -v88, v7, v131
    v_mfma_f32_16x16x32_bf16 v[164:167], v[32:35], v[56:59], v[164:167]
    ds_read_b64_tr_b16 v[24:25], v72 offset:22528
    ds_read_b64_tr_b16 v[26:27], v72 offset:23040
    v_fma_f32 v132, -v90, v4, v132
    v_fma_f32 v133, -v90, v5, v133
    v_fma_f32 v134, -v90, v6, v134
    v_fma_f32 v135, -v90, v7, v135
    v_mfma_f32_16x16x32_bf16 v[168:171], v[32:35], v[60:63], v[168:171]
    v_fma_f32 v136, -v92, v4, v136
    v_fma_f32 v137, -v92, v5, v137
    v_fma_f32 v138, -v92, v6, v138
    v_fma_f32 v139, -v92, v7, v139
    v_mfma_f32_16x16x32_bf16 v[172:175], v[32:35], v[64:67], v[172:175]
    v_fma_f32 v140, -v94, v4, v140
    v_fma_f32 v141, -v94, v5, v141
    v_fma_f32 v142, -v94, v6, v142
    v_fma_f32 v143, -v94, v7, v143
    ds_read_b128 v[4:7], v74 offset:256
    s_waitcnt lgkmcnt(5)
    v_mfma_f32_16x16x32_bf16 v[176:179], v[16:19], v[52:55], v[176:179]
    v_fma_f32 v144, -v88, v8, v144
    v_fma_f32 v145, -v88, v9, v145
    v_fma_f32 v146, -v88, v10, v146
    v_fma_f32 v147, -v88, v11, v147
    v_mfma_f32_16x16x32_bf16 v[180:183], v[16:19], v[56:59], v[180:183]
    ds_read_b64_tr_b16 v[28:29], v73 offset:21504
    ds_read_b64_tr_b16 v[30:31], v73 offset:22016
    v_fma_f32 v148, -v90, v8, v148
    v_fma_f32 v149, -v90, v9, v149
    v_fma_f32 v150, -v90, v10, v150
    v_fma_f32 v151, -v90, v11, v151
    v_mfma_f32_16x16x32_bf16 v[184:187], v[16:19], v[60:63], v[184:187]
    v_fma_f32 v152, -v92, v8, v152
    v_fma_f32 v153, -v92, v9, v153
    v_fma_f32 v154, -v92, v10, v154
    v_fma_f32 v155, -v92, v11, v155
    v_mfma_f32_16x16x32_bf16 v[188:191], v[16:19], v[64:67], v[188:191]
    v_fma_f32 v156, -v94, v8, v156
    v_fma_f32 v157, -v94, v9, v157
    v_fma_f32 v158, -v94, v10, v158
    v_fma_f32 v159, -v94, v11, v159
    ds_read_b128 v[8:11], v74 offset:320
    s_waitcnt lgkmcnt(6)
    v_mfma_f32_16x16x32_bf16 v[192:195], v[20:23], v[52:55], v[192:195]
    s_waitcnt lgkmcnt(3)
    v_fma_f32 v160, -v88, v4, v160
    v_fma_f32 v161, -v88, v5, v161
    v_fma_f32 v162, -v88, v6, v162
    v_fma_f32 v163, -v88, v7, v163
    v_mfma_f32_16x16x32_bf16 v[196:199], v[20:23], v[56:59], v[196:199]
    ds_read_b64_tr_b16 v[32:33], v73 offset:22528
    ds_read_b64_tr_b16 v[34:35], v73 offset:23040
    v_fma_f32 v164, -v90, v4, v164
    v_fma_f32 v165, -v90, v5, v165
    v_fma_f32 v166, -v90, v6, v166
    v_fma_f32 v167, -v90, v7, v167
    v_mfma_f32_16x16x32_bf16 v[200:203], v[20:23], v[60:63], v[200:203]
    v_fma_f32 v168, -v92, v4, v168
    v_fma_f32 v169, -v92, v5, v169
    v_fma_f32 v170, -v92, v6, v170
    v_fma_f32 v171, -v92, v7, v171
    v_mfma_f32_16x16x32_bf16 v[204:207], v[20:23], v[64:67], v[204:207]
    v_fma_f32 v172, -v94, v4, v172
    v_fma_f32 v173, -v94, v5, v173
    v_fma_f32 v174, -v94, v6, v174
    v_fma_f32 v175, -v94, v7, v175
    ds_read_b128 v[4:7], v74 offset:384
    s_waitcnt vmcnt(0)
    s_barrier
    v_mfma_f32_16x16x32_bf16 v[208:211], v[24:27], v[52:55], v[208:211]
    ds_read_b128 v[36:39], v80 offset:32768
    ds_read_b128 v[40:43], v80 offset:34816
    s_waitcnt lgkmcnt(5)
    v_fma_f32 v176, -v88, v8, v176
    v_fma_f32 v177, -v88, v9, v177
    v_fma_f32 v178, -v88, v10, v178
    v_fma_f32 v179, -v88, v11, v179
    v_mfma_f32_16x16x32_bf16 v[212:215], v[24:27], v[56:59], v[212:215]
    ds_read_b64_tr_b16 v[16:17], v68 offset:40960
    ds_read_b64_tr_b16 v[18:19], v68 offset:41472
    v_fma_f32 v180, -v90, v8, v180
    v_fma_f32 v181, -v90, v9, v181
    v_fma_f32 v182, -v90, v10, v182
    v_fma_f32 v183, -v90, v11, v183
    v_mfma_f32_16x16x32_bf16 v[216:219], v[24:27], v[60:63], v[216:219]
    ds_read_b128 v[44:47], v80 offset:36864
    ds_read_b128 v[48:51], v80 offset:38912
    v_fma_f32 v184, -v92, v8, v184
    v_fma_f32 v185, -v92, v9, v185
    v_fma_f32 v186, -v92, v10, v186
    v_fma_f32 v187, -v92, v11, v187
    v_mfma_f32_16x16x32_bf16 v[220:223], v[24:27], v[64:67], v[220:223]
    v_fma_f32 v188, -v94, v8, v188
    v_fma_f32 v189, -v94, v9, v189
    v_fma_f32 v190, -v94, v10, v190
    v_fma_f32 v191, -v94, v11, v191
    ds_read_b128 v[8:11], v74 offset:448
    v_mfma_f32_16x16x32_bf16 v[224:227], v[28:31], v[52:55], v[224:227]
    s_waitcnt lgkmcnt(7)
    v_fma_f32 v192, -v88, v4, v192
    v_fma_f32 v193, -v88, v5, v193
    v_fma_f32 v194, -v88, v6, v194
    v_fma_f32 v195, -v88, v7, v195
    v_mfma_f32_16x16x32_bf16 v[228:231], v[28:31], v[56:59], v[228:231]
    ds_read_b64_tr_b16 v[20:21], v69 offset:40960
    ds_read_b64_tr_b16 v[22:23], v69 offset:41472
    v_fma_f32 v196, -v90, v4, v196
    v_fma_f32 v197, -v90, v5, v197
    v_fma_f32 v198, -v90, v6, v198
    v_fma_f32 v199, -v90, v7, v199
    v_mfma_f32_16x16x32_bf16 v[232:235], v[28:31], v[60:63], v[232:235]
    v_fma_f32 v200, -v92, v4, v200
    v_fma_f32 v201, -v92, v5, v201
    v_fma_f32 v202, -v92, v6, v202
    v_fma_f32 v203, -v92, v7, v203
    v_mfma_f32_16x16x32_bf16 v[236:239], v[28:31], v[64:67], v[236:239]
    v_fma_f32 v204, -v94, v4, v204
    v_fma_f32 v205, -v94, v5, v205
    v_fma_f32 v206, -v94, v6, v206
    v_fma_f32 v207, -v94, v7, v207
    ds_read_b128 v[4:7], v74 offset:512
    v_mfma_f32_16x16x32_bf16 v[240:243], v[32:35], v[52:55], v[240:243]
    s_waitcnt lgkmcnt(3)
    v_fma_f32 v208, -v88, v8, v208
    v_fma_f32 v209, -v88, v9, v209
    v_fma_f32 v210, -v88, v10, v210
    v_fma_f32 v211, -v88, v11, v211
    v_mfma_f32_16x16x32_bf16 v[244:247], v[32:35], v[56:59], v[244:247]
    ds_read_b64_tr_b16 v[24:25], v68 offset:61440
    ds_read_b64_tr_b16 v[26:27], v68 offset:61952
    v_fma_f32 v212, -v90, v8, v212
    v_fma_f32 v213, -v90, v9, v213
    v_fma_f32 v214, -v90, v10, v214
    v_fma_f32 v215, -v90, v11, v215
    v_mfma_f32_16x16x32_bf16 v[248:251], v[32:35], v[60:63], v[248:251]
    v_fma_f32 v216, -v92, v8, v216
    v_fma_f32 v217, -v92, v9, v217
    v_fma_f32 v218, -v92, v10, v218
    v_fma_f32 v219, -v92, v11, v219
    v_mfma_f32_16x16x32_bf16 v[252:255], v[32:35], v[64:67], v[252:255]
    v_fma_f32 v220, -v94, v8, v220
    v_fma_f32 v221, -v94, v9, v221
    v_fma_f32 v222, -v94, v10, v222
    v_fma_f32 v223, -v94, v11, v223
    ds_read_b128 v[8:11], v74 offset:576
    v_mfma_f32_16x16x32_bf16 v[96:99], v[36:39], v[16:19], v[96:99]
    ds_read_b128 v[52:55], v81 offset:32768
    ds_read_b128 v[56:59], v81 offset:34816
    s_waitcnt lgkmcnt(5)
    v_fma_f32 v224, -v88, v4, v224
    v_fma_f32 v225, -v88, v5, v225
    v_fma_f32 v226, -v88, v6, v226
    v_fma_f32 v227, -v88, v7, v227
    v_mfma_f32_16x16x32_bf16 v[100:103], v[40:43], v[16:19], v[100:103]
    ds_read_b64_tr_b16 v[28:29], v69 offset:61440
    ds_read_b64_tr_b16 v[30:31], v69 offset:61952
    v_fma_f32 v228, -v90, v4, v228
    v_fma_f32 v229, -v90, v5, v229
    v_fma_f32 v230, -v90, v6, v230
    v_fma_f32 v231, -v90, v7, v231
    v_mfma_f32_16x16x32_bf16 v[104:107], v[44:47], v[16:19], v[104:107]
    ds_read_b128 v[60:63], v81 offset:36864
    ds_read_b128 v[64:67], v81 offset:38912
    v_fma_f32 v232, -v92, v4, v232
    v_fma_f32 v233, -v92, v5, v233
    v_fma_f32 v234, -v92, v6, v234
    v_fma_f32 v235, -v92, v7, v235
    v_mfma_f32_16x16x32_bf16 v[108:111], v[48:51], v[16:19], v[108:111]
    v_fma_f32 v236, -v94, v4, v236
    v_fma_f32 v237, -v94, v5, v237
    v_fma_f32 v238, -v94, v6, v238
    v_fma_f32 v239, -v94, v7, v239
    v_mfma_f32_16x16x32_bf16 v[112:115], v[36:39], v[20:23], v[112:115]
    s_waitcnt lgkmcnt(6)
    v_fma_f32 v240, -v88, v8, v240
    v_fma_f32 v241, -v88, v9, v241
    v_fma_f32 v242, -v88, v10, v242
    v_fma_f32 v243, -v88, v11, v243
    v_mfma_f32_16x16x32_bf16 v[116:119], v[40:43], v[20:23], v[116:119]
    ds_read_b64_tr_b16 v[32:33], v72 offset:62464
    ds_read_b64_tr_b16 v[34:35], v72 offset:62976
    v_fma_f32 v244, -v90, v8, v244
    v_fma_f32 v245, -v90, v9, v245
    v_fma_f32 v246, -v90, v10, v246
    v_fma_f32 v247, -v90, v11, v247
    v_mfma_f32_16x16x32_bf16 v[120:123], v[44:47], v[20:23], v[120:123]
    v_fma_f32 v248, -v92, v8, v248
    v_fma_f32 v249, -v92, v9, v249
    v_fma_f32 v250, -v92, v10, v250
    v_fma_f32 v251, -v92, v11, v251
    v_mfma_f32_16x16x32_bf16 v[124:127], v[48:51], v[20:23], v[124:127]
    v_fma_f32 v252, -v94, v8, v252
    v_fma_f32 v253, -v94, v9, v253
    v_fma_f32 v254, -v94, v10, v254
    v_fma_f32 v255, -v94, v11, v255
    s_waitcnt lgkmcnt(2)
    v_mfma_f32_16x16x32_bf16 v[96:99], v[52:55], v[24:27], v[96:99]
    buffer_load_dword v14, v13, s[12:15], s39 offen sc0 sc1
    ds_read_b32 v86, v12 offset:64
    ds_read_b32 v12, v12 offset:0
    v_mfma_f32_16x16x32_bf16 v[100:103], v[56:59], v[24:27], v[100:103]
    ds_read_b64_tr_b16 v[16:17], v72 offset:63488
    ds_read_b64_tr_b16 v[18:19], v72 offset:64000
    ds_read_b128 v[4:7], v75 offset:0
    ds_read_b128 v[8:11], v75 offset:256
    ds_read_b128 v[76:79], v75 offset:64
    v_mfma_f32_16x16x32_bf16 v[104:107], v[60:63], v[24:27], v[104:107]
    ds_read_b128 v[82:85], v75 offset:320
    v_mfma_f32_16x16x32_bf16 v[108:111], v[64:67], v[24:27], v[108:111]
    v_mfma_f32_16x16x32_bf16 v[112:115], v[52:55], v[28:31], v[112:115]
    v_mfma_f32_16x16x32_bf16 v[116:119], v[56:59], v[28:31], v[116:119]
    ds_read_b64_tr_b16 v[20:21], v73 offset:62464
    ds_read_b64_tr_b16 v[22:23], v73 offset:62976
    v_mfma_f32_16x16x32_bf16 v[120:123], v[60:63], v[28:31], v[120:123]
    v_mfma_f32_16x16x32_bf16 v[124:127], v[64:67], v[28:31], v[124:127]
    s_waitcnt lgkmcnt(10)
    v_mfma_f32_16x16x32_bf16 v[192:195], v[32:35], v[52:55], v[192:195]
    v_mfma_f32_16x16x32_bf16 v[196:199], v[32:35], v[56:59], v[196:199]
    ds_read_b64_tr_b16 v[24:25], v73 offset:63488
    ds_read_b64_tr_b16 v[26:27], v73 offset:64000
    v_mfma_f32_16x16x32_bf16 v[200:203], v[32:35], v[60:63], v[200:203]
    v_mfma_f32_16x16x32_bf16 v[204:207], v[32:35], v[64:67], v[204:207]
    s_waitcnt lgkmcnt(8)
    v_mfma_f32_16x16x32_bf16 v[208:211], v[16:19], v[52:55], v[208:211]
    s_waitcnt lgkmcnt(6)
    v_fma_f32 v96, -v4, v12, v96
    v_fma_f32 v97, -v5, v12, v97
    v_fma_f32 v98, -v6, v12, v98
    v_mfma_f32_16x16x32_bf16 v[212:215], v[16:19], v[56:59], v[212:215]
    ds_read_b64_tr_b16 v[28:29], v72 offset:41984
    ds_read_b64_tr_b16 v[30:31], v72 offset:42496
    v_fma_f32 v99, -v7, v12, v99
    v_fma_f32 v112, -v4, v86, v112
    v_fma_f32 v113, -v5, v86, v113
    v_mfma_f32_16x16x32_bf16 v[216:219], v[16:19], v[60:63], v[216:219]
    v_fma_f32 v114, -v6, v86, v114
    v_fma_f32 v115, -v7, v86, v115
    v_mul_f32 v96, v8, v96
    v_mfma_f32_16x16x32_bf16 v[220:223], v[16:19], v[64:67], v[220:223]
    v_mul_f32 v97, v9, v97
    v_mul_f32 v98, v10, v98
    v_mul_f32 v99, v11, v99
    s_waitcnt lgkmcnt(4)
    v_mfma_f32_16x16x32_bf16 v[224:227], v[20:23], v[52:55], v[224:227]
    v_mul_f32 v112, v8, v112
    v_mul_f32 v113, v9, v113
    v_mul_f32 v114, v10, v114
    v_mfma_f32_16x16x32_bf16 v[228:231], v[20:23], v[56:59], v[228:231]
    ds_read_b64_tr_b16 v[32:33], v72 offset:43008
    ds_read_b64_tr_b16 v[34:35], v72 offset:43520
    v_mul_f32 v115, v11, v115
    ds_read_b128 v[4:7], v75 offset:128
    ds_read_b128 v[8:11], v75 offset:384
    v_mfma_f32_16x16x32_bf16 v[232:235], v[20:23], v[60:63], v[232:235]
    v_cvt_pk_bf16_f32 v96, v96, v97
    v_cvt_pk_bf16_f32 v97, v98, v99
    v_cvt_pk_bf16_f32 v98, v112, v113
    v_mfma_f32_16x16x32_bf16 v[236:239], v[20:23], v[64:67], v[236:239]
    v_cvt_pk_bf16_f32 v99, v114, v115
    s_nop 1
    v_permlane32_swap_b32 v96, v98
    s_waitcnt lgkmcnt(6)
    v_mfma_f32_16x16x32_bf16 v[240:243], v[24:27], v[52:55], v[240:243]
    v_permlane32_swap_b32 v97, v99
    s_nop 1
    buffer_store_dwordx4 v[96:99], v3, s[32:35], s66 offen offset:0 sc0 sc1
    v_mfma_f32_16x16x32_bf16 v[244:247], v[24:27], v[56:59], v[244:247]
    ds_read_b64_tr_b16 v[16:17], v73 offset:41984
    ds_read_b64_tr_b16 v[18:19], v73 offset:42496
    v_fma_f32 v100, -v76, v12, v100
    v_fma_f32 v101, -v77, v12, v101
    v_fma_f32 v102, -v78, v12, v102
    v_mfma_f32_16x16x32_bf16 v[248:251], v[24:27], v[60:63], v[248:251]
    v_fma_f32 v103, -v79, v12, v103
    v_fma_f32 v116, -v76, v86, v116
    v_fma_f32 v117, -v77, v86, v117
    v_mfma_f32_16x16x32_bf16 v[252:255], v[24:27], v[64:67], v[252:255]
    v_fma_f32 v118, -v78, v86, v118
    v_fma_f32 v119, -v79, v86, v119
    v_mul_f32 v100, v82, v100
    s_waitcnt lgkmcnt(6)
    v_mfma_f32_16x16x32_bf16 v[192:195], v[28:31], v[36:39], v[192:195]
    v_mul_f32 v101, v83, v101
    v_mul_f32 v102, v84, v102
    v_mul_f32 v103, v85, v103
    v_mfma_f32_16x16x32_bf16 v[196:199], v[28:31], v[40:43], v[196:199]
    ds_read_b64_tr_b16 v[20:21], v73 offset:43008
    ds_read_b64_tr_b16 v[22:23], v73 offset:43520
    v_mul_f32 v116, v82, v116
    v_mul_f32 v117, v83, v117
    v_mul_f32 v118, v84, v118
    v_mfma_f32_16x16x32_bf16 v[200:203], v[28:31], v[44:47], v[200:203]
    v_mul_f32 v119, v85, v119
    ds_read_b128 v[76:79], v75 offset:192
    ds_read_b128 v[82:85], v75 offset:448
    v_mfma_f32_16x16x32_bf16 v[204:207], v[28:31], v[48:51], v[204:207]
    v_cvt_pk_bf16_f32 v100, v100, v101
    v_cvt_pk_bf16_f32 v101, v102, v103
    v_cvt_pk_bf16_f32 v102, v116, v117
    s_waitcnt lgkmcnt(8)
    v_mfma_f32_16x16x32_bf16 v[208:211], v[32:35], v[36:39], v[208:211]
    v_cvt_pk_bf16_f32 v103, v118, v119
    s_nop 1
    v_permlane32_swap_b32 v100, v102
    v_mfma_f32_16x16x32_bf16 v[212:215], v[32:35], v[40:43], v[212:215]
    ds_read_b64_tr_b16 v[24:25], v70 offset:62464
    ds_read_b64_tr_b16 v[26:27], v70 offset:62976
    v_permlane32_swap_b32 v101, v103
    s_nop 1
    buffer_store_dwordx4 v[100:103], v3, s[32:35], s66 offen offset:1024 sc0 sc1
    v_mfma_f32_16x16x32_bf16 v[216:219], v[32:35], v[44:47], v[216:219]
    s_waitcnt lgkmcnt(8)
    v_fma_f32 v104, -v4, v12, v104
    v_fma_f32 v105, -v5, v12, v105
    v_fma_f32 v106, -v6, v12, v106
    v_mfma_f32_16x16x32_bf16 v[220:223], v[32:35], v[48:51], v[220:223]
    v_fma_f32 v107, -v7, v12, v107
    v_fma_f32 v120, -v4, v86, v120
    v_fma_f32 v121, -v5, v86, v121
    s_waitcnt lgkmcnt(6)
    v_mfma_f32_16x16x32_bf16 v[224:227], v[16:19], v[36:39], v[224:227]
    v_fma_f32 v122, -v6, v86, v122
    v_fma_f32 v123, -v7, v86, v123
    v_mul_f32 v104, v8, v104
    v_mfma_f32_16x16x32_bf16 v[228:231], v[16:19], v[40:43], v[228:231]
    ds_read_b64_tr_b16 v[28:29], v70 offset:63488
    ds_read_b64_tr_b16 v[30:31], v70 offset:64000
    v_mul_f32 v105, v9, v105
    v_mul_f32 v106, v10, v106
    v_mul_f32 v107, v11, v107
    v_mfma_f32_16x16x32_bf16 v[232:235], v[16:19], v[44:47], v[232:235]
    v_mul_f32 v120, v8, v120
    v_mul_f32 v121, v9, v121
    v_mul_f32 v122, v10, v122
    v_mfma_f32_16x16x32_bf16 v[236:239], v[16:19], v[48:51], v[236:239]
    v_mul_f32 v123, v11, v123
    v_cvt_pk_bf16_f32 v104, v104, v105
    v_cvt_pk_bf16_f32 v105, v106, v107
    s_waitcnt lgkmcnt(6)
    v_mfma_f32_16x16x32_bf16 v[240:243], v[20:23], v[36:39], v[240:243]
    v_cvt_pk_bf16_f32 v106, v120, v121
    v_cvt_pk_bf16_f32 v107, v122, v123
    s_nop 1
    v_mfma_f32_16x16x32_bf16 v[244:247], v[20:23], v[40:43], v[244:247]
    ds_read_b64_tr_b16 v[32:33], v71 offset:62464
    ds_read_b64_tr_b16 v[34:35], v71 offset:62976
    v_permlane32_swap_b32 v104, v106
    v_permlane32_swap_b32 v105, v107
    s_nop 1
    v_mfma_f32_16x16x32_bf16 v[248:251], v[20:23], v[44:47], v[248:251]
    buffer_store_dwordx4 v[104:107], v3, s[32:35], s66 offen offset:2048 sc0 sc1
    s_waitcnt lgkmcnt(6)
    v_fma_f32 v108, -v76, v12, v108
    v_fma_f32 v109, -v77, v12, v109
    v_mfma_f32_16x16x32_bf16 v[252:255], v[20:23], v[48:51], v[252:255]
    v_fma_f32 v110, -v78, v12, v110
    v_fma_f32 v111, -v79, v12, v111
    v_fma_f32 v124, -v76, v86, v124
    s_waitcnt lgkmcnt(4)
    v_mfma_f32_16x16x32_bf16 v[128:131], v[24:27], v[52:55], v[128:131]
    v_fma_f32 v125, -v77, v86, v125
    v_fma_f32 v126, -v78, v86, v126
    v_fma_f32 v127, -v79, v86, v127
    v_mfma_f32_16x16x32_bf16 v[132:135], v[24:27], v[56:59], v[132:135]
    ds_read_b64_tr_b16 v[16:17], v71 offset:63488
    ds_read_b64_tr_b16 v[18:19], v71 offset:64000
    v_mul_f32 v108, v82, v108
    v_mul_f32 v109, v83, v109
    v_mul_f32 v110, v84, v110
    v_mfma_f32_16x16x32_bf16 v[136:139], v[24:27], v[60:63], v[136:139]
    v_mul_f32 v111, v85, v111
    v_mul_f32 v124, v82, v124
    v_mul_f32 v125, v83, v125
    v_mfma_f32_16x16x32_bf16 v[140:143], v[24:27], v[64:67], v[140:143]
    v_mul_f32 v126, v84, v126
    v_mul_f32 v127, v85, v127
    v_cvt_pk_bf16_f32 v108, v108, v109
    s_waitcnt lgkmcnt(4)
    v_mfma_f32_16x16x32_bf16 v[144:147], v[28:31], v[52:55], v[144:147]
    v_cvt_pk_bf16_f32 v109, v110, v111
    v_cvt_pk_bf16_f32 v110, v124, v125
    v_cvt_pk_bf16_f32 v111, v126, v127
    v_mfma_f32_16x16x32_bf16 v[148:151], v[28:31], v[56:59], v[148:151]
    ds_read_b64_tr_b16 v[20:21], v70 offset:41984
    ds_read_b64_tr_b16 v[22:23], v70 offset:42496
    s_nop 1
    v_permlane32_swap_b32 v108, v110
    v_permlane32_swap_b32 v109, v111
    v_mfma_f32_16x16x32_bf16 v[152:155], v[28:31], v[60:63], v[152:155]
    s_nop 1
    buffer_store_dwordx4 v[108:111], v3, s[32:35], s66 offen offset:3072 sc0 sc1
    v_mul_f32 v76, v89, v89
    v_mfma_f32_16x16x32_bf16 v[156:159], v[28:31], v[64:67], v[156:159]
    v_mul_f32 v78, v91, v91
    v_mul_f32 v82, v93, v93
    v_mul_f32 v84, v95, v95
    s_waitcnt lgkmcnt(4)
    v_mfma_f32_16x16x32_bf16 v[160:163], v[32:35], v[52:55], v[160:163]
    v_max_f32 v192, 0, v192
    v_max_f32 v193, 0, v193
    v_max_f32 v194, 0, v194
    v_mfma_f32_16x16x32_bf16 v[164:167], v[32:35], v[56:59], v[164:167]
    ds_read_b64_tr_b16 v[24:25], v70 offset:43008
    ds_read_b64_tr_b16 v[26:27], v70 offset:43520
    v_max_f32 v195, 0, v195
    v_mul_f32 v208, v76, v208
    v_mul_f32 v209, v76, v209
    v_mfma_f32_16x16x32_bf16 v[168:171], v[32:35], v[60:63], v[168:171]
    v_mul_f32 v210, v76, v210
    v_mul_f32 v211, v76, v211
    v_max_f32 v224, 0, v224
    v_mfma_f32_16x16x32_bf16 v[172:175], v[32:35], v[64:67], v[172:175]
    v_max_f32 v225, 0, v225
    v_max_f32 v226, 0, v226
    v_max_f32 v227, 0, v227
    s_waitcnt lgkmcnt(4)
    v_mfma_f32_16x16x32_bf16 v[176:179], v[16:19], v[52:55], v[176:179]
    v_mul_f32 v240, v76, v240
    v_mul_f32 v241, v76, v241
    v_mul_f32 v242, v76, v242
    v_mfma_f32_16x16x32_bf16 v[180:183], v[16:19], v[56:59], v[180:183]
    ds_read_b64_tr_b16 v[28:29], v71 offset:41984
    ds_read_b64_tr_b16 v[30:31], v71 offset:42496
    v_mul_f32 v243, v76, v243
    v_mul_f32 v192, v192, v208
    v_mul_f32 v193, v193, v209
    v_mfma_f32_16x16x32_bf16 v[184:187], v[16:19], v[60:63], v[184:187]
    v_mul_f32 v194, v194, v210
    v_mul_f32 v195, v195, v211
    v_mul_f32 v224, v224, v240
    v_mfma_f32_16x16x32_bf16 v[188:191], v[16:19], v[64:67], v[188:191]
    v_mul_f32 v225, v225, v241
    v_mul_f32 v226, v226, v242
    v_mul_f32 v227, v227, v243
    s_waitcnt lgkmcnt(4)
    v_mfma_f32_16x16x32_bf16 v[128:131], v[20:23], v[36:39], v[128:131]
    v_cvt_pk_bf16_f32 v208, v192, v193
    v_cvt_pk_bf16_f32 v209, v194, v195
    v_cvt_pk_bf16_f32 v210, v224, v225
    v_mfma_f32_16x16x32_bf16 v[132:135], v[20:23], v[40:43], v[132:135]
    ds_read_b64_tr_b16 v[32:33], v71 offset:43008
    ds_read_b64_tr_b16 v[34:35], v71 offset:43520
    v_cvt_pk_bf16_f32 v211, v226, v227
    v_max_f32 v196, 0, v196
    v_max_f32 v197, 0, v197
    v_mfma_f32_16x16x32_bf16 v[136:139], v[20:23], v[44:47], v[136:139]
    v_max_f32 v198, 0, v198
    v_max_f32 v199, 0, v199
    v_mul_f32 v212, v78, v212
    v_mfma_f32_16x16x32_bf16 v[140:143], v[20:23], v[48:51], v[140:143]
    v_mul_f32 v213, v78, v213
    v_mul_f32 v214, v78, v214
    v_mul_f32 v215, v78, v215
    s_waitcnt lgkmcnt(4)
    v_mfma_f32_16x16x32_bf16 v[144:147], v[24:27], v[36:39], v[144:147]
    v_max_f32 v228, 0, v228
    v_max_f32 v229, 0, v229
    v_max_f32 v230, 0, v230
    v_mfma_f32_16x16x32_bf16 v[148:151], v[24:27], v[40:43], v[148:151]
    v_max_f32 v231, 0, v231
    v_mul_f32 v244, v78, v244
    v_mul_f32 v245, v78, v245
    v_mfma_f32_16x16x32_bf16 v[152:155], v[24:27], v[44:47], v[152:155]
    v_mul_f32 v246, v78, v246
    v_mul_f32 v247, v78, v247
    v_mul_f32 v196, v196, v212
    v_mfma_f32_16x16x32_bf16 v[156:159], v[24:27], v[48:51], v[156:159]
    v_mul_f32 v197, v197, v213
    v_mul_f32 v198, v198, v214
    v_mul_f32 v199, v199, v215
    s_waitcnt lgkmcnt(2)
    v_mfma_f32_16x16x32_bf16 v[160:163], v[28:31], v[36:39], v[160:163]
    v_mul_f32 v228, v228, v244
    v_mul_f32 v229, v229, v245
    v_mul_f32 v230, v230, v246
    v_mfma_f32_16x16x32_bf16 v[164:167], v[28:31], v[40:43], v[164:167]
    v_mul_f32 v231, v231, v247
    v_cvt_pk_bf16_f32 v212, v196, v197
    v_cvt_pk_bf16_f32 v213, v198, v199
    v_mfma_f32_16x16x32_bf16 v[168:171], v[28:31], v[44:47], v[168:171]
    v_cvt_pk_bf16_f32 v214, v228, v229
    v_cvt_pk_bf16_f32 v215, v230, v231
    v_max_f32 v200, 0, v200
    v_mfma_f32_16x16x32_bf16 v[172:175], v[28:31], v[48:51], v[172:175]
    v_max_f32 v201, 0, v201
    v_max_f32 v202, 0, v202
    v_max_f32 v203, 0, v203
    s_waitcnt lgkmcnt(0)
    v_mfma_f32_16x16x32_bf16 v[176:179], v[32:35], v[36:39], v[176:179]
    v_mul_f32 v216, v82, v216
    v_mul_f32 v217, v82, v217
    v_mul_f32 v218, v82, v218
    v_mfma_f32_16x16x32_bf16 v[180:183], v[32:35], v[40:43], v[180:183]
    v_mul_f32 v219, v82, v219
    v_max_f32 v232, 0, v232
    v_max_f32 v233, 0, v233
    v_mfma_f32_16x16x32_bf16 v[184:187], v[32:35], v[44:47], v[184:187]
    v_max_f32 v234, 0, v234
    v_max_f32 v235, 0, v235
    v_mul_f32 v248, v82, v248
    v_mfma_f32_16x16x32_bf16 v[188:191], v[32:35], v[48:51], v[188:191]
    v_mul_f32 v249, v82, v249
    v_mul_f32 v250, v82, v250
    v_mul_f32 v251, v82, v251
    s_nop 7
    v_mul_f32 v200, v200, v216
    v_mul_f32 v201, v201, v217
    v_mul_f32 v202, v202, v218
    v_mul_f32 v203, v203, v219
    v_mul_f32 v232, v232, v248
    v_mul_f32 v233, v233, v249
    v_mul_f32 v234, v234, v250
    v_mul_f32 v235, v235, v251
    v_cvt_pk_bf16_f32 v216, v200, v201
    v_cvt_pk_bf16_f32 v217, v202, v203
    v_cvt_pk_bf16_f32 v218, v232, v233
    v_cvt_pk_bf16_f32 v219, v234, v235
    v_max_f32 v204, 0, v204
    v_max_f32 v205, 0, v205
    v_max_f32 v206, 0, v206
    v_max_f32 v207, 0, v207
    v_mul_f32 v220, v84, v220
    v_mul_f32 v221, v84, v221
    v_mul_f32 v222, v84, v222
    v_mul_f32 v223, v84, v223
    v_max_f32 v236, 0, v236
    v_max_f32 v237, 0, v237
    v_max_f32 v238, 0, v238
    v_max_f32 v239, 0, v239
    v_mul_f32 v252, v84, v252
    v_mul_f32 v253, v84, v253
    v_mul_f32 v254, v84, v254
    v_mul_f32 v255, v84, v255
    v_mul_f32 v204, v204, v220
    v_mul_f32 v205, v205, v221
    v_mul_f32 v206, v206, v222
    v_mul_f32 v207, v207, v223
    v_mul_f32 v236, v236, v252
    v_mul_f32 v237, v237, v253
    v_mul_f32 v238, v238, v254
    v_mul_f32 v239, v239, v255
    v_cvt_pk_bf16_f32 v220, v204, v205
    v_cvt_pk_bf16_f32 v221, v206, v207
    v_cvt_pk_bf16_f32 v222, v236, v237
    v_cvt_pk_bf16_f32 v223, v238, v239
    s_and_b32 s52, s2, 7
    s_lshl_b32 s52, s52, 7
    s_lshr_b32 s53, s2, 3
    s_lshl_b32 s53, s53, 2
    s_add_u32 s52, s52, s53
    s_add_u32 s52, s52, 52430848
    s_cmp_eq_u32 s49, 0
    s_cselect_b32 s52, s52, 2147418112
    v_mov_b32 v2, 0
    v_mov_b32 v3, 1
    s_mov_b32 s63, 1879048192
    s_waitcnt vmcnt(0)
    s_barrier
    buffer_store_dword v3, v2, s[32:35], s52 offen sc0 sc1
    v_mul_f32 v76, v89, v89
    v_mul_f32 v78, v91, v91
    v_mul_f32 v82, v93, v93
    v_mul_f32 v84, v95, v95
    v_max_f32 v128, 0, v128
    v_max_f32 v129, 0, v129
    v_max_f32 v130, 0, v130
    v_max_f32 v131, 0, v131
    v_mul_f32 v144, v76, v144
    v_mul_f32 v145, v76, v145
    v_mul_f32 v146, v76, v146
    v_mul_f32 v147, v76, v147
    v_max_f32 v160, 0, v160
    v_max_f32 v161, 0, v161
    v_max_f32 v162, 0, v162
    v_max_f32 v163, 0, v163
    v_mul_f32 v176, v76, v176
    v_mul_f32 v177, v76, v177
    v_mul_f32 v178, v76, v178
    v_mul_f32 v179, v76, v179
    v_mul_f32 v128, v128, v144
    v_mul_f32 v129, v129, v145
    v_mul_f32 v130, v130, v146
    v_mul_f32 v131, v131, v147
    v_mul_f32 v160, v160, v176
    v_mul_f32 v161, v161, v177
    v_mul_f32 v162, v162, v178
    v_mul_f32 v163, v163, v179
    v_cvt_pk_bf16_f32 v196, v128, v129
    v_cvt_pk_bf16_f32 v197, v130, v131
    v_cvt_pk_bf16_f32 v198, v160, v161
    v_cvt_pk_bf16_f32 v199, v162, v163
    v_max_f32 v132, 0, v132
    v_max_f32 v133, 0, v133
    v_max_f32 v134, 0, v134
    v_max_f32 v135, 0, v135
    v_mul_f32 v148, v78, v148
    v_mul_f32 v149, v78, v149
    v_mul_f32 v150, v78, v150
    v_mul_f32 v151, v78, v151
    v_max_f32 v164, 0, v164
    v_max_f32 v165, 0, v165
    v_max_f32 v166, 0, v166
    v_max_f32 v167, 0, v167
    v_mul_f32 v180, v78, v180
    v_mul_f32 v181, v78, v181
    v_mul_f32 v182, v78, v182
    v_mul_f32 v183, v78, v183
    v_mul_f32 v132, v132, v148
    v_mul_f32 v133, v133, v149
    v_mul_f32 v134, v134, v150
    v_mul_f32 v135, v135, v151
    v_mul_f32 v164, v164, v180
    v_mul_f32 v165, v165, v181
    v_mul_f32 v166, v166, v182
    v_mul_f32 v167, v167, v183
    v_cvt_pk_bf16_f32 v200, v132, v133
    v_cvt_pk_bf16_f32 v201, v134, v135
    v_cvt_pk_bf16_f32 v202, v164, v165
    v_cvt_pk_bf16_f32 v203, v166, v167
    v_max_f32 v136, 0, v136
    v_max_f32 v137, 0, v137
    v_max_f32 v138, 0, v138
    v_max_f32 v139, 0, v139
    v_mul_f32 v152, v82, v152
    v_mul_f32 v153, v82, v153
    v_mul_f32 v154, v82, v154
    v_mul_f32 v155, v82, v155
    v_max_f32 v168, 0, v168
    v_max_f32 v169, 0, v169
    v_max_f32 v170, 0, v170
    v_max_f32 v171, 0, v171
    v_mul_f32 v184, v82, v184
    v_mul_f32 v185, v82, v185
    v_mul_f32 v186, v82, v186
    v_mul_f32 v187, v82, v187
    v_mul_f32 v136, v136, v152
    v_mul_f32 v137, v137, v153
    v_mul_f32 v138, v138, v154
    v_mul_f32 v139, v139, v155
    v_mul_f32 v168, v168, v184
    v_mul_f32 v169, v169, v185
    v_mul_f32 v170, v170, v186
    v_mul_f32 v171, v171, v187
    v_cvt_pk_bf16_f32 v204, v136, v137
    v_cvt_pk_bf16_f32 v205, v138, v139
    v_cvt_pk_bf16_f32 v206, v168, v169
    v_cvt_pk_bf16_f32 v207, v170, v171
    v_max_f32 v140, 0, v140
    v_max_f32 v141, 0, v141
    v_max_f32 v142, 0, v142
    v_max_f32 v143, 0, v143
    v_mul_f32 v156, v84, v156
    v_mul_f32 v157, v84, v157
    v_mul_f32 v158, v84, v158
    v_mul_f32 v159, v84, v159
    v_max_f32 v172, 0, v172
    v_max_f32 v173, 0, v173
    v_max_f32 v174, 0, v174
    v_max_f32 v175, 0, v175
    v_mul_f32 v188, v84, v188
    v_mul_f32 v189, v84, v189
    v_mul_f32 v190, v84, v190
    v_mul_f32 v191, v84, v191
    v_mul_f32 v140, v140, v156
    v_mul_f32 v141, v141, v157
    v_mul_f32 v142, v142, v158
    v_mul_f32 v143, v143, v159
    v_mul_f32 v172, v172, v188
    v_mul_f32 v173, v173, v189
    v_mul_f32 v174, v174, v190
    v_mul_f32 v175, v175, v191
    v_cvt_pk_bf16_f32 v224, v140, v141
    v_cvt_pk_bf16_f32 v225, v142, v143
    v_cvt_pk_bf16_f32 v226, v172, v173
    v_cvt_pk_bf16_f32 v227, v174, v175
    s_branch L_g1_fin
L_g1_tB:
    v_mfma_f32_16x16x32_bf16 v[208:211], v[24:27], v[36:39], v[208:211]
    s_and_b32 s52, s49, 3
    s_lshl_b32 s52, s52, 1
    s_lshl_b32 s53, s48, 3
    s_add_u32 s60, s52, s53
    s_lshl_b32 s61, s60, 11
    s_mul_i32 s62, s60, 229376
    s_add_u32 s62, s62, 16777216
    s_mul_i32 s63, s46, 7
    s_lshl_b32 s64, s46, 1
    s_add_u32 s64, s64, s50
    v_lshrrev_b32 v8, 4, v1
    v_and_b32 v9, 15, v1
    v_lshrrev_b32 v10, 1, v8
    v_mfma_f32_16x16x32_bf16 v[212:215], v[24:27], v[40:43], v[212:215]
    ds_read_b64_tr_b16 v[16:17], v68 offset:20480
    ds_read_b64_tr_b16 v[18:19], v68 offset:20992
    v_and_b32 v11, 1, v8
    v_lshlrev_b32 v12, 4, v9
    v_lshl_add_u32 v12, v11, 9, v12
    v_mfma_f32_16x16x32_bf16 v[216:219], v[24:27], v[44:47], v[216:219]
    v_lshl_add_u32 v2, v10, 10, v12
    v_lshl_add_u32 v3, v10, 8, v12
    s_mov_b32 s56, 0x3e8293ee
    s_mov_b32 s57, s56
    s_mov_b32 s12, s98
    s_mov_b32 s13, s99
    s_mov_b32 s14, 256
    s_mov_b32 s15, 0x20000
    s_cmp_eq_u32 s49, 0
    s_cselect_b32 s39, 0, 2147418112
    v_and_b32 v13, 7, v1
    v_mfma_f32_16x16x32_bf16 v[220:223], v[24:27], v[48:51], v[220:223]
    v_lshlrev_b32 v13, 5, v13
    s_lshl_b32 s53, s63, 1
    s_add_u32 s53, s53, s50
    s_lshl_b32 s53, s53, 10
    s_add_u32 s65, s53, s62
    s_mov_b32 s62, 1879048192
    s_add_u32 s66, s64, 0
    s_lshl_b32 s66, s66, 17
    s_add_u32 s66, s66, s61
    s_add_u32 s66, s66, 12582912
    s_add_u32 s67, s64, 0
    s_lshl_b32 s67, s67, 17
    s_add_u32 s67, s67, s61
    s_add_u32 s67, s67, 4194304
    s_add_u32 s58, s64, 0
    s_lshl_b32 s58, s58, 17
    s_add_u32 s58, s58, s61
    s_add_u32 s58, s58, 8388608
    s_mul_i32 s52, s50, 640
    s_add_u32 s52, s52, 147456
    v_lshrrev_b32 v6, 4, v1
    v_and_b32 v7, 15, v1
    v_mfma_f32_16x16x32_bf16 v[224:227], v[28:31], v[36:39], v[224:227]
    v_lshl_add_u32 v74, v6, 4, s52
    v_lshl_add_u32 v12, v7, 2, s52
    s_and_b32 s53, s49, 3
    s_lshl_b32 s53, s53, 9
    s_add_u32 s53, s53, 149504
    v_lshl_add_u32 v75, v6, 4, s53
    v_mfma_f32_16x16x32_bf16 v[228:231], v[28:31], v[40:43], v[228:231]
    ds_read_b64_tr_b16 v[20:21], v69 offset:20480
    ds_read_b64_tr_b16 v[22:23], v69 offset:20992
    v_lshl_add_u32 v87, v7, 2, s53
    ds_read2_b32 v[88:89], v87 offset0:0 offset1:64
    ds_read2_b32 v[90:91], v87 offset0:16 offset1:80
    v_mfma_f32_16x16x32_bf16 v[232:235], v[28:31], v[44:47], v[232:235]
    ds_read2_b32 v[92:93], v87 offset0:32 offset1:96
    ds_read2_b32 v[94:95], v87 offset0:48 offset1:112
    ds_read_b128 v[4:7], v74 offset:384
    v_mfma_f32_16x16x32_bf16 v[236:239], v[28:31], v[48:51], v[236:239]
    ds_read_b128 v[8:11], v74 offset:448
    v_mfma_f32_16x16x32_bf16 v[240:243], v[32:35], v[36:39], v[240:243]
    v_mfma_f32_16x16x32_bf16 v[244:247], v[32:35], v[40:43], v[244:247]
    ds_read_b64_tr_b16 v[24:25], v70 offset:21504
    ds_read_b64_tr_b16 v[26:27], v70 offset:22016
    v_mfma_f32_16x16x32_bf16 v[248:251], v[32:35], v[44:47], v[248:251]
    v_mfma_f32_16x16x32_bf16 v[252:255], v[32:35], v[48:51], v[252:255]
    s_waitcnt lgkmcnt(10)
    v_mfma_f32_16x16x32_bf16 v[96:99], v[52:55], v[16:19], v[96:99]
    s_waitcnt lgkmcnt(3)
    v_fma_f32 v192, -v88, v4, v192
    v_fma_f32 v193, -v88, v5, v193
    v_fma_f32 v194, -v88, v6, v194
    v_fma_f32 v195, -v88, v7, v195
    v_mfma_f32_16x16x32_bf16 v[100:103], v[56:59], v[16:19], v[100:103]
    ds_read_b64_tr_b16 v[28:29], v70 offset:22528
    ds_read_b64_tr_b16 v[30:31], v70 offset:23040
    v_fma_f32 v196, -v90, v4, v196
    v_fma_f32 v197, -v90, v5, v197
    v_fma_f32 v198, -v90, v6, v198
    v_fma_f32 v199, -v90, v7, v199
    v_mfma_f32_16x16x32_bf16 v[104:107], v[60:63], v[16:19], v[104:107]
    v_fma_f32 v200, -v92, v4, v200
    v_fma_f32 v201, -v92, v5, v201
    v_fma_f32 v202, -v92, v6, v202
    v_fma_f32 v203, -v92, v7, v203
    v_mfma_f32_16x16x32_bf16 v[108:111], v[64:67], v[16:19], v[108:111]
    v_fma_f32 v204, -v94, v4, v204
    v_fma_f32 v205, -v94, v5, v205
    v_fma_f32 v206, -v94, v6, v206
    v_fma_f32 v207, -v94, v7, v207
    ds_read_b128 v[4:7], v74 offset:512
    v_mfma_f32_16x16x32_bf16 v[112:115], v[52:55], v[20:23], v[112:115]
    s_waitcnt lgkmcnt(5)
    v_fma_f32 v208, -v88, v8, v208
    v_fma_f32 v209, -v88, v9, v209
    v_fma_f32 v210, -v88, v10, v210
    v_fma_f32 v211, -v88, v11, v211
    v_mfma_f32_16x16x32_bf16 v[116:119], v[56:59], v[20:23], v[116:119]
    ds_read_b64_tr_b16 v[32:33], v71 offset:21504
    ds_read_b64_tr_b16 v[34:35], v71 offset:22016
    v_fma_f32 v212, -v90, v8, v212
    v_fma_f32 v213, -v90, v9, v213
    v_fma_f32 v214, -v90, v10, v214
    v_fma_f32 v215, -v90, v11, v215
    v_mfma_f32_16x16x32_bf16 v[120:123], v[60:63], v[20:23], v[120:123]
    v_fma_f32 v216, -v92, v8, v216
    v_fma_f32 v217, -v92, v9, v217
    v_fma_f32 v218, -v92, v10, v218
    v_fma_f32 v219, -v92, v11, v219
    v_mfma_f32_16x16x32_bf16 v[124:127], v[64:67], v[20:23], v[124:127]
    v_fma_f32 v220, -v94, v8, v220
    v_fma_f32 v221, -v94, v9, v221
    v_fma_f32 v222, -v94, v10, v222
    v_fma_f32 v223, -v94, v11, v223
    ds_read_b128 v[8:11], v74 offset:576
    s_waitcnt lgkmcnt(6)
    v_mfma_f32_16x16x32_bf16 v[128:131], v[24:27], v[52:55], v[128:131]
    s_waitcnt lgkmcnt(3)
    v_fma_f32 v224, -v88, v4, v224
    v_fma_f32 v225, -v88, v5, v225
    v_fma_f32 v226, -v88, v6, v226
    v_fma_f32 v227, -v88, v7, v227
    v_mfma_f32_16x16x32_bf16 v[132:135], v[24:27], v[56:59], v[132:135]
    ds_read_b64_tr_b16 v[16:17], v71 offset:22528
    ds_read_b64_tr_b16 v[18:19], v71 offset:23040
    v_fma_f32 v228, -v90, v4, v228
    v_fma_f32 v229, -v90, v5, v229
    v_fma_f32 v230, -v90, v6, v230
    v_fma_f32 v231, -v90, v7, v231
    v_mfma_f32_16x16x32_bf16 v[136:139], v[24:27], v[60:63], v[136:139]
    v_fma_f32 v232, -v92, v4, v232
    v_fma_f32 v233, -v92, v5, v233
    v_fma_f32 v234, -v92, v6, v234
    v_fma_f32 v235, -v92, v7, v235
    v_mfma_f32_16x16x32_bf16 v[140:143], v[24:27], v[64:67], v[140:143]
    v_fma_f32 v236, -v94, v4, v236
    v_fma_f32 v237, -v94, v5, v237
    v_fma_f32 v238, -v94, v6, v238
    v_fma_f32 v239, -v94, v7, v239
    ds_read_b128 v[4:7], v74 offset:128
    s_cmp_eq_u32 s50, 0
    s_cbranch_scc1 L_g1_sx_77
    s_waitcnt vmcnt(0)
L_g1_sx_77:
    s_waitcnt vmcnt(5)
    s_barrier
    v_mfma_f32_16x16x32_bf16 v[144:147], v[28:31], v[52:55], v[144:147]
    ds_read_b128 v[36:39], v80 offset:32768
    ds_read_b128 v[40:43], v80 offset:34816
    s_waitcnt lgkmcnt(5)
    v_fma_f32 v240, -v88, v8, v240
    v_fma_f32 v241, -v88, v9, v241
    v_fma_f32 v242, -v88, v10, v242
    v_fma_f32 v243, -v88, v11, v243
    v_mfma_f32_16x16x32_bf16 v[148:151], v[28:31], v[56:59], v[148:151]
    ds_read_b64_tr_b16 v[20:21], v68 offset:40960
    ds_read_b64_tr_b16 v[22:23], v68 offset:41472
    v_fma_f32 v244, -v90, v8, v244
    v_fma_f32 v245, -v90, v9, v245
    v_fma_f32 v246, -v90, v10, v246
    v_fma_f32 v247, -v90, v11, v247
    v_mfma_f32_16x16x32_bf16 v[152:155], v[28:31], v[60:63], v[152:155]
    ds_read_b128 v[44:47], v80 offset:36864
    ds_read_b128 v[48:51], v80 offset:38912
    v_fma_f32 v248, -v92, v8, v248
    v_fma_f32 v249, -v92, v9, v249
    v_fma_f32 v250, -v92, v10, v250
    v_fma_f32 v251, -v92, v11, v251
    v_mfma_f32_16x16x32_bf16 v[156:159], v[28:31], v[64:67], v[156:159]
    v_fma_f32 v252, -v94, v8, v252
    v_fma_f32 v253, -v94, v9, v253
    v_fma_f32 v254, -v94, v10, v254
    v_fma_f32 v255, -v94, v11, v255
    ds_read_b128 v[8:11], v74 offset:192
    v_mfma_f32_16x16x32_bf16 v[160:163], v[32:35], v[52:55], v[160:163]
    s_waitcnt lgkmcnt(7)
    v_fma_f32 v128, -v88, v4, v128
    v_fma_f32 v129, -v88, v5, v129
    v_fma_f32 v130, -v88, v6, v130
    v_fma_f32 v131, -v88, v7, v131
    v_mfma_f32_16x16x32_bf16 v[164:167], v[32:35], v[56:59], v[164:167]
    ds_read_b64_tr_b16 v[24:25], v69 offset:40960
    ds_read_b64_tr_b16 v[26:27], v69 offset:41472
    v_fma_f32 v132, -v90, v4, v132
    v_fma_f32 v133, -v90, v5, v133
    v_fma_f32 v134, -v90, v6, v134
    v_fma_f32 v135, -v90, v7, v135
    v_mfma_f32_16x16x32_bf16 v[168:171], v[32:35], v[60:63], v[168:171]
    v_fma_f32 v136, -v92, v4, v136
    v_fma_f32 v137, -v92, v5, v137
    v_fma_f32 v138, -v92, v6, v138
    v_fma_f32 v139, -v92, v7, v139
    v_mfma_f32_16x16x32_bf16 v[172:175], v[32:35], v[64:67], v[172:175]
    v_fma_f32 v140, -v94, v4, v140
    v_fma_f32 v141, -v94, v5, v141
    v_fma_f32 v142, -v94, v6, v142
    v_fma_f32 v143, -v94, v7, v143
    ds_read_b128 v[4:7], v74 offset:256
    v_mfma_f32_16x16x32_bf16 v[176:179], v[16:19], v[52:55], v[176:179]
    s_waitcnt lgkmcnt(3)
    v_fma_f32 v144, -v88, v8, v144
    v_fma_f32 v145, -v88, v9, v145
    v_fma_f32 v146, -v88, v10, v146
    v_fma_f32 v147, -v88, v11, v147
    v_mfma_f32_16x16x32_bf16 v[180:183], v[16:19], v[56:59], v[180:183]
    ds_read_b64_tr_b16 v[28:29], v70 offset:41984
    ds_read_b64_tr_b16 v[30:31], v70 offset:42496
    v_fma_f32 v148, -v90, v8, v148
    v_fma_f32 v149, -v90, v9, v149
    v_fma_f32 v150, -v90, v10, v150
    v_fma_f32 v151, -v90, v11, v151
    v_mfma_f32_16x16x32_bf16 v[184:187], v[16:19], v[60:63], v[184:187]
    v_fma_f32 v152, -v92, v8, v152
    v_fma_f32 v153, -v92, v9, v153
    v_fma_f32 v154, -v92, v10, v154
    v_fma_f32 v155, -v92, v11, v155
    v_mfma_f32_16x16x32_bf16 v[188:191], v[16:19], v[64:67], v[188:191]
    v_fma_f32 v156, -v94, v8, v156
    v_fma_f32 v157, -v94, v9, v157
    v_fma_f32 v158, -v94, v10, v158
    v_fma_f32 v159, -v94, v11, v159
    ds_read_b128 v[8:11], v74 offset:320
    v_mfma_f32_16x16x32_bf16 v[96:99], v[36:39], v[20:23], v[96:99]
    s_waitcnt lgkmcnt(3)
    v_fma_f32 v160, -v88, v4, v160
    v_fma_f32 v161, -v88, v5, v161
    v_fma_f32 v162, -v88, v6, v162
    v_fma_f32 v163, -v88, v7, v163
    v_mfma_f32_16x16x32_bf16 v[100:103], v[40:43], v[20:23], v[100:103]
    ds_read_b64_tr_b16 v[32:33], v70 offset:43008
    ds_read_b64_tr_b16 v[34:35], v70 offset:43520
    v_fma_f32 v164, -v90, v4, v164
    v_fma_f32 v165, -v90, v5, v165
    v_fma_f32 v166, -v90, v6, v166
    v_fma_f32 v167, -v90, v7, v167
    v_mfma_f32_16x16x32_bf16 v[104:107], v[44:47], v[20:23], v[104:107]
    v_fma_f32 v168, -v92, v4, v168
    v_fma_f32 v169, -v92, v5, v169
    v_fma_f32 v170, -v92, v6, v170
    v_fma_f32 v171, -v92, v7, v171
    v_mfma_f32_16x16x32_bf16 v[108:111], v[48:51], v[20:23], v[108:111]
    v_fma_f32 v172, -v94, v4, v172
    v_fma_f32 v173, -v94, v5, v173
    v_fma_f32 v174, -v94, v6, v174
    v_fma_f32 v175, -v94, v7, v175
    v_mfma_f32_16x16x32_bf16 v[112:115], v[36:39], v[24:27], v[112:115]
    s_waitcnt lgkmcnt(2)
    v_fma_f32 v176, -v88, v8, v176
    v_fma_f32 v177, -v88, v9, v177
    v_fma_f32 v178, -v88, v10, v178
    v_fma_f32 v179, -v88, v11, v179
    v_mfma_f32_16x16x32_bf16 v[116:119], v[40:43], v[24:27], v[116:119]
    ds_read_b64_tr_b16 v[16:17], v71 offset:41984
    ds_read_b64_tr_b16 v[18:19], v71 offset:42496
    v_fma_f32 v180, -v90, v8, v180
    v_fma_f32 v181, -v90, v9, v181
    v_fma_f32 v182, -v90, v10, v182
    v_fma_f32 v183, -v90, v11, v183
    v_mfma_f32_16x16x32_bf16 v[120:123], v[44:47], v[24:27], v[120:123]
    v_fma_f32 v184, -v92, v8, v184
    v_fma_f32 v185, -v92, v9, v185
    v_fma_f32 v186, -v92, v10, v186
    v_fma_f32 v187, -v92, v11, v187
    v_mfma_f32_16x16x32_bf16 v[124:127], v[48:51], v[24:27], v[124:127]
    v_fma_f32 v188, -v94, v8, v188
    v_fma_f32 v189, -v94, v9, v189
    v_fma_f32 v190, -v94, v10, v190
    v_fma_f32 v191, -v94, v11, v191
    v_mfma_f32_16x16x32_bf16 v[128:131], v[28:31], v[36:39], v[128:131]
    v_mfma_f32_16x16x32_bf16 v[132:135], v[28:31], v[40:43], v[132:135]
    ds_read_b64_tr_b16 v[20:21], v71 offset:43008
    ds_read_b64_tr_b16 v[22:23], v71 offset:43520
    v_mfma_f32_16x16x32_bf16 v[136:139], v[28:31], v[44:47], v[136:139]
    v_mfma_f32_16x16x32_bf16 v[140:143], v[28:31], v[48:51], v[140:143]
    s_waitcnt vmcnt(0)
    s_barrier
    s_waitcnt lgkmcnt(4)
    v_mfma_f32_16x16x32_bf16 v[144:147], v[32:35], v[36:39], v[144:147]
    ds_read_b128 v[52:55], v81 offset:32768
    ds_read_b128 v[56:59], v81 offset:34816
    buffer_load_dword v14, v13, s[12:15], s39 offen sc0 sc1
    v_mfma_f32_16x16x32_bf16 v[148:151], v[32:35], v[40:43], v[148:151]
    ds_read_b64_tr_b16 v[24:25], v68 offset:61440
    ds_read_b64_tr_b16 v[26:27], v68 offset:61952
    v_mfma_f32_16x16x32_bf16 v[152:155], v[32:35], v[44:47], v[152:155]
    ds_read_b128 v[60:63], v81 offset:36864
    ds_read_b128 v[64:67], v81 offset:38912
    v_mfma_f32_16x16x32_bf16 v[156:159], v[32:35], v[48:51], v[156:159]
    s_waitcnt lgkmcnt(8)
    v_mfma_f32_16x16x32_bf16 v[160:163], v[16:19], v[36:39], v[160:163]
    v_mfma_f32_16x16x32_bf16 v[164:167], v[16:19], v[40:43], v[164:167]
    ds_read_b64_tr_b16 v[28:29], v69 offset:61440
    ds_read_b64_tr_b16 v[30:31], v69 offset:61952
    v_mfma_f32_16x16x32_bf16 v[168:171], v[16:19], v[44:47], v[168:171]
    v_mfma_f32_16x16x32_bf16 v[172:175], v[16:19], v[48:51], v[172:175]
    s_waitcnt lgkmcnt(8)
    v_mfma_f32_16x16x32_bf16 v[176:179], v[20:23], v[36:39], v[176:179]
    v_mfma_f32_16x16x32_bf16 v[180:183], v[20:23], v[40:43], v[180:183]
    ds_read_b64_tr_b16 v[32:33], v70 offset:62464
    ds_read_b64_tr_b16 v[34:35], v70 offset:62976
    v_mfma_f32_16x16x32_bf16 v[184:187], v[20:23], v[44:47], v[184:187]
    v_mfma_f32_16x16x32_bf16 v[188:191], v[20:23], v[48:51], v[188:191]
    s_waitcnt lgkmcnt(4)
    v_mfma_f32_16x16x32_bf16 v[96:99], v[52:55], v[24:27], v[96:99]
    ds_read_b32 v86, v12 offset:64
    ds_read_b32 v12, v12 offset:0
    ds_read_b128 v[4:7], v75 offset:0
    v_mfma_f32_16x16x32_bf16 v[100:103], v[56:59], v[24:27], v[100:103]
    ds_read_b64_tr_b16 v[16:17], v70 offset:63488
    ds_read_b64_tr_b16 v[18:19], v70 offset:64000
    ds_read_b128 v[8:11], v75 offset:256
    ds_read_b128 v[76:79], v75 offset:64
    ds_read_b128 v[82:85], v75 offset:320
    v_mfma_f32_16x16x32_bf16 v[104:107], v[60:63], v[24:27], v[104:107]
    v_mfma_f32_16x16x32_bf16 v[108:111], v[64:67], v[24:27], v[108:111]
    s_waitcnt lgkmcnt(10)
    v_mfma_f32_16x16x32_bf16 v[112:115], v[52:55], v[28:31], v[112:115]
    v_mfma_f32_16x16x32_bf16 v[116:119], v[56:59], v[28:31], v[116:119]
    ds_read_b64_tr_b16 v[20:21], v71 offset:62464
    ds_read_b64_tr_b16 v[22:23], v71 offset:62976
    v_mfma_f32_16x16x32_bf16 v[120:123], v[60:63], v[28:31], v[120:123]
    v_mfma_f32_16x16x32_bf16 v[124:127], v[64:67], v[28:31], v[124:127]
    s_waitcnt lgkmcnt(10)
    v_mfma_f32_16x16x32_bf16 v[128:131], v[32:35], v[52:55], v[128:131]
    v_mfma_f32_16x16x32_bf16 v[132:135], v[32:35], v[56:59], v[132:135]
    ds_read_b64_tr_b16 v[24:25], v71 offset:63488
    ds_read_b64_tr_b16 v[26:27], v71 offset:64000
    v_mfma_f32_16x16x32_bf16 v[136:139], v[32:35], v[60:63], v[136:139]
    v_mfma_f32_16x16x32_bf16 v[140:143], v[32:35], v[64:67], v[140:143]
    s_waitcnt lgkmcnt(7)
    v_mfma_f32_16x16x32_bf16 v[144:147], v[16:19], v[52:55], v[144:147]
    s_waitcnt lgkmcnt(6)
    v_fma_f32 v96, -v4, v12, v96
    v_fma_f32 v97, -v5, v12, v97
    v_fma_f32 v98, -v6, v12, v98
    v_mfma_f32_16x16x32_bf16 v[148:151], v[16:19], v[56:59], v[148:151]
    ds_read_b64_tr_b16 v[28:29], v72 offset:62464
    ds_read_b64_tr_b16 v[30:31], v72 offset:62976
    v_fma_f32 v99, -v7, v12, v99
    v_fma_f32 v112, -v4, v86, v112
    v_fma_f32 v113, -v5, v86, v113
    v_mfma_f32_16x16x32_bf16 v[152:155], v[16:19], v[60:63], v[152:155]
    v_fma_f32 v114, -v6, v86, v114
    v_fma_f32 v115, -v7, v86, v115
    v_mul_f32 v96, v8, v96
    v_mfma_f32_16x16x32_bf16 v[156:159], v[16:19], v[64:67], v[156:159]
    v_mul_f32 v97, v9, v97
    v_mul_f32 v98, v10, v98
    v_mul_f32 v99, v11, v99
    s_waitcnt lgkmcnt(4)
    v_mfma_f32_16x16x32_bf16 v[160:163], v[20:23], v[52:55], v[160:163]
    v_mul_f32 v112, v8, v112
    v_mul_f32 v113, v9, v113
    v_mul_f32 v114, v10, v114
    v_mfma_f32_16x16x32_bf16 v[164:167], v[20:23], v[56:59], v[164:167]
    ds_read_b64_tr_b16 v[32:33], v72 offset:63488
    ds_read_b64_tr_b16 v[34:35], v72 offset:64000
    v_mul_f32 v115, v11, v115
    ds_read_b128 v[4:7], v75 offset:128
    ds_read_b128 v[8:11], v75 offset:384
    v_mfma_f32_16x16x32_bf16 v[168:171], v[20:23], v[60:63], v[168:171]
    v_cvt_pk_bf16_f32 v96, v96, v97
    v_cvt_pk_bf16_f32 v97, v98, v99
    v_cvt_pk_bf16_f32 v98, v112, v113
    v_mfma_f32_16x16x32_bf16 v[172:175], v[20:23], v[64:67], v[172:175]
    v_cvt_pk_bf16_f32 v99, v114, v115
    s_nop 1
    v_permlane32_swap_b32 v96, v98
    s_waitcnt lgkmcnt(6)
    v_mfma_f32_16x16x32_bf16 v[176:179], v[24:27], v[52:55], v[176:179]
    v_permlane32_swap_b32 v97, v99
    s_nop 1
    buffer_store_dwordx4 v[96:99], v3, s[32:35], s66 offen offset:0 sc0 sc1
    v_mfma_f32_16x16x32_bf16 v[180:183], v[24:27], v[56:59], v[180:183]
    ds_read_b64_tr_b16 v[16:17], v73 offset:62464
    ds_read_b64_tr_b16 v[18:19], v73 offset:62976
    v_fma_f32 v100, -v76, v12, v100
    v_fma_f32 v101, -v77, v12, v101
    v_fma_f32 v102, -v78, v12, v102
    v_mfma_f32_16x16x32_bf16 v[184:187], v[24:27], v[60:63], v[184:187]
    v_fma_f32 v103, -v79, v12, v103
    v_fma_f32 v116, -v76, v86, v116
    v_fma_f32 v117, -v77, v86, v117
    v_mfma_f32_16x16x32_bf16 v[188:191], v[24:27], v[64:67], v[188:191]
    v_fma_f32 v118, -v78, v86, v118
    v_fma_f32 v119, -v79, v86, v119
    v_mul_f32 v100, v82, v100
    s_waitcnt lgkmcnt(6)
    v_mfma_f32_16x16x32_bf16 v[192:195], v[28:31], v[52:55], v[192:195]
    v_mul_f32 v101, v83, v101
    v_mul_f32 v102, v84, v102
    v_mul_f32 v103, v85, v103
    v_mfma_f32_16x16x32_bf16 v[196:199], v[28:31], v[56:59], v[196:199]
    ds_read_b64_tr_b16 v[20:21], v73 offset:63488
    ds_read_b64_tr_b16 v[22:23], v73 offset:64000
    v_mul_f32 v116, v82, v116
    v_mul_f32 v117, v83, v117
    v_mul_f32 v118, v84, v118
    v_mfma_f32_16x16x32_bf16 v[200:203], v[28:31], v[60:63], v[200:203]
    v_mul_f32 v119, v85, v119
    ds_read_b128 v[76:79], v75 offset:192
    ds_read_b128 v[82:85], v75 offset:448
    v_mfma_f32_16x16x32_bf16 v[204:207], v[28:31], v[64:67], v[204:207]
    v_cvt_pk_bf16_f32 v100, v100, v101
    v_cvt_pk_bf16_f32 v101, v102, v103
    v_cvt_pk_bf16_f32 v102, v116, v117
    s_waitcnt lgkmcnt(8)
    v_mfma_f32_16x16x32_bf16 v[208:211], v[32:35], v[52:55], v[208:211]
    v_cvt_pk_bf16_f32 v103, v118, v119
    s_nop 1
    v_permlane32_swap_b32 v100, v102
    v_mfma_f32_16x16x32_bf16 v[212:215], v[32:35], v[56:59], v[212:215]
    ds_read_b64_tr_b16 v[24:25], v72 offset:41984
    ds_read_b64_tr_b16 v[26:27], v72 offset:42496
    v_permlane32_swap_b32 v101, v103
    s_nop 1
    buffer_store_dwordx4 v[100:103], v3, s[32:35], s66 offen offset:1024 sc0 sc1
    v_mfma_f32_16x16x32_bf16 v[216:219], v[32:35], v[60:63], v[216:219]
    s_waitcnt lgkmcnt(8)
    v_fma_f32 v104, -v4, v12, v104
    v_fma_f32 v105, -v5, v12, v105
    v_fma_f32 v106, -v6, v12, v106
    v_mfma_f32_16x16x32_bf16 v[220:223], v[32:35], v[64:67], v[220:223]
    v_fma_f32 v107, -v7, v12, v107
    v_fma_f32 v120, -v4, v86, v120
    v_fma_f32 v121, -v5, v86, v121
    s_waitcnt lgkmcnt(6)
    v_mfma_f32_16x16x32_bf16 v[224:227], v[16:19], v[52:55], v[224:227]
    v_fma_f32 v122, -v6, v86, v122
    v_fma_f32 v123, -v7, v86, v123
    v_mul_f32 v104, v8, v104
    v_mfma_f32_16x16x32_bf16 v[228:231], v[16:19], v[56:59], v[228:231]
    ds_read_b64_tr_b16 v[28:29], v72 offset:43008
    ds_read_b64_tr_b16 v[30:31], v72 offset:43520
    v_mul_f32 v105, v9, v105
    v_mul_f32 v106, v10, v106
    v_mul_f32 v107, v11, v107
    v_mfma_f32_16x16x32_bf16 v[232:235], v[16:19], v[60:63], v[232:235]
    v_mul_f32 v120, v8, v120
    v_mul_f32 v121, v9, v121
    v_mul_f32 v122, v10, v122
    v_mfma_f32_16x16x32_bf16 v[236:239], v[16:19], v[64:67], v[236:239]
    v_mul_f32 v123, v11, v123
    v_cvt_pk_bf16_f32 v104, v104, v105
    v_cvt_pk_bf16_f32 v105, v106, v107
    s_waitcnt lgkmcnt(6)
    v_mfma_f32_16x16x32_bf16 v[240:243], v[20:23], v[52:55], v[240:243]
    v_cvt_pk_bf16_f32 v106, v120, v121
    v_cvt_pk_bf16_f32 v107, v122, v123
    s_nop 1
    v_mfma_f32_16x16x32_bf16 v[244:247], v[20:23], v[56:59], v[244:247]
    ds_read_b64_tr_b16 v[32:33], v73 offset:41984
    ds_read_b64_tr_b16 v[34:35], v73 offset:42496
    v_permlane32_swap_b32 v104, v106
    v_permlane32_swap_b32 v105, v107
    s_nop 1
    v_mfma_f32_16x16x32_bf16 v[248:251], v[20:23], v[60:63], v[248:251]
    buffer_store_dwordx4 v[104:107], v3, s[32:35], s66 offen offset:2048 sc0 sc1
    s_waitcnt lgkmcnt(6)
    v_fma_f32 v108, -v76, v12, v108
    v_fma_f32 v109, -v77, v12, v109
    v_mfma_f32_16x16x32_bf16 v[252:255], v[20:23], v[64:67], v[252:255]
    v_fma_f32 v110, -v78, v12, v110
    v_fma_f32 v111, -v79, v12, v111
    v_fma_f32 v124, -v76, v86, v124
    s_waitcnt lgkmcnt(4)
    v_mfma_f32_16x16x32_bf16 v[192:195], v[24:27], v[36:39], v[192:195]
    ds_read_b128 v[52:55], v81 offset:0
    ds_read_b128 v[56:59], v81 offset:2048
    v_fma_f32 v125, -v77, v86, v125
    v_fma_f32 v126, -v78, v86, v126
    v_fma_f32 v127, -v79, v86, v127
    v_mfma_f32_16x16x32_bf16 v[196:199], v[24:27], v[40:43], v[196:199]
    ds_read_b64_tr_b16 v[16:17], v73 offset:43008
    ds_read_b64_tr_b16 v[18:19], v73 offset:43520
    v_mul_f32 v108, v82, v108
    v_mul_f32 v109, v83, v109
    v_mul_f32 v110, v84, v110
    v_mfma_f32_16x16x32_bf16 v[200:203], v[24:27], v[44:47], v[200:203]
    ds_read_b128 v[60:63], v81 offset:4096
    ds_read_b128 v[64:67], v81 offset:6144
    v_mul_f32 v111, v85, v111
    v_mul_f32 v124, v82, v124
    v_mul_f32 v125, v83, v125
    v_mfma_f32_16x16x32_bf16 v[204:207], v[24:27], v[48:51], v[204:207]
    v_mul_f32 v126, v84, v126
    v_mul_f32 v127, v85, v127
    v_cvt_pk_bf16_f32 v108, v108, v109
    s_waitcnt lgkmcnt(8)
    v_mfma_f32_16x16x32_bf16 v[208:211], v[28:31], v[36:39], v[208:211]
    v_cvt_pk_bf16_f32 v109, v110, v111
    v_cvt_pk_bf16_f32 v110, v124, v125
    v_cvt_pk_bf16_f32 v111, v126, v127
    v_mfma_f32_16x16x32_bf16 v[212:215], v[28:31], v[40:43], v[212:215]
    ds_read_b64_tr_b16 v[20:21], v72 offset:21504
    ds_read_b64_tr_b16 v[22:23], v72 offset:22016
    s_nop 1
    v_permlane32_swap_b32 v108, v110
    v_permlane32_swap_b32 v109, v111
    v_mfma_f32_16x16x32_bf16 v[216:219], v[28:31], v[44:47], v[216:219]
    s_nop 1
    buffer_store_dwordx4 v[108:111], v3, s[32:35], s66 offen offset:3072 sc0 sc1
    v_mul_f32 v76, s56, v89
    v_mfma_f32_16x16x32_bf16 v[220:223], v[28:31], v[48:51], v[220:223]
    v_mul_f32 v78, s56, v91
    v_mul_f32 v82, s56, v93
    v_mul_f32 v84, s56, v95
    s_waitcnt lgkmcnt(8)
    v_mfma_f32_16x16x32_bf16 v[224:227], v[32:35], v[36:39], v[224:227]
    v_mul_f32 v128, v76, v128
    v_mul_f32 v129, v76, v129
    v_mul_f32 v130, v76, v130
    v_mfma_f32_16x16x32_bf16 v[228:231], v[32:35], v[40:43], v[228:231]
    ds_read_b64_tr_b16 v[24:25], v72 offset:22528
    ds_read_b64_tr_b16 v[26:27], v72 offset:23040
    v_mul_f32 v131, v76, v131
    v_mul_f32 v160, v76, v160
    v_mul_f32 v161, v76, v161
    v_mfma_f32_16x16x32_bf16 v[232:235], v[32:35], v[44:47], v[232:235]
    v_mul_f32 v162, v76, v162
    v_mul_f32 v163, v76, v163
    v_cvt_pk_bf16_f32 v128, v128, v129
    v_mfma_f32_16x16x32_bf16 v[236:239], v[32:35], v[48:51], v[236:239]
    v_cvt_pk_bf16_f32 v129, v130, v131
    v_cvt_pk_bf16_f32 v130, v160, v161
    v_cvt_pk_bf16_f32 v131, v162, v163
    s_waitcnt lgkmcnt(6)
    v_mfma_f32_16x16x32_bf16 v[240:243], v[16:19], v[36:39], v[240:243]
    buffer_store_dwordx4 v[128:131], v2, s[32:35], s67 offen offset:0 sc0 sc1
    v_mul_f32 v132, v78, v132
    v_mul_f32 v133, v78, v133
    v_mfma_f32_16x16x32_bf16 v[244:247], v[16:19], v[40:43], v[244:247]
    ds_read_b64_tr_b16 v[28:29], v73 offset:21504
    ds_read_b64_tr_b16 v[30:31], v73 offset:22016
    v_mul_f32 v134, v78, v134
    v_mul_f32 v135, v78, v135
    v_mul_f32 v164, v78, v164
    v_mfma_f32_16x16x32_bf16 v[248:251], v[16:19], v[44:47], v[248:251]
    v_mul_f32 v165, v78, v165
    v_mul_f32 v166, v78, v166
    v_mul_f32 v167, v78, v167
    v_mfma_f32_16x16x32_bf16 v[252:255], v[16:19], v[48:51], v[252:255]
    v_cvt_pk_bf16_f32 v132, v132, v133
    v_cvt_pk_bf16_f32 v133, v134, v135
    v_cvt_pk_bf16_f32 v134, v164, v165
    s_waitcnt lgkmcnt(4)
    v_mfma_f32_16x16x32_bf16 v[192:195], v[20:23], v[52:55], v[192:195]
    v_cvt_pk_bf16_f32 v135, v166, v167
    buffer_store_dwordx4 v[132:135], v2, s[32:35], s67 offen offset:256 sc0 sc1
    v_mul_f32 v136, v82, v136
    v_mfma_f32_16x16x32_bf16 v[196:199], v[20:23], v[56:59], v[196:199]
    ds_read_b64_tr_b16 v[32:33], v73 offset:22528
    ds_read_b64_tr_b16 v[34:35], v73 offset:23040
    v_mul_f32 v137, v82, v137
    v_mul_f32 v138, v82, v138
    v_mul_f32 v139, v82, v139
    v_mfma_f32_16x16x32_bf16 v[200:203], v[20:23], v[60:63], v[200:203]
    v_mul_f32 v168, v82, v168
    v_mul_f32 v169, v82, v169
    v_mul_f32 v170, v82, v170
    v_mfma_f32_16x16x32_bf16 v[204:207], v[20:23], v[64:67], v[204:207]
    v_mul_f32 v171, v82, v171
    v_cvt_pk_bf16_f32 v136, v136, v137
    v_cvt_pk_bf16_f32 v137, v138, v139
    s_waitcnt lgkmcnt(4)
    v_mfma_f32_16x16x32_bf16 v[208:211], v[24:27], v[52:55], v[208:211]
    v_cvt_pk_bf16_f32 v138, v168, v169
    v_cvt_pk_bf16_f32 v139, v170, v171
    buffer_store_dwordx4 v[136:139], v2, s[32:35], s67 offen offset:2048 sc0 sc1
    v_mfma_f32_16x16x32_bf16 v[212:215], v[24:27], v[56:59], v[212:215]
    v_mul_f32 v140, v84, v140
    v_mul_f32 v141, v84, v141
    v_mul_f32 v142, v84, v142
    v_mfma_f32_16x16x32_bf16 v[216:219], v[24:27], v[60:63], v[216:219]
    v_mul_f32 v143, v84, v143
    v_mul_f32 v172, v84, v172
    v_mul_f32 v173, v84, v173
    v_mfma_f32_16x16x32_bf16 v[220:223], v[24:27], v[64:67], v[220:223]
    v_mul_f32 v174, v84, v174
    v_mul_f32 v175, v84, v175
    v_cvt_pk_bf16_f32 v140, v140, v141
    s_waitcnt lgkmcnt(2)
    v_mfma_f32_16x16x32_bf16 v[224:227], v[28:31], v[52:55], v[224:227]
    v_cvt_pk_bf16_f32 v141, v142, v143
    v_cvt_pk_bf16_f32 v142, v172, v173
    v_cvt_pk_bf16_f32 v143, v174, v175
    v_mfma_f32_16x16x32_bf16 v[228:231], v[28:31], v[56:59], v[228:231]
    buffer_store_dwordx4 v[140:143], v2, s[32:35], s67 offen offset:2304 sc0 sc1
    v_mul_f32 v144, v89, v144
    v_mul_f32 v145, v89, v145
    v_mfma_f32_16x16x32_bf16 v[232:235], v[28:31], v[60:63], v[232:235]
    v_mul_f32 v146, v89, v146
    v_mul_f32 v147, v89, v147
    v_mul_f32 v176, v89, v176
    v_mfma_f32_16x16x32_bf16 v[236:239], v[28:31], v[64:67], v[236:239]
    v_mul_f32 v177, v89, v177
    v_mul_f32 v178, v89, v178
    v_mul_f32 v179, v89, v179
    s_waitcnt lgkmcnt(0)
    v_mfma_f32_16x16x32_bf16 v[240:243], v[32:35], v[52:55], v[240:243]
    v_cvt_pk_bf16_f32 v144, v144, v145
    v_cvt_pk_bf16_f32 v145, v146, v147
    v_cvt_pk_bf16_f32 v146, v176, v177
    v_mfma_f32_16x16x32_bf16 v[244:247], v[32:35], v[56:59], v[244:247]
    v_cvt_pk_bf16_f32 v147, v178, v179
    buffer_store_dwordx4 v[144:147], v2, s[32:35], s58 offen offset:0 sc0 sc1
    v_mul_f32 v148, v91, v148
    v_mfma_f32_16x16x32_bf16 v[248:251], v[32:35], v[60:63], v[248:251]
    v_mul_f32 v149, v91, v149
    v_mul_f32 v150, v91, v150
    v_mul_f32 v151, v91, v151
    v_mfma_f32_16x16x32_bf16 v[252:255], v[32:35], v[64:67], v[252:255]
    v_mul_f32 v180, v91, v180
    v_mul_f32 v181, v91, v181
    v_mul_f32 v182, v91, v182
    s_nop 7
    v_mul_f32 v183, v91, v183
    v_cvt_pk_bf16_f32 v148, v148, v149
    v_cvt_pk_bf16_f32 v149, v150, v151
    v_cvt_pk_bf16_f32 v150, v180, v181
    v_cvt_pk_bf16_f32 v151, v182, v183
    buffer_store_dwordx4 v[148:151], v2, s[32:35], s58 offen offset:256 sc0 sc1
    v_mul_f32 v152, v93, v152
    v_mul_f32 v153, v93, v153
    v_mul_f32 v154, v93, v154
    v_mul_f32 v155, v93, v155
    v_mul_f32 v184, v93, v184
    v_mul_f32 v185, v93, v185
    v_mul_f32 v186, v93, v186
    v_mul_f32 v187, v93, v187
    v_cvt_pk_bf16_f32 v152, v152, v153
    v_cvt_pk_bf16_f32 v153, v154, v155
    v_cvt_pk_bf16_f32 v154, v184, v185
    v_cvt_pk_bf16_f32 v155, v186, v187
    buffer_store_dwordx4 v[152:155], v2, s[32:35], s58 offen offset:2048 sc0 sc1
    v_mul_f32 v156, v95, v156
    v_mul_f32 v157, v95, v157
    v_mul_f32 v158, v95, v158
    v_mul_f32 v159, v95, v159
    v_mul_f32 v188, v95, v188
    v_mul_f32 v189, v95, v189
    v_mul_f32 v190, v95, v190
    v_mul_f32 v191, v95, v191
    v_cvt_pk_bf16_f32 v156, v156, v157
    v_cvt_pk_bf16_f32 v157, v158, v159
    v_cvt_pk_bf16_f32 v158, v188, v189
    v_cvt_pk_bf16_f32 v159, v190, v191
    buffer_store_dwordx4 v[156:159], v2, s[32:35], s58 offen offset:2304 sc0 sc1
    v_mul_f32 v76, v89, v89
    v_mul_f32 v78, v91, v91
    v_mul_f32 v82, v93, v93
    v_mul_f32 v84, v95, v95
    v_max_f32 v192, 0, v192
    v_max_f32 v193, 0, v193
    v_max_f32 v194, 0, v194
    v_max_f32 v195, 0, v195
    v_mul_f32 v208, v76, v208
    v_mul_f32 v209, v76, v209
    v_mul_f32 v210, v76, v210
    v_mul_f32 v211, v76, v211
    v_max_f32 v224, 0, v224
    v_max_f32 v225, 0, v225
    v_max_f32 v226, 0, v226
    v_max_f32 v227, 0, v227
    v_mul_f32 v240, v76, v240
    v_mul_f32 v241, v76, v241
    v_mul_f32 v242, v76, v242
    v_mul_f32 v243, v76, v243
    v_mul_f32 v192, v192, v208
    v_mul_f32 v193, v193, v209
    v_mul_f32 v194, v194, v210
    v_mul_f32 v195, v195, v211
    v_mul_f32 v224, v224, v240
    v_mul_f32 v225, v225, v241
    v_mul_f32 v226, v226, v242
    v_mul_f32 v227, v227, v243
    v_cvt_pk_bf16_f32 v208, v192, v193
    v_cvt_pk_bf16_f32 v209, v194, v195
    v_cvt_pk_bf16_f32 v210, v224, v225
    v_cvt_pk_bf16_f32 v211, v226, v227
    v_max_f32 v196, 0, v196
    v_max_f32 v197, 0, v197
    v_max_f32 v198, 0, v198
    v_max_f32 v199, 0, v199
    v_mul_f32 v212, v78, v212
    v_mul_f32 v213, v78, v213
    v_mul_f32 v214, v78, v214
    v_mul_f32 v215, v78, v215
    v_max_f32 v228, 0, v228
    v_max_f32 v229, 0, v229
    v_max_f32 v230, 0, v230
    v_max_f32 v231, 0, v231
    v_mul_f32 v244, v78, v244
    v_mul_f32 v245, v78, v245
    v_mul_f32 v246, v78, v246
    v_mul_f32 v247, v78, v247
    v_mul_f32 v196, v196, v212
    v_mul_f32 v197, v197, v213
    v_mul_f32 v198, v198, v214
    v_mul_f32 v199, v199, v215
    v_mul_f32 v228, v228, v244
    v_mul_f32 v229, v229, v245
    v_mul_f32 v230, v230, v246
    v_mul_f32 v231, v231, v247
    v_cvt_pk_bf16_f32 v212, v196, v197
    v_cvt_pk_bf16_f32 v213, v198, v199
    v_cvt_pk_bf16_f32 v214, v228, v229
    v_cvt_pk_bf16_f32 v215, v230, v231
    v_max_f32 v200, 0, v200
    v_max_f32 v201, 0, v201
    v_max_f32 v202, 0, v202
    v_max_f32 v203, 0, v203
    v_mul_f32 v216, v82, v216
    v_mul_f32 v217, v82, v217
    v_mul_f32 v218, v82, v218
    v_mul_f32 v219, v82, v219
    v_max_f32 v232, 0, v232
    v_max_f32 v233, 0, v233
    v_max_f32 v234, 0, v234
    v_max_f32 v235, 0, v235
    v_mul_f32 v248, v82, v248
    v_mul_f32 v249, v82, v249
    v_mul_f32 v250, v82, v250
    v_mul_f32 v251, v82, v251
    v_mul_f32 v200, v200, v216
    v_mul_f32 v201, v201, v217
    v_mul_f32 v202, v202, v218
    v_mul_f32 v203, v203, v219
    v_mul_f32 v232, v232, v248
    v_mul_f32 v233, v233, v249
    v_mul_f32 v234, v234, v250
    v_mul_f32 v235, v235, v251
    v_cvt_pk_bf16_f32 v216, v200, v201
    v_cvt_pk_bf16_f32 v217, v202, v203
    v_cvt_pk_bf16_f32 v218, v232, v233
    v_cvt_pk_bf16_f32 v219, v234, v235
    v_max_f32 v204, 0, v204
    v_max_f32 v205, 0, v205
    v_max_f32 v206, 0, v206
    v_max_f32 v207, 0, v207
    v_mul_f32 v220, v84, v220
    v_mul_f32 v221, v84, v221
    v_mul_f32 v222, v84, v222
    v_mul_f32 v223, v84, v223
    v_max_f32 v236, 0, v236
    v_max_f32 v237, 0, v237
    v_max_f32 v238, 0, v238
    v_max_f32 v239, 0, v239
    v_mul_f32 v252, v84, v252
    v_mul_f32 v253, v84, v253
    v_mul_f32 v254, v84, v254
    v_mul_f32 v255, v84, v255
    v_mul_f32 v204, v204, v220
    v_mul_f32 v205, v205, v221
    v_mul_f32 v206, v206, v222
    v_mul_f32 v207, v207, v223
    v_mul_f32 v236, v236, v252
    v_mul_f32 v237, v237, v253
    v_mul_f32 v238, v238, v254
    v_mul_f32 v239, v239, v255
    v_cvt_pk_bf16_f32 v220, v204, v205
    v_cvt_pk_bf16_f32 v221, v206, v207
    v_cvt_pk_bf16_f32 v222, v236, v237
    v_cvt_pk_bf16_f32 v223, v238, v239
    s_and_b32 s52, s2, 7
    s_lshl_b32 s52, s52, 7
    s_lshr_b32 s53, s2, 3
    s_lshl_b32 s53, s53, 2
    s_add_u32 s52, s52, s53
    s_add_u32 s52, s52, 52430848
    s_cmp_eq_u32 s49, 0
    s_cselect_b32 s52, s52, 2147418112
    v_mov_b32 v2, 0
    v_mov_b32 v3, 1
    s_mov_b32 s63, 1879048192
    s_waitcnt vmcnt(0)
    s_barrier
    buffer_store_dword v3, v2, s[32:35], s52 offen sc0 sc1
    s_branch L_g1_fin
L_g1_fin:
    s_mov_b32 s4, s6
    s_mov_b32 s5, s7
    v_lshrrev_b32 v2, 6, v0
    v_and_b32 v1, 63, v0
    s_and_b32 s28, s2, 7
    s_lshl_b32 s21, s28, 1
    s_bfe_u32 s29, s2, 0x10003
    s_add_u32 s21, s21, s29
    s_bfe_u32 s29, s2, 0x10004
    s_lshl_b32 s29, s29, 4
    s_add_u32 s21, s21, s29
    s_lshr_b32 s22, s2, 5
    v_readfirstlane_b32 s20, v2
    v_lshlrev_b32 v231, 4, v1
    s_lshl_b32 s36, s21, 17
    s_mov_b32 s23, 0
    s_and_b32 s37, s20, 3
    s_lshr_b32 s27, s20, 2
    s_lshl_b32 s28, s22, 3
    s_lshl_b32 s29, s37, 1
    s_add_u32 s28, s28, s29
    s_lshl_b32 s30, s28, 11
    s_add_u32 s30, s30, s36
    s_add_u32 s30, s30, 4194304
    s_lshl_b32 s33, s27, 16
    s_add_u32 s33, s33, s36
    s_and_b32 s34, s37, 1
    s_cmp_eq_u32 s34, 0
    s_cselect_b32 s31, 0, 4192256
    s_cselect_b32 s32, s27, 0
    s_add_u32 s31, s31, 8390656
    s_add_u32 s31, s31, s33
    s_lshl_b32 s32, s32, 11
    s_sub_u32 s32, 65536, s32
    s_lshr_b32 s28, s37, 1
    s_lshl_b32 s38, s28, 11
    s_lshl_b32 s25, s28, 12
    s_lshl_b32 s34, s34, 11
    s_add_u32 s25, s25, s34
    s_lshl_b32 s28, s27, 13
    s_add_u32 s25, s25, s28
    v_add_u32 v228, s28, v231
    s_add_u32 s36, s33, 8388608
    s_mov_b32 s16, s4
    s_mov_b32 s17, s5
    s_mov_b32 s18, 52826112
    s_mov_b32 s19, 0x20000
    s_add_u32 s8, s4, s31
    s_addc_u32 s9, s5, 0
    s_mov_b32 s10, s32
    s_mov_b32 s11, 0x20000
    s_mov_b32 s54, s30
    s_mov_b32 s63, s65
    s_cmp_eq_u32 s20, 0
    s_cbranch_scc0 L_at_resetup
    s_setprio 3
    s_mov_b32 s26, 0
L_at_z:
    v_cmp_ne_u32 vcc, 32, v14
    s_cbranch_vccz L_at_zok
    s_add_u32 s26, s26, 1
    s_cmp_lt_u32 s26, 65536
    s_cbranch_scc0 L_at_zok
    buffer_load_dword v14, v13, s[12:15], s39 offen sc0 sc1
    s_waitcnt vmcnt(0)
    s_branch L_at_z
L_at_zok:
    s_and_b32 s24, s2, 7
    s_lshl_b32 s24, s24, 7
    s_add_u32 s24, s24, 52430848
    s_lshl_b32 s28, s22, 2
    s_add_u32 s28, s28, 1
    s_lshl_b32 s28, 1, s28
    s_or_b32 s28, s28, 0xcccccccc
    s_bitcmp1_b32 s2, 4
    s_cselect_b32 s28, s28, 0x11111111
    s_mov_b32 s29, 0
    v_cndmask_b32 v250, 0, 1, s[28:29]
    v_lshlrev_b32 v246, 2, v1
    v_mov_b32 v2, 2147418112
    v_cndmask_b32 v246, v2, v246, s[28:29]
    s_mov_b32 s55, s24
    buffer_load_dword v247, v246, s[16:19], s55 offen sc0 sc1
L_at_resetup:
    v_lshrrev_b32 v3, 4, v1
    v_bfe_u32 v4, v1, 2, 1
    v_lshl_add_u32 v3, v3, 1, v4
    v_mul_u32_u24 v3, 589824, v3
    v_bfe_u32 v4, v1, 3, 1
    v_and_b32 v5, 3, v1
    v_lshl_add_u32 v4, v4, 2, v5
    v_lshl_add_u32 v251, v4, 4, v3
    s_lshr_b32 s28, s20, 1
    s_and_b32 s29, s20, 1
    s_mul_i32 s30, s2, 14
    s_add_u32 s30, s30, s28
    s_lshl_b32 s31, s2, 2
    s_add_u32 s31, s31, s28
    s_lshl_b32 s32, s29, 10
    s_mul_i32 s33, s29, 4718592
    s_add_u32 s33, s33, 37748736
    s_lshl_b32 s67, s30, 11
    s_add_u32 s67, s67, s32
    s_mov_b32 s40, s68
    s_mov_b32 s41, s69
    s_mov_b32 s42, 7340032
    s_mov_b32 s43, 0x20000
    s_mov_b32 s44, s94
    s_mov_b32 s45, s95
    s_mov_b32 s46, 2097152
    s_mov_b32 s47, 0x20000
    v_mov_b32 v236, -1
    v_mov_b32 v237, -1
    v_mov_b32 v238, -1
    v_mov_b32 v239, -1
    s_lshl_b32 s34, s2, 14
    s_lshl_b32 s35, s20, 11
    s_add_u32 s34, s34, s35
    s_add_u32 s66, s34, 48234496
    s_cmp_ge_u32 s20, 4
    s_cselect_b32 s35, 2147418112, 0
    s_add_u32 s48, s67, 8192
    s_add_u32 s49, s67, 16384
    s_add_u32 s52, s67, 24576
    s_or_b32 s52, s52, s35
    s_lshl_b32 s53, s31, 11
    s_add_u32 s53, s53, s32
    s_add_u32 s31, s31, 3584
    s_lshl_b32 s51, s31, 7
    s_add_u32 s51, s51, s33
    s_lshl_b32 s60, s2, 2
    s_add_u32 s60, s60, 52428800
    s_cmp_eq_u32 s20, 0
    s_cselect_b32 s60, s60, 2147418112
    s_and_b32 s33, s2, 1
    s_bfe_u32 s34, s2, 0x20001
    s_lshl_b32 s34, s34, 2
    s_bfe_u32 s28, s2, 0x20003
    s_add_u32 s34, s34, s28
    s_lshr_b32 s35, s2, 5
    s_and_b32 s28, s20, 3
    s_lshl_b32 s3, s28, 12
    s_cmp_ge_u32 s20, 4
    s_cbranch_scc1 L_fi_ex
    v_and_b32 v4, 7, v1
    v_bfe_u32 v5, v1, 4, 2
    v_lshlrev_b32 v5, 1, v5
    v_xor_b32 v4, v4, v5
    v_lshlrev_b32 v4, 4, v4
    v_lshrrev_b32 v3, 3, v1
    v_lshl_add_u32 v244, v3, 11, v4
    v_add_u32 v245, 15360, v244
    v_add_u32 v232, 30720, v244
    v_add_u32 v233, 46080, v244
    s_mul_i32 s61, s33, 3670016
    s_and_b32 s30, s28, 1
    s_lshl_b32 s30, s30, 16
    s_add_u32 s61, s61, s30
    s_lshl_b32 s30, s35, 8
    s_add_u32 s61, s61, s30
    s_lshr_b32 s30, s28, 1
    s_lshl_b32 s30, s30, 7
    s_add_u32 s61, s61, s30
    s_mov_b32 s64, 131072
    s_mov_b32 s56, s68
    s_mov_b32 s57, s69
    s_mov_b32 s58, 7340032
    s_branch L_fi_edone
L_fi_ex:
    v_mov_b32 v244, v231
    v_mov_b32 v245, v231
    v_add_u32 v232, 112640, v231
    v_add_u32 v233, 112640, v231
    s_lshl_b32 s29, s34, 3
    s_lshl_b32 s30, s28, 1
    s_add_u32 s29, s29, s30
    s_mul_i32 s61, s29, 114688
    s_mul_i32 s30, s33, 57344
    s_add_u32 s61, s61, s30
    s_add_u32 s61, s61, 16777216
    s_add_u32 s3, s3, 16384
    s_mov_b32 s64, 2048
    s_mov_b32 s56, s4
    s_mov_b32 s57, s5
    s_mov_b32 s58, 52826112
L_fi_edone:
    s_mov_b32 s59, 0x20000
    s_and_b32 s33, s2, 1
    s_bfe_u32 s34, s2, 0x20001
    s_lshl_b32 s34, s34, 2
    s_bfe_u32 s28, s2, 0x20003
    s_add_u32 s34, s34, s28
    s_lshr_b32 s35, s2, 5
    s_lshl_b32 s50, s34, 18
    s_lshl_b32 s28, s35, 8
    s_add_u32 s50, s50, s28
    s_lshr_b32 s28, s20, 1
    s_lshl_b32 s28, s28, 17
    s_add_u32 s50, s50, s28
    s_and_b32 s28, s20, 1
    s_lshl_b32 s28, s28, 7
    s_add_u32 s50, s50, s28
    s_lshl_b32 s28, s33, 6
    s_add_u32 s50, s50, s28
    s_cmp_ge_u32 s20, 4
    s_cselect_b32 s50, 0x7fff0000, s50
    v_and_b32 v4, 15, v1
    v_lshlrev_b32 v4, 11, v4
    v_bfe_u32 v5, v1, 4, 1
    v_lshl_add_u32 v4, v5, 5, v4
    v_lshrrev_b32 v5, 5, v1
    v_lshl_add_u32 v235, v5, 4, v4
    v_add_u32 v234, 65536, v228
    v_bfe_u32 v4, v1, 4, 1
    v_bfe_u32 v5, v1, 2, 1
    v_cmp_eq_u32 vcc, v4, v5
    v_mov_b32 v6, 0x3f803f80
    s_nop 0
    v_cndmask_b32 v40, 0, v6, vcc
    v_mov_b32 v41, v40
    v_mov_b32 v42, v40
    v_mov_b32 v43, v40
    v_mov_b32 v229, 0xff800000
    v_mov_b32 v230, 0xff800000
    s_add_u32 s24, s38, 8192
    s_lshl_b32 s28, s37, 11
    s_add_u32 s28, s28, s36
    s_add_u32 s30, s28, 2048
    s_add_u32 s32, s28, 4194304
    s_lshr_b32 s28, s37, 1
    s_lshl_b32 s31, s28, 14
    s_and_b32 s28, s37, 1
    s_lshl_b32 s29, s28, 12
    s_add_u32 s31, s31, s29
    s_lshl_b32 s29, s27, 13
    s_add_u32 s31, s31, s29
    s_lshl_b32 s28, s28, 10
    s_add_u32 s33, s36, s28
    s_add_u32 s34, s29, s28
    s_add_u32 s34, s34, 65536
    v_lshlrev_b32 v3, 2, v1
    s_lshl_b32 s28, s20, 8
    s_xor_b32 s29, s28, 1024
    s_add_u32 s28, s28, 81984
    s_add_u32 s29, s29, 81984
    v_add_u32 v6, s28, v3
    v_add_u32 v7, s29, v3
    s_or_b32 s28, s20, s23
    s_cbranch_scc1 L_at_go
    s_mov_b32 s26, 0
L_at_q:
    s_waitcnt vmcnt(0)
    v_cmp_ne_u32 vcc, v250, v247
    s_cbranch_vccz L_at_go
    buffer_load_dword v247, v246, s[16:19], s55 offen sc0 sc1
    s_add_u32 s26, s26, 1
    s_cmp_lt_u32 s26, 65536
    s_cbranch_scc1 L_at_q
L_at_go:
    s_barrier
    s_cmp_eq_u32 s27, 0
    s_cbranch_scc0 L_at_h1
    s_mov_b32 m0, s31
    s_nop 0
    buffer_load_dwordx4 v231, s[16:19], s30 offen offset:0 lds
    buffer_load_dwordx4 v231, s[16:19], s30 offen offset:1024 lds
    s_barrier
    buffer_load_dwordx4 v[8:11], v231, s[16:19], s54 offen offset:0
    buffer_load_dwordx4 v[12:15], v231, s[16:19], s54 offen offset:1024
    s_barrier
    s_add_u32 m0, s31, 2048
    s_nop 0
    buffer_load_dwordx4 v231, s[16:19], s32 offen offset:0 lds
    buffer_load_dwordx4 v231, s[16:19], s32 offen offset:1024 lds
    s_mov_b32 m0, s34
    s_nop 0
    buffer_load_dwordx4 v231, s[16:19], s33 offen lds
    buffer_load_dwordx4 v[16:19], v231, s[16:19], s54 offen offset:2048
    buffer_load_dwordx4 v[20:23], v231, s[16:19], s54 offen offset:3072
    s_waitcnt vmcnt(7)
    s_barrier
    ds_read_b128 v[164:167], v231 offset:0
    ds_read_b128 v[168:171], v231 offset:1024
    ds_read_b128 v[172:175], v231 offset:4096
    ds_read_b128 v[176:179], v231 offset:5120
    ds_read_b128 v[180:183], v231 offset:16384
    ds_read_b128 v[184:187], v231 offset:17408
    ds_read_b128 v[188:191], v231 offset:20480
    ds_read_b128 v[192:195], v231 offset:21504
    s_waitcnt vmcnt(5)
    s_cmp_eq_u32 s23, 0
    s_cbranch_scc0 L_at_known
    s_waitcnt lgkmcnt(6)
    v_mfma_f32_32x32x16_bf16 v[100:115], v[164:167], v[8:11], 0
    v_mfma_f32_32x32x16_bf16 v[100:115], v[168:171], v[12:15], v[100:115]
    ds_read_b128 v[164:167], v231 offset:8192
    ds_read_b128 v[168:171], v231 offset:9216
    s_waitcnt lgkmcnt(6)
    v_mfma_f32_32x32x16_bf16 v[116:131], v[172:175], v[8:11], 0
    v_mfma_f32_32x32x16_bf16 v[116:131], v[176:179], v[12:15], v[116:131]
    ds_read_b128 v[172:175], v231 offset:12288
    ds_read_b128 v[176:179], v231 offset:13312
    s_waitcnt lgkmcnt(6)
    v_mfma_f32_32x32x16_bf16 v[68:83], v[180:183], v[8:11], 0
    v_max3_f32 v229, v100, v101, v229
    v_max3_f32 v229, v102, v103, v229
    v_max3_f32 v229, v104, v105, v229
    v_max3_f32 v229, v106, v107, v229
    v_mfma_f32_32x32x16_bf16 v[68:83], v[184:187], v[12:15], v[68:83]
    ds_read_b128 v[180:183], v231 offset:24576
    ds_read_b128 v[184:187], v231 offset:25600
    v_max3_f32 v229, v108, v109, v229
    v_max3_f32 v229, v110, v111, v229
    v_max3_f32 v229, v112, v113, v229
    v_max3_f32 v229, v114, v115, v229
    s_waitcnt lgkmcnt(6)
    v_mfma_f32_32x32x16_bf16 v[84:99], v[188:191], v[8:11], 0
    v_max3_f32 v229, v116, v117, v229
    v_max3_f32 v229, v118, v119, v229
    v_max3_f32 v229, v120, v121, v229
    v_max3_f32 v229, v122, v123, v229
    v_mfma_f32_32x32x16_bf16 v[84:99], v[192:195], v[12:15], v[84:99]
    ds_read_b128 v[188:191], v231 offset:28672
    ds_read_b128 v[192:195], v231 offset:29696
    v_max3_f32 v229, v124, v125, v229
    v_max3_f32 v229, v126, v127, v229
    v_max3_f32 v229, v128, v129, v229
    v_max3_f32 v229, v130, v131, v229
    s_waitcnt lgkmcnt(6)
    v_mfma_f32_32x32x16_bf16 v[100:115], v[164:167], v[8:11], 0
    v_max3_f32 v229, v68, v69, v229
    v_max3_f32 v229, v70, v71, v229
    v_max3_f32 v229, v72, v73, v229
    v_max3_f32 v229, v74, v75, v229
    s_add_u32 m0, s25, 32768
    s_nop 0
    buffer_load_dwordx4 v231, s[8:11], s24 offen lds
    v_mfma_f32_32x32x16_bf16 v[100:115], v[168:171], v[12:15], v[100:115]
    v_max3_f32 v229, v76, v77, v229
    v_max3_f32 v229, v78, v79, v229
    v_max3_f32 v229, v80, v81, v229
    v_max3_f32 v229, v82, v83, v229
    s_waitcnt lgkmcnt(4)
    v_mfma_f32_32x32x16_bf16 v[116:131], v[172:175], v[8:11], 0
    v_max3_f32 v229, v84, v85, v229
    v_max3_f32 v229, v86, v87, v229
    v_max3_f32 v229, v88, v89, v229
    v_max3_f32 v229, v90, v91, v229
    buffer_load_dwordx4 v231, s[8:11], s24 offen offset:1024 lds
    s_add_u32 s24, s24, 4096
    v_mfma_f32_32x32x16_bf16 v[116:131], v[176:179], v[12:15], v[116:131]
    v_max3_f32 v229, v92, v93, v229
    v_max3_f32 v229, v94, v95, v229
    v_max3_f32 v229, v96, v97, v229
    v_max3_f32 v229, v98, v99, v229
    s_waitcnt lgkmcnt(2)
    v_mfma_f32_32x32x16_bf16 v[68:83], v[180:183], v[8:11], 0
    v_max3_f32 v229, v100, v101, v229
    v_max3_f32 v229, v102, v103, v229
    v_max3_f32 v229, v104, v105, v229
    v_max3_f32 v229, v106, v107, v229
    buffer_load_dwordx4 v[240:243], v231, s[44:47], s53 offen
    v_mfma_f32_32x32x16_bf16 v[68:83], v[184:187], v[12:15], v[68:83]
    v_max3_f32 v229, v108, v109, v229
    v_max3_f32 v229, v110, v111, v229
    v_max3_f32 v229, v112, v113, v229
    v_max3_f32 v229, v114, v115, v229
    s_waitcnt lgkmcnt(0)
    v_mfma_f32_32x32x16_bf16 v[84:99], v[188:191], v[8:11], 0
    v_max3_f32 v229, v116, v117, v229
    v_max3_f32 v229, v118, v119, v229
    v_max3_f32 v229, v120, v121, v229
    v_max3_f32 v229, v122, v123, v229
    v_mfma_f32_32x32x16_bf16 v[84:99], v[192:195], v[12:15], v[84:99]
    v_max3_f32 v229, v124, v125, v229
    v_max3_f32 v229, v126, v127, v229
    v_max3_f32 v229, v128, v129, v229
    v_max3_f32 v229, v130, v131, v229
    v_max3_f32 v229, v68, v69, v229
    v_max3_f32 v229, v70, v71, v229
    v_max3_f32 v229, v72, v73, v229
    v_max3_f32 v229, v74, v75, v229
    v_max3_f32 v229, v76, v77, v229
    v_max3_f32 v229, v78, v79, v229
    v_max3_f32 v229, v80, v81, v229
    v_max3_f32 v229, v82, v83, v229
    s_nop 3
    v_max3_f32 v229, v84, v85, v229
    v_max3_f32 v229, v86, v87, v229
    v_max3_f32 v229, v88, v89, v229
    v_max3_f32 v229, v90, v91, v229
    v_max3_f32 v229, v92, v93, v229
    v_max3_f32 v229, v94, v95, v229
    v_max3_f32 v229, v96, v97, v229
    v_max3_f32 v229, v98, v99, v229
    v_mov_b32 v2, v229
    s_nop 1
    v_permlane32_swap_b32 v229, v2
    s_nop 1
    v_max_f32 v229, v229, v2
    ds_write_b32 v6, v229
    v_sub_f32 v2, 0xc2d80000, v229
    v_mov_b32 v100, v2
    v_mov_b32 v101, v2
    v_mov_b32 v102, v2
    v_mov_b32 v103, v2
    v_mov_b32 v104, v2
    v_mov_b32 v105, v2
    v_mov_b32 v106, v2
    v_mov_b32 v107, v2
    v_mov_b32 v108, v2
    v_mov_b32 v109, v2
    v_mov_b32 v110, v2
    v_mov_b32 v111, v2
    v_mov_b32 v112, v2
    v_mov_b32 v113, v2
    v_mov_b32 v114, v2
    v_mov_b32 v115, v2
    s_waitcnt vmcnt(3) lgkmcnt(0)
    s_barrier
    ds_read_b32 v3, v7
    ds_read_b128 v[24:27], v234 offset:0
    ds_read_b128 v[28:31], v234 offset:1024
    s_waitcnt lgkmcnt(2)
    v_sub_f32 v2, 0xc2d80000, v3
    v_mov_b32 v116, v2
    v_mov_b32 v117, v2
    v_mov_b32 v118, v2
    v_mov_b32 v119, v2
    v_mov_b32 v120, v2
    v_mov_b32 v121, v2
    v_mov_b32 v122, v2
    v_mov_b32 v123, v2
    v_mov_b32 v124, v2
    v_mov_b32 v125, v2
    v_mov_b32 v126, v2
    v_mov_b32 v127, v2
    v_mov_b32 v128, v2
    v_mov_b32 v129, v2
    v_mov_b32 v130, v2
    v_mov_b32 v131, v2
    s_branch L_at_havem
L_at_h1:
    s_mov_b32 m0, s31
    s_nop 0
    buffer_load_dwordx4 v231, s[16:19], s30 offen offset:0 lds
    buffer_load_dwordx4 v231, s[16:19], s30 offen offset:1024 lds
    s_barrier
    buffer_load_dwordx4 v[16:19], v231, s[16:19], s54 offen offset:2048
    buffer_load_dwordx4 v[20:23], v231, s[16:19], s54 offen offset:3072
    s_barrier
    s_add_u32 m0, s31, 2048
    s_nop 0
    buffer_load_dwordx4 v231, s[16:19], s32 offen offset:0 lds
    buffer_load_dwordx4 v231, s[16:19], s32 offen offset:1024 lds
    s_mov_b32 m0, s34
    s_nop 0
    buffer_load_dwordx4 v231, s[16:19], s33 offen lds
    buffer_load_dwordx4 v[8:11], v231, s[16:19], s54 offen offset:0
    buffer_load_dwordx4 v[12:15], v231, s[16:19], s54 offen offset:1024
    s_waitcnt vmcnt(7)
    s_barrier
    ds_read_b128 v[164:167], v231 offset:0
    ds_read_b128 v[168:171], v231 offset:1024
    ds_read_b128 v[172:175], v231 offset:4096
    ds_read_b128 v[176:179], v231 offset:5120
    ds_read_b128 v[180:183], v231 offset:16384
    ds_read_b128 v[184:187], v231 offset:17408
    ds_read_b128 v[188:191], v231 offset:20480
    ds_read_b128 v[192:195], v231 offset:21504
    s_waitcnt vmcnt(5)
    s_cmp_eq_u32 s23, 0
    s_cbranch_scc0 L_at_known
    s_waitcnt lgkmcnt(6)
    v_mfma_f32_32x32x16_bf16 v[100:115], v[164:167], v[16:19], 0
    v_mfma_f32_32x32x16_bf16 v[100:115], v[168:171], v[20:23], v[100:115]
    ds_read_b128 v[164:167], v231 offset:8192
    ds_read_b128 v[168:171], v231 offset:9216
    s_waitcnt lgkmcnt(6)
    v_mfma_f32_32x32x16_bf16 v[116:131], v[172:175], v[16:19], 0
    v_mfma_f32_32x32x16_bf16 v[116:131], v[176:179], v[20:23], v[116:131]
    ds_read_b128 v[172:175], v231 offset:12288
    ds_read_b128 v[176:179], v231 offset:13312
    s_waitcnt lgkmcnt(6)
    v_mfma_f32_32x32x16_bf16 v[68:83], v[180:183], v[16:19], 0
    v_max3_f32 v230, v100, v101, v230
    v_max3_f32 v230, v102, v103, v230
    v_max3_f32 v230, v104, v105, v230
    v_max3_f32 v230, v106, v107, v230
    v_mfma_f32_32x32x16_bf16 v[68:83], v[184:187], v[20:23], v[68:83]
    ds_read_b128 v[180:183], v231 offset:24576
    ds_read_b128 v[184:187], v231 offset:25600
    v_max3_f32 v230, v108, v109, v230
    v_max3_f32 v230, v110, v111, v230
    v_max3_f32 v230, v112, v113, v230
    v_max3_f32 v230, v114, v115, v230
    s_waitcnt lgkmcnt(6)
    v_mfma_f32_32x32x16_bf16 v[84:99], v[188:191], v[16:19], 0
    v_max3_f32 v230, v116, v117, v230
    v_max3_f32 v230, v118, v119, v230
    v_max3_f32 v230, v120, v121, v230
    v_max3_f32 v230, v122, v123, v230
    v_mfma_f32_32x32x16_bf16 v[84:99], v[192:195], v[20:23], v[84:99]
    ds_read_b128 v[188:191], v231 offset:28672
    ds_read_b128 v[192:195], v231 offset:29696
    v_max3_f32 v230, v124, v125, v230
    v_max3_f32 v230, v126, v127, v230
    v_max3_f32 v230, v128, v129, v230
    v_max3_f32 v230, v130, v131, v230
    s_waitcnt lgkmcnt(6)
    v_mfma_f32_32x32x16_bf16 v[100:115], v[164:167], v[16:19], 0
    v_max3_f32 v230, v68, v69, v230
    v_max3_f32 v230, v70, v71, v230
    v_max3_f32 v230, v72, v73, v230
    v_max3_f32 v230, v74, v75, v230
    s_add_u32 m0, s25, 32768
    s_nop 0
    buffer_load_dwordx4 v231, s[8:11], s24 offen lds
    v_mfma_f32_32x32x16_bf16 v[100:115], v[168:171], v[20:23], v[100:115]
    v_max3_f32 v230, v76, v77, v230
    v_max3_f32 v230, v78, v79, v230
    v_max3_f32 v230, v80, v81, v230
    v_max3_f32 v230, v82, v83, v230
    s_waitcnt lgkmcnt(4)
    v_mfma_f32_32x32x16_bf16 v[116:131], v[172:175], v[16:19], 0
    v_max3_f32 v230, v84, v85, v230
    v_max3_f32 v230, v86, v87, v230
    v_max3_f32 v230, v88, v89, v230
    v_max3_f32 v230, v90, v91, v230
    buffer_load_dwordx4 v231, s[8:11], s24 offen offset:1024 lds
    s_add_u32 s24, s24, 4096
    v_mfma_f32_32x32x16_bf16 v[116:131], v[176:179], v[20:23], v[116:131]
    v_max3_f32 v230, v92, v93, v230
    v_max3_f32 v230, v94, v95, v230
    v_max3_f32 v230, v96, v97, v230
    v_max3_f32 v230, v98, v99, v230
    s_waitcnt lgkmcnt(2)
    v_mfma_f32_32x32x16_bf16 v[68:83], v[180:183], v[16:19], 0
    v_max3_f32 v230, v100, v101, v230
    v_max3_f32 v230, v102, v103, v230
    v_max3_f32 v230, v104, v105, v230
    v_max3_f32 v230, v106, v107, v230
    buffer_load_dwordx4 v[240:243], v231, s[44:47], s53 offen
    v_mfma_f32_32x32x16_bf16 v[68:83], v[184:187], v[20:23], v[68:83]
    v_max3_f32 v230, v108, v109, v230
    v_max3_f32 v230, v110, v111, v230
    v_max3_f32 v230, v112, v113, v230
    v_max3_f32 v230, v114, v115, v230
    s_waitcnt lgkmcnt(0)
    v_mfma_f32_32x32x16_bf16 v[84:99], v[188:191], v[16:19], 0
    v_max3_f32 v230, v116, v117, v230
    v_max3_f32 v230, v118, v119, v230
    v_max3_f32 v230, v120, v121, v230
    v_max3_f32 v230, v122, v123, v230
    v_mfma_f32_32x32x16_bf16 v[84:99], v[192:195], v[20:23], v[84:99]
    v_max3_f32 v230, v124, v125, v230
    v_max3_f32 v230, v126, v127, v230
    v_max3_f32 v230, v128, v129, v230
    v_max3_f32 v230, v130, v131, v230
    v_max3_f32 v230, v68, v69, v230
    v_max3_f32 v230, v70, v71, v230
    v_max3_f32 v230, v72, v73, v230
    v_max3_f32 v230, v74, v75, v230
    v_max3_f32 v230, v76, v77, v230
    v_max3_f32 v230, v78, v79, v230
    v_max3_f32 v230, v80, v81, v230
    v_max3_f32 v230, v82, v83, v230
    s_nop 3
    v_max3_f32 v230, v84, v85, v230
    v_max3_f32 v230, v86, v87, v230
    v_max3_f32 v230, v88, v89, v230
    v_max3_f32 v230, v90, v91, v230
    v_max3_f32 v230, v92, v93, v230
    v_max3_f32 v230, v94, v95, v230
    v_max3_f32 v230, v96, v97, v230
    v_max3_f32 v230, v98, v99, v230
    v_mov_b32 v2, v230
    s_nop 1
    v_permlane32_swap_b32 v230, v2
    s_nop 1
    v_max_f32 v230, v230, v2
    ds_write_b32 v6, v230
    v_sub_f32 v2, 0xc2d80000, v230
    v_mov_b32 v116, v2
    v_mov_b32 v117, v2
    v_mov_b32 v118, v2
    v_mov_b32 v119, v2
    v_mov_b32 v120, v2
    v_mov_b32 v121, v2
    v_mov_b32 v122, v2
    v_mov_b32 v123, v2
    v_mov_b32 v124, v2
    v_mov_b32 v125, v2
    v_mov_b32 v126, v2
    v_mov_b32 v127, v2
    v_mov_b32 v128, v2
    v_mov_b32 v129, v2
    v_mov_b32 v130, v2
    v_mov_b32 v131, v2
    s_waitcnt vmcnt(3) lgkmcnt(0)
    s_barrier
    ds_read_b32 v3, v7
    ds_read_b128 v[24:27], v234 offset:0
    ds_read_b128 v[28:31], v234 offset:1024
    s_waitcnt lgkmcnt(2)
    v_sub_f32 v2, 0xc2d80000, v3
    v_mov_b32 v100, v2
    v_mov_b32 v101, v2
    v_mov_b32 v102, v2
    v_mov_b32 v103, v2
    v_mov_b32 v104, v2
    v_mov_b32 v105, v2
    v_mov_b32 v106, v2
    v_mov_b32 v107, v2
    v_mov_b32 v108, v2
    v_mov_b32 v109, v2
    v_mov_b32 v110, v2
    v_mov_b32 v111, v2
    v_mov_b32 v112, v2
    v_mov_b32 v113, v2
    v_mov_b32 v114, v2
    v_mov_b32 v115, v2
    s_branch L_at_havem
L_at_known:
    s_add_u32 m0, s25, 32768
    s_nop 0
    buffer_load_dwordx4 v231, s[8:11], s24 offen lds
    buffer_load_dwordx4 v231, s[8:11], s24 offen offset:1024 lds
    s_add_u32 s24, s24, 4096
    buffer_load_dwordx4 v[240:243], v231, s[44:47], s53 offen
    s_waitcnt vmcnt(3) lgkmcnt(0)
    s_barrier
    ds_read_b128 v[24:27], v234 offset:0
    ds_read_b128 v[28:31], v234 offset:1024
L_at_havem:
    s_waitcnt lgkmcnt(0)
    v_mfma_f32_32x32x16_bf16 v[68:83], v[24:27], v[8:11], v[100:115]
    v_mfma_f32_32x32x16_bf16 v[68:83], v[28:31], v[12:15], v[68:83]
    s_mov_b32 s26, 3
    s_nop 7
    s_nop 3
    .p2align 6
    s_waitcnt vmcnt(4)
    s_barrier
    s_setprio 3
    v_mfma_f32_32x32x16_bf16 v[84:99], v[24:27], v[16:19], v[116:131]
    v_exp_f32 v68, v68
    v_exp_f32 v69, v69
    v_exp_f32 v70, v70
    s_add_u32 m0, s25, 49152
    s_nop 0
    v_exp_f32 v71, v71
    v_cvt_pk_bf16_f32 v44, v68, v69
    v_exp_f32 v72, v72
    v_exp_f32 v73, v73
    buffer_load_dwordx4 v231, s[8:11], s24 offen lds
    v_mfma_f32_32x32x16_bf16 v[84:99], v[28:31], v[20:23], v[84:99]
    v_cvt_pk_bf16_f32 v45, v70, v71
    v_exp_f32 v74, v74
    ds_read_b128 v[24:27], v228 offset:0
    ds_read_b128 v[28:31], v228 offset:1024
    v_exp_f32 v75, v75
    v_exp_f32 v76, v76
    v_cvt_pk_bf16_f32 v46, v72, v73
    v_cvt_pk_bf16_f32 v47, v74, v75
    v_exp_f32 v77, v77
    ds_read_b128 v[32:35], v228 offset:2048
    ds_read_b128 v[36:39], v228 offset:3072
    v_exp_f32 v78, v78
    v_exp_f32 v79, v79
    v_cvt_pk_bf16_f32 v48, v76, v77
    v_exp_f32 v80, v80
    v_exp_f32 v81, v81
    v_cvt_pk_bf16_f32 v49, v78, v79
    v_exp_f32 v82, v82
    v_exp_f32 v83, v83
    v_cvt_pk_bf16_f32 v50, v80, v81
    v_cvt_pk_bf16_f32 v51, v82, v83
    s_waitcnt lgkmcnt(2)
    v_mfma_f32_32x32x16_bf16 v[68:83], v[24:27], v[8:11], v[100:115]
    v_exp_f32 v84, v84
    v_exp_f32 v85, v85
    v_exp_f32 v86, v86
    buffer_load_dwordx4 v231, s[8:11], s24 offen offset:1024 lds
    s_add_u32 s24, s24, 4096
    s_waitcnt lgkmcnt(0)
    v_mfma_f32_32x32x16_bf16 v[132:147], v[32:35], v[44:47], 0
    v_exp_f32 v87, v87
    s_setprio 2
    v_cvt_pk_bf16_f32 v52, v84, v85
    v_exp_f32 v88, v88
    v_exp_f32 v89, v89
    buffer_store_dwordx4 v[196:199], v231, s[16:19], s62 offen sc0 sc1
    s_add_u32 s62, s62, 114688
    v_mfma_f32_32x32x16_bf16 v[68:83], v[28:31], v[12:15], v[68:83]
    v_cvt_pk_bf16_f32 v53, v86, v87
    v_exp_f32 v90, v90
    v_exp_f32 v91, v91
    v_exp_f32 v92, v92
    v_mfma_f32_32x32x16_bf16 v[132:147], v[36:39], v[48:51], v[132:147]
    v_cvt_pk_bf16_f32 v54, v88, v89
    v_cvt_pk_bf16_f32 v55, v90, v91
    v_exp_f32 v93, v93
    v_exp_f32 v94, v94
    v_mfma_f32_16x16x32_bf16 v[60:63], v[40:43], v[44:47], 0
    v_exp_f32 v95, v95
    v_cvt_pk_bf16_f32 v56, v92, v93
    v_exp_f32 v96, v96
    v_mfma_f32_16x16x32_bf16 v[60:63], v[40:43], v[48:51], v[60:63]
    v_exp_f32 v97, v97
    v_cvt_pk_bf16_f32 v57, v94, v95
    v_exp_f32 v98, v98
    v_exp_f32 v99, v99
    v_cvt_pk_bf16_f32 v58, v96, v97
    v_cvt_pk_bf16_f32 v59, v98, v99
    v_mfma_f32_32x32x16_bf16 v[84:99], v[24:27], v[16:19], v[116:131]
    v_exp_f32 v68, v68
    v_exp_f32 v69, v69
    v_exp_f32 v70, v70
    v_mfma_f32_32x32x16_bf16 v[148:163], v[32:35], v[52:55], 0
    v_exp_f32 v71, v71
    v_cvt_pk_bf16_f32 v44, v68, v69
    v_exp_f32 v72, v72
    v_exp_f32 v73, v73
    v_mfma_f32_32x32x16_bf16 v[84:99], v[28:31], v[20:23], v[84:99]
    v_cvt_pk_bf16_f32 v45, v70, v71
    v_exp_f32 v74, v74
    ds_read_b128 v[24:27], v228 offset:4096
    ds_read_b128 v[28:31], v228 offset:5120
    v_exp_f32 v75, v75
    v_exp_f32 v76, v76
    v_mfma_f32_32x32x16_bf16 v[148:163], v[36:39], v[56:59], v[148:163]
    v_cvt_pk_bf16_f32 v46, v72, v73
    v_cvt_pk_bf16_f32 v47, v74, v75
    v_exp_f32 v77, v77
    s_setprio 1
    ds_read_b128 v[32:35], v228 offset:6144
    ds_read_b128 v[36:39], v228 offset:7168
    v_exp_f32 v78, v78
    v_mfma_f32_16x16x32_bf16 v[64:67], v[40:43], v[52:55], 0
    v_exp_f32 v79, v79
    v_cvt_pk_bf16_f32 v48, v76, v77
    v_exp_f32 v80, v80
    v_mfma_f32_16x16x32_bf16 v[64:67], v[40:43], v[56:59], v[64:67]
    v_exp_f32 v81, v81
    v_cvt_pk_bf16_f32 v49, v78, v79
    v_exp_f32 v82, v82
    v_exp_f32 v83, v83
    v_cvt_pk_bf16_f32 v50, v80, v81
    v_cvt_pk_bf16_f32 v51, v82, v83
    s_waitcnt lgkmcnt(2)
    v_mfma_f32_32x32x16_bf16 v[68:83], v[24:27], v[8:11], v[100:115]
    v_exp_f32 v84, v84
    v_exp_f32 v85, v85
    v_exp_f32 v86, v86
    buffer_store_dwordx4 v[236:239], v231, s[16:19], s66 offen offset:0 sc0 sc1
    buffer_store_dwordx4 v[236:239], v231, s[16:19], s66 offen offset:1024 sc0 sc1
    s_waitcnt lgkmcnt(0)
    v_mfma_f32_32x32x16_bf16 v[132:147], v[32:35], v[44:47], v[132:147]
    v_exp_f32 v87, v87
    v_cvt_pk_bf16_f32 v52, v84, v85
    v_exp_f32 v88, v88
    v_exp_f32 v89, v89
    v_mfma_f32_32x32x16_bf16 v[68:83], v[28:31], v[12:15], v[68:83]
    v_cvt_pk_bf16_f32 v53, v86, v87
    s_setprio 0
    v_exp_f32 v90, v90
    v_exp_f32 v91, v91
    v_exp_f32 v92, v92
    v_mfma_f32_32x32x16_bf16 v[132:147], v[36:39], v[48:51], v[132:147]
    v_cvt_pk_bf16_f32 v54, v88, v89
    v_cvt_pk_bf16_f32 v55, v90, v91
    v_exp_f32 v93, v93
    v_exp_f32 v94, v94
    v_mfma_f32_16x16x32_bf16 v[60:63], v[40:43], v[44:47], v[60:63]
    v_exp_f32 v95, v95
    v_cvt_pk_bf16_f32 v56, v92, v93
    v_exp_f32 v96, v96
    v_mfma_f32_16x16x32_bf16 v[60:63], v[40:43], v[48:51], v[60:63]
    v_exp_f32 v97, v97
    v_cvt_pk_bf16_f32 v57, v94, v95
    v_exp_f32 v98, v98
    v_exp_f32 v99, v99
    v_cvt_pk_bf16_f32 v58, v96, v97
    v_cvt_pk_bf16_f32 v59, v98, v99
    s_waitcnt vmcnt(8)
    s_barrier
    s_setprio 3
    v_mfma_f32_32x32x16_bf16 v[84:99], v[24:27], v[16:19], v[116:131]
    v_exp_f32 v68, v68
    v_exp_f32 v69, v69
    v_exp_f32 v70, v70
    s_add_u32 m0, s25, 0
    s_nop 0
    v_mfma_f32_32x32x16_bf16 v[148:163], v[32:35], v[52:55], v[148:163]
    v_exp_f32 v71, v71
    v_cvt_pk_bf16_f32 v44, v68, v69
    v_exp_f32 v72, v72
    v_exp_f32 v73, v73
    buffer_load_dwordx4 v231, s[8:11], s24 offen lds
    v_mfma_f32_32x32x16_bf16 v[84:99], v[28:31], v[20:23], v[84:99]
    v_cvt_pk_bf16_f32 v45, v70, v71
    v_exp_f32 v74, v74
    ds_read_b128 v[24:27], v228 offset:16384
    ds_read_b128 v[28:31], v228 offset:17408
    v_exp_f32 v75, v75
    v_exp_f32 v76, v76
    v_mfma_f32_32x32x16_bf16 v[148:163], v[36:39], v[56:59], v[148:163]
    v_cvt_pk_bf16_f32 v46, v72, v73
    v_cvt_pk_bf16_f32 v47, v74, v75
    v_exp_f32 v77, v77
    ds_read_b128 v[32:35], v228 offset:18432
    ds_read_b128 v[36:39], v228 offset:19456
    v_exp_f32 v78, v78
    v_mfma_f32_16x16x32_bf16 v[64:67], v[40:43], v[52:55], v[64:67]
    v_exp_f32 v79, v79
    v_cvt_pk_bf16_f32 v48, v76, v77
    v_exp_f32 v80, v80
    v_mfma_f32_16x16x32_bf16 v[64:67], v[40:43], v[56:59], v[64:67]
    v_exp_f32 v81, v81
    v_cvt_pk_bf16_f32 v49, v78, v79
    v_exp_f32 v82, v82
    v_exp_f32 v83, v83
    v_cvt_pk_bf16_f32 v50, v80, v81
    v_cvt_pk_bf16_f32 v51, v82, v83
    s_waitcnt lgkmcnt(2)
    v_mfma_f32_32x32x16_bf16 v[68:83], v[24:27], v[8:11], v[100:115]
    v_exp_f32 v84, v84
    v_exp_f32 v85, v85
    v_exp_f32 v86, v86
    buffer_load_dwordx4 v231, s[8:11], s24 offen offset:1024 lds
    s_add_u32 s24, s24, 4096
    s_waitcnt lgkmcnt(0)
    v_mfma_f32_32x32x16_bf16 v[132:147], v[32:35], v[44:47], v[132:147]
    v_exp_f32 v87, v87
    s_setprio 2
    v_cvt_pk_bf16_f32 v52, v84, v85
    v_exp_f32 v88, v88
    v_exp_f32 v89, v89
    buffer_store_dwordx4 v[200:203], v231, s[16:19], s62 offen sc0 sc1
    s_add_u32 s62, s62, 114688
    v_mfma_f32_32x32x16_bf16 v[68:83], v[28:31], v[12:15], v[68:83]
    v_cvt_pk_bf16_f32 v53, v86, v87
    v_exp_f32 v90, v90
    v_exp_f32 v91, v91
    v_exp_f32 v92, v92
    v_mfma_f32_32x32x16_bf16 v[132:147], v[36:39], v[48:51], v[132:147]
    v_cvt_pk_bf16_f32 v54, v88, v89
    v_cvt_pk_bf16_f32 v55, v90, v91
    v_exp_f32 v93, v93
    v_exp_f32 v94, v94
    v_mfma_f32_16x16x32_bf16 v[60:63], v[40:43], v[44:47], v[60:63]
    v_exp_f32 v95, v95
    v_cvt_pk_bf16_f32 v56, v92, v93
    v_exp_f32 v96, v96
    v_mfma_f32_16x16x32_bf16 v[60:63], v[40:43], v[48:51], v[60:63]
    v_exp_f32 v97, v97
    v_cvt_pk_bf16_f32 v57, v94, v95
    v_exp_f32 v98, v98
    v_exp_f32 v99, v99
    v_cvt_pk_bf16_f32 v58, v96, v97
    v_cvt_pk_bf16_f32 v59, v98, v99
    v_mfma_f32_32x32x16_bf16 v[84:99], v[24:27], v[16:19], v[116:131]
    v_exp_f32 v68, v68
    v_exp_f32 v69, v69
    v_exp_f32 v70, v70
    buffer_load_dwordx4 v[246:249], v231, s[40:43], s67 offen
    v_mfma_f32_32x32x16_bf16 v[148:163], v[32:35], v[52:55], v[148:163]
    v_exp_f32 v71, v71
    v_cvt_pk_bf16_f32 v44, v68, v69
    v_exp_f32 v72, v72
    v_exp_f32 v73, v73
    v_mfma_f32_32x32x16_bf16 v[84:99], v[28:31], v[20:23], v[84:99]
    v_cvt_pk_bf16_f32 v45, v70, v71
    v_exp_f32 v74, v74
    ds_read_b128 v[24:27], v228 offset:20480
    ds_read_b128 v[28:31], v228 offset:21504
    v_exp_f32 v75, v75
    v_exp_f32 v76, v76
    v_mfma_f32_32x32x16_bf16 v[148:163], v[36:39], v[56:59], v[148:163]
    v_cvt_pk_bf16_f32 v46, v72, v73
    v_cvt_pk_bf16_f32 v47, v74, v75
    s_setprio 1
    v_exp_f32 v77, v77
    ds_read_b128 v[32:35], v228 offset:22528
    ds_read_b128 v[36:39], v228 offset:23552
    v_exp_f32 v78, v78
    v_mfma_f32_16x16x32_bf16 v[64:67], v[40:43], v[52:55], v[64:67]
    v_exp_f32 v79, v79
    v_cvt_pk_bf16_f32 v48, v76, v77
    v_exp_f32 v80, v80
    v_mfma_f32_16x16x32_bf16 v[64:67], v[40:43], v[56:59], v[64:67]
    v_exp_f32 v81, v81
    v_cvt_pk_bf16_f32 v49, v78, v79
    v_exp_f32 v82, v82
    v_exp_f32 v83, v83
    v_cvt_pk_bf16_f32 v50, v80, v81
    v_cvt_pk_bf16_f32 v51, v82, v83
    s_waitcnt lgkmcnt(2)
    v_mfma_f32_32x32x16_bf16 v[68:83], v[24:27], v[8:11], v[100:115]
    v_exp_f32 v84, v84
    v_exp_f32 v85, v85
    v_exp_f32 v86, v86
    s_waitcnt lgkmcnt(0)
    v_mfma_f32_32x32x16_bf16 v[132:147], v[32:35], v[44:47], v[132:147]
    v_exp_f32 v87, v87
    v_cvt_pk_bf16_f32 v52, v84, v85
    v_exp_f32 v88, v88
    v_exp_f32 v89, v89
    v_mfma_f32_32x32x16_bf16 v[68:83], v[28:31], v[12:15], v[68:83]
    v_cvt_pk_bf16_f32 v53, v86, v87
    v_exp_f32 v90, v90
    v_exp_f32 v91, v91
    s_setprio 0
    v_exp_f32 v92, v92
    v_mfma_f32_32x32x16_bf16 v[132:147], v[36:39], v[48:51], v[132:147]
    v_cvt_pk_bf16_f32 v54, v88, v89
    v_cvt_pk_bf16_f32 v55, v90, v91
    v_exp_f32 v93, v93
    v_exp_f32 v94, v94
    v_mfma_f32_16x16x32_bf16 v[60:63], v[40:43], v[44:47], v[60:63]
    v_exp_f32 v95, v95
    v_cvt_pk_bf16_f32 v56, v92, v93
    v_exp_f32 v96, v96
    v_mfma_f32_16x16x32_bf16 v[60:63], v[40:43], v[48:51], v[60:63]
    v_exp_f32 v97, v97
    v_cvt_pk_bf16_f32 v57, v94, v95
    v_exp_f32 v98, v98
    v_exp_f32 v99, v99
    v_cvt_pk_bf16_f32 v58, v96, v97
    v_cvt_pk_bf16_f32 v59, v98, v99
    s_waitcnt vmcnt(10)
    s_barrier
    s_setprio 3
    v_mfma_f32_32x32x16_bf16 v[84:99], v[24:27], v[16:19], v[116:131]
    v_exp_f32 v68, v68
    v_exp_f32 v69, v69
    v_exp_f32 v70, v70
    s_add_u32 m0, s25, 16384
    s_nop 0
    v_mfma_f32_32x32x16_bf16 v[148:163], v[32:35], v[52:55], v[148:163]
    v_exp_f32 v71, v71
    v_cvt_pk_bf16_f32 v44, v68, v69
    v_exp_f32 v72, v72
    v_exp_f32 v73, v73
    buffer_load_dwordx4 v231, s[8:11], s24 offen lds
    v_mfma_f32_32x32x16_bf16 v[84:99], v[28:31], v[20:23], v[84:99]
    v_cvt_pk_bf16_f32 v45, v70, v71
    v_exp_f32 v74, v74
    ds_read_b128 v[24:27], v228 offset:32768
    ds_read_b128 v[28:31], v228 offset:33792
    v_exp_f32 v75, v75
    v_exp_f32 v76, v76
    v_mfma_f32_32x32x16_bf16 v[148:163], v[36:39], v[56:59], v[148:163]
    v_cvt_pk_bf16_f32 v46, v72, v73
    v_cvt_pk_bf16_f32 v47, v74, v75
    v_exp_f32 v77, v77
    ds_read_b128 v[32:35], v228 offset:34816
    ds_read_b128 v[36:39], v228 offset:35840
    v_exp_f32 v78, v78
    v_mfma_f32_16x16x32_bf16 v[64:67], v[40:43], v[52:55], v[64:67]
    v_exp_f32 v79, v79
    v_cvt_pk_bf16_f32 v48, v76, v77
    v_exp_f32 v80, v80
    v_mfma_f32_16x16x32_bf16 v[64:67], v[40:43], v[56:59], v[64:67]
    v_exp_f32 v81, v81
    v_cvt_pk_bf16_f32 v49, v78, v79
    v_exp_f32 v82, v82
    v_exp_f32 v83, v83
    v_cvt_pk_bf16_f32 v50, v80, v81
    v_cvt_pk_bf16_f32 v51, v82, v83
    s_waitcnt lgkmcnt(2)
    v_mfma_f32_32x32x16_bf16 v[68:83], v[24:27], v[8:11], v[100:115]
    v_exp_f32 v84, v84
    v_exp_f32 v85, v85
    v_exp_f32 v86, v86
    buffer_load_dwordx4 v231, s[8:11], s24 offen offset:1024 lds
    s_add_u32 s24, s24, 4096
    s_waitcnt lgkmcnt(0)
    v_mfma_f32_32x32x16_bf16 v[132:147], v[32:35], v[44:47], v[132:147]
    v_exp_f32 v87, v87
    s_setprio 2
    v_cvt_pk_bf16_f32 v52, v84, v85
    v_exp_f32 v88, v88
    v_exp_f32 v89, v89
    buffer_store_dwordx4 v[204:207], v231, s[16:19], s62 offen sc0 sc1
    s_add_u32 s62, s62, 114688
    v_mfma_f32_32x32x16_bf16 v[68:83], v[28:31], v[12:15], v[68:83]
    v_cvt_pk_bf16_f32 v53, v86, v87
    v_exp_f32 v90, v90
    v_exp_f32 v91, v91
    v_exp_f32 v92, v92
    v_mfma_f32_32x32x16_bf16 v[132:147], v[36:39], v[48:51], v[132:147]
    v_cvt_pk_bf16_f32 v54, v88, v89
    v_cvt_pk_bf16_f32 v55, v90, v91
    v_exp_f32 v93, v93
    v_exp_f32 v94, v94
    v_mfma_f32_16x16x32_bf16 v[60:63], v[40:43], v[44:47], v[60:63]
    v_exp_f32 v95, v95
    v_cvt_pk_bf16_f32 v56, v92, v93
    v_exp_f32 v96, v96
    v_mfma_f32_16x16x32_bf16 v[60:63], v[40:43], v[48:51], v[60:63]
    v_exp_f32 v97, v97
    v_cvt_pk_bf16_f32 v57, v94, v95
    v_exp_f32 v98, v98
    v_exp_f32 v99, v99
    v_cvt_pk_bf16_f32 v58, v96, v97
    v_cvt_pk_bf16_f32 v59, v98, v99
    v_mfma_f32_32x32x16_bf16 v[84:99], v[24:27], v[16:19], v[116:131]
    v_exp_f32 v68, v68
    v_exp_f32 v69, v69
    v_exp_f32 v70, v70
    s_waitcnt vmcnt(12)
    buffer_store_dwordx4 v[240:243], v251, s[16:19], s51 offen sc0 sc1
    v_mfma_f32_32x32x16_bf16 v[148:163], v[32:35], v[52:55], v[148:163]
    v_exp_f32 v71, v71
    v_cvt_pk_bf16_f32 v44, v68, v69
    v_exp_f32 v72, v72
    v_exp_f32 v73, v73
    buffer_load_dwordx4 v[246:249], v231, s[40:43], s48 offen
    v_mfma_f32_32x32x16_bf16 v[84:99], v[28:31], v[20:23], v[84:99]
    v_cvt_pk_bf16_f32 v45, v70, v71
    v_exp_f32 v74, v74
    ds_read_b128 v[24:27], v228 offset:36864
    ds_read_b128 v[28:31], v228 offset:37888
    v_exp_f32 v75, v75
    v_exp_f32 v76, v76
    v_mfma_f32_32x32x16_bf16 v[148:163], v[36:39], v[56:59], v[148:163]
    s_setprio 1
    v_cvt_pk_bf16_f32 v46, v72, v73
    v_cvt_pk_bf16_f32 v47, v74, v75
    v_exp_f32 v77, v77
    ds_read_b128 v[32:35], v228 offset:38912
    ds_read_b128 v[36:39], v228 offset:39936
    v_exp_f32 v78, v78
    v_mfma_f32_16x16x32_bf16 v[64:67], v[40:43], v[52:55], v[64:67]
    v_exp_f32 v79, v79
    v_cvt_pk_bf16_f32 v48, v76, v77
    v_exp_f32 v80, v80
    v_mfma_f32_16x16x32_bf16 v[64:67], v[40:43], v[56:59], v[64:67]
    v_exp_f32 v81, v81
    v_cvt_pk_bf16_f32 v49, v78, v79
    v_exp_f32 v82, v82
    v_exp_f32 v83, v83
    v_cvt_pk_bf16_f32 v50, v80, v81
    v_cvt_pk_bf16_f32 v51, v82, v83
    s_waitcnt lgkmcnt(2)
    v_mfma_f32_32x32x16_bf16 v[68:83], v[24:27], v[8:11], v[100:115]
    v_exp_f32 v84, v84
    v_exp_f32 v85, v85
    v_exp_f32 v86, v86
    s_waitcnt lgkmcnt(0)
    v_mfma_f32_32x32x16_bf16 v[132:147], v[32:35], v[44:47], v[132:147]
    v_exp_f32 v87, v87
    v_cvt_pk_bf16_f32 v52, v84, v85
    v_exp_f32 v88, v88
    v_exp_f32 v89, v89
    v_mfma_f32_32x32x16_bf16 v[68:83], v[28:31], v[12:15], v[68:83]
    v_cvt_pk_bf16_f32 v53, v86, v87
    v_exp_f32 v90, v90
    v_exp_f32 v91, v91
    s_setprio 0
    v_exp_f32 v92, v92
    v_mfma_f32_32x32x16_bf16 v[132:147], v[36:39], v[48:51], v[132:147]
    v_cvt_pk_bf16_f32 v54, v88, v89
    v_cvt_pk_bf16_f32 v55, v90, v91
    v_exp_f32 v93, v93
    v_exp_f32 v94, v94
    v_mfma_f32_16x16x32_bf16 v[60:63], v[40:43], v[44:47], v[60:63]
    v_exp_f32 v95, v95
    v_cvt_pk_bf16_f32 v56, v92, v93
    v_exp_f32 v96, v96
    v_mfma_f32_16x16x32_bf16 v[60:63], v[40:43], v[48:51], v[60:63]
    v_exp_f32 v97, v97
    v_cvt_pk_bf16_f32 v57, v94, v95
    v_exp_f32 v98, v98
    v_exp_f32 v99, v99
    v_cvt_pk_bf16_f32 v58, v96, v97
    v_cvt_pk_bf16_f32 v59, v98, v99
    s_waitcnt vmcnt(12)
    s_barrier
    s_setprio 3
    v_mfma_f32_32x32x16_bf16 v[84:99], v[24:27], v[16:19], v[116:131]
    v_exp_f32 v68, v68
    v_exp_f32 v69, v69
    v_exp_f32 v70, v70
    s_add_u32 m0, s25, 32768
    s_nop 0
    v_mfma_f32_32x32x16_bf16 v[148:163], v[32:35], v[52:55], v[148:163]
    v_exp_f32 v71, v71
    v_cvt_pk_bf16_f32 v44, v68, v69
    v_exp_f32 v72, v72
    v_exp_f32 v73, v73
    buffer_load_dwordx4 v231, s[8:11], s24 offen lds
    v_mfma_f32_32x32x16_bf16 v[84:99], v[28:31], v[20:23], v[84:99]
    v_cvt_pk_bf16_f32 v45, v70, v71
    v_exp_f32 v74, v74
    ds_read_b128 v[24:27], v228 offset:49152
    ds_read_b128 v[28:31], v228 offset:50176
    v_exp_f32 v75, v75
    v_exp_f32 v76, v76
    v_mfma_f32_32x32x16_bf16 v[148:163], v[36:39], v[56:59], v[148:163]
    v_cvt_pk_bf16_f32 v46, v72, v73
    v_cvt_pk_bf16_f32 v47, v74, v75
    v_exp_f32 v77, v77
    ds_read_b128 v[32:35], v228 offset:51200
    ds_read_b128 v[36:39], v228 offset:52224
    v_exp_f32 v78, v78
    v_mfma_f32_16x16x32_bf16 v[64:67], v[40:43], v[52:55], v[64:67]
    v_exp_f32 v79, v79
    v_cvt_pk_bf16_f32 v48, v76, v77
    v_exp_f32 v80, v80
    v_mfma_f32_16x16x32_bf16 v[64:67], v[40:43], v[56:59], v[64:67]
    v_exp_f32 v81, v81
    v_cvt_pk_bf16_f32 v49, v78, v79
    v_exp_f32 v82, v82
    v_exp_f32 v83, v83
    v_cvt_pk_bf16_f32 v50, v80, v81
    v_cvt_pk_bf16_f32 v51, v82, v83
    s_waitcnt lgkmcnt(2)
    v_mfma_f32_32x32x16_bf16 v[68:83], v[24:27], v[8:11], v[100:115]
    v_exp_f32 v84, v84
    v_exp_f32 v85, v85
    v_exp_f32 v86, v86
    buffer_load_dwordx4 v231, s[8:11], s24 offen offset:1024 lds
    s_add_u32 s24, s24, 4096
    s_waitcnt lgkmcnt(0)
    v_mfma_f32_32x32x16_bf16 v[132:147], v[32:35], v[44:47], v[132:147]
    v_exp_f32 v87, v87
    s_setprio 2
    v_cvt_pk_bf16_f32 v52, v84, v85
    v_exp_f32 v88, v88
    v_exp_f32 v89, v89
    buffer_store_dwordx4 v[224:227], v231, s[16:19], s62 offen sc0 sc1
    s_mov_b32 s62, 1879048192
    v_mfma_f32_32x32x16_bf16 v[68:83], v[28:31], v[12:15], v[68:83]
    v_cvt_pk_bf16_f32 v53, v86, v87
    v_exp_f32 v90, v90
    v_exp_f32 v91, v91
    v_exp_f32 v92, v92
    v_mfma_f32_32x32x16_bf16 v[132:147], v[36:39], v[48:51], v[132:147]
    v_cvt_pk_bf16_f32 v54, v88, v89
    v_cvt_pk_bf16_f32 v55, v90, v91
    v_exp_f32 v93, v93
    v_exp_f32 v94, v94
    v_mfma_f32_16x16x32_bf16 v[60:63], v[40:43], v[44:47], v[60:63]
    v_exp_f32 v95, v95
    v_cvt_pk_bf16_f32 v56, v92, v93
    v_exp_f32 v96, v96
    v_mfma_f32_16x16x32_bf16 v[60:63], v[40:43], v[48:51], v[60:63]
    v_exp_f32 v97, v97
    v_cvt_pk_bf16_f32 v57, v94, v95
    v_exp_f32 v98, v98
    v_exp_f32 v99, v99
    v_cvt_pk_bf16_f32 v58, v96, v97
    v_cvt_pk_bf16_f32 v59, v98, v99
    v_mfma_f32_32x32x16_bf16 v[84:99], v[24:27], v[16:19], v[116:131]
    v_exp_f32 v68, v68
    v_exp_f32 v69, v69
    v_exp_f32 v70, v70
    buffer_load_dwordx4 v[246:249], v231, s[40:43], s49 offen
    v_mfma_f32_32x32x16_bf16 v[148:163], v[32:35], v[52:55], v[148:163]
    v_exp_f32 v71, v71
    v_cvt_pk_bf16_f32 v44, v68, v69
    v_exp_f32 v72, v72
    v_exp_f32 v73, v73
    v_mfma_f32_32x32x16_bf16 v[84:99], v[28:31], v[20:23], v[84:99]
    v_cvt_pk_bf16_f32 v45, v70, v71
    v_exp_f32 v74, v74
    ds_read_b128 v[24:27], v228 offset:53248
    ds_read_b128 v[28:31], v228 offset:54272
    v_exp_f32 v75, v75
    v_exp_f32 v76, v76
    v_mfma_f32_32x32x16_bf16 v[148:163], v[36:39], v[56:59], v[148:163]
    v_cvt_pk_bf16_f32 v46, v72, v73
    v_cvt_pk_bf16_f32 v47, v74, v75
    s_setprio 1
    v_exp_f32 v77, v77
    ds_read_b128 v[32:35], v228 offset:55296
    ds_read_b128 v[36:39], v228 offset:56320
    v_exp_f32 v78, v78
    v_mfma_f32_16x16x32_bf16 v[64:67], v[40:43], v[52:55], v[64:67]
    v_exp_f32 v79, v79
    v_cvt_pk_bf16_f32 v48, v76, v77
    v_exp_f32 v80, v80
    v_mfma_f32_16x16x32_bf16 v[64:67], v[40:43], v[56:59], v[64:67]
    v_exp_f32 v81, v81
    v_cvt_pk_bf16_f32 v49, v78, v79
    v_exp_f32 v82, v82
    v_exp_f32 v83, v83
    v_cvt_pk_bf16_f32 v50, v80, v81
    v_cvt_pk_bf16_f32 v51, v82, v83
    s_waitcnt lgkmcnt(2)
    v_mfma_f32_32x32x16_bf16 v[68:83], v[24:27], v[8:11], v[100:115]
    v_exp_f32 v84, v84
    v_exp_f32 v85, v85
    v_exp_f32 v86, v86
    s_waitcnt lgkmcnt(0)
    v_mfma_f32_32x32x16_bf16 v[132:147], v[32:35], v[44:47], v[132:147]
    v_exp_f32 v87, v87
    v_cvt_pk_bf16_f32 v52, v84, v85
    v_exp_f32 v88, v88
    v_exp_f32 v89, v89
    v_mfma_f32_32x32x16_bf16 v[68:83], v[28:31], v[12:15], v[68:83]
    v_cvt_pk_bf16_f32 v53, v86, v87
    v_exp_f32 v90, v90
    v_exp_f32 v91, v91
    s_setprio 0
    v_exp_f32 v92, v92
    v_mfma_f32_32x32x16_bf16 v[132:147], v[36:39], v[48:51], v[132:147]
    v_cvt_pk_bf16_f32 v54, v88, v89
    v_cvt_pk_bf16_f32 v55, v90, v91
    v_exp_f32 v93, v93
    v_exp_f32 v94, v94
    v_mfma_f32_16x16x32_bf16 v[60:63], v[40:43], v[44:47], v[60:63]
    v_exp_f32 v95, v95
    v_cvt_pk_bf16_f32 v56, v92, v93
    v_exp_f32 v96, v96
    v_mfma_f32_16x16x32_bf16 v[60:63], v[40:43], v[48:51], v[60:63]
    v_exp_f32 v97, v97
    v_cvt_pk_bf16_f32 v57, v94, v95
    v_exp_f32 v98, v98
    v_exp_f32 v99, v99
    v_cvt_pk_bf16_f32 v58, v96, v97
    v_cvt_pk_bf16_f32 v59, v98, v99
    s_waitcnt vmcnt(11)
    s_barrier
    s_setprio 3
    v_mfma_f32_32x32x16_bf16 v[84:99], v[24:27], v[16:19], v[116:131]
    v_exp_f32 v68, v68
    v_exp_f32 v69, v69
    v_exp_f32 v70, v70
    s_add_u32 m0, s25, 49152
    s_nop 0
    v_mfma_f32_32x32x16_bf16 v[148:163], v[32:35], v[52:55], v[148:163]
    v_exp_f32 v71, v71
    v_cvt_pk_bf16_f32 v44, v68, v69
    v_exp_f32 v72, v72
    v_exp_f32 v73, v73
    buffer_load_dwordx4 v231, s[8:11], s24 offen lds
    v_mfma_f32_32x32x16_bf16 v[84:99], v[28:31], v[20:23], v[84:99]
    v_cvt_pk_bf16_f32 v45, v70, v71
    v_exp_f32 v74, v74
    ds_read_b128 v[24:27], v228 offset:0
    ds_read_b128 v[28:31], v228 offset:1024
    v_exp_f32 v75, v75
    v_exp_f32 v76, v76
    v_mfma_f32_32x32x16_bf16 v[148:163], v[36:39], v[56:59], v[148:163]
    v_cvt_pk_bf16_f32 v46, v72, v73
    v_cvt_pk_bf16_f32 v47, v74, v75
    v_exp_f32 v77, v77
    ds_read_b128 v[32:35], v228 offset:2048
    ds_read_b128 v[36:39], v228 offset:3072
    v_exp_f32 v78, v78
    v_mfma_f32_16x16x32_bf16 v[64:67], v[40:43], v[52:55], v[64:67]
    v_exp_f32 v79, v79
    v_cvt_pk_bf16_f32 v48, v76, v77
    v_exp_f32 v80, v80
    v_mfma_f32_16x16x32_bf16 v[64:67], v[40:43], v[56:59], v[64:67]
    v_exp_f32 v81, v81
    v_cvt_pk_bf16_f32 v49, v78, v79
    v_exp_f32 v82, v82
    v_exp_f32 v83, v83
    v_cvt_pk_bf16_f32 v50, v80, v81
    v_cvt_pk_bf16_f32 v51, v82, v83
    s_waitcnt lgkmcnt(2)
    v_mfma_f32_32x32x16_bf16 v[68:83], v[24:27], v[8:11], v[100:115]
    v_exp_f32 v84, v84
    v_exp_f32 v85, v85
    v_exp_f32 v86, v86
    buffer_load_dwordx4 v231, s[8:11], s24 offen offset:1024 lds
    s_add_u32 s24, s24, 4096
    s_waitcnt lgkmcnt(0)
    v_mfma_f32_32x32x16_bf16 v[132:147], v[32:35], v[44:47], v[132:147]
    v_exp_f32 v87, v87
    s_setprio 2
    v_cvt_pk_bf16_f32 v52, v84, v85
    v_exp_f32 v88, v88
    v_exp_f32 v89, v89
    buffer_store_dwordx4 v[208:211], v231, s[16:19], s63 offen sc0 sc1
    s_add_u32 s63, s63, 114688
    v_mfma_f32_32x32x16_bf16 v[68:83], v[28:31], v[12:15], v[68:83]
    v_cvt_pk_bf16_f32 v53, v86, v87
    v_exp_f32 v90, v90
    v_exp_f32 v91, v91
    v_exp_f32 v92, v92
    v_mfma_f32_32x32x16_bf16 v[132:147], v[36:39], v[48:51], v[132:147]
    v_cvt_pk_bf16_f32 v54, v88, v89
    v_cvt_pk_bf16_f32 v55, v90, v91
    v_exp_f32 v93, v93
    v_exp_f32 v94, v94
    v_mfma_f32_16x16x32_bf16 v[60:63], v[40:43], v[44:47], v[60:63]
    v_exp_f32 v95, v95
    v_cvt_pk_bf16_f32 v56, v92, v93
    v_exp_f32 v96, v96
    v_mfma_f32_16x16x32_bf16 v[60:63], v[40:43], v[48:51], v[60:63]
    v_exp_f32 v97, v97
    v_cvt_pk_bf16_f32 v57, v94, v95
    v_exp_f32 v98, v98
    v_exp_f32 v99, v99
    v_cvt_pk_bf16_f32 v58, v96, v97
    v_cvt_pk_bf16_f32 v59, v98, v99
    v_mfma_f32_32x32x16_bf16 v[84:99], v[24:27], v[16:19], v[116:131]
    v_exp_f32 v68, v68
    v_exp_f32 v69, v69
    v_exp_f32 v70, v70
    buffer_load_dwordx4 v[246:249], v231, s[40:43], s52 offen
    v_mfma_f32_32x32x16_bf16 v[148:163], v[32:35], v[52:55], v[148:163]
    v_exp_f32 v71, v71
    v_cvt_pk_bf16_f32 v44, v68, v69
    v_exp_f32 v72, v72
    v_exp_f32 v73, v73
    v_mfma_f32_32x32x16_bf16 v[84:99], v[28:31], v[20:23], v[84:99]
    v_cvt_pk_bf16_f32 v45, v70, v71
    v_exp_f32 v74, v74
    ds_read_b128 v[24:27], v228 offset:4096
    ds_read_b128 v[28:31], v228 offset:5120
    v_exp_f32 v75, v75
    v_exp_f32 v76, v76
    v_mfma_f32_32x32x16_bf16 v[148:163], v[36:39], v[56:59], v[148:163]
    v_cvt_pk_bf16_f32 v46, v72, v73
    v_cvt_pk_bf16_f32 v47, v74, v75
    s_setprio 1
    v_exp_f32 v77, v77
    ds_read_b128 v[32:35], v228 offset:6144
    ds_read_b128 v[36:39], v228 offset:7168
    v_exp_f32 v78, v78
    v_mfma_f32_16x16x32_bf16 v[64:67], v[40:43], v[52:55], v[64:67]
    v_exp_f32 v79, v79
    v_cvt_pk_bf16_f32 v48, v76, v77
    v_exp_f32 v80, v80
    v_mfma_f32_16x16x32_bf16 v[64:67], v[40:43], v[56:59], v[64:67]
    v_exp_f32 v81, v81
    v_cvt_pk_bf16_f32 v49, v78, v79
    v_exp_f32 v82, v82
    v_exp_f32 v83, v83
    v_cvt_pk_bf16_f32 v50, v80, v81
    v_cvt_pk_bf16_f32 v51, v82, v83
    s_waitcnt lgkmcnt(2)
    v_mfma_f32_32x32x16_bf16 v[68:83], v[24:27], v[8:11], v[100:115]
    v_exp_f32 v84, v84
    v_exp_f32 v85, v85
    v_exp_f32 v86, v86
    s_waitcnt lgkmcnt(0)
    v_mfma_f32_32x32x16_bf16 v[132:147], v[32:35], v[44:47], v[132:147]
    v_exp_f32 v87, v87
    v_cvt_pk_bf16_f32 v52, v84, v85
    v_exp_f32 v88, v88
    v_exp_f32 v89, v89
    v_mfma_f32_32x32x16_bf16 v[68:83], v[28:31], v[12:15], v[68:83]
    v_cvt_pk_bf16_f32 v53, v86, v87
    v_exp_f32 v90, v90
    v_exp_f32 v91, v91
    s_setprio 0
    v_exp_f32 v92, v92
    v_mfma_f32_32x32x16_bf16 v[132:147], v[36:39], v[48:51], v[132:147]
    v_cvt_pk_bf16_f32 v54, v88, v89
    v_cvt_pk_bf16_f32 v55, v90, v91
    v_exp_f32 v93, v93
    v_exp_f32 v94, v94
    v_mfma_f32_16x16x32_bf16 v[60:63], v[40:43], v[44:47], v[60:63]
    v_exp_f32 v95, v95
    v_cvt_pk_bf16_f32 v56, v92, v93
    v_exp_f32 v96, v96
    v_mfma_f32_16x16x32_bf16 v[60:63], v[40:43], v[48:51], v[60:63]
    v_exp_f32 v97, v97
    v_cvt_pk_bf16_f32 v57, v94, v95
    v_exp_f32 v98, v98
    v_exp_f32 v99, v99
    v_cvt_pk_bf16_f32 v58, v96, v97
    v_cvt_pk_bf16_f32 v59, v98, v99
    s_waitcnt vmcnt(11)
    s_barrier
    s_setprio 3
    v_mfma_f32_32x32x16_bf16 v[84:99], v[24:27], v[16:19], v[116:131]
    v_exp_f32 v68, v68
    v_exp_f32 v69, v69
    v_exp_f32 v70, v70
    s_add_u32 m0, s25, 0
    s_nop 0
    v_mfma_f32_32x32x16_bf16 v[148:163], v[32:35], v[52:55], v[148:163]
    v_exp_f32 v71, v71
    v_cvt_pk_bf16_f32 v44, v68, v69
    v_exp_f32 v72, v72
    v_exp_f32 v73, v73
    buffer_load_dwordx4 v231, s[8:11], s24 offen lds
    v_mfma_f32_32x32x16_bf16 v[84:99], v[28:31], v[20:23], v[84:99]
    v_cvt_pk_bf16_f32 v45, v70, v71
    v_exp_f32 v74, v74
    ds_read_b128 v[24:27], v228 offset:16384
    ds_read_b128 v[28:31], v228 offset:17408
    v_exp_f32 v75, v75
    v_exp_f32 v76, v76
    v_mfma_f32_32x32x16_bf16 v[148:163], v[36:39], v[56:59], v[148:163]
    v_cvt_pk_bf16_f32 v46, v72, v73
    v_cvt_pk_bf16_f32 v47, v74, v75
    v_exp_f32 v77, v77
    ds_read_b128 v[32:35], v228 offset:18432
    ds_read_b128 v[36:39], v228 offset:19456
    v_exp_f32 v78, v78
    v_mfma_f32_16x16x32_bf16 v[64:67], v[40:43], v[52:55], v[64:67]
    v_exp_f32 v79, v79
    v_cvt_pk_bf16_f32 v48, v76, v77
    v_exp_f32 v80, v80
    v_mfma_f32_16x16x32_bf16 v[64:67], v[40:43], v[56:59], v[64:67]
    v_exp_f32 v81, v81
    v_cvt_pk_bf16_f32 v49, v78, v79
    v_exp_f32 v82, v82
    v_exp_f32 v83, v83
    v_cvt_pk_bf16_f32 v50, v80, v81
    v_cvt_pk_bf16_f32 v51, v82, v83
    s_waitcnt lgkmcnt(2)
    v_mfma_f32_32x32x16_bf16 v[68:83], v[24:27], v[8:11], v[100:115]
    v_exp_f32 v84, v84
    v_exp_f32 v85, v85
    v_exp_f32 v86, v86
    buffer_load_dwordx4 v231, s[8:11], s24 offen offset:1024 lds
    s_add_u32 s24, s24, 4096
    s_waitcnt lgkmcnt(0)
    v_mfma_f32_32x32x16_bf16 v[132:147], v[32:35], v[44:47], v[132:147]
    v_exp_f32 v87, v87
    s_setprio 2
    v_cvt_pk_bf16_f32 v52, v84, v85
    v_exp_f32 v88, v88
    v_exp_f32 v89, v89
    buffer_store_dwordx4 v[212:215], v231, s[16:19], s63 offen sc0 sc1
    s_add_u32 s63, s63, 114688
    v_mfma_f32_32x32x16_bf16 v[68:83], v[28:31], v[12:15], v[68:83]
    v_cvt_pk_bf16_f32 v53, v86, v87
    v_exp_f32 v90, v90
    v_exp_f32 v91, v91
    v_exp_f32 v92, v92
    v_mfma_f32_32x32x16_bf16 v[132:147], v[36:39], v[48:51], v[132:147]
    v_cvt_pk_bf16_f32 v54, v88, v89
    v_cvt_pk_bf16_f32 v55, v90, v91
    v_exp_f32 v93, v93
    v_exp_f32 v94, v94
    v_mfma_f32_16x16x32_bf16 v[60:63], v[40:43], v[44:47], v[60:63]
    v_exp_f32 v95, v95
    v_cvt_pk_bf16_f32 v56, v92, v93
    v_exp_f32 v96, v96
    v_mfma_f32_16x16x32_bf16 v[60:63], v[40:43], v[48:51], v[60:63]
    v_exp_f32 v97, v97
    v_cvt_pk_bf16_f32 v57, v94, v95
    v_exp_f32 v98, v98
    v_exp_f32 v99, v99
    v_cvt_pk_bf16_f32 v58, v96, v97
    v_cvt_pk_bf16_f32 v59, v98, v99
    v_mfma_f32_32x32x16_bf16 v[84:99], v[24:27], v[16:19], v[116:131]
    v_exp_f32 v68, v68
    v_exp_f32 v69, v69
    v_exp_f32 v70, v70
    v_mfma_f32_32x32x16_bf16 v[148:163], v[32:35], v[52:55], v[148:163]
    v_exp_f32 v71, v71
    v_cvt_pk_bf16_f32 v44, v68, v69
    v_exp_f32 v72, v72
    v_exp_f32 v73, v73
    v_mfma_f32_32x32x16_bf16 v[84:99], v[28:31], v[20:23], v[84:99]
    v_cvt_pk_bf16_f32 v45, v70, v71
    v_exp_f32 v74, v74
    ds_read_b128 v[24:27], v228 offset:20480
    ds_read_b128 v[28:31], v228 offset:21504
    v_exp_f32 v75, v75
    v_exp_f32 v76, v76
    v_mfma_f32_32x32x16_bf16 v[148:163], v[36:39], v[56:59], v[148:163]
    v_cvt_pk_bf16_f32 v46, v72, v73
    v_cvt_pk_bf16_f32 v47, v74, v75
    v_exp_f32 v77, v77
    s_setprio 1
    ds_read_b128 v[32:35], v228 offset:22528
    ds_read_b128 v[36:39], v228 offset:23552
    v_exp_f32 v78, v78
    v_mfma_f32_16x16x32_bf16 v[64:67], v[40:43], v[52:55], v[64:67]
    v_exp_f32 v79, v79
    v_cvt_pk_bf16_f32 v48, v76, v77
    v_exp_f32 v80, v80
    v_mfma_f32_16x16x32_bf16 v[64:67], v[40:43], v[56:59], v[64:67]
    v_exp_f32 v81, v81
    v_cvt_pk_bf16_f32 v49, v78, v79
    v_exp_f32 v82, v82
    v_exp_f32 v83, v83
    v_cvt_pk_bf16_f32 v50, v80, v81
    v_cvt_pk_bf16_f32 v51, v82, v83
    s_waitcnt lgkmcnt(2)
    v_mfma_f32_32x32x16_bf16 v[68:83], v[24:27], v[8:11], v[100:115]
    v_exp_f32 v84, v84
    v_exp_f32 v85, v85
    v_exp_f32 v86, v86
    s_waitcnt lgkmcnt(0)
    v_mfma_f32_32x32x16_bf16 v[132:147], v[32:35], v[44:47], v[132:147]
    v_exp_f32 v87, v87
    v_cvt_pk_bf16_f32 v52, v84, v85
    v_exp_f32 v88, v88
    v_exp_f32 v89, v89
    v_mfma_f32_32x32x16_bf16 v[68:83], v[28:31], v[12:15], v[68:83]
    v_cvt_pk_bf16_f32 v53, v86, v87
    v_exp_f32 v90, v90
    v_exp_f32 v91, v91
    s_setprio 0
    v_exp_f32 v92, v92
    v_mfma_f32_32x32x16_bf16 v[132:147], v[36:39], v[48:51], v[132:147]
    v_cvt_pk_bf16_f32 v54, v88, v89
    v_cvt_pk_bf16_f32 v55, v90, v91
    v_exp_f32 v93, v93
    v_exp_f32 v94, v94
    v_mfma_f32_16x16x32_bf16 v[60:63], v[40:43], v[44:47], v[60:63]
    v_exp_f32 v95, v95
    v_cvt_pk_bf16_f32 v56, v92, v93
    v_exp_f32 v96, v96
    v_mfma_f32_16x16x32_bf16 v[60:63], v[40:43], v[48:51], v[60:63]
    v_exp_f32 v97, v97
    v_cvt_pk_bf16_f32 v57, v94, v95
    v_exp_f32 v98, v98
    v_exp_f32 v99, v99
    v_cvt_pk_bf16_f32 v58, v96, v97
    v_cvt_pk_bf16_f32 v59, v98, v99
    s_waitcnt vmcnt(9)
    s_barrier
    s_setprio 3
    v_mfma_f32_32x32x16_bf16 v[84:99], v[24:27], v[16:19], v[116:131]
    v_exp_f32 v68, v68
    v_exp_f32 v69, v69
    v_exp_f32 v70, v70
    s_add_u32 m0, s25, 16384
    s_nop 0
    v_mfma_f32_32x32x16_bf16 v[148:163], v[32:35], v[52:55], v[148:163]
    v_exp_f32 v71, v71
    v_cvt_pk_bf16_f32 v44, v68, v69
    v_exp_f32 v72, v72
    v_exp_f32 v73, v73
    buffer_load_dwordx4 v231, s[8:11], s24 offen lds
    v_mfma_f32_32x32x16_bf16 v[84:99], v[28:31], v[20:23], v[84:99]
    v_cvt_pk_bf16_f32 v45, v70, v71
    v_exp_f32 v74, v74
    ds_read_b128 v[24:27], v228 offset:32768
    ds_read_b128 v[28:31], v228 offset:33792
    v_exp_f32 v75, v75
    v_exp_f32 v76, v76
    v_mfma_f32_32x32x16_bf16 v[148:163], v[36:39], v[56:59], v[148:163]
    v_cvt_pk_bf16_f32 v46, v72, v73
    v_cvt_pk_bf16_f32 v47, v74, v75
    v_exp_f32 v77, v77
    ds_read_b128 v[32:35], v228 offset:34816
    ds_read_b128 v[36:39], v228 offset:35840
    v_exp_f32 v78, v78
    v_mfma_f32_16x16x32_bf16 v[64:67], v[40:43], v[52:55], v[64:67]
    v_exp_f32 v79, v79
    v_cvt_pk_bf16_f32 v48, v76, v77
    v_exp_f32 v80, v80
    v_mfma_f32_16x16x32_bf16 v[64:67], v[40:43], v[56:59], v[64:67]
    v_exp_f32 v81, v81
    v_cvt_pk_bf16_f32 v49, v78, v79
    v_exp_f32 v82, v82
    v_exp_f32 v83, v83
    v_cvt_pk_bf16_f32 v50, v80, v81
    v_cvt_pk_bf16_f32 v51, v82, v83
    s_waitcnt lgkmcnt(2)
    v_mfma_f32_32x32x16_bf16 v[68:83], v[24:27], v[8:11], v[100:115]
    v_exp_f32 v84, v84
    v_exp_f32 v85, v85
    v_exp_f32 v86, v86
    buffer_load_dwordx4 v231, s[8:11], s24 offen offset:1024 lds
    s_add_u32 s24, s24, 4096
    s_waitcnt lgkmcnt(0)
    v_mfma_f32_32x32x16_bf16 v[132:147], v[32:35], v[44:47], v[132:147]
    v_exp_f32 v87, v87
    s_setprio 2
    v_cvt_pk_bf16_f32 v52, v84, v85
    v_exp_f32 v88, v88
    v_exp_f32 v89, v89
    buffer_store_dwordx4 v[216:219], v231, s[16:19], s63 offen sc0 sc1
    s_add_u32 s63, s63, 114688
    v_mfma_f32_32x32x16_bf16 v[68:83], v[28:31], v[12:15], v[68:83]
    v_cvt_pk_bf16_f32 v53, v86, v87
    v_exp_f32 v90, v90
    v_exp_f32 v91, v91
    v_exp_f32 v92, v92
    v_mfma_f32_32x32x16_bf16 v[132:147], v[36:39], v[48:51], v[132:147]
    v_cvt_pk_bf16_f32 v54, v88, v89
    v_cvt_pk_bf16_f32 v55, v90, v91
    v_exp_f32 v93, v93
    v_exp_f32 v94, v94
    v_mfma_f32_16x16x32_bf16 v[60:63], v[40:43], v[44:47], v[60:63]
    v_exp_f32 v95, v95
    v_cvt_pk_bf16_f32 v56, v92, v93
    v_exp_f32 v96, v96
    v_mfma_f32_16x16x32_bf16 v[60:63], v[40:43], v[48:51], v[60:63]
    v_exp_f32 v97, v97
    v_cvt_pk_bf16_f32 v57, v94, v95
    v_exp_f32 v98, v98
    v_exp_f32 v99, v99
    v_cvt_pk_bf16_f32 v58, v96, v97
    v_cvt_pk_bf16_f32 v59, v98, v99
    v_mfma_f32_32x32x16_bf16 v[84:99], v[24:27], v[16:19], v[116:131]
    v_exp_f32 v68, v68
    v_exp_f32 v69, v69
    v_exp_f32 v70, v70
    v_mfma_f32_32x32x16_bf16 v[148:163], v[32:35], v[52:55], v[148:163]
    v_exp_f32 v71, v71
    v_cvt_pk_bf16_f32 v44, v68, v69
    v_exp_f32 v72, v72
    v_exp_f32 v73, v73
    v_mfma_f32_32x32x16_bf16 v[84:99], v[28:31], v[20:23], v[84:99]
    v_cvt_pk_bf16_f32 v45, v70, v71
    v_exp_f32 v74, v74
    ds_read_b128 v[24:27], v228 offset:36864
    ds_read_b128 v[28:31], v228 offset:37888
    v_exp_f32 v75, v75
    v_exp_f32 v76, v76
    v_mfma_f32_32x32x16_bf16 v[148:163], v[36:39], v[56:59], v[148:163]
    v_cvt_pk_bf16_f32 v46, v72, v73
    v_cvt_pk_bf16_f32 v47, v74, v75
    v_exp_f32 v77, v77
    s_setprio 1
    ds_read_b128 v[32:35], v228 offset:38912
    ds_read_b128 v[36:39], v228 offset:39936
    v_exp_f32 v78, v78
    v_mfma_f32_16x16x32_bf16 v[64:67], v[40:43], v[52:55], v[64:67]
    v_exp_f32 v79, v79
    v_cvt_pk_bf16_f32 v48, v76, v77
    v_exp_f32 v80, v80
    v_mfma_f32_16x16x32_bf16 v[64:67], v[40:43], v[56:59], v[64:67]
    v_exp_f32 v81, v81
    v_cvt_pk_bf16_f32 v49, v78, v79
    v_exp_f32 v82, v82
    v_exp_f32 v83, v83
    v_cvt_pk_bf16_f32 v50, v80, v81
    v_cvt_pk_bf16_f32 v51, v82, v83
    s_waitcnt lgkmcnt(2)
    v_mfma_f32_32x32x16_bf16 v[68:83], v[24:27], v[8:11], v[100:115]
    v_exp_f32 v84, v84
    v_exp_f32 v85, v85
    v_exp_f32 v86, v86
    s_mov_b32 s44, s100
    s_mov_b32 s45, s101
    s_waitcnt lgkmcnt(0)
    v_mfma_f32_32x32x16_bf16 v[132:147], v[32:35], v[44:47], v[132:147]
    v_exp_f32 v87, v87
    v_cvt_pk_bf16_f32 v52, v84, v85
    v_exp_f32 v88, v88
    v_exp_f32 v89, v89
    s_mov_b32 s46, 4194304
    v_mfma_f32_32x32x16_bf16 v[68:83], v[28:31], v[12:15], v[68:83]
    s_setprio 0
    v_cvt_pk_bf16_f32 v53, v86, v87
    v_exp_f32 v90, v90
    v_exp_f32 v91, v91
    v_exp_f32 v92, v92
    v_mfma_f32_32x32x16_bf16 v[132:147], v[36:39], v[48:51], v[132:147]
    v_cvt_pk_bf16_f32 v54, v88, v89
    v_cvt_pk_bf16_f32 v55, v90, v91
    v_exp_f32 v93, v93
    v_exp_f32 v94, v94
    v_mfma_f32_16x16x32_bf16 v[60:63], v[40:43], v[44:47], v[60:63]
    v_exp_f32 v95, v95
    v_cvt_pk_bf16_f32 v56, v92, v93
    v_exp_f32 v96, v96
    v_mfma_f32_16x16x32_bf16 v[60:63], v[40:43], v[48:51], v[60:63]
    v_exp_f32 v97, v97
    v_cvt_pk_bf16_f32 v57, v94, v95
    v_exp_f32 v98, v98
    v_exp_f32 v99, v99
    v_cvt_pk_bf16_f32 v58, v96, v97
    v_cvt_pk_bf16_f32 v59, v98, v99
    s_waitcnt vmcnt(8)
    s_barrier
    s_setprio 3
    v_mfma_f32_32x32x16_bf16 v[84:99], v[24:27], v[16:19], v[116:131]
    v_exp_f32 v68, v68
    v_exp_f32 v69, v69
    v_exp_f32 v70, v70
    s_add_u32 m0, s25, 32768
    s_nop 0
    v_mfma_f32_32x32x16_bf16 v[148:163], v[32:35], v[52:55], v[148:163]
    v_exp_f32 v71, v71
    v_cvt_pk_bf16_f32 v44, v68, v69
    v_exp_f32 v72, v72
    v_exp_f32 v73, v73
    buffer_load_dwordx4 v231, s[8:11], s24 offen lds
    v_mfma_f32_32x32x16_bf16 v[84:99], v[28:31], v[20:23], v[84:99]
    v_cvt_pk_bf16_f32 v45, v70, v71
    v_exp_f32 v74, v74
    ds_read_b128 v[24:27], v228 offset:49152
    ds_read_b128 v[28:31], v228 offset:50176
    v_exp_f32 v75, v75
    v_exp_f32 v76, v76
    v_mfma_f32_32x32x16_bf16 v[148:163], v[36:39], v[56:59], v[148:163]
    v_cvt_pk_bf16_f32 v46, v72, v73
    v_cvt_pk_bf16_f32 v47, v74, v75
    v_exp_f32 v77, v77
    ds_read_b128 v[32:35], v228 offset:51200
    ds_read_b128 v[36:39], v228 offset:52224
    v_exp_f32 v78, v78
    v_mfma_f32_16x16x32_bf16 v[64:67], v[40:43], v[52:55], v[64:67]
    v_exp_f32 v79, v79
    v_cvt_pk_bf16_f32 v48, v76, v77
    v_exp_f32 v80, v80
    v_mfma_f32_16x16x32_bf16 v[64:67], v[40:43], v[56:59], v[64:67]
    v_exp_f32 v81, v81
    v_cvt_pk_bf16_f32 v49, v78, v79
    v_exp_f32 v82, v82
    v_exp_f32 v83, v83
    v_cvt_pk_bf16_f32 v50, v80, v81
    v_cvt_pk_bf16_f32 v51, v82, v83
    s_waitcnt lgkmcnt(2)
    v_mfma_f32_32x32x16_bf16 v[68:83], v[24:27], v[8:11], v[100:115]
    v_exp_f32 v84, v84
    v_exp_f32 v85, v85
    v_exp_f32 v86, v86
    buffer_load_dwordx4 v231, s[8:11], s24 offen offset:1024 lds
    s_add_u32 s24, s24, 4096
    s_waitcnt lgkmcnt(0)
    v_mfma_f32_32x32x16_bf16 v[132:147], v[32:35], v[44:47], v[132:147]
    v_exp_f32 v87, v87
    s_setprio 2
    v_cvt_pk_bf16_f32 v52, v84, v85
    v_exp_f32 v88, v88
    v_exp_f32 v89, v89
    buffer_store_dwordx4 v[220:223], v231, s[16:19], s63 offen sc0 sc1
    s_mov_b32 s63, 1879048192
    v_mfma_f32_32x32x16_bf16 v[68:83], v[28:31], v[12:15], v[68:83]
    v_cvt_pk_bf16_f32 v53, v86, v87
    v_exp_f32 v90, v90
    v_exp_f32 v91, v91
    v_exp_f32 v92, v92
    v_mfma_f32_32x32x16_bf16 v[132:147], v[36:39], v[48:51], v[132:147]
    v_cvt_pk_bf16_f32 v54, v88, v89
    v_cvt_pk_bf16_f32 v55, v90, v91
    v_exp_f32 v93, v93
    v_exp_f32 v94, v94
    v_mfma_f32_16x16x32_bf16 v[60:63], v[40:43], v[44:47], v[60:63]
    v_exp_f32 v95, v95
    v_cvt_pk_bf16_f32 v56, v92, v93
    v_exp_f32 v96, v96
    v_mfma_f32_16x16x32_bf16 v[60:63], v[40:43], v[48:51], v[60:63]
    v_exp_f32 v97, v97
    v_cvt_pk_bf16_f32 v57, v94, v95
    v_exp_f32 v98, v98
    v_exp_f32 v99, v99
    v_cvt_pk_bf16_f32 v58, v96, v97
    v_cvt_pk_bf16_f32 v59, v98, v99
    v_mfma_f32_32x32x16_bf16 v[84:99], v[24:27], v[16:19], v[116:131]
    v_exp_f32 v68, v68
    v_exp_f32 v69, v69
    v_exp_f32 v70, v70
    v_mfma_f32_32x32x16_bf16 v[148:163], v[32:35], v[52:55], v[148:163]
    v_exp_f32 v71, v71
    v_cvt_pk_bf16_f32 v44, v68, v69
    v_exp_f32 v72, v72
    v_exp_f32 v73, v73
    v_mfma_f32_32x32x16_bf16 v[84:99], v[28:31], v[20:23], v[84:99]
    v_cvt_pk_bf16_f32 v45, v70, v71
    v_exp_f32 v74, v74
    ds_read_b128 v[24:27], v228 offset:53248
    ds_read_b128 v[28:31], v228 offset:54272
    v_exp_f32 v75, v75
    v_exp_f32 v76, v76
    v_mfma_f32_32x32x16_bf16 v[148:163], v[36:39], v[56:59], v[148:163]
    v_cvt_pk_bf16_f32 v46, v72, v73
    v_cvt_pk_bf16_f32 v47, v74, v75
    v_exp_f32 v77, v77
    s_setprio 1
    ds_read_b128 v[32:35], v228 offset:55296
    ds_read_b128 v[36:39], v228 offset:56320
    v_exp_f32 v78, v78
    v_mfma_f32_16x16x32_bf16 v[64:67], v[40:43], v[52:55], v[64:67]
    v_exp_f32 v79, v79
    v_cvt_pk_bf16_f32 v48, v76, v77
    v_exp_f32 v80, v80
    v_mfma_f32_16x16x32_bf16 v[64:67], v[40:43], v[56:59], v[64:67]
    v_exp_f32 v81, v81
    v_cvt_pk_bf16_f32 v49, v78, v79
    v_exp_f32 v82, v82
    v_exp_f32 v83, v83
    v_cvt_pk_bf16_f32 v50, v80, v81
    v_cvt_pk_bf16_f32 v51, v82, v83
    s_waitcnt lgkmcnt(2)
    v_mfma_f32_32x32x16_bf16 v[68:83], v[24:27], v[8:11], v[100:115]
    v_exp_f32 v84, v84
    v_exp_f32 v85, v85
    v_exp_f32 v86, v86
    buffer_load_dwordx4 v[200:203], v235, s[44:47], s50 offen
    s_add_u32 s50, s50, 32768
    s_waitcnt lgkmcnt(0)
    v_mfma_f32_32x32x16_bf16 v[132:147], v[32:35], v[44:47], v[132:147]
    v_exp_f32 v87, v87
    v_cvt_pk_bf16_f32 v52, v84, v85
    v_exp_f32 v88, v88
    v_exp_f32 v89, v89
    v_mfma_f32_32x32x16_bf16 v[68:83], v[28:31], v[12:15], v[68:83]
    v_cvt_pk_bf16_f32 v53, v86, v87
    s_setprio 0
    v_exp_f32 v90, v90
    v_exp_f32 v91, v91
    v_exp_f32 v92, v92
    v_mfma_f32_32x32x16_bf16 v[132:147], v[36:39], v[48:51], v[132:147]
    v_cvt_pk_bf16_f32 v54, v88, v89
    v_cvt_pk_bf16_f32 v55, v90, v91
    v_exp_f32 v93, v93
    v_exp_f32 v94, v94
    v_mfma_f32_16x16x32_bf16 v[60:63], v[40:43], v[44:47], v[60:63]
    v_exp_f32 v95, v95
    v_cvt_pk_bf16_f32 v56, v92, v93
    v_exp_f32 v96, v96
    v_mfma_f32_16x16x32_bf16 v[60:63], v[40:43], v[48:51], v[60:63]
    v_exp_f32 v97, v97
    v_cvt_pk_bf16_f32 v57, v94, v95
    v_exp_f32 v98, v98
    v_exp_f32 v99, v99
    v_cvt_pk_bf16_f32 v58, v96, v97
    v_cvt_pk_bf16_f32 v59, v98, v99
    s_waitcnt vmcnt(8)
    s_barrier
    s_setprio 3
    v_mfma_f32_32x32x16_bf16 v[84:99], v[24:27], v[16:19], v[116:131]
    v_exp_f32 v68, v68
    v_exp_f32 v69, v69
    v_exp_f32 v70, v70
    s_add_u32 m0, s25, 49152
    s_nop 0
    v_mfma_f32_32x32x16_bf16 v[148:163], v[32:35], v[52:55], v[148:163]
    v_exp_f32 v71, v71
    v_cvt_pk_bf16_f32 v44, v68, v69
    v_exp_f32 v72, v72
    v_exp_f32 v73, v73
    buffer_load_dwordx4 v231, s[8:11], s24 offen lds
    v_mfma_f32_32x32x16_bf16 v[84:99], v[28:31], v[20:23], v[84:99]
    v_cvt_pk_bf16_f32 v45, v70, v71
    v_exp_f32 v74, v74
    ds_read_b128 v[24:27], v228 offset:0
    ds_read_b128 v[28:31], v228 offset:1024
    v_exp_f32 v75, v75
    v_exp_f32 v76, v76
    v_mfma_f32_32x32x16_bf16 v[148:163], v[36:39], v[56:59], v[148:163]
    v_cvt_pk_bf16_f32 v46, v72, v73
    v_cvt_pk_bf16_f32 v47, v74, v75
    v_exp_f32 v77, v77
    ds_read_b128 v[32:35], v228 offset:2048
    ds_read_b128 v[36:39], v228 offset:3072
    v_exp_f32 v78, v78
    v_mfma_f32_16x16x32_bf16 v[64:67], v[40:43], v[52:55], v[64:67]
    v_exp_f32 v79, v79
    v_cvt_pk_bf16_f32 v48, v76, v77
    v_exp_f32 v80, v80
    v_mfma_f32_16x16x32_bf16 v[64:67], v[40:43], v[56:59], v[64:67]
    v_exp_f32 v81, v81
    v_cvt_pk_bf16_f32 v49, v78, v79
    v_exp_f32 v82, v82
    v_exp_f32 v83, v83
    v_cvt_pk_bf16_f32 v50, v80, v81
    v_cvt_pk_bf16_f32 v51, v82, v83
    s_waitcnt lgkmcnt(2)
    v_mfma_f32_32x32x16_bf16 v[68:83], v[24:27], v[8:11], v[100:115]
    v_exp_f32 v84, v84
    v_exp_f32 v85, v85
    v_exp_f32 v86, v86
    buffer_load_dwordx4 v231, s[8:11], s24 offen offset:1024 lds
    s_add_u32 s24, s24, 4096
    s_waitcnt lgkmcnt(0)
    v_mfma_f32_32x32x16_bf16 v[132:147], v[32:35], v[44:47], v[132:147]
    v_exp_f32 v87, v87
    s_setprio 2
    v_cvt_pk_bf16_f32 v52, v84, v85
    v_exp_f32 v88, v88
    v_exp_f32 v89, v89
    v_mfma_f32_32x32x16_bf16 v[68:83], v[28:31], v[12:15], v[68:83]
    v_cvt_pk_bf16_f32 v53, v86, v87
    v_exp_f32 v90, v90
    v_exp_f32 v91, v91
    v_exp_f32 v92, v92
    v_mfma_f32_32x32x16_bf16 v[132:147], v[36:39], v[48:51], v[132:147]
    v_cvt_pk_bf16_f32 v54, v88, v89
    v_cvt_pk_bf16_f32 v55, v90, v91
    v_exp_f32 v93, v93
    v_exp_f32 v94, v94
    v_mfma_f32_16x16x32_bf16 v[60:63], v[40:43], v[44:47], v[60:63]
    v_exp_f32 v95, v95
    v_cvt_pk_bf16_f32 v56, v92, v93
    v_exp_f32 v96, v96
    v_mfma_f32_16x16x32_bf16 v[60:63], v[40:43], v[48:51], v[60:63]
    v_exp_f32 v97, v97
    v_cvt_pk_bf16_f32 v57, v94, v95
    v_exp_f32 v98, v98
    v_exp_f32 v99, v99
    v_cvt_pk_bf16_f32 v58, v96, v97
    v_cvt_pk_bf16_f32 v59, v98, v99
    v_mfma_f32_32x32x16_bf16 v[84:99], v[24:27], v[16:19], v[116:131]
    v_exp_f32 v68, v68
    v_exp_f32 v69, v69
    v_exp_f32 v70, v70
    v_mfma_f32_32x32x16_bf16 v[148:163], v[32:35], v[52:55], v[148:163]
    v_exp_f32 v71, v71
    v_cvt_pk_bf16_f32 v44, v68, v69
    v_exp_f32 v72, v72
    v_exp_f32 v73, v73
    v_mfma_f32_32x32x16_bf16 v[84:99], v[28:31], v[20:23], v[84:99]
    v_cvt_pk_bf16_f32 v45, v70, v71
    v_exp_f32 v74, v74
    ds_read_b128 v[24:27], v228 offset:4096
    ds_read_b128 v[28:31], v228 offset:5120
    v_exp_f32 v75, v75
    v_exp_f32 v76, v76
    v_mfma_f32_32x32x16_bf16 v[148:163], v[36:39], v[56:59], v[148:163]
    v_cvt_pk_bf16_f32 v46, v72, v73
    v_cvt_pk_bf16_f32 v47, v74, v75
    v_exp_f32 v77, v77
    s_setprio 1
    ds_read_b128 v[32:35], v228 offset:6144
    ds_read_b128 v[36:39], v228 offset:7168
    v_exp_f32 v78, v78
    v_mfma_f32_16x16x32_bf16 v[64:67], v[40:43], v[52:55], v[64:67]
    v_exp_f32 v79, v79
    v_cvt_pk_bf16_f32 v48, v76, v77
    v_exp_f32 v80, v80
    v_mfma_f32_16x16x32_bf16 v[64:67], v[40:43], v[56:59], v[64:67]
    v_exp_f32 v81, v81
    v_cvt_pk_bf16_f32 v49, v78, v79
    v_exp_f32 v82, v82
    v_exp_f32 v83, v83
    v_cvt_pk_bf16_f32 v50, v80, v81
    v_cvt_pk_bf16_f32 v51, v82, v83
    s_waitcnt lgkmcnt(2)
    v_mfma_f32_32x32x16_bf16 v[68:83], v[24:27], v[8:11], v[100:115]
    v_exp_f32 v84, v84
    v_exp_f32 v85, v85
    v_exp_f32 v86, v86
    buffer_load_dwordx4 v[204:207], v235, s[44:47], s50 offen
    s_add_u32 s50, s50, 32768
    s_waitcnt lgkmcnt(0)
    v_mfma_f32_32x32x16_bf16 v[132:147], v[32:35], v[44:47], v[132:147]
    v_exp_f32 v87, v87
    v_cvt_pk_bf16_f32 v52, v84, v85
    v_exp_f32 v88, v88
    v_exp_f32 v89, v89
    v_mfma_f32_32x32x16_bf16 v[68:83], v[28:31], v[12:15], v[68:83]
    v_cvt_pk_bf16_f32 v53, v86, v87
    s_setprio 0
    v_exp_f32 v90, v90
    v_exp_f32 v91, v91
    v_exp_f32 v92, v92
    v_mfma_f32_32x32x16_bf16 v[132:147], v[36:39], v[48:51], v[132:147]
    v_cvt_pk_bf16_f32 v54, v88, v89
    v_cvt_pk_bf16_f32 v55, v90, v91
    v_exp_f32 v93, v93
    v_exp_f32 v94, v94
    v_mfma_f32_16x16x32_bf16 v[60:63], v[40:43], v[44:47], v[60:63]
    v_exp_f32 v95, v95
    v_cvt_pk_bf16_f32 v56, v92, v93
    v_exp_f32 v96, v96
    v_mfma_f32_16x16x32_bf16 v[60:63], v[40:43], v[48:51], v[60:63]
    v_exp_f32 v97, v97
    v_cvt_pk_bf16_f32 v57, v94, v95
    v_exp_f32 v98, v98
    v_exp_f32 v99, v99
    v_cvt_pk_bf16_f32 v58, v96, v97
    v_cvt_pk_bf16_f32 v59, v98, v99
    s_waitcnt vmcnt(4)
    s_barrier
    v_mov_b32 v2, 0
    v_mov_b32 v3, 1
    buffer_store_dword v3, v2, s[16:19], s60 offen sc0 sc1
    s_setprio 3
    v_mfma_f32_32x32x16_bf16 v[84:99], v[24:27], v[16:19], v[116:131]
    v_exp_f32 v68, v68
    v_exp_f32 v69, v69
    v_exp_f32 v70, v70
    s_add_u32 m0, s25, 0
    s_nop 0
    v_mfma_f32_32x32x16_bf16 v[148:163], v[32:35], v[52:55], v[148:163]
    v_exp_f32 v71, v71
    v_cvt_pk_bf16_f32 v44, v68, v69
    v_exp_f32 v72, v72
    v_exp_f32 v73, v73
    buffer_load_dwordx4 v231, s[8:11], s24 offen lds
    v_mfma_f32_32x32x16_bf16 v[84:99], v[28:31], v[20:23], v[84:99]
    v_cvt_pk_bf16_f32 v45, v70, v71
    v_exp_f32 v74, v74
    ds_read_b128 v[24:27], v228 offset:16384
    ds_read_b128 v[28:31], v228 offset:17408
    v_exp_f32 v75, v75
    v_exp_f32 v76, v76
    v_mfma_f32_32x32x16_bf16 v[148:163], v[36:39], v[56:59], v[148:163]
    v_cvt_pk_bf16_f32 v46, v72, v73
    v_cvt_pk_bf16_f32 v47, v74, v75
    v_exp_f32 v77, v77
    ds_read_b128 v[32:35], v228 offset:18432
    ds_read_b128 v[36:39], v228 offset:19456
    v_exp_f32 v78, v78
    v_mfma_f32_16x16x32_bf16 v[64:67], v[40:43], v[52:55], v[64:67]
    v_exp_f32 v79, v79
    v_cvt_pk_bf16_f32 v48, v76, v77
    v_exp_f32 v80, v80
    v_mfma_f32_16x16x32_bf16 v[64:67], v[40:43], v[56:59], v[64:67]
    v_exp_f32 v81, v81
    v_cvt_pk_bf16_f32 v49, v78, v79
    v_exp_f32 v82, v82
    v_exp_f32 v83, v83
    v_cvt_pk_bf16_f32 v50, v80, v81
    v_cvt_pk_bf16_f32 v51, v82, v83
    s_waitcnt lgkmcnt(2)
    v_mfma_f32_32x32x16_bf16 v[68:83], v[24:27], v[8:11], v[100:115]
    v_exp_f32 v84, v84
    v_exp_f32 v85, v85
    v_exp_f32 v86, v86
    buffer_load_dwordx4 v231, s[8:11], s24 offen offset:1024 lds
    s_add_u32 s24, s24, 4096
    s_waitcnt lgkmcnt(0)
    v_mfma_f32_32x32x16_bf16 v[132:147], v[32:35], v[44:47], v[132:147]
    v_exp_f32 v87, v87
    s_setprio 2
    v_cvt_pk_bf16_f32 v52, v84, v85
    v_exp_f32 v88, v88
    v_exp_f32 v89, v89
    v_mfma_f32_32x32x16_bf16 v[68:83], v[28:31], v[12:15], v[68:83]
    v_cvt_pk_bf16_f32 v53, v86, v87
    v_exp_f32 v90, v90
    v_exp_f32 v91, v91
    v_exp_f32 v92, v92
    v_mfma_f32_32x32x16_bf16 v[132:147], v[36:39], v[48:51], v[132:147]
    v_cvt_pk_bf16_f32 v54, v88, v89
    v_cvt_pk_bf16_f32 v55, v90, v91
    v_exp_f32 v93, v93
    v_exp_f32 v94, v94
    v_mfma_f32_16x16x32_bf16 v[60:63], v[40:43], v[44:47], v[60:63]
    v_exp_f32 v95, v95
    v_cvt_pk_bf16_f32 v56, v92, v93
    v_exp_f32 v96, v96
    v_mfma_f32_16x16x32_bf16 v[60:63], v[40:43], v[48:51], v[60:63]
    v_exp_f32 v97, v97
    v_cvt_pk_bf16_f32 v57, v94, v95
    v_exp_f32 v98, v98
    v_exp_f32 v99, v99
    v_cvt_pk_bf16_f32 v58, v96, v97
    v_cvt_pk_bf16_f32 v59, v98, v99
    v_mfma_f32_32x32x16_bf16 v[84:99], v[24:27], v[16:19], v[116:131]
    v_exp_f32 v68, v68
    v_exp_f32 v69, v69
    v_exp_f32 v70, v70
    v_mfma_f32_32x32x16_bf16 v[148:163], v[32:35], v[52:55], v[148:163]
    v_exp_f32 v71, v71
    v_cvt_pk_bf16_f32 v44, v68, v69
    v_exp_f32 v72, v72
    v_exp_f32 v73, v73
    v_mfma_f32_32x32x16_bf16 v[84:99], v[28:31], v[20:23], v[84:99]
    v_cvt_pk_bf16_f32 v45, v70, v71
    v_exp_f32 v74, v74
    ds_read_b128 v[24:27], v228 offset:20480
    ds_read_b128 v[28:31], v228 offset:21504
    v_exp_f32 v75, v75
    v_exp_f32 v76, v76
    v_mfma_f32_32x32x16_bf16 v[148:163], v[36:39], v[56:59], v[148:163]
    v_cvt_pk_bf16_f32 v46, v72, v73
    v_cvt_pk_bf16_f32 v47, v74, v75
    v_exp_f32 v77, v77
    s_setprio 1
    ds_read_b128 v[32:35], v228 offset:22528
    ds_read_b128 v[36:39], v228 offset:23552
    v_exp_f32 v78, v78
    v_mfma_f32_16x16x32_bf16 v[64:67], v[40:43], v[52:55], v[64:67]
    v_exp_f32 v79, v79
    v_cvt_pk_bf16_f32 v48, v76, v77
    v_exp_f32 v80, v80
    v_mfma_f32_16x16x32_bf16 v[64:67], v[40:43], v[56:59], v[64:67]
    v_exp_f32 v81, v81
    v_cvt_pk_bf16_f32 v49, v78, v79
    v_exp_f32 v82, v82
    v_exp_f32 v83, v83
    v_cvt_pk_bf16_f32 v50, v80, v81
    v_cvt_pk_bf16_f32 v51, v82, v83
    s_waitcnt lgkmcnt(2)
    v_mfma_f32_32x32x16_bf16 v[68:83], v[24:27], v[8:11], v[100:115]
    v_exp_f32 v84, v84
    v_exp_f32 v85, v85
    v_exp_f32 v86, v86
    buffer_load_dwordx4 v[208:211], v235, s[44:47], s50 offen
    s_add_u32 s50, s50, 32768
    s_waitcnt lgkmcnt(0)
    v_mfma_f32_32x32x16_bf16 v[132:147], v[32:35], v[44:47], v[132:147]
    v_exp_f32 v87, v87
    v_cvt_pk_bf16_f32 v52, v84, v85
    v_exp_f32 v88, v88
    v_exp_f32 v89, v89
    v_mfma_f32_32x32x16_bf16 v[68:83], v[28:31], v[12:15], v[68:83]
    v_cvt_pk_bf16_f32 v53, v86, v87
    s_setprio 0
    v_exp_f32 v90, v90
    v_exp_f32 v91, v91
    v_exp_f32 v92, v92
    v_mfma_f32_32x32x16_bf16 v[132:147], v[36:39], v[48:51], v[132:147]
    v_cvt_pk_bf16_f32 v54, v88, v89
    v_cvt_pk_bf16_f32 v55, v90, v91
    v_exp_f32 v93, v93
    v_exp_f32 v94, v94
    v_mfma_f32_16x16x32_bf16 v[60:63], v[40:43], v[44:47], v[60:63]
    v_exp_f32 v95, v95
    v_cvt_pk_bf16_f32 v56, v92, v93
    v_exp_f32 v96, v96
    v_mfma_f32_16x16x32_bf16 v[60:63], v[40:43], v[48:51], v[60:63]
    v_exp_f32 v97, v97
    v_cvt_pk_bf16_f32 v57, v94, v95
    v_exp_f32 v98, v98
    v_exp_f32 v99, v99
    v_cvt_pk_bf16_f32 v58, v96, v97
    v_cvt_pk_bf16_f32 v59, v98, v99
    s_waitcnt vmcnt(9)
    s_barrier
    s_setprio 3
    v_mfma_f32_32x32x16_bf16 v[84:99], v[24:27], v[16:19], v[116:131]
    v_exp_f32 v68, v68
    v_exp_f32 v69, v69
    v_exp_f32 v70, v70
    s_add_u32 m0, s25, 16384
    s_nop 0
    v_mfma_f32_32x32x16_bf16 v[148:163], v[32:35], v[52:55], v[148:163]
    v_exp_f32 v71, v71
    v_cvt_pk_bf16_f32 v44, v68, v69
    v_exp_f32 v72, v72
    v_exp_f32 v73, v73
    buffer_load_dwordx4 v231, s[8:11], s24 offen lds
    v_mfma_f32_32x32x16_bf16 v[84:99], v[28:31], v[20:23], v[84:99]
    v_cvt_pk_bf16_f32 v45, v70, v71
    v_exp_f32 v74, v74
    ds_read_b128 v[24:27], v228 offset:32768
    ds_read_b128 v[28:31], v228 offset:33792
    v_exp_f32 v75, v75
    v_exp_f32 v76, v76
    v_mfma_f32_32x32x16_bf16 v[148:163], v[36:39], v[56:59], v[148:163]
    v_cvt_pk_bf16_f32 v46, v72, v73
    v_cvt_pk_bf16_f32 v47, v74, v75
    v_exp_f32 v77, v77
    ds_read_b128 v[32:35], v228 offset:34816
    ds_read_b128 v[36:39], v228 offset:35840
    v_exp_f32 v78, v78
    v_mfma_f32_16x16x32_bf16 v[64:67], v[40:43], v[52:55], v[64:67]
    v_exp_f32 v79, v79
    v_cvt_pk_bf16_f32 v48, v76, v77
    v_exp_f32 v80, v80
    v_mfma_f32_16x16x32_bf16 v[64:67], v[40:43], v[56:59], v[64:67]
    v_exp_f32 v81, v81
    v_cvt_pk_bf16_f32 v49, v78, v79
    v_exp_f32 v82, v82
    v_exp_f32 v83, v83
    v_cvt_pk_bf16_f32 v50, v80, v81
    v_cvt_pk_bf16_f32 v51, v82, v83
    s_waitcnt lgkmcnt(2)
    v_mfma_f32_32x32x16_bf16 v[68:83], v[24:27], v[8:11], v[100:115]
    v_exp_f32 v84, v84
    v_exp_f32 v85, v85
    v_exp_f32 v86, v86
    buffer_load_dwordx4 v231, s[8:11], s24 offen offset:1024 lds
    s_add_u32 s24, s24, 4096
    s_waitcnt lgkmcnt(0)
    v_mfma_f32_32x32x16_bf16 v[132:147], v[32:35], v[44:47], v[132:147]
    v_exp_f32 v87, v87
    s_setprio 2
    v_cvt_pk_bf16_f32 v52, v84, v85
    v_exp_f32 v88, v88
    v_exp_f32 v89, v89
    v_mfma_f32_32x32x16_bf16 v[68:83], v[28:31], v[12:15], v[68:83]
    v_cvt_pk_bf16_f32 v53, v86, v87
    v_exp_f32 v90, v90
    v_exp_f32 v91, v91
    v_exp_f32 v92, v92
    v_mfma_f32_32x32x16_bf16 v[132:147], v[36:39], v[48:51], v[132:147]
    v_cvt_pk_bf16_f32 v54, v88, v89
    v_cvt_pk_bf16_f32 v55, v90, v91
    v_exp_f32 v93, v93
    v_exp_f32 v94, v94
    v_mfma_f32_16x16x32_bf16 v[60:63], v[40:43], v[44:47], v[60:63]
    v_exp_f32 v95, v95
    v_cvt_pk_bf16_f32 v56, v92, v93
    v_exp_f32 v96, v96
    v_mfma_f32_16x16x32_bf16 v[60:63], v[40:43], v[48:51], v[60:63]
    v_exp_f32 v97, v97
    v_cvt_pk_bf16_f32 v57, v94, v95
    v_exp_f32 v98, v98
    v_exp_f32 v99, v99
    v_cvt_pk_bf16_f32 v58, v96, v97
    v_cvt_pk_bf16_f32 v59, v98, v99
    v_mfma_f32_32x32x16_bf16 v[84:99], v[24:27], v[16:19], v[116:131]
    v_exp_f32 v68, v68
    v_exp_f32 v69, v69
    v_exp_f32 v70, v70
    s_mov_b32 s28, 52428800
    buffer_load_dwordx4 v[236:239], v231, s[16:19], s28 offen
    v_mfma_f32_32x32x16_bf16 v[148:163], v[32:35], v[52:55], v[148:163]
    v_exp_f32 v71, v71
    v_cvt_pk_bf16_f32 v44, v68, v69
    v_exp_f32 v72, v72
    v_exp_f32 v73, v73
    v_mfma_f32_32x32x16_bf16 v[84:99], v[28:31], v[20:23], v[84:99]
    v_cvt_pk_bf16_f32 v45, v70, v71
    v_exp_f32 v74, v74
    ds_read_b128 v[24:27], v228 offset:36864
    ds_read_b128 v[28:31], v228 offset:37888
    v_exp_f32 v75, v75
    v_exp_f32 v76, v76
    v_mfma_f32_32x32x16_bf16 v[148:163], v[36:39], v[56:59], v[148:163]
    v_cvt_pk_bf16_f32 v46, v72, v73
    s_setprio 1
    v_cvt_pk_bf16_f32 v47, v74, v75
    v_exp_f32 v77, v77
    ds_read_b128 v[32:35], v228 offset:38912
    ds_read_b128 v[36:39], v228 offset:39936
    v_exp_f32 v78, v78
    v_mfma_f32_16x16x32_bf16 v[64:67], v[40:43], v[52:55], v[64:67]
    v_exp_f32 v79, v79
    v_cvt_pk_bf16_f32 v48, v76, v77
    v_exp_f32 v80, v80
    v_mfma_f32_16x16x32_bf16 v[64:67], v[40:43], v[56:59], v[64:67]
    v_exp_f32 v81, v81
    v_cvt_pk_bf16_f32 v49, v78, v79
    v_exp_f32 v82, v82
    v_exp_f32 v83, v83
    v_cvt_pk_bf16_f32 v50, v80, v81
    v_cvt_pk_bf16_f32 v51, v82, v83
    s_waitcnt lgkmcnt(2)
    v_mfma_f32_32x32x16_bf16 v[68:83], v[24:27], v[8:11], v[100:115]
    v_exp_f32 v84, v84
    v_exp_f32 v85, v85
    v_exp_f32 v86, v86
    buffer_load_dwordx4 v[212:215], v235, s[44:47], s50 offen
    s_add_u32 s50, s50, 32768
    s_waitcnt lgkmcnt(0)
    v_mfma_f32_32x32x16_bf16 v[132:147], v[32:35], v[44:47], v[132:147]
    v_exp_f32 v87, v87
    v_cvt_pk_bf16_f32 v52, v84, v85
    v_exp_f32 v88, v88
    v_exp_f32 v89, v89
    v_mfma_f32_32x32x16_bf16 v[68:83], v[28:31], v[12:15], v[68:83]
    v_cvt_pk_bf16_f32 v53, v86, v87
    s_setprio 0
    v_exp_f32 v90, v90
    v_exp_f32 v91, v91
    v_exp_f32 v92, v92
    v_mfma_f32_32x32x16_bf16 v[132:147], v[36:39], v[48:51], v[132:147]
    v_cvt_pk_bf16_f32 v54, v88, v89
    v_cvt_pk_bf16_f32 v55, v90, v91
    v_exp_f32 v93, v93
    v_exp_f32 v94, v94
    v_mfma_f32_16x16x32_bf16 v[60:63], v[40:43], v[44:47], v[60:63]
    v_exp_f32 v95, v95
    v_cvt_pk_bf16_f32 v56, v92, v93
    v_exp_f32 v96, v96
    v_mfma_f32_16x16x32_bf16 v[60:63], v[40:43], v[48:51], v[60:63]
    v_exp_f32 v97, v97
    v_cvt_pk_bf16_f32 v57, v94, v95
    v_exp_f32 v98, v98
    v_exp_f32 v99, v99
    v_cvt_pk_bf16_f32 v58, v96, v97
    v_cvt_pk_bf16_f32 v59, v98, v99
    s_waitcnt vmcnt(9)
    s_barrier
    s_setprio 3
    v_mfma_f32_32x32x16_bf16 v[84:99], v[24:27], v[16:19], v[116:131]
    v_exp_f32 v68, v68
    v_exp_f32 v69, v69
    v_exp_f32 v70, v70
    s_add_u32 m0, s25, 32768
    s_nop 0
    v_mfma_f32_32x32x16_bf16 v[148:163], v[32:35], v[52:55], v[148:163]
    v_exp_f32 v71, v71
    v_cvt_pk_bf16_f32 v44, v68, v69
    v_exp_f32 v72, v72
    v_exp_f32 v73, v73
    buffer_load_dwordx4 v231, s[8:11], s24 offen lds
    v_mfma_f32_32x32x16_bf16 v[84:99], v[28:31], v[20:23], v[84:99]
    v_cvt_pk_bf16_f32 v45, v70, v71
    v_exp_f32 v74, v74
    ds_read_b128 v[24:27], v228 offset:49152
    ds_read_b128 v[28:31], v228 offset:50176
    v_exp_f32 v75, v75
    v_exp_f32 v76, v76
    v_mfma_f32_32x32x16_bf16 v[148:163], v[36:39], v[56:59], v[148:163]
    v_cvt_pk_bf16_f32 v46, v72, v73
    v_cvt_pk_bf16_f32 v47, v74, v75
    v_exp_f32 v77, v77
    ds_read_b128 v[32:35], v228 offset:51200
    ds_read_b128 v[36:39], v228 offset:52224
    v_exp_f32 v78, v78
    v_mfma_f32_16x16x32_bf16 v[64:67], v[40:43], v[52:55], v[64:67]
    v_exp_f32 v79, v79
    v_cvt_pk_bf16_f32 v48, v76, v77
    v_exp_f32 v80, v80
    v_mfma_f32_16x16x32_bf16 v[64:67], v[40:43], v[56:59], v[64:67]
    v_exp_f32 v81, v81
    v_cvt_pk_bf16_f32 v49, v78, v79
    v_exp_f32 v82, v82
    v_exp_f32 v83, v83
    v_cvt_pk_bf16_f32 v50, v80, v81
    v_cvt_pk_bf16_f32 v51, v82, v83
    s_waitcnt lgkmcnt(2)
    v_mfma_f32_32x32x16_bf16 v[68:83], v[24:27], v[8:11], v[100:115]
    v_exp_f32 v84, v84
    v_exp_f32 v85, v85
    v_exp_f32 v86, v86
    buffer_load_dwordx4 v231, s[8:11], s24 offen offset:1024 lds
    s_add_u32 s24, s24, 4096
    s_waitcnt lgkmcnt(0)
    v_mfma_f32_32x32x16_bf16 v[132:147], v[32:35], v[44:47], v[132:147]
    v_exp_f32 v87, v87
    s_setprio 2
    v_cvt_pk_bf16_f32 v52, v84, v85
    v_exp_f32 v88, v88
    v_exp_f32 v89, v89
    v_mfma_f32_32x32x16_bf16 v[68:83], v[28:31], v[12:15], v[68:83]
    v_cvt_pk_bf16_f32 v53, v86, v87
    v_exp_f32 v90, v90
    v_exp_f32 v91, v91
    v_exp_f32 v92, v92
    v_mfma_f32_32x32x16_bf16 v[132:147], v[36:39], v[48:51], v[132:147]
    v_cvt_pk_bf16_f32 v54, v88, v89
    v_cvt_pk_bf16_f32 v55, v90, v91
    v_exp_f32 v93, v93
    v_exp_f32 v94, v94
    v_mfma_f32_16x16x32_bf16 v[60:63], v[40:43], v[44:47], v[60:63]
    v_exp_f32 v95, v95
    v_cvt_pk_bf16_f32 v56, v92, v93
    v_exp_f32 v96, v96
    v_mfma_f32_16x16x32_bf16 v[60:63], v[40:43], v[48:51], v[60:63]
    v_exp_f32 v97, v97
    v_cvt_pk_bf16_f32 v57, v94, v95
    v_exp_f32 v98, v98
    v_exp_f32 v99, v99
    v_cvt_pk_bf16_f32 v58, v96, v97
    v_cvt_pk_bf16_f32 v59, v98, v99
    v_mfma_f32_32x32x16_bf16 v[84:99], v[24:27], v[16:19], v[116:131]
    v_exp_f32 v68, v68
    v_exp_f32 v69, v69
    v_exp_f32 v70, v70
    v_mfma_f32_32x32x16_bf16 v[148:163], v[32:35], v[52:55], v[148:163]
    v_exp_f32 v71, v71
    v_cvt_pk_bf16_f32 v44, v68, v69
    v_exp_f32 v72, v72
    v_exp_f32 v73, v73
    v_mfma_f32_32x32x16_bf16 v[84:99], v[28:31], v[20:23], v[84:99]
    v_cvt_pk_bf16_f32 v45, v70, v71
    v_exp_f32 v74, v74
    ds_read_b128 v[24:27], v228 offset:53248
    ds_read_b128 v[28:31], v228 offset:54272
    v_exp_f32 v75, v75
    v_exp_f32 v76, v76
    v_mfma_f32_32x32x16_bf16 v[148:163], v[36:39], v[56:59], v[148:163]
    v_cvt_pk_bf16_f32 v46, v72, v73
    v_cvt_pk_bf16_f32 v47, v74, v75
    v_exp_f32 v77, v77
    s_setprio 1
    ds_read_b128 v[32:35], v228 offset:55296
    ds_read_b128 v[36:39], v228 offset:56320
    v_exp_f32 v78, v78
    v_mfma_f32_16x16x32_bf16 v[64:67], v[40:43], v[52:55], v[64:67]
    v_exp_f32 v79, v79
    v_cvt_pk_bf16_f32 v48, v76, v77
    v_exp_f32 v80, v80
    v_mfma_f32_16x16x32_bf16 v[64:67], v[40:43], v[56:59], v[64:67]
    v_exp_f32 v81, v81
    v_cvt_pk_bf16_f32 v49, v78, v79
    v_exp_f32 v82, v82
    v_exp_f32 v83, v83
    v_cvt_pk_bf16_f32 v50, v80, v81
    v_cvt_pk_bf16_f32 v51, v82, v83
    s_waitcnt lgkmcnt(2)
    v_mfma_f32_32x32x16_bf16 v[68:83], v[24:27], v[8:11], v[100:115]
    v_exp_f32 v84, v84
    v_exp_f32 v85, v85
    v_exp_f32 v86, v86
    s_waitcnt lgkmcnt(0)
    v_mfma_f32_32x32x16_bf16 v[132:147], v[32:35], v[44:47], v[132:147]
    v_exp_f32 v87, v87
    v_cvt_pk_bf16_f32 v52, v84, v85
    v_exp_f32 v88, v88
    v_exp_f32 v89, v89
    v_mfma_f32_32x32x16_bf16 v[68:83], v[28:31], v[12:15], v[68:83]
    v_cvt_pk_bf16_f32 v53, v86, v87
    v_exp_f32 v90, v90
    v_exp_f32 v91, v91
    s_setprio 0
    v_exp_f32 v92, v92
    v_mfma_f32_32x32x16_bf16 v[132:147], v[36:39], v[48:51], v[132:147]
    v_cvt_pk_bf16_f32 v54, v88, v89
    v_cvt_pk_bf16_f32 v55, v90, v91
    v_exp_f32 v93, v93
    v_exp_f32 v94, v94
    v_mfma_f32_16x16x32_bf16 v[60:63], v[40:43], v[44:47], v[60:63]
    v_exp_f32 v95, v95
    v_cvt_pk_bf16_f32 v56, v92, v93
    v_exp_f32 v96, v96
    v_mfma_f32_16x16x32_bf16 v[60:63], v[40:43], v[48:51], v[60:63]
    v_exp_f32 v97, v97
    v_cvt_pk_bf16_f32 v57, v94, v95
    v_exp_f32 v98, v98
    v_exp_f32 v99, v99
    v_cvt_pk_bf16_f32 v58, v96, v97
    v_cvt_pk_bf16_f32 v59, v98, v99
    s_waitcnt vmcnt(7)
    s_barrier
    s_setprio 3
    v_mfma_f32_32x32x16_bf16 v[84:99], v[24:27], v[16:19], v[116:131]
    v_exp_f32 v68, v68
    v_exp_f32 v69, v69
    v_exp_f32 v70, v70
    s_add_u32 m0, s25, 49152
    s_nop 0
    v_mfma_f32_32x32x16_bf16 v[148:163], v[32:35], v[52:55], v[148:163]
    v_exp_f32 v71, v71
    v_cvt_pk_bf16_f32 v44, v68, v69
    v_exp_f32 v72, v72
    v_exp_f32 v73, v73
    buffer_load_dwordx4 v231, s[8:11], s24 offen lds
    v_mfma_f32_32x32x16_bf16 v[84:99], v[28:31], v[20:23], v[84:99]
    v_cvt_pk_bf16_f32 v45, v70, v71
    v_exp_f32 v74, v74
    ds_read_b128 v[24:27], v228 offset:0
    ds_read_b128 v[28:31], v228 offset:1024
    v_exp_f32 v75, v75
    v_exp_f32 v76, v76
    v_mfma_f32_32x32x16_bf16 v[148:163], v[36:39], v[56:59], v[148:163]
    v_cvt_pk_bf16_f32 v46, v72, v73
    v_cvt_pk_bf16_f32 v47, v74, v75
    v_exp_f32 v77, v77
    ds_read_b128 v[32:35], v228 offset:2048
    ds_read_b128 v[36:39], v228 offset:3072
    v_exp_f32 v78, v78
    v_mfma_f32_16x16x32_bf16 v[64:67], v[40:43], v[52:55], v[64:67]
    v_exp_f32 v79, v79
    v_cvt_pk_bf16_f32 v48, v76, v77
    v_exp_f32 v80, v80
    v_mfma_f32_16x16x32_bf16 v[64:67], v[40:43], v[56:59], v[64:67]
    v_exp_f32 v81, v81
    v_cvt_pk_bf16_f32 v49, v78, v79
    v_exp_f32 v82, v82
    v_exp_f32 v83, v83
    v_cvt_pk_bf16_f32 v50, v80, v81
    v_cvt_pk_bf16_f32 v51, v82, v83
    s_waitcnt lgkmcnt(2)
    v_mfma_f32_32x32x16_bf16 v[68:83], v[24:27], v[8:11], v[100:115]
    v_exp_f32 v84, v84
    v_exp_f32 v85, v85
    v_exp_f32 v86, v86
    buffer_load_dwordx4 v231, s[8:11], s24 offen offset:1024 lds
    s_add_u32 s24, s24, 4096
    s_waitcnt lgkmcnt(0)
    v_mfma_f32_32x32x16_bf16 v[132:147], v[32:35], v[44:47], v[132:147]
    v_exp_f32 v87, v87
    s_setprio 2
    v_cvt_pk_bf16_f32 v52, v84, v85
    v_exp_f32 v88, v88
    v_exp_f32 v89, v89
    v_mfma_f32_32x32x16_bf16 v[68:83], v[28:31], v[12:15], v[68:83]
    v_cvt_pk_bf16_f32 v53, v86, v87
    v_exp_f32 v90, v90
    v_exp_f32 v91, v91
    v_exp_f32 v92, v92
    v_mfma_f32_32x32x16_bf16 v[132:147], v[36:39], v[48:51], v[132:147]
    v_cvt_pk_bf16_f32 v54, v88, v89
    v_cvt_pk_bf16_f32 v55, v90, v91
    v_exp_f32 v93, v93
    v_exp_f32 v94, v94
    v_mfma_f32_16x16x32_bf16 v[60:63], v[40:43], v[44:47], v[60:63]
    v_exp_f32 v95, v95
    v_cvt_pk_bf16_f32 v56, v92, v93
    v_exp_f32 v96, v96
    v_mfma_f32_16x16x32_bf16 v[60:63], v[40:43], v[48:51], v[60:63]
    v_exp_f32 v97, v97
    v_cvt_pk_bf16_f32 v57, v94, v95
    v_exp_f32 v98, v98
    v_exp_f32 v99, v99
    v_cvt_pk_bf16_f32 v58, v96, v97
    v_cvt_pk_bf16_f32 v59, v98, v99
    s_mov_b32 s26, 0
    s_waitcnt vmcnt(5)
L_fi_wpoll:
    v_min_u32 v2, v236, v237
    v_min3_u32 v2, v2, v238, v239
    v_cmp_eq_u32 vcc, 0, v2
    s_cbranch_vccz L_fi_wok
    s_add_u32 s26, s26, 1
    s_cmp_lt_u32 s26, 65536
    s_cbranch_scc0 L_fi_wok
    s_mov_b32 s28, 52428800
    buffer_load_dwordx4 v[236:239], v231, s[16:19], s28 offen sc0 sc1
    s_waitcnt vmcnt(0)
    s_branch L_fi_wpoll
L_fi_wok:
    v_mfma_f32_32x32x16_bf16 v[84:99], v[24:27], v[16:19], v[116:131]
    v_exp_f32 v68, v68
    v_exp_f32 v69, v69
    v_exp_f32 v70, v70
    s_add_u32 m0, s3, 98304
    s_nop 0
    v_mfma_f32_32x32x16_bf16 v[148:163], v[32:35], v[52:55], v[148:163]
    v_exp_f32 v71, v71
    v_cvt_pk_bf16_f32 v44, v68, v69
    v_exp_f32 v72, v72
    v_exp_f32 v73, v73
    buffer_load_dwordx4 v244, s[56:59], s61 offen offset:0 lds
    buffer_load_dwordx4 v245, s[56:59], s61 offen offset:1024 lds
    v_mfma_f32_32x32x16_bf16 v[84:99], v[28:31], v[20:23], v[84:99]
    v_cvt_pk_bf16_f32 v45, v70, v71
    v_exp_f32 v74, v74
    ds_read_b128 v[24:27], v228 offset:4096
    ds_read_b128 v[28:31], v228 offset:5120
    v_exp_f32 v75, v75
    v_exp_f32 v76, v76
    s_setprio 1
    buffer_load_dwordx4 v232, s[56:59], s61 offen offset:2048 lds
    buffer_load_dwordx4 v233, s[56:59], s61 offen offset:3072 lds
    v_mfma_f32_32x32x16_bf16 v[148:163], v[36:39], v[56:59], v[148:163]
    v_cvt_pk_bf16_f32 v46, v72, v73
    v_cvt_pk_bf16_f32 v47, v74, v75
    v_exp_f32 v77, v77
    ds_read_b128 v[32:35], v228 offset:6144
    ds_read_b128 v[36:39], v228 offset:7168
    v_exp_f32 v78, v78
    s_add_u32 s61, s61, s64
    v_mfma_f32_16x16x32_bf16 v[64:67], v[40:43], v[52:55], v[64:67]
    v_exp_f32 v79, v79
    v_cvt_pk_bf16_f32 v48, v76, v77
    v_exp_f32 v80, v80
    v_mfma_f32_16x16x32_bf16 v[64:67], v[40:43], v[56:59], v[64:67]
    v_exp_f32 v81, v81
    v_cvt_pk_bf16_f32 v49, v78, v79
    v_exp_f32 v82, v82
    v_exp_f32 v83, v83
    v_cvt_pk_bf16_f32 v50, v80, v81
    v_cvt_pk_bf16_f32 v51, v82, v83
    s_waitcnt lgkmcnt(2)
    v_mfma_f32_32x32x16_bf16 v[68:83], v[24:27], v[8:11], v[100:115]
    v_exp_f32 v84, v84
    v_exp_f32 v85, v85
    v_exp_f32 v86, v86
    s_waitcnt lgkmcnt(0)
    v_mfma_f32_32x32x16_bf16 v[132:147], v[32:35], v[44:47], v[132:147]
    v_exp_f32 v87, v87
    v_cvt_pk_bf16_f32 v52, v84, v85
    v_exp_f32 v88, v88
    v_exp_f32 v89, v89
    v_mfma_f32_32x32x16_bf16 v[68:83], v[28:31], v[12:15], v[68:83]
    v_cvt_pk_bf16_f32 v53, v86, v87
    v_exp_f32 v90, v90
    v_exp_f32 v91, v91
    s_setprio 0
    v_exp_f32 v92, v92
    v_mfma_f32_32x32x16_bf16 v[132:147], v[36:39], v[48:51], v[132:147]
    v_cvt_pk_bf16_f32 v54, v88, v89
    v_cvt_pk_bf16_f32 v55, v90, v91
    v_exp_f32 v93, v93
    v_exp_f32 v94, v94
    v_mfma_f32_16x16x32_bf16 v[60:63], v[40:43], v[44:47], v[60:63]
    v_exp_f32 v95, v95
    v_cvt_pk_bf16_f32 v56, v92, v93
    v_exp_f32 v96, v96
    v_mfma_f32_16x16x32_bf16 v[60:63], v[40:43], v[48:51], v[60:63]
    v_exp_f32 v97, v97
    v_cvt_pk_bf16_f32 v57, v94, v95
    v_exp_f32 v98, v98
    v_exp_f32 v99, v99
    v_cvt_pk_bf16_f32 v58, v96, v97
    v_cvt_pk_bf16_f32 v59, v98, v99
    s_waitcnt vmcnt(10)
    s_barrier
    s_setprio 3
    v_mfma_f32_32x32x16_bf16 v[84:99], v[24:27], v[16:19], v[116:131]
    v_exp_f32 v68, v68
    v_exp_f32 v69, v69
    v_exp_f32 v70, v70
    v_mfma_f32_32x32x16_bf16 v[148:163], v[32:35], v[52:55], v[148:163]
    v_exp_f32 v71, v71
    v_cvt_pk_bf16_f32 v44, v68, v69
    v_exp_f32 v72, v72
    v_exp_f32 v73, v73
    v_mfma_f32_32x32x16_bf16 v[84:99], v[28:31], v[20:23], v[84:99]
    v_cvt_pk_bf16_f32 v45, v70, v71
    v_exp_f32 v74, v74
    ds_read_b128 v[24:27], v228 offset:16384
    ds_read_b128 v[28:31], v228 offset:17408
    v_exp_f32 v75, v75
    v_exp_f32 v76, v76
    v_mfma_f32_32x32x16_bf16 v[148:163], v[36:39], v[56:59], v[148:163]
    v_cvt_pk_bf16_f32 v46, v72, v73
    v_cvt_pk_bf16_f32 v47, v74, v75
    v_exp_f32 v77, v77
    ds_read_b128 v[32:35], v228 offset:18432
    ds_read_b128 v[36:39], v228 offset:19456
    v_exp_f32 v78, v78
    v_mfma_f32_16x16x32_bf16 v[64:67], v[40:43], v[52:55], v[64:67]
    v_exp_f32 v79, v79
    v_cvt_pk_bf16_f32 v48, v76, v77
    v_exp_f32 v80, v80
    v_mfma_f32_16x16x32_bf16 v[64:67], v[40:43], v[56:59], v[64:67]
    v_exp_f32 v81, v81
    v_cvt_pk_bf16_f32 v49, v78, v79
    v_exp_f32 v82, v82
    v_exp_f32 v83, v83
    v_cvt_pk_bf16_f32 v50, v80, v81
    v_cvt_pk_bf16_f32 v51, v82, v83
    s_waitcnt lgkmcnt(2)
    v_mfma_f32_32x32x16_bf16 v[68:83], v[24:27], v[8:11], v[100:115]
    v_exp_f32 v84, v84
    v_exp_f32 v85, v85
    v_exp_f32 v86, v86
    s_waitcnt lgkmcnt(0)
    v_mfma_f32_32x32x16_bf16 v[132:147], v[32:35], v[44:47], v[132:147]
    v_exp_f32 v87, v87
    v_cvt_pk_bf16_f32 v52, v84, v85
    v_exp_f32 v88, v88
    s_setprio 2
    v_exp_f32 v89, v89
    v_mfma_f32_32x32x16_bf16 v[68:83], v[28:31], v[12:15], v[68:83]
    v_cvt_pk_bf16_f32 v53, v86, v87
    v_exp_f32 v90, v90
    v_exp_f32 v91, v91
    v_exp_f32 v92, v92
    v_mfma_f32_32x32x16_bf16 v[132:147], v[36:39], v[48:51], v[132:147]
    v_cvt_pk_bf16_f32 v54, v88, v89
    v_cvt_pk_bf16_f32 v55, v90, v91
    v_exp_f32 v93, v93
    v_exp_f32 v94, v94
    v_mfma_f32_16x16x32_bf16 v[60:63], v[40:43], v[44:47], v[60:63]
    v_exp_f32 v95, v95
    v_cvt_pk_bf16_f32 v56, v92, v93
    v_exp_f32 v96, v96
    v_mfma_f32_16x16x32_bf16 v[60:63], v[40:43], v[48:51], v[60:63]
    v_exp_f32 v97, v97
    v_cvt_pk_bf16_f32 v57, v94, v95
    v_exp_f32 v98, v98
    v_exp_f32 v99, v99
    v_cvt_pk_bf16_f32 v58, v96, v97
    v_cvt_pk_bf16_f32 v59, v98, v99
    v_mfma_f32_32x32x16_bf16 v[84:99], v[24:27], v[16:19], v[116:131]
    v_exp_f32 v68, v68
    v_exp_f32 v69, v69
    v_exp_f32 v70, v70
    s_add_u32 m0, s3, 131072
    s_nop 0
    v_mfma_f32_32x32x16_bf16 v[148:163], v[32:35], v[52:55], v[148:163]
    v_exp_f32 v71, v71
    v_cvt_pk_bf16_f32 v44, v68, v69
    v_exp_f32 v72, v72
    v_exp_f32 v73, v73
    buffer_load_dwordx4 v244, s[56:59], s61 offen offset:0 lds
    buffer_load_dwordx4 v245, s[56:59], s61 offen offset:1024 lds
    v_mfma_f32_32x32x16_bf16 v[84:99], v[28:31], v[20:23], v[84:99]
    v_cvt_pk_bf16_f32 v45, v70, v71
    v_exp_f32 v74, v74
    ds_read_b128 v[24:27], v228 offset:20480
    ds_read_b128 v[28:31], v228 offset:21504
    v_exp_f32 v75, v75
    v_exp_f32 v76, v76
    s_setprio 1
    buffer_load_dwordx4 v232, s[56:59], s61 offen offset:2048 lds
    buffer_load_dwordx4 v233, s[56:59], s61 offen offset:3072 lds
    v_mfma_f32_32x32x16_bf16 v[148:163], v[36:39], v[56:59], v[148:163]
    v_cvt_pk_bf16_f32 v46, v72, v73
    v_cvt_pk_bf16_f32 v47, v74, v75
    v_exp_f32 v77, v77
    ds_read_b128 v[32:35], v228 offset:22528
    ds_read_b128 v[36:39], v228 offset:23552
    v_exp_f32 v78, v78
    s_add_u32 s61, s61, s64
    v_mfma_f32_16x16x32_bf16 v[64:67], v[40:43], v[52:55], v[64:67]
    v_exp_f32 v79, v79
    v_cvt_pk_bf16_f32 v48, v76, v77
    v_exp_f32 v80, v80
    v_mfma_f32_16x16x32_bf16 v[64:67], v[40:43], v[56:59], v[64:67]
    v_exp_f32 v81, v81
    v_cvt_pk_bf16_f32 v49, v78, v79
    v_exp_f32 v82, v82
    v_exp_f32 v83, v83
    v_cvt_pk_bf16_f32 v50, v80, v81
    v_cvt_pk_bf16_f32 v51, v82, v83
    s_waitcnt lgkmcnt(2)
    v_mfma_f32_32x32x16_bf16 v[68:83], v[24:27], v[8:11], v[100:115]
    v_exp_f32 v84, v84
    v_exp_f32 v85, v85
    v_exp_f32 v86, v86
    s_waitcnt lgkmcnt(0)
    v_mfma_f32_32x32x16_bf16 v[132:147], v[32:35], v[44:47], v[132:147]
    v_exp_f32 v87, v87
    v_cvt_pk_bf16_f32 v52, v84, v85
    v_exp_f32 v88, v88
    v_exp_f32 v89, v89
    v_mfma_f32_32x32x16_bf16 v[68:83], v[28:31], v[12:15], v[68:83]
    v_cvt_pk_bf16_f32 v53, v86, v87
    v_exp_f32 v90, v90
    v_exp_f32 v91, v91
    s_setprio 0
    v_exp_f32 v92, v92
    v_mfma_f32_32x32x16_bf16 v[132:147], v[36:39], v[48:51], v[132:147]
    v_cvt_pk_bf16_f32 v54, v88, v89
    v_cvt_pk_bf16_f32 v55, v90, v91
    v_exp_f32 v93, v93
    v_exp_f32 v94, v94
    v_mfma_f32_16x16x32_bf16 v[60:63], v[40:43], v[44:47], v[60:63]
    v_exp_f32 v95, v95
    v_cvt_pk_bf16_f32 v56, v92, v93
    v_exp_f32 v96, v96
    v_mfma_f32_16x16x32_bf16 v[60:63], v[40:43], v[48:51], v[60:63]
    v_exp_f32 v97, v97
    v_cvt_pk_bf16_f32 v57, v94, v95
    v_exp_f32 v98, v98
    v_exp_f32 v99, v99
    v_cvt_pk_bf16_f32 v58, v96, v97
    v_cvt_pk_bf16_f32 v59, v98, v99
    s_waitcnt vmcnt(10)
    s_barrier
    s_setprio 3
    v_mfma_f32_32x32x16_bf16 v[84:99], v[24:27], v[16:19], v[116:131]
    v_exp_f32 v68, v68
    v_exp_f32 v69, v69
    v_exp_f32 v70, v70
    v_mfma_f32_32x32x16_bf16 v[148:163], v[32:35], v[52:55], v[148:163]
    v_exp_f32 v71, v71
    v_cvt_pk_bf16_f32 v44, v68, v69
    v_exp_f32 v72, v72
    v_exp_f32 v73, v73
    v_mfma_f32_32x32x16_bf16 v[84:99], v[28:31], v[20:23], v[84:99]
    v_cvt_pk_bf16_f32 v45, v70, v71
    v_exp_f32 v74, v74
    ds_read_b128 v[24:27], v228 offset:32768
    ds_read_b128 v[28:31], v228 offset:33792
    v_exp_f32 v75, v75
    v_exp_f32 v76, v76
    v_mfma_f32_32x32x16_bf16 v[148:163], v[36:39], v[56:59], v[148:163]
    v_cvt_pk_bf16_f32 v46, v72, v73
    v_cvt_pk_bf16_f32 v47, v74, v75
    v_exp_f32 v77, v77
    ds_read_b128 v[32:35], v228 offset:34816
    ds_read_b128 v[36:39], v228 offset:35840
    v_exp_f32 v78, v78
    v_mfma_f32_16x16x32_bf16 v[64:67], v[40:43], v[52:55], v[64:67]
    v_exp_f32 v79, v79
    v_cvt_pk_bf16_f32 v48, v76, v77
    v_exp_f32 v80, v80
    v_mfma_f32_16x16x32_bf16 v[64:67], v[40:43], v[56:59], v[64:67]
    v_exp_f32 v81, v81
    v_cvt_pk_bf16_f32 v49, v78, v79
    v_exp_f32 v82, v82
    v_exp_f32 v83, v83
    v_cvt_pk_bf16_f32 v50, v80, v81
    v_cvt_pk_bf16_f32 v51, v82, v83
    s_waitcnt lgkmcnt(2)
    v_mfma_f32_32x32x16_bf16 v[68:83], v[24:27], v[8:11], v[100:115]
    v_exp_f32 v84, v84
    v_exp_f32 v85, v85
    v_exp_f32 v86, v86
    s_waitcnt lgkmcnt(0)
    v_mfma_f32_32x32x16_bf16 v[132:147], v[32:35], v[44:47], v[132:147]
    v_exp_f32 v87, v87
    v_cvt_pk_bf16_f32 v52, v84, v85
    v_exp_f32 v88, v88
    s_setprio 2
    v_exp_f32 v89, v89
    v_mfma_f32_32x32x16_bf16 v[68:83], v[28:31], v[12:15], v[68:83]
    v_cvt_pk_bf16_f32 v53, v86, v87
    v_exp_f32 v90, v90
    v_exp_f32 v91, v91
    v_exp_f32 v92, v92
    v_mfma_f32_32x32x16_bf16 v[132:147], v[36:39], v[48:51], v[132:147]
    v_cvt_pk_bf16_f32 v54, v88, v89
    v_cvt_pk_bf16_f32 v55, v90, v91
    v_exp_f32 v93, v93
    v_exp_f32 v94, v94
    v_mfma_f32_16x16x32_bf16 v[60:63], v[40:43], v[44:47], v[60:63]
    v_exp_f32 v95, v95
    v_cvt_pk_bf16_f32 v56, v92, v93
    v_exp_f32 v96, v96
    v_mfma_f32_16x16x32_bf16 v[60:63], v[40:43], v[48:51], v[60:63]
    v_exp_f32 v97, v97
    v_cvt_pk_bf16_f32 v57, v94, v95
    v_exp_f32 v98, v98
    v_exp_f32 v99, v99
    v_cvt_pk_bf16_f32 v58, v96, v97
    v_cvt_pk_bf16_f32 v59, v98, v99
    v_mfma_f32_32x32x16_bf16 v[84:99], v[24:27], v[16:19], v[116:131]
    v_exp_f32 v68, v68
    v_exp_f32 v69, v69
    v_exp_f32 v70, v70
    s_add_u32 m0, s3, 0
    s_nop 0
    v_mfma_f32_32x32x16_bf16 v[148:163], v[32:35], v[52:55], v[148:163]
    v_exp_f32 v71, v71
    v_cvt_pk_bf16_f32 v44, v68, v69
    v_exp_f32 v72, v72
    v_exp_f32 v73, v73
    buffer_load_dwordx4 v244, s[56:59], s61 offen offset:0 lds
    buffer_load_dwordx4 v245, s[56:59], s61 offen offset:1024 lds
    v_mfma_f32_32x32x16_bf16 v[84:99], v[28:31], v[20:23], v[84:99]
    v_cvt_pk_bf16_f32 v45, v70, v71
    v_exp_f32 v74, v74
    ds_read_b128 v[24:27], v228 offset:36864
    ds_read_b128 v[28:31], v228 offset:37888
    v_exp_f32 v75, v75
    v_exp_f32 v76, v76
    s_setprio 1
    buffer_load_dwordx4 v232, s[56:59], s61 offen offset:2048 lds
    buffer_load_dwordx4 v233, s[56:59], s61 offen offset:3072 lds
    v_mfma_f32_32x32x16_bf16 v[148:163], v[36:39], v[56:59], v[148:163]
    v_cvt_pk_bf16_f32 v46, v72, v73
    v_cvt_pk_bf16_f32 v47, v74, v75
    v_exp_f32 v77, v77
    ds_read_b128 v[32:35], v228 offset:38912
    ds_read_b128 v[36:39], v228 offset:39936
    v_exp_f32 v78, v78
    s_add_u32 s61, s61, s64
    v_mfma_f32_16x16x32_bf16 v[64:67], v[40:43], v[52:55], v[64:67]
    v_exp_f32 v79, v79
    v_cvt_pk_bf16_f32 v48, v76, v77
    v_exp_f32 v80, v80
    v_mfma_f32_16x16x32_bf16 v[64:67], v[40:43], v[56:59], v[64:67]
    v_exp_f32 v81, v81
    v_cvt_pk_bf16_f32 v49, v78, v79
    v_exp_f32 v82, v82
    v_exp_f32 v83, v83
    v_cvt_pk_bf16_f32 v50, v80, v81
    v_cvt_pk_bf16_f32 v51, v82, v83
    s_waitcnt lgkmcnt(2)
    v_mfma_f32_32x32x16_bf16 v[68:83], v[24:27], v[8:11], v[100:115]
    v_exp_f32 v84, v84
    v_exp_f32 v85, v85
    v_exp_f32 v86, v86
    s_waitcnt lgkmcnt(0)
    v_mfma_f32_32x32x16_bf16 v[132:147], v[32:35], v[44:47], v[132:147]
    v_exp_f32 v87, v87
    v_cvt_pk_bf16_f32 v52, v84, v85
    v_exp_f32 v88, v88
    v_exp_f32 v89, v89
    v_mfma_f32_32x32x16_bf16 v[68:83], v[28:31], v[12:15], v[68:83]
    v_cvt_pk_bf16_f32 v53, v86, v87
    v_exp_f32 v90, v90
    v_exp_f32 v91, v91
    s_setprio 0
    v_exp_f32 v92, v92
    v_mfma_f32_32x32x16_bf16 v[132:147], v[36:39], v[48:51], v[132:147]
    v_cvt_pk_bf16_f32 v54, v88, v89
    v_cvt_pk_bf16_f32 v55, v90, v91
    v_exp_f32 v93, v93
    v_exp_f32 v94, v94
    v_mfma_f32_16x16x32_bf16 v[60:63], v[40:43], v[44:47], v[60:63]
    v_exp_f32 v95, v95
    v_cvt_pk_bf16_f32 v56, v92, v93
    v_exp_f32 v96, v96
    v_mfma_f32_16x16x32_bf16 v[60:63], v[40:43], v[48:51], v[60:63]
    v_exp_f32 v97, v97
    v_cvt_pk_bf16_f32 v57, v94, v95
    v_exp_f32 v98, v98
    v_exp_f32 v99, v99
    v_cvt_pk_bf16_f32 v58, v96, v97
    v_cvt_pk_bf16_f32 v59, v98, v99
    s_waitcnt vmcnt(12)
    s_barrier
    s_setprio 3
    v_mfma_f32_32x32x16_bf16 v[84:99], v[24:27], v[16:19], v[116:131]
    v_exp_f32 v68, v68
    v_exp_f32 v69, v69
    v_exp_f32 v70, v70
    v_mfma_f32_32x32x16_bf16 v[148:163], v[32:35], v[52:55], v[148:163]
    v_exp_f32 v71, v71
    v_cvt_pk_bf16_f32 v44, v68, v69
    v_exp_f32 v72, v72
    v_exp_f32 v73, v73
    v_mfma_f32_32x32x16_bf16 v[84:99], v[28:31], v[20:23], v[84:99]
    v_cvt_pk_bf16_f32 v45, v70, v71
    v_exp_f32 v74, v74
    ds_read_b128 v[24:27], v228 offset:49152
    ds_read_b128 v[28:31], v228 offset:50176
    v_exp_f32 v75, v75
    v_exp_f32 v76, v76
    v_mfma_f32_32x32x16_bf16 v[148:163], v[36:39], v[56:59], v[148:163]
    v_cvt_pk_bf16_f32 v46, v72, v73
    v_cvt_pk_bf16_f32 v47, v74, v75
    v_exp_f32 v77, v77
    ds_read_b128 v[32:35], v228 offset:51200
    ds_read_b128 v[36:39], v228 offset:52224
    v_exp_f32 v78, v78
    v_mfma_f32_16x16x32_bf16 v[64:67], v[40:43], v[52:55], v[64:67]
    v_exp_f32 v79, v79
    v_cvt_pk_bf16_f32 v48, v76, v77
    v_exp_f32 v80, v80
    v_mfma_f32_16x16x32_bf16 v[64:67], v[40:43], v[56:59], v[64:67]
    v_exp_f32 v81, v81
    v_cvt_pk_bf16_f32 v49, v78, v79
    v_exp_f32 v82, v82
    v_exp_f32 v83, v83
    v_cvt_pk_bf16_f32 v50, v80, v81
    v_cvt_pk_bf16_f32 v51, v82, v83
    s_waitcnt lgkmcnt(2)
    v_mfma_f32_32x32x16_bf16 v[68:83], v[24:27], v[8:11], v[100:115]
    v_exp_f32 v84, v84
    v_exp_f32 v85, v85
    v_exp_f32 v86, v86
    s_waitcnt lgkmcnt(0)
    v_mfma_f32_32x32x16_bf16 v[132:147], v[32:35], v[44:47], v[132:147]
    v_exp_f32 v87, v87
    v_cvt_pk_bf16_f32 v52, v84, v85
    v_exp_f32 v88, v88
    s_setprio 2
    v_exp_f32 v89, v89
    v_mfma_f32_32x32x16_bf16 v[68:83], v[28:31], v[12:15], v[68:83]
    v_cvt_pk_bf16_f32 v53, v86, v87
    v_exp_f32 v90, v90
    v_exp_f32 v91, v91
    v_exp_f32 v92, v92
    v_mfma_f32_32x32x16_bf16 v[132:147], v[36:39], v[48:51], v[132:147]
    v_cvt_pk_bf16_f32 v54, v88, v89
    v_cvt_pk_bf16_f32 v55, v90, v91
    v_exp_f32 v93, v93
    v_exp_f32 v94, v94
    v_mfma_f32_16x16x32_bf16 v[60:63], v[40:43], v[44:47], v[60:63]
    v_exp_f32 v95, v95
    v_cvt_pk_bf16_f32 v56, v92, v93
    v_exp_f32 v96, v96
    v_mfma_f32_16x16x32_bf16 v[60:63], v[40:43], v[48:51], v[60:63]
    v_exp_f32 v97, v97
    v_cvt_pk_bf16_f32 v57, v94, v95
    v_exp_f32 v98, v98
    v_exp_f32 v99, v99
    v_cvt_pk_bf16_f32 v58, v96, v97
    v_cvt_pk_bf16_f32 v59, v98, v99
    v_mfma_f32_32x32x16_bf16 v[84:99], v[24:27], v[16:19], v[116:131]
    v_exp_f32 v68, v68
    v_exp_f32 v69, v69
    v_exp_f32 v70, v70
    v_mfma_f32_32x32x16_bf16 v[148:163], v[32:35], v[52:55], v[148:163]
    v_exp_f32 v71, v71
    v_cvt_pk_bf16_f32 v44, v68, v69
    v_exp_f32 v72, v72
    v_exp_f32 v73, v73
    v_mfma_f32_32x32x16_bf16 v[84:99], v[28:31], v[20:23], v[84:99]
    v_cvt_pk_bf16_f32 v45, v70, v71
    v_exp_f32 v74, v74
    ds_read_b128 v[24:27], v228 offset:53248
    ds_read_b128 v[28:31], v228 offset:54272
    v_exp_f32 v75, v75
    v_exp_f32 v76, v76
    v_mfma_f32_32x32x16_bf16 v[148:163], v[36:39], v[56:59], v[148:163]
    v_cvt_pk_bf16_f32 v46, v72, v73
    v_cvt_pk_bf16_f32 v47, v74, v75
    v_exp_f32 v77, v77
    s_setprio 1
    ds_read_b128 v[32:35], v228 offset:55296
    ds_read_b128 v[36:39], v228 offset:56320
    v_exp_f32 v78, v78
    v_mfma_f32_16x16x32_bf16 v[64:67], v[40:43], v[52:55], v[64:67]
    v_exp_f32 v79, v79
    v_cvt_pk_bf16_f32 v48, v76, v77
    v_exp_f32 v80, v80
    v_mfma_f32_16x16x32_bf16 v[64:67], v[40:43], v[56:59], v[64:67]
    v_exp_f32 v81, v81
    v_cvt_pk_bf16_f32 v49, v78, v79
    v_exp_f32 v82, v82
    v_exp_f32 v83, v83
    v_cvt_pk_bf16_f32 v50, v80, v81
    v_cvt_pk_bf16_f32 v51, v82, v83
    s_waitcnt lgkmcnt(2)
    v_mfma_f32_32x32x16_bf16 v[68:83], v[24:27], v[8:11], v[100:115]
    v_exp_f32 v84, v84
    v_exp_f32 v85, v85
    v_exp_f32 v86, v86
    s_lshl_b32 s29, s20, 12
    s_xor_b32 s30, s29, 16384
    s_waitcnt lgkmcnt(0)
    v_mfma_f32_32x32x16_bf16 v[132:147], v[32:35], v[44:47], v[132:147]
    v_exp_f32 v87, v87
    v_cvt_pk_bf16_f32 v52, v84, v85
    v_exp_f32 v88, v88
    v_exp_f32 v89, v89
    s_add_u32 s29, s29, 65536
    s_add_u32 s30, s30, 65536
    s_setprio 0
    v_mfma_f32_32x32x16_bf16 v[68:83], v[28:31], v[12:15], v[68:83]
    v_cvt_pk_bf16_f32 v53, v86, v87
    v_exp_f32 v90, v90
    v_exp_f32 v91, v91
    v_exp_f32 v92, v92
    s_lshl_b32 s31, s20, 8
    s_xor_b32 s32, s31, 1024
    v_mfma_f32_32x32x16_bf16 v[132:147], v[36:39], v[48:51], v[132:147]
    v_cvt_pk_bf16_f32 v54, v88, v89
    v_cvt_pk_bf16_f32 v55, v90, v91
    v_exp_f32 v93, v93
    v_exp_f32 v94, v94
    s_add_u32 s31, s31, 32768
    s_add_u32 s32, s32, 32768
    v_mfma_f32_16x16x32_bf16 v[60:63], v[40:43], v[44:47], v[60:63]
    v_exp_f32 v95, v95
    v_cvt_pk_bf16_f32 v56, v92, v93
    v_exp_f32 v96, v96
    v_mfma_f32_16x16x32_bf16 v[60:63], v[40:43], v[48:51], v[60:63]
    v_exp_f32 v97, v97
    v_cvt_pk_bf16_f32 v57, v94, v95
    v_exp_f32 v98, v98
    v_exp_f32 v99, v99
    v_cvt_pk_bf16_f32 v58, v96, v97
    s_lshl_b32 s33, s20, 2
    s_add_u32 s33, s33, 34816
    s_lshl_b32 s34, s22, 3
    s_lshl_b32 s35, s37, 1
    s_add_u32 s34, s34, s35
    s_add_u32 s34, s34, s27
    s_lshl_b32 s34, s34, 16
    s_lshl_b32 s35, s21, 10
    s_add_u32 s34, s34, s35
    s_add_u32 s65, s34, 33554432
    s_mov_b32 s34, 0x7b000000
    v_cvt_pk_bf16_f32 v59, v98, v99
    v_mfma_f32_32x32x16_bf16 v[148:163], v[32:35], v[52:55], v[148:163]
    v_mfma_f32_16x16x32_bf16 v[64:67], v[40:43], v[52:55], v[64:67]
    v_mfma_f32_32x32x16_bf16 v[148:163], v[36:39], v[56:59], v[148:163]
    v_mfma_f32_16x16x32_bf16 v[64:67], v[40:43], v[56:59], v[64:67]
    v_add_u32 v216, s29, v231
    v_add_u32 v217, s30, v231
    v_lshlrev_b32 v3, 2, v1
    v_add_u32 v218, s31, v3
    v_add_u32 v219, s32, v3
    v_mov_b32 v221, s33
    v_and_b32 v222, 28, v3
    v_add_u32 v222, 34816, v222
    v_and_b32 v2, 15, v1
    v_lshlrev_b32 v2, 4, v2
    v_lshrrev_b32 v3, 5, v1
    v_lshl_add_u32 v2, v3, 8, v2
    v_bfe_u32 v3, v1, 4, 1
    v_lshl_add_u32 v220, v3, 15, v2
    s_cmp_eq_u32 s27, 0
    s_cbranch_scc0 L_at_x1
    s_nop 7
    ds_write_b128 v216, v[148:151] offset:0
    ds_write_b128 v216, v[152:155] offset:1024
    ds_write_b128 v216, v[156:159] offset:2048
    ds_write_b128 v216, v[160:163] offset:3072
    ds_write_b32 v218, v64
    v_cmp_nle_f32 vcc, v60, s34
    v_cmp_nle_f32 s[30:31], v64, s34
    s_or_b64 vcc, vcc, s[30:31]
    s_cmp_lg_u64 vcc, 0
    s_cselect_b32 s32, 1, 0
    s_cmp_eq_u32 s23, 0
    s_cselect_b32 s32, s32, 0
    v_mov_b32 v223, s32
    ds_write_b32 v221, v223
    v_lshrrev_b32 v2, 6, v0
    s_and_b32 s27, s2, 1
    s_bfe_u32 s25, s2, 0x20001
    s_lshl_b32 s25, s25, 2
    s_bfe_u32 s52, s2, 0x20003
    s_add_u32 s25, s25, s52
    s_lshr_b32 s26, s2, 5
    v_readfirstlane_b32 s24, v2
    v_lshlrev_b32 v34, 4, v1
    s_mov_b32 s60, 0
    s_lshr_b32 s52, s24, 1
    s_and_b32 s53, s24, 1
    s_lshl_b32 s40, s25, 18
    s_lshl_b32 s54, s26, 8
    s_add_u32 s40, s40, s54
    s_lshl_b32 s54, s52, 17
    s_add_u32 s40, s40, s54
    s_lshl_b32 s54, s53, 7
    s_add_u32 s40, s40, s54
    s_lshl_b32 s54, s27, 6
    s_add_u32 s40, s40, s54
    s_add_u32 s41, s40, 32768
    s_add_u32 s42, s40, 65536
    s_add_u32 s43, s40, 98304
    v_and_b32 v4, 15, v1
    v_lshlrev_b32 v4, 11, v4
    v_bfe_u32 v5, v1, 4, 1
    v_lshl_add_u32 v4, v5, 5, v4
    v_lshrrev_b32 v5, 5, v1
    v_lshl_add_u32 v35, v5, 4, v4
    s_mov_b32 s20, s96
    s_mov_b32 s21, s97
    s_mov_b32 s22, 4194304
    s_mov_b32 s23, 0x20000
    s_mov_b32 s12, s4
    s_mov_b32 s13, s5
    s_mov_b32 s14, 52826112
    s_mov_b32 s15, 0x20000
    v_lshrrev_b32 v3, 4, v1
    v_bfe_u32 v4, v1, 2, 2
    v_and_b32 v5, 3, v1
    v_lshl_add_u32 v6, v3, 2, v4
    v_lshrrev_b32 v7, 1, v6
    v_and_b32 v7, 3, v7
    v_lshlrev_b32 v7, 5, v7
    v_lshlrev_b32 v6, 7, v6
    v_lshl_add_u32 v6, v5, 3, v6
    s_lshl_b32 s54, s53, 13
    v_add_u32 v9, s54, v6
    s_lshl_b32 s55, s27, 6
    s_lshl_b32 s56, s53, 6
    s_xor_b32 s54, s55, 0
    v_xor_b32 v8, s54, v7
    v_add_u32 v10, v9, v8
    v_add_u32 v14, 65536, v10
    v_add_u32 v18, 131072, v10
    s_xor_b32 s54, s55, 32
    v_xor_b32 v8, s54, v7
    v_add_u32 v11, v9, v8
    v_add_u32 v15, 65536, v11
    v_add_u32 v19, 131072, v11
    s_xor_b32 s54, s55, 64
    v_xor_b32 v8, s54, v7
    v_add_u32 v12, v9, v8
    v_add_u32 v16, 65536, v12
    v_add_u32 v20, 131072, v12
    s_xor_b32 s54, s55, 96
    v_xor_b32 v8, s54, v7
    v_add_u32 v13, v9, v8
    v_add_u32 v17, 65536, v13
    v_add_u32 v21, 131072, v13
    s_add_u32 s54, s56, 0
    v_xor_b32 v8, s54, v7
    v_add_u32 v22, v6, v8
    v_add_u32 v24, 65536, v22
    v_add_u32 v26, 131072, v22
    s_add_u32 s54, s56, 32
    v_xor_b32 v8, s54, v7
    v_add_u32 v23, v6, v8
    v_add_u32 v25, 65536, v23
    v_add_u32 v27, 131072, v23
    s_lshl_b32 s54, s52, 13
    s_add_u32 s54, s54, 16384
    v_add_u32 v28, s54, v34
    v_add_u32 v29, 65536, v28
    v_add_u32 v30, 131072, v28
    s_lshl_b32 s52, s2, 2
    s_add_u32 s52, s52, s24
    s_xor_b32 s53, s52, 4
    s_lshl_b32 s44, s52, 12
    s_add_u32 s44, s44, 48234496
    s_lshl_b32 s45, s53, 12
    s_add_u32 s45, s45, 48234496
    s_mov_b32 s46, 1.0
    s_mov_b32 s47, 1.0
    s_mov_b32 s48, 0xbfb8aa3b
    s_mov_b32 s49, 0xbfb8aa3b
    s_mov_b32 s50, 0xffff0000
    s_lshl_b32 s61, s2, 2
    s_add_u32 s61, s61, 52429824
    s_cmp_eq_u32 s24, 0
    s_cselect_b32 s61, s61, 0x7fff0000
    v_mov_b32 v38, 0
    v_mov_b32 v39, 1
    s_waitcnt vmcnt(0) lgkmcnt(0)
    s_barrier
    ds_read_b128 v[168:171], v217 offset:0
    ds_read_b128 v[172:175], v217 offset:1024
    ds_read_b128 v[176:179], v217 offset:2048
    ds_read_b128 v[180:183], v217 offset:3072
    ds_read_b32 v192, v219
    ds_read_b32 v196, v222
    ds_read_b128 v[72:75], v29 offset:32768
    ds_read_b128 v[76:79], v29 offset:34816
    ds_read_b128 v[80:83], v29 offset:36864
    ds_read_b128 v[84:87], v29 offset:38912
    ds_read_b64_tr_b16 v[48:49], v16 offset:32768
    ds_read_b64_tr_b16 v[50:51], v16 offset:34816
    ds_read_b64_tr_b16 v[52:53], v17 offset:32768
    ds_read_b64_tr_b16 v[54:55], v17 offset:34816
    ds_read_b64_tr_b16 v[40:41], v14 offset:32768
    ds_read_b64_tr_b16 v[42:43], v14 offset:34816
    ds_read_b64_tr_b16 v[44:45], v15 offset:32768
    ds_read_b64_tr_b16 v[46:47], v15 offset:34816
    s_waitcnt lgkmcnt(12)
    v_cmp_ne_u32 vcc, 0, v196
    v_add_f32 v192, v192, v60
    s_cbranch_vccnz L_at_fallback
    v_rcp_f32 v194, v192
    v_add_f32 v168, v168, v132
    v_add_f32 v169, v169, v133
    v_add_f32 v170, v170, v134
    v_add_f32 v171, v171, v135
    v_add_f32 v172, v172, v136
    v_add_f32 v173, v173, v137
    v_add_f32 v174, v174, v138
    v_add_f32 v175, v175, v139
    v_add_f32 v176, v176, v140
    v_add_f32 v177, v177, v141
    v_add_f32 v178, v178, v142
    v_add_f32 v179, v179, v143
    v_add_f32 v180, v180, v144
    v_add_f32 v181, v181, v145
    v_add_f32 v182, v182, v146
    v_add_f32 v183, v183, v147
    v_pk_mul_f32 v[168:169], v[168:169], v[194:195] op_sel_hi:[1,0]
    v_pk_mul_f32 v[170:171], v[170:171], v[194:195] op_sel_hi:[1,0]
    v_pk_mul_f32 v[172:173], v[172:173], v[194:195] op_sel_hi:[1,0]
    v_pk_mul_f32 v[174:175], v[174:175], v[194:195] op_sel_hi:[1,0]
    v_pk_mul_f32 v[176:177], v[176:177], v[194:195] op_sel_hi:[1,0]
    v_pk_mul_f32 v[178:179], v[178:179], v[194:195] op_sel_hi:[1,0]
    v_pk_mul_f32 v[180:181], v[180:181], v[194:195] op_sel_hi:[1,0]
    v_pk_mul_f32 v[182:183], v[182:183], v[194:195] op_sel_hi:[1,0]
    v_cvt_pk_bf16_f32 v184, v168, v169
    v_cvt_pk_bf16_f32 v185, v170, v171
    v_cvt_pk_bf16_f32 v186, v176, v177
    v_cvt_pk_bf16_f32 v187, v178, v179
    v_cvt_pk_bf16_f32 v188, v172, v173
    v_cvt_pk_bf16_f32 v189, v174, v175
    v_cvt_pk_bf16_f32 v190, v180, v181
    v_cvt_pk_bf16_f32 v191, v182, v183
    buffer_store_dwordx4 v[184:187], v220, s[12:15], s65 offen sc0 sc1
    buffer_store_dwordx4 v[188:191], v220, s[12:15], s65 offen offset:512 sc0 sc1
    s_branch L_fi_cbody
L_at_x1:
    ds_write_b128 v216, v[132:135] offset:0
    ds_write_b128 v216, v[136:139] offset:1024
    ds_write_b128 v216, v[140:143] offset:2048
    ds_write_b128 v216, v[144:147] offset:3072
    ds_write_b32 v218, v60
    v_cmp_nle_f32 vcc, v60, s34
    v_cmp_nle_f32 s[30:31], v64, s34
    s_or_b64 vcc, vcc, s[30:31]
    s_cmp_lg_u64 vcc, 0
    s_cselect_b32 s32, 1, 0
    s_cmp_eq_u32 s23, 0
    s_cselect_b32 s32, s32, 0
    v_mov_b32 v223, s32
    ds_write_b32 v221, v223
    s_waitcnt vmcnt(0) lgkmcnt(0)
    s_barrier
    ds_read_b128 v[168:171], v217 offset:0
    ds_read_b128 v[172:175], v217 offset:1024
    ds_read_b128 v[176:179], v217 offset:2048
    ds_read_b128 v[180:183], v217 offset:3072
    ds_read_b32 v192, v219
    ds_read_b32 v196, v222
    s_waitcnt lgkmcnt(0)
    v_cmp_ne_u32 vcc, 0, v196
    v_add_f32 v192, v192, v64
    s_cbranch_vccnz L_at_fallback
    v_rcp_f32 v194, v192
    v_add_f32 v168, v168, v148
    v_add_f32 v169, v169, v149
    v_add_f32 v170, v170, v150
    v_add_f32 v171, v171, v151
    v_add_f32 v172, v172, v152
    v_add_f32 v173, v173, v153
    v_add_f32 v174, v174, v154
    v_add_f32 v175, v175, v155
    v_add_f32 v176, v176, v156
    v_add_f32 v177, v177, v157
    v_add_f32 v178, v178, v158
    v_add_f32 v179, v179, v159
    v_add_f32 v180, v180, v160
    v_add_f32 v181, v181, v161
    v_add_f32 v182, v182, v162
    v_add_f32 v183, v183, v163
    v_pk_mul_f32 v[168:169], v[168:169], v[194:195] op_sel_hi:[1,0]
    v_pk_mul_f32 v[170:171], v[170:171], v[194:195] op_sel_hi:[1,0]
    v_pk_mul_f32 v[172:173], v[172:173], v[194:195] op_sel_hi:[1,0]
    v_pk_mul_f32 v[174:175], v[174:175], v[194:195] op_sel_hi:[1,0]
    v_pk_mul_f32 v[176:177], v[176:177], v[194:195] op_sel_hi:[1,0]
    v_pk_mul_f32 v[178:179], v[178:179], v[194:195] op_sel_hi:[1,0]
    v_pk_mul_f32 v[180:181], v[180:181], v[194:195] op_sel_hi:[1,0]
    v_pk_mul_f32 v[182:183], v[182:183], v[194:195] op_sel_hi:[1,0]
    v_cvt_pk_bf16_f32 v184, v168, v169
    v_cvt_pk_bf16_f32 v185, v170, v171
    v_cvt_pk_bf16_f32 v186, v176, v177
    v_cvt_pk_bf16_f32 v187, v178, v179
    v_cvt_pk_bf16_f32 v188, v172, v173
    v_cvt_pk_bf16_f32 v189, v174, v175
    v_cvt_pk_bf16_f32 v190, v180, v181
    v_cvt_pk_bf16_f32 v191, v182, v183
    buffer_store_dwordx4 v[184:187], v220, s[16:19], s65 offen sc0 sc1
    buffer_store_dwordx4 v[188:191], v220, s[16:19], s65 offen offset:512 sc0 sc1
    v_lshrrev_b32 v2, 6, v0
    s_and_b32 s27, s2, 1
    s_bfe_u32 s25, s2, 0x20001
    s_lshl_b32 s25, s25, 2
    s_bfe_u32 s52, s2, 0x20003
    s_add_u32 s25, s25, s52
    s_lshr_b32 s26, s2, 5
    v_readfirstlane_b32 s24, v2
    v_lshlrev_b32 v34, 4, v1
    s_mov_b32 s60, 0
    s_sub_u32 s24, s24, 4
    v_and_b32 v4, 7, v1
    v_bfe_u32 v5, v1, 4, 2
    v_lshlrev_b32 v5, 1, v5
    v_xor_b32 v4, v4, v5
    v_lshlrev_b32 v4, 4, v4
    v_lshrrev_b32 v3, 3, v1
    v_lshl_add_u32 v33, v3, 7, v4
    v_mov_b32 v31, v34
    v_add_u32 v32, 112640, v34
    v_add_u32 v35, 30720, v34
    s_lshl_b32 s34, s24, 12
    s_add_u32 s35, s34, 16384
    s_lshl_b32 s38, s24, 11
    s_lshl_b32 s52, s25, 3
    s_lshl_b32 s53, s24, 1
    s_add_u32 s52, s52, s53
    s_mul_i32 s32, s52, 114688
    s_mul_i32 s53, s27, 57344
    s_add_u32 s32, s32, s53
    s_add_u32 s32, s32, 16781312
    s_lshl_b32 s36, s52, 15
    s_add_u32 s36, s36, 33552384
    v_and_b32 v4, 7, v1
    v_bfe_u32 v5, v1, 4, 2
    v_lshlrev_b32 v5, 1, v5
    v_xor_b32 v4, v4, v5
    v_lshlrev_b32 v4, 4, v4
    v_lshrrev_b32 v3, 3, v1
    v_lshl_add_u32 v40, v3, 11, v4
    v_add_u32 v41, 15360, v40
    v_add_u32 v42, 30720, v40
    v_add_u32 v43, 46080, v40
    s_mul_i32 s30, s27, 3670016
    s_and_b32 s53, s24, 1
    s_lshl_b32 s53, s53, 16
    s_add_u32 s30, s30, s53
    s_lshl_b32 s53, s26, 8
    s_add_u32 s30, s30, s53
    s_lshr_b32 s53, s24, 1
    s_lshl_b32 s53, s53, 7
    s_add_u32 s30, s30, s53
    s_add_u32 s30, s30, 393216
    s_mov_b32 s16, s68
    s_mov_b32 s17, s69
    s_mov_b32 s18, 7340032
    s_mov_b32 s19, 0x20000
    s_lshl_b32 s52, s26, 1
    s_add_u32 s52, s52, s27
    s_mul_i32 s37, s52, 589824
    s_add_u32 s37, s37, s38
    s_add_u32 s37, s37, 38207488
    s_add_u32 m0, s34, 32768
    s_mov_b32 s12, s4
    s_mov_b32 s13, s5
    s_mov_b32 s14, 52826112
    s_mov_b32 s15, 0x20000
    s_lshr_b32 s61, s25, 1
    s_lshl_b32 s61, s61, 7
    s_add_u32 s61, s61, 52429824
    v_and_b32 v3, 31, v1
    v_lshlrev_b32 v37, 2, v3
    s_branch L_fi_lbody
L_at_fallback:
    s_waitcnt lgkmcnt(0)
    s_mov_b32 s4, s6
    s_mov_b32 s5, s7
    v_lshrrev_b32 v2, 6, v0
    v_and_b32 v1, 63, v0
    s_and_b32 s28, s2, 7
    s_lshl_b32 s21, s28, 1
    s_bfe_u32 s29, s2, 0x10003
    s_add_u32 s21, s21, s29
    s_bfe_u32 s29, s2, 0x10004
    s_lshl_b32 s29, s29, 4
    s_add_u32 s21, s21, s29
    s_lshr_b32 s22, s2, 5
    v_readfirstlane_b32 s20, v2
    v_lshlrev_b32 v231, 4, v1
    s_lshl_b32 s36, s21, 17
    s_mov_b32 s23, 0
    s_and_b32 s37, s20, 3
    s_lshr_b32 s27, s20, 2
    s_lshl_b32 s28, s22, 3
    s_lshl_b32 s29, s37, 1
    s_add_u32 s28, s28, s29
    s_lshl_b32 s30, s28, 11
    s_add_u32 s30, s30, s36
    s_add_u32 s30, s30, 4194304
    s_lshl_b32 s33, s27, 16
    s_add_u32 s33, s33, s36
    s_and_b32 s34, s37, 1
    s_cmp_eq_u32 s34, 0
    s_cselect_b32 s31, 0, 4192256
    s_cselect_b32 s32, s27, 0
    s_add_u32 s31, s31, 8390656
    s_add_u32 s31, s31, s33
    s_lshl_b32 s32, s32, 11
    s_sub_u32 s32, 65536, s32
    s_lshr_b32 s28, s37, 1
    s_lshl_b32 s38, s28, 11
    s_lshl_b32 s25, s28, 12
    s_lshl_b32 s34, s34, 11
    s_add_u32 s25, s25, s34
    s_lshl_b32 s28, s27, 13
    s_add_u32 s25, s25, s28
    v_add_u32 v228, s28, v231
    s_add_u32 s36, s33, 8388608
    s_mov_b32 s16, s4
    s_mov_b32 s17, s5
    s_mov_b32 s18, 52826112
    s_mov_b32 s19, 0x20000
    s_add_u32 s8, s4, s31
    s_addc_u32 s9, s5, 0
    s_mov_b32 s10, s32
    s_mov_b32 s11, 0x20000
    s_mov_b32 s23, 1
    s_mov_b32 s62, 1879048192
    s_mov_b32 s63, 1879048192
    s_mov_b32 s54, s30
    buffer_load_dwordx4 v[8:11], v231, s[16:19], s30 offen offset:0
    buffer_load_dwordx4 v[12:15], v231, s[16:19], s30 offen offset:1024
    buffer_load_dwordx4 v[16:19], v231, s[16:19], s30 offen offset:2048
    buffer_load_dwordx4 v[20:23], v231, s[16:19], s30 offen offset:3072
    v_mov_b32 v229, 0xff800000
    v_mov_b32 v230, 0xff800000
    s_lshl_b32 s28, s21, 17
    s_add_u32 s28, s28, 8388608
    s_mov_b32 s26, 8
L_at_fb:
    buffer_load_dwordx4 v[164:167], v231, s[16:19], s28 offen offset:0
    buffer_load_dwordx4 v[168:171], v231, s[16:19], s28 offen offset:1024
    buffer_load_dwordx4 v[172:175], v231, s[16:19], s28 offen offset:2048
    buffer_load_dwordx4 v[176:179], v231, s[16:19], s28 offen offset:3072
    s_add_u32 s28, s28, 4096
    buffer_load_dwordx4 v[180:183], v231, s[16:19], s28 offen offset:0
    buffer_load_dwordx4 v[184:187], v231, s[16:19], s28 offen offset:1024
    buffer_load_dwordx4 v[188:191], v231, s[16:19], s28 offen offset:2048
    buffer_load_dwordx4 v[192:195], v231, s[16:19], s28 offen offset:3072
    s_add_u32 s28, s28, 4096
    buffer_load_dwordx4 v[196:199], v231, s[16:19], s28 offen offset:0
    buffer_load_dwordx4 v[200:203], v231, s[16:19], s28 offen offset:1024
    buffer_load_dwordx4 v[204:207], v231, s[16:19], s28 offen offset:2048
    buffer_load_dwordx4 v[208:211], v231, s[16:19], s28 offen offset:3072
    s_add_u32 s28, s28, 4096
    buffer_load_dwordx4 v[212:215], v231, s[16:19], s28 offen offset:0
    buffer_load_dwordx4 v[216:219], v231, s[16:19], s28 offen offset:1024
    buffer_load_dwordx4 v[220:223], v231, s[16:19], s28 offen offset:2048
    buffer_load_dwordx4 v[224:227], v231, s[16:19], s28 offen offset:3072
    s_add_u32 s28, s28, 4096
    s_waitcnt vmcnt(0)
    v_mfma_f32_32x32x16_bf16 v[68:83], v[164:167], v[8:11], 0
    v_mfma_f32_32x32x16_bf16 v[68:83], v[168:171], v[12:15], v[68:83]
    v_mfma_f32_32x32x16_bf16 v[84:99], v[164:167], v[16:19], 0
    v_mfma_f32_32x32x16_bf16 v[84:99], v[168:171], v[20:23], v[84:99]
    v_mfma_f32_32x32x16_bf16 v[100:115], v[172:175], v[8:11], 0
    v_max3_f32 v229, v68, v69, v229
    v_max3_f32 v229, v70, v71, v229
    v_max3_f32 v229, v72, v73, v229
    v_max3_f32 v229, v74, v75, v229
    v_mfma_f32_32x32x16_bf16 v[100:115], v[176:179], v[12:15], v[100:115]
    v_max3_f32 v229, v76, v77, v229
    v_max3_f32 v229, v78, v79, v229
    v_max3_f32 v229, v80, v81, v229
    v_max3_f32 v229, v82, v83, v229
    v_mfma_f32_32x32x16_bf16 v[116:131], v[172:175], v[16:19], 0
    v_max3_f32 v230, v84, v85, v230
    v_max3_f32 v230, v86, v87, v230
    v_max3_f32 v230, v88, v89, v230
    v_max3_f32 v230, v90, v91, v230
    v_mfma_f32_32x32x16_bf16 v[116:131], v[176:179], v[20:23], v[116:131]
    v_max3_f32 v230, v92, v93, v230
    v_max3_f32 v230, v94, v95, v230
    v_max3_f32 v230, v96, v97, v230
    v_max3_f32 v230, v98, v99, v230
    v_mfma_f32_32x32x16_bf16 v[68:83], v[180:183], v[8:11], 0
    v_max3_f32 v229, v100, v101, v229
    v_max3_f32 v229, v102, v103, v229
    v_max3_f32 v229, v104, v105, v229
    v_max3_f32 v229, v106, v107, v229
    v_mfma_f32_32x32x16_bf16 v[68:83], v[184:187], v[12:15], v[68:83]
    v_max3_f32 v229, v108, v109, v229
    v_max3_f32 v229, v110, v111, v229
    v_max3_f32 v229, v112, v113, v229
    v_max3_f32 v229, v114, v115, v229
    v_mfma_f32_32x32x16_bf16 v[84:99], v[180:183], v[16:19], 0
    v_max3_f32 v230, v116, v117, v230
    v_max3_f32 v230, v118, v119, v230
    v_max3_f32 v230, v120, v121, v230
    v_max3_f32 v230, v122, v123, v230
    v_mfma_f32_32x32x16_bf16 v[84:99], v[184:187], v[20:23], v[84:99]
    v_max3_f32 v230, v124, v125, v230
    v_max3_f32 v230, v126, v127, v230
    v_max3_f32 v230, v128, v129, v230
    v_max3_f32 v230, v130, v131, v230
    v_mfma_f32_32x32x16_bf16 v[100:115], v[188:191], v[8:11], 0
    v_max3_f32 v229, v68, v69, v229
    v_max3_f32 v229, v70, v71, v229
    v_max3_f32 v229, v72, v73, v229
    v_max3_f32 v229, v74, v75, v229
    v_mfma_f32_32x32x16_bf16 v[100:115], v[192:195], v[12:15], v[100:115]
    v_max3_f32 v229, v76, v77, v229
    v_max3_f32 v229, v78, v79, v229
    v_max3_f32 v229, v80, v81, v229
    v_max3_f32 v229, v82, v83, v229
    v_mfma_f32_32x32x16_bf16 v[116:131], v[188:191], v[16:19], 0
    v_max3_f32 v230, v84, v85, v230
    v_max3_f32 v230, v86, v87, v230
    v_max3_f32 v230, v88, v89, v230
    v_max3_f32 v230, v90, v91, v230
    v_mfma_f32_32x32x16_bf16 v[116:131], v[192:195], v[20:23], v[116:131]
    v_max3_f32 v230, v92, v93, v230
    v_max3_f32 v230, v94, v95, v230
    v_max3_f32 v230, v96, v97, v230
    v_max3_f32 v230, v98, v99, v230
    v_mfma_f32_32x32x16_bf16 v[68:83], v[196:199], v[8:11], 0
    v_max3_f32 v229, v100, v101, v229
    v_max3_f32 v229, v102, v103, v229
    v_max3_f32 v229, v104, v105, v229
    v_max3_f32 v229, v106, v107, v229
    v_mfma_f32_32x32x16_bf16 v[68:83], v[200:203], v[12:15], v[68:83]
    v_max3_f32 v229, v108, v109, v229
    v_max3_f32 v229, v110, v111, v229
    v_max3_f32 v229, v112, v113, v229
    v_max3_f32 v229, v114, v115, v229
    v_mfma_f32_32x32x16_bf16 v[84:99], v[196:199], v[16:19], 0
    v_max3_f32 v230, v116, v117, v230
    v_max3_f32 v230, v118, v119, v230
    v_max3_f32 v230, v120, v121, v230
    v_max3_f32 v230, v122, v123, v230
    v_mfma_f32_32x32x16_bf16 v[84:99], v[200:203], v[20:23], v[84:99]
    v_max3_f32 v230, v124, v125, v230
    v_max3_f32 v230, v126, v127, v230
    v_max3_f32 v230, v128, v129, v230
    v_max3_f32 v230, v130, v131, v230
    v_mfma_f32_32x32x16_bf16 v[100:115], v[204:207], v[8:11], 0
    v_max3_f32 v229, v68, v69, v229
    v_max3_f32 v229, v70, v71, v229
    v_max3_f32 v229, v72, v73, v229
    v_max3_f32 v229, v74, v75, v229
    v_mfma_f32_32x32x16_bf16 v[100:115], v[208:211], v[12:15], v[100:115]
    v_max3_f32 v229, v76, v77, v229
    v_max3_f32 v229, v78, v79, v229
    v_max3_f32 v229, v80, v81, v229
    v_max3_f32 v229, v82, v83, v229
    v_mfma_f32_32x32x16_bf16 v[116:131], v[204:207], v[16:19], 0
    v_max3_f32 v230, v84, v85, v230
    v_max3_f32 v230, v86, v87, v230
    v_max3_f32 v230, v88, v89, v230
    v_max3_f32 v230, v90, v91, v230
    v_mfma_f32_32x32x16_bf16 v[116:131], v[208:211], v[20:23], v[116:131]
    v_max3_f32 v230, v92, v93, v230
    v_max3_f32 v230, v94, v95, v230
    v_max3_f32 v230, v96, v97, v230
    v_max3_f32 v230, v98, v99, v230
    v_mfma_f32_32x32x16_bf16 v[68:83], v[212:215], v[8:11], 0
    v_max3_f32 v229, v100, v101, v229
    v_max3_f32 v229, v102, v103, v229
    v_max3_f32 v229, v104, v105, v229
    v_max3_f32 v229, v106, v107, v229
    v_mfma_f32_32x32x16_bf16 v[68:83], v[216:219], v[12:15], v[68:83]
    v_max3_f32 v229, v108, v109, v229
    v_max3_f32 v229, v110, v111, v229
    v_max3_f32 v229, v112, v113, v229
    v_max3_f32 v229, v114, v115, v229
    v_mfma_f32_32x32x16_bf16 v[84:99], v[212:215], v[16:19], 0
    v_max3_f32 v230, v116, v117, v230
    v_max3_f32 v230, v118, v119, v230
    v_max3_f32 v230, v120, v121, v230
    v_max3_f32 v230, v122, v123, v230
    v_mfma_f32_32x32x16_bf16 v[84:99], v[216:219], v[20:23], v[84:99]
    v_max3_f32 v230, v124, v125, v230
    v_max3_f32 v230, v126, v127, v230
    v_max3_f32 v230, v128, v129, v230
    v_max3_f32 v230, v130, v131, v230
    v_mfma_f32_32x32x16_bf16 v[100:115], v[220:223], v[8:11], 0
    v_max3_f32 v229, v68, v69, v229
    v_max3_f32 v229, v70, v71, v229
    v_max3_f32 v229, v72, v73, v229
    v_max3_f32 v229, v74, v75, v229
    v_mfma_f32_32x32x16_bf16 v[100:115], v[224:227], v[12:15], v[100:115]
    v_max3_f32 v229, v76, v77, v229
    v_max3_f32 v229, v78, v79, v229
    v_max3_f32 v229, v80, v81, v229
    v_max3_f32 v229, v82, v83, v229
    v_mfma_f32_32x32x16_bf16 v[116:131], v[220:223], v[16:19], 0
    v_max3_f32 v230, v84, v85, v230
    v_max3_f32 v230, v86, v87, v230
    v_max3_f32 v230, v88, v89, v230
    v_max3_f32 v230, v90, v91, v230
    v_mfma_f32_32x32x16_bf16 v[116:131], v[224:227], v[20:23], v[116:131]
    v_max3_f32 v230, v92, v93, v230
    v_max3_f32 v230, v94, v95, v230
    v_max3_f32 v230, v96, v97, v230
    v_max3_f32 v230, v98, v99, v230
    s_nop 7
    v_max3_f32 v229, v100, v101, v229
    v_max3_f32 v229, v102, v103, v229
    v_max3_f32 v229, v104, v105, v229
    v_max3_f32 v229, v106, v107, v229
    s_nop 3
    v_max3_f32 v229, v108, v109, v229
    v_max3_f32 v229, v110, v111, v229
    v_max3_f32 v229, v112, v113, v229
    v_max3_f32 v229, v114, v115, v229
    s_nop 7
    v_max3_f32 v230, v116, v117, v230
    v_max3_f32 v230, v118, v119, v230
    v_max3_f32 v230, v120, v121, v230
    v_max3_f32 v230, v122, v123, v230
    s_nop 3
    v_max3_f32 v230, v124, v125, v230
    v_max3_f32 v230, v126, v127, v230
    v_max3_f32 v230, v128, v129, v230
    v_max3_f32 v230, v130, v131, v230
    s_sub_u32 s26, s26, 1
    s_cmp_lg_u32 s26, 0
    s_cbranch_scc1 L_at_fb
    v_mov_b32 v2, v229
    s_nop 1
    v_permlane32_swap_b32 v229, v2
    s_nop 1
    v_max_f32 v229, v229, v2
    v_mov_b32 v2, v230
    s_nop 1
    v_permlane32_swap_b32 v230, v2
    s_nop 1
    v_max_f32 v230, v230, v2
    v_sub_f32 v2, 0, v229
    v_mov_b32 v100, v2
    v_mov_b32 v101, v2
    v_mov_b32 v102, v2
    v_mov_b32 v103, v2
    v_mov_b32 v104, v2
    v_mov_b32 v105, v2
    v_mov_b32 v106, v2
    v_mov_b32 v107, v2
    v_mov_b32 v108, v2
    v_mov_b32 v109, v2
    v_mov_b32 v110, v2
    v_mov_b32 v111, v2
    v_mov_b32 v112, v2
    v_mov_b32 v113, v2
    v_mov_b32 v114, v2
    v_mov_b32 v115, v2
    v_sub_f32 v2, 0, v230
    v_mov_b32 v116, v2
    v_mov_b32 v117, v2
    v_mov_b32 v118, v2
    v_mov_b32 v119, v2
    v_mov_b32 v120, v2
    v_mov_b32 v121, v2
    v_mov_b32 v122, v2
    v_mov_b32 v123, v2
    v_mov_b32 v124, v2
    v_mov_b32 v125, v2
    v_mov_b32 v126, v2
    v_mov_b32 v127, v2
    v_mov_b32 v128, v2
    v_mov_b32 v129, v2
    v_mov_b32 v130, v2
    v_mov_b32 v131, v2
    s_waitcnt vmcnt(0)
    s_barrier
    s_branch L_at_resetup
L_fi_lbody:
    s_barrier
    s_mov_b32 s28, 5
L_fi_lff:
    buffer_load_dwordx4 v40, s[16:19], s30 offen offset:0 lds
    s_add_u32 s32, s32, 2048
    buffer_load_dwordx4 v41, s[16:19], s30 offen offset:1024 lds
    buffer_load_dwordx4 v42, s[16:19], s30 offen offset:2048 lds
    buffer_load_dwordx4 v43, s[16:19], s30 offen offset:3072 lds
    s_add_u32 m0, s35, 32768
    s_add_u32 s30, s30, 131072
    buffer_load_dwordx4 v31, s[12:15], s32 offen lds
    buffer_load_dwordx4 v31, s[12:15], s32 offen offset:1024 lds
    buffer_load_dwordx4 v32, s[12:15], s32 offen offset:2048 lds
    buffer_load_dwordx4 v32, s[12:15], s32 offen offset:3072 lds
    s_add_u32 m0, s34, 65536
    s_waitcnt vmcnt(8)
    s_barrier
    buffer_load_dwordx4 v40, s[16:19], s30 offen offset:0 lds
    s_add_u32 s32, s32, 2048
    buffer_load_dwordx4 v41, s[16:19], s30 offen offset:1024 lds
    buffer_load_dwordx4 v42, s[16:19], s30 offen offset:2048 lds
    buffer_load_dwordx4 v43, s[16:19], s30 offen offset:3072 lds
    s_add_u32 m0, s35, 65536
    s_add_u32 s30, s30, 131072
    buffer_load_dwordx4 v31, s[12:15], s32 offen lds
    buffer_load_dwordx4 v31, s[12:15], s32 offen offset:1024 lds
    buffer_load_dwordx4 v32, s[12:15], s32 offen offset:2048 lds
    buffer_load_dwordx4 v32, s[12:15], s32 offen offset:3072 lds
    s_add_u32 m0, s34, 98304
    s_waitcnt vmcnt(8)
    s_barrier
    buffer_load_dwordx4 v40, s[16:19], s30 offen offset:0 lds
    s_add_u32 s32, s32, 2048
    buffer_load_dwordx4 v41, s[16:19], s30 offen offset:1024 lds
    buffer_load_dwordx4 v42, s[16:19], s30 offen offset:2048 lds
    buffer_load_dwordx4 v43, s[16:19], s30 offen offset:3072 lds
    s_add_u32 m0, s35, 98304
    s_add_u32 s30, s30, 131072
    buffer_load_dwordx4 v31, s[12:15], s32 offen lds
    buffer_load_dwordx4 v31, s[12:15], s32 offen offset:1024 lds
    buffer_load_dwordx4 v32, s[12:15], s32 offen offset:2048 lds
    buffer_load_dwordx4 v32, s[12:15], s32 offen offset:3072 lds
    s_add_u32 m0, s34, 131072
    s_waitcnt vmcnt(8)
    s_barrier
    buffer_load_dwordx4 v40, s[16:19], s30 offen offset:0 lds
    s_add_u32 s32, s32, 2048
    buffer_load_dwordx4 v41, s[16:19], s30 offen offset:1024 lds
    buffer_load_dwordx4 v42, s[16:19], s30 offen offset:2048 lds
    buffer_load_dwordx4 v43, s[16:19], s30 offen offset:3072 lds
    s_add_u32 m0, s35, 131072
    s_add_u32 s30, s30, 131072
    buffer_load_dwordx4 v31, s[12:15], s32 offen lds
    buffer_load_dwordx4 v31, s[12:15], s32 offen offset:1024 lds
    buffer_load_dwordx4 v32, s[12:15], s32 offen offset:2048 lds
    buffer_load_dwordx4 v32, s[12:15], s32 offen offset:3072 lds
    s_add_u32 m0, s34, 0
    s_waitcnt vmcnt(8)
    s_barrier
    buffer_load_dwordx4 v40, s[16:19], s30 offen offset:0 lds
    s_add_u32 s32, s32, 2048
    buffer_load_dwordx4 v41, s[16:19], s30 offen offset:1024 lds
    buffer_load_dwordx4 v42, s[16:19], s30 offen offset:2048 lds
    buffer_load_dwordx4 v43, s[16:19], s30 offen offset:3072 lds
    s_add_u32 m0, s35, 0
    s_add_u32 s30, s30, 131072
    buffer_load_dwordx4 v31, s[12:15], s32 offen lds
    buffer_load_dwordx4 v31, s[12:15], s32 offen offset:1024 lds
    buffer_load_dwordx4 v32, s[12:15], s32 offen offset:2048 lds
    buffer_load_dwordx4 v32, s[12:15], s32 offen offset:3072 lds
    s_add_u32 m0, s34, 32768
    s_sub_u32 s28, s28, 1
    s_cmp_eq_u32 s28, 0
    s_waitcnt vmcnt(8)
    s_barrier
    s_cbranch_scc1 L_fi_lffd
    s_cmp_eq_u32 s28, 2
    s_cbranch_scc0 L_fi_lff
    buffer_load_dword v36, v37, s[12:15], s61 offen
    s_branch L_fi_lff
L_fi_lffd:
L_fi_o_poll_1001:
    v_cmp_eq_u32 vcc, 0, v36
    s_cbranch_vccz L_fi_o_ok_1002
    s_add_u32 s60, s60, 1
    s_cmp_lt_u32 s60, 65536
    s_cbranch_scc0 L_fi_o_ok_1002
    buffer_load_dword v36, v37, s[12:15], s61 offen sc0 sc1
    s_waitcnt vmcnt(0)
    s_branch L_fi_o_poll_1001
L_fi_o_ok_1002:
    s_add_u32 m0, s38, 32768
    s_mov_b32 s30, s37
    s_mov_b32 s32, s36
    s_mov_b32 s28, 4
L_fi_ls:
    buffer_load_dwordx4 v33, s[12:15], s30 offen offset:0 lds
    s_add_u32 s32, s32, 2048
    buffer_load_dwordx4 v33, s[12:15], s30 offen offset:1024 lds
    s_add_u32 m0, s35, 32768
    s_add_u32 s30, s30, 8192
    buffer_load_dwordx4 v31, s[12:15], s32 offen lds
    buffer_load_dwordx4 v31, s[12:15], s32 offen offset:1024 lds
    buffer_load_dwordx4 v35, s[12:15], s32 offen offset:2048 lds
    buffer_load_dwordx4 v35, s[12:15], s32 offen offset:3072 lds
    s_add_u32 m0, s38, 65536
    s_sub_u32 s28, s28, 1
    s_cmp_eq_u32 s28, 0
    s_waitcnt vmcnt(6)
    s_barrier
    s_cbranch_scc1 L_fi_lsd
    buffer_load_dwordx4 v33, s[12:15], s30 offen offset:0 lds
    s_add_u32 s32, s32, 2048
    buffer_load_dwordx4 v33, s[12:15], s30 offen offset:1024 lds
    s_add_u32 m0, s35, 65536
    s_add_u32 s30, s30, 8192
    buffer_load_dwordx4 v31, s[12:15], s32 offen lds
    buffer_load_dwordx4 v31, s[12:15], s32 offen offset:1024 lds
    buffer_load_dwordx4 v35, s[12:15], s32 offen offset:2048 lds
    buffer_load_dwordx4 v35, s[12:15], s32 offen offset:3072 lds
    s_add_u32 m0, s38, 98304
    s_waitcnt vmcnt(6)
    s_barrier
    buffer_load_dwordx4 v33, s[12:15], s30 offen offset:0 lds
    s_add_u32 s32, s32, 2048
    buffer_load_dwordx4 v33, s[12:15], s30 offen offset:1024 lds
    s_add_u32 m0, s35, 98304
    s_add_u32 s30, s30, 8192
    buffer_load_dwordx4 v31, s[12:15], s32 offen lds
    buffer_load_dwordx4 v31, s[12:15], s32 offen offset:1024 lds
    buffer_load_dwordx4 v35, s[12:15], s32 offen offset:2048 lds
    buffer_load_dwordx4 v35, s[12:15], s32 offen offset:3072 lds
    s_add_u32 m0, s38, 131072
    s_waitcnt vmcnt(6)
    s_barrier
    buffer_load_dwordx4 v33, s[12:15], s30 offen offset:0 lds
    s_add_u32 s32, s32, 2048
    buffer_load_dwordx4 v33, s[12:15], s30 offen offset:1024 lds
    s_add_u32 m0, s35, 131072
    s_add_u32 s30, s30, 8192
    buffer_load_dwordx4 v31, s[12:15], s32 offen lds
    buffer_load_dwordx4 v31, s[12:15], s32 offen offset:1024 lds
    buffer_load_dwordx4 v35, s[12:15], s32 offen offset:2048 lds
    buffer_load_dwordx4 v35, s[12:15], s32 offen offset:3072 lds
    s_add_u32 m0, s38, 0
    s_waitcnt vmcnt(6)
    s_barrier
    buffer_load_dwordx4 v33, s[12:15], s30 offen offset:0 lds
    s_add_u32 s32, s32, 2048
    buffer_load_dwordx4 v33, s[12:15], s30 offen offset:1024 lds
    s_add_u32 m0, s35, 0
    s_add_u32 s30, s30, 8192
    buffer_load_dwordx4 v31, s[12:15], s32 offen lds
    buffer_load_dwordx4 v31, s[12:15], s32 offen offset:1024 lds
    buffer_load_dwordx4 v35, s[12:15], s32 offen offset:2048 lds
    buffer_load_dwordx4 v35, s[12:15], s32 offen offset:3072 lds
    s_add_u32 m0, s38, 32768
    s_waitcnt vmcnt(6)
    s_barrier
    s_branch L_fi_ls
L_fi_lsd:
    s_waitcnt vmcnt(0)
    s_barrier
    s_endpgm
L_fi_cbody:
    s_waitcnt lgkmcnt(0)
    v_mfma_f32_16x16x32_bf16 v[112:115], v[48:51], v[72:75], 0
    ds_read_b128 v[88:91], v29 offset:33792
    ds_read_b128 v[92:95], v29 offset:35840
    v_mfma_f32_16x16x32_bf16 v[128:131], v[48:51], v[76:79], 0
    ds_read_b128 v[96:99], v29 offset:37888
    ds_read_b128 v[100:103], v29 offset:39936
    v_mfma_f32_16x16x32_bf16 v[144:147], v[48:51], v[80:83], 0
    ds_read_b64_tr_b16 v[64:65], v16 offset:36864
    ds_read_b64_tr_b16 v[66:67], v16 offset:38912
    v_mfma_f32_16x16x32_bf16 v[160:163], v[48:51], v[84:87], 0
    ds_read_b64_tr_b16 v[68:69], v17 offset:36864
    ds_read_b64_tr_b16 v[70:71], v17 offset:38912
    v_mfma_f32_16x16x32_bf16 v[116:119], v[52:55], v[72:75], 0
    ds_read_b64_tr_b16 v[56:57], v14 offset:36864
    ds_read_b64_tr_b16 v[58:59], v14 offset:38912
    v_mfma_f32_16x16x32_bf16 v[132:135], v[52:55], v[76:79], 0
    ds_read_b64_tr_b16 v[60:61], v15 offset:36864
    ds_read_b64_tr_b16 v[62:63], v15 offset:38912
    v_mfma_f32_16x16x32_bf16 v[148:151], v[52:55], v[80:83], 0
    v_mfma_f32_16x16x32_bf16 v[164:167], v[52:55], v[84:87], 0
    v_mfma_f32_16x16x32_bf16 v[104:107], v[40:43], v[72:75], 0
    v_mfma_f32_16x16x32_bf16 v[120:123], v[40:43], v[76:79], 0
    v_mfma_f32_16x16x32_bf16 v[136:139], v[40:43], v[80:83], 0
    v_mfma_f32_16x16x32_bf16 v[152:155], v[40:43], v[84:87], 0
    v_mfma_f32_16x16x32_bf16 v[108:111], v[44:47], v[72:75], 0
    v_mfma_f32_16x16x32_bf16 v[124:127], v[44:47], v[76:79], 0
    v_mfma_f32_16x16x32_bf16 v[140:143], v[44:47], v[80:83], 0
    v_mfma_f32_16x16x32_bf16 v[156:159], v[44:47], v[84:87], 0
    s_waitcnt lgkmcnt(0)
    s_barrier
    s_mov_b32 s28, 6
    .p2align 6
L_fi_cloop:
    v_mfma_f32_16x16x32_bf16 v[112:115], v[64:67], v[88:91], v[112:115]
    ds_read_b128 v[72:75], v30 offset:0
    ds_read_b128 v[76:79], v30 offset:2048
    v_mfma_f32_16x16x32_bf16 v[128:131], v[64:67], v[92:95], v[128:131]
    ds_read_b128 v[80:83], v30 offset:4096
    ds_read_b128 v[84:87], v30 offset:6144
    v_mfma_f32_16x16x32_bf16 v[144:147], v[64:67], v[96:99], v[144:147]
    ds_read_b64_tr_b16 v[48:49], v20 offset:0
    ds_read_b64_tr_b16 v[50:51], v20 offset:2048
    v_mfma_f32_16x16x32_bf16 v[160:163], v[64:67], v[100:103], v[160:163]
    ds_read_b64_tr_b16 v[52:53], v21 offset:0
    ds_read_b64_tr_b16 v[54:55], v21 offset:2048
    v_mfma_f32_16x16x32_bf16 v[116:119], v[68:71], v[88:91], v[116:119]
    ds_read_b64_tr_b16 v[40:41], v18 offset:0
    ds_read_b64_tr_b16 v[42:43], v18 offset:2048
    v_mfma_f32_16x16x32_bf16 v[132:135], v[68:71], v[92:95], v[132:135]
    ds_read_b64_tr_b16 v[44:45], v19 offset:0
    ds_read_b64_tr_b16 v[46:47], v19 offset:2048
    v_mfma_f32_16x16x32_bf16 v[148:151], v[68:71], v[96:99], v[148:151]
    v_mfma_f32_16x16x32_bf16 v[164:167], v[68:71], v[100:103], v[164:167]
    v_mfma_f32_16x16x32_bf16 v[104:107], v[56:59], v[88:91], v[104:107]
    v_mfma_f32_16x16x32_bf16 v[120:123], v[56:59], v[92:95], v[120:123]
    v_mfma_f32_16x16x32_bf16 v[136:139], v[56:59], v[96:99], v[136:139]
    v_mfma_f32_16x16x32_bf16 v[152:155], v[56:59], v[100:103], v[152:155]
    v_mfma_f32_16x16x32_bf16 v[108:111], v[60:63], v[88:91], v[108:111]
    v_mfma_f32_16x16x32_bf16 v[124:127], v[60:63], v[92:95], v[124:127]
    v_mfma_f32_16x16x32_bf16 v[140:143], v[60:63], v[96:99], v[140:143]
    v_mfma_f32_16x16x32_bf16 v[156:159], v[60:63], v[100:103], v[156:159]
    s_waitcnt lgkmcnt(0)
    v_mfma_f32_16x16x32_bf16 v[112:115], v[48:51], v[72:75], v[112:115]
    ds_read_b128 v[88:91], v30 offset:1024
    ds_read_b128 v[92:95], v30 offset:3072
    v_mfma_f32_16x16x32_bf16 v[128:131], v[48:51], v[76:79], v[128:131]
    ds_read_b128 v[96:99], v30 offset:5120
    ds_read_b128 v[100:103], v30 offset:7168
    v_mfma_f32_16x16x32_bf16 v[144:147], v[48:51], v[80:83], v[144:147]
    ds_read_b64_tr_b16 v[64:65], v20 offset:4096
    ds_read_b64_tr_b16 v[66:67], v20 offset:6144
    v_mfma_f32_16x16x32_bf16 v[160:163], v[48:51], v[84:87], v[160:163]
    ds_read_b64_tr_b16 v[68:69], v21 offset:4096
    ds_read_b64_tr_b16 v[70:71], v21 offset:6144
    v_mfma_f32_16x16x32_bf16 v[116:119], v[52:55], v[72:75], v[116:119]
    ds_read_b64_tr_b16 v[56:57], v18 offset:4096
    ds_read_b64_tr_b16 v[58:59], v18 offset:6144
    v_mfma_f32_16x16x32_bf16 v[132:135], v[52:55], v[76:79], v[132:135]
    ds_read_b64_tr_b16 v[60:61], v19 offset:4096
    ds_read_b64_tr_b16 v[62:63], v19 offset:6144
    v_mfma_f32_16x16x32_bf16 v[148:151], v[52:55], v[80:83], v[148:151]
    v_mfma_f32_16x16x32_bf16 v[164:167], v[52:55], v[84:87], v[164:167]
    v_mfma_f32_16x16x32_bf16 v[104:107], v[40:43], v[72:75], v[104:107]
    v_mfma_f32_16x16x32_bf16 v[120:123], v[40:43], v[76:79], v[120:123]
    v_mfma_f32_16x16x32_bf16 v[136:139], v[40:43], v[80:83], v[136:139]
    v_mfma_f32_16x16x32_bf16 v[152:155], v[40:43], v[84:87], v[152:155]
    v_mfma_f32_16x16x32_bf16 v[108:111], v[44:47], v[72:75], v[108:111]
    v_mfma_f32_16x16x32_bf16 v[124:127], v[44:47], v[76:79], v[124:127]
    v_mfma_f32_16x16x32_bf16 v[140:143], v[44:47], v[80:83], v[140:143]
    v_mfma_f32_16x16x32_bf16 v[156:159], v[44:47], v[84:87], v[156:159]
    s_waitcnt lgkmcnt(0)
    s_barrier
    v_mfma_f32_16x16x32_bf16 v[112:115], v[64:67], v[88:91], v[112:115]
    ds_read_b128 v[72:75], v28 offset:0
    ds_read_b128 v[76:79], v28 offset:2048
    v_mfma_f32_16x16x32_bf16 v[128:131], v[64:67], v[92:95], v[128:131]
    ds_read_b128 v[80:83], v28 offset:4096
    ds_read_b128 v[84:87], v28 offset:6144
    v_mfma_f32_16x16x32_bf16 v[144:147], v[64:67], v[96:99], v[144:147]
    ds_read_b64_tr_b16 v[48:49], v12 offset:0
    ds_read_b64_tr_b16 v[50:51], v12 offset:2048
    v_mfma_f32_16x16x32_bf16 v[160:163], v[64:67], v[100:103], v[160:163]
    ds_read_b64_tr_b16 v[52:53], v13 offset:0
    ds_read_b64_tr_b16 v[54:55], v13 offset:2048
    v_mfma_f32_16x16x32_bf16 v[116:119], v[68:71], v[88:91], v[116:119]
    ds_read_b64_tr_b16 v[40:41], v10 offset:0
    ds_read_b64_tr_b16 v[42:43], v10 offset:2048
    v_mfma_f32_16x16x32_bf16 v[132:135], v[68:71], v[92:95], v[132:135]
    ds_read_b64_tr_b16 v[44:45], v11 offset:0
    ds_read_b64_tr_b16 v[46:47], v11 offset:2048
    v_mfma_f32_16x16x32_bf16 v[148:151], v[68:71], v[96:99], v[148:151]
    v_mfma_f32_16x16x32_bf16 v[164:167], v[68:71], v[100:103], v[164:167]
    v_mfma_f32_16x16x32_bf16 v[104:107], v[56:59], v[88:91], v[104:107]
    v_mfma_f32_16x16x32_bf16 v[120:123], v[56:59], v[92:95], v[120:123]
    v_mfma_f32_16x16x32_bf16 v[136:139], v[56:59], v[96:99], v[136:139]
    v_mfma_f32_16x16x32_bf16 v[152:155], v[56:59], v[100:103], v[152:155]
    v_mfma_f32_16x16x32_bf16 v[108:111], v[60:63], v[88:91], v[108:111]
    v_mfma_f32_16x16x32_bf16 v[124:127], v[60:63], v[92:95], v[124:127]
    v_mfma_f32_16x16x32_bf16 v[140:143], v[60:63], v[96:99], v[140:143]
    v_mfma_f32_16x16x32_bf16 v[156:159], v[60:63], v[100:103], v[156:159]
    s_waitcnt lgkmcnt(0)
    v_mfma_f32_16x16x32_bf16 v[112:115], v[48:51], v[72:75], v[112:115]
    ds_read_b128 v[88:91], v28 offset:1024
    ds_read_b128 v[92:95], v28 offset:3072
    v_mfma_f32_16x16x32_bf16 v[128:131], v[48:51], v[76:79], v[128:131]
    ds_read_b128 v[96:99], v28 offset:5120
    ds_read_b128 v[100:103], v28 offset:7168
    v_mfma_f32_16x16x32_bf16 v[144:147], v[48:51], v[80:83], v[144:147]
    ds_read_b64_tr_b16 v[64:65], v12 offset:4096
    ds_read_b64_tr_b16 v[66:67], v12 offset:6144
    v_mfma_f32_16x16x32_bf16 v[160:163], v[48:51], v[84:87], v[160:163]
    ds_read_b64_tr_b16 v[68:69], v13 offset:4096
    ds_read_b64_tr_b16 v[70:71], v13 offset:6144
    v_mfma_f32_16x16x32_bf16 v[116:119], v[52:55], v[72:75], v[116:119]
    ds_read_b64_tr_b16 v[56:57], v10 offset:4096
    ds_read_b64_tr_b16 v[58:59], v10 offset:6144
    v_mfma_f32_16x16x32_bf16 v[132:135], v[52:55], v[76:79], v[132:135]
    ds_read_b64_tr_b16 v[60:61], v11 offset:4096
    ds_read_b64_tr_b16 v[62:63], v11 offset:6144
    v_mfma_f32_16x16x32_bf16 v[148:151], v[52:55], v[80:83], v[148:151]
    s_sub_u32 s28, s28, 1
    v_mfma_f32_16x16x32_bf16 v[164:167], v[52:55], v[84:87], v[164:167]
    s_cmp_eq_u32 s28, 0
    v_mfma_f32_16x16x32_bf16 v[104:107], v[40:43], v[72:75], v[104:107]
    v_mfma_f32_16x16x32_bf16 v[120:123], v[40:43], v[76:79], v[120:123]
    v_mfma_f32_16x16x32_bf16 v[136:139], v[40:43], v[80:83], v[136:139]
    v_mfma_f32_16x16x32_bf16 v[152:155], v[40:43], v[84:87], v[152:155]
    v_mfma_f32_16x16x32_bf16 v[108:111], v[44:47], v[72:75], v[108:111]
    v_mfma_f32_16x16x32_bf16 v[124:127], v[44:47], v[76:79], v[124:127]
    v_mfma_f32_16x16x32_bf16 v[140:143], v[44:47], v[80:83], v[140:143]
    v_mfma_f32_16x16x32_bf16 v[156:159], v[44:47], v[84:87], v[156:159]
    s_waitcnt lgkmcnt(0)
    s_barrier
    s_cbranch_scc1 L_fi_cdone
    v_mfma_f32_16x16x32_bf16 v[112:115], v[64:67], v[88:91], v[112:115]
    ds_read_b128 v[72:75], v28 offset:32768
    ds_read_b128 v[76:79], v28 offset:34816
    v_mfma_f32_16x16x32_bf16 v[128:131], v[64:67], v[92:95], v[128:131]
    ds_read_b128 v[80:83], v28 offset:36864
    ds_read_b128 v[84:87], v28 offset:38912
    v_mfma_f32_16x16x32_bf16 v[144:147], v[64:67], v[96:99], v[144:147]
    ds_read_b64_tr_b16 v[48:49], v12 offset:32768
    ds_read_b64_tr_b16 v[50:51], v12 offset:34816
    v_mfma_f32_16x16x32_bf16 v[160:163], v[64:67], v[100:103], v[160:163]
    ds_read_b64_tr_b16 v[52:53], v13 offset:32768
    ds_read_b64_tr_b16 v[54:55], v13 offset:34816
    v_mfma_f32_16x16x32_bf16 v[116:119], v[68:71], v[88:91], v[116:119]
    ds_read_b64_tr_b16 v[40:41], v10 offset:32768
    ds_read_b64_tr_b16 v[42:43], v10 offset:34816
    v_mfma_f32_16x16x32_bf16 v[132:135], v[68:71], v[92:95], v[132:135]
    ds_read_b64_tr_b16 v[44:45], v11 offset:32768
    ds_read_b64_tr_b16 v[46:47], v11 offset:34816
    v_mfma_f32_16x16x32_bf16 v[148:151], v[68:71], v[96:99], v[148:151]
    v_mfma_f32_16x16x32_bf16 v[164:167], v[68:71], v[100:103], v[164:167]
    v_mfma_f32_16x16x32_bf16 v[104:107], v[56:59], v[88:91], v[104:107]
    v_mfma_f32_16x16x32_bf16 v[120:123], v[56:59], v[92:95], v[120:123]
    v_mfma_f32_16x16x32_bf16 v[136:139], v[56:59], v[96:99], v[136:139]
    v_mfma_f32_16x16x32_bf16 v[152:155], v[56:59], v[100:103], v[152:155]
    v_mfma_f32_16x16x32_bf16 v[108:111], v[60:63], v[88:91], v[108:111]
    v_mfma_f32_16x16x32_bf16 v[124:127], v[60:63], v[92:95], v[124:127]
    v_mfma_f32_16x16x32_bf16 v[140:143], v[60:63], v[96:99], v[140:143]
    v_mfma_f32_16x16x32_bf16 v[156:159], v[60:63], v[100:103], v[156:159]
    s_waitcnt lgkmcnt(0)
    v_mfma_f32_16x16x32_bf16 v[112:115], v[48:51], v[72:75], v[112:115]
    ds_read_b128 v[88:91], v28 offset:33792
    ds_read_b128 v[92:95], v28 offset:35840
    v_mfma_f32_16x16x32_bf16 v[128:131], v[48:51], v[76:79], v[128:131]
    ds_read_b128 v[96:99], v28 offset:37888
    ds_read_b128 v[100:103], v28 offset:39936
    v_mfma_f32_16x16x32_bf16 v[144:147], v[48:51], v[80:83], v[144:147]
    ds_read_b64_tr_b16 v[64:65], v12 offset:36864
    ds_read_b64_tr_b16 v[66:67], v12 offset:38912
    v_mfma_f32_16x16x32_bf16 v[160:163], v[48:51], v[84:87], v[160:163]
    ds_read_b64_tr_b16 v[68:69], v13 offset:36864
    ds_read_b64_tr_b16 v[70:71], v13 offset:38912
    v_mfma_f32_16x16x32_bf16 v[116:119], v[52:55], v[72:75], v[116:119]
    ds_read_b64_tr_b16 v[56:57], v10 offset:36864
    ds_read_b64_tr_b16 v[58:59], v10 offset:38912
    v_mfma_f32_16x16x32_bf16 v[132:135], v[52:55], v[76:79], v[132:135]
    ds_read_b64_tr_b16 v[60:61], v11 offset:36864
    ds_read_b64_tr_b16 v[62:63], v11 offset:38912
    v_mfma_f32_16x16x32_bf16 v[148:151], v[52:55], v[80:83], v[148:151]
    v_mfma_f32_16x16x32_bf16 v[164:167], v[52:55], v[84:87], v[164:167]
    v_mfma_f32_16x16x32_bf16 v[104:107], v[40:43], v[72:75], v[104:107]
    v_mfma_f32_16x16x32_bf16 v[120:123], v[40:43], v[76:79], v[120:123]
    v_mfma_f32_16x16x32_bf16 v[136:139], v[40:43], v[80:83], v[136:139]
    v_mfma_f32_16x16x32_bf16 v[152:155], v[40:43], v[84:87], v[152:155]
    v_mfma_f32_16x16x32_bf16 v[108:111], v[44:47], v[72:75], v[108:111]
    v_mfma_f32_16x16x32_bf16 v[124:127], v[44:47], v[76:79], v[124:127]
    v_mfma_f32_16x16x32_bf16 v[140:143], v[44:47], v[80:83], v[140:143]
    v_mfma_f32_16x16x32_bf16 v[156:159], v[44:47], v[84:87], v[156:159]
    s_waitcnt lgkmcnt(0)
    s_barrier
    v_mfma_f32_16x16x32_bf16 v[112:115], v[64:67], v[88:91], v[112:115]
    ds_read_b128 v[72:75], v29 offset:0
    ds_read_b128 v[76:79], v29 offset:2048
    v_mfma_f32_16x16x32_bf16 v[128:131], v[64:67], v[92:95], v[128:131]
    ds_read_b128 v[80:83], v29 offset:4096
    ds_read_b128 v[84:87], v29 offset:6144
    v_mfma_f32_16x16x32_bf16 v[144:147], v[64:67], v[96:99], v[144:147]
    ds_read_b64_tr_b16 v[48:49], v16 offset:0
    ds_read_b64_tr_b16 v[50:51], v16 offset:2048
    v_mfma_f32_16x16x32_bf16 v[160:163], v[64:67], v[100:103], v[160:163]
    ds_read_b64_tr_b16 v[52:53], v17 offset:0
    ds_read_b64_tr_b16 v[54:55], v17 offset:2048
    v_mfma_f32_16x16x32_bf16 v[116:119], v[68:71], v[88:91], v[116:119]
    ds_read_b64_tr_b16 v[40:41], v14 offset:0
    ds_read_b64_tr_b16 v[42:43], v14 offset:2048
    v_mfma_f32_16x16x32_bf16 v[132:135], v[68:71], v[92:95], v[132:135]
    ds_read_b64_tr_b16 v[44:45], v15 offset:0
    ds_read_b64_tr_b16 v[46:47], v15 offset:2048
    v_mfma_f32_16x16x32_bf16 v[148:151], v[68:71], v[96:99], v[148:151]
    v_mfma_f32_16x16x32_bf16 v[164:167], v[68:71], v[100:103], v[164:167]
    v_mfma_f32_16x16x32_bf16 v[104:107], v[56:59], v[88:91], v[104:107]
    v_mfma_f32_16x16x32_bf16 v[120:123], v[56:59], v[92:95], v[120:123]
    v_mfma_f32_16x16x32_bf16 v[136:139], v[56:59], v[96:99], v[136:139]
    v_mfma_f32_16x16x32_bf16 v[152:155], v[56:59], v[100:103], v[152:155]
    v_mfma_f32_16x16x32_bf16 v[108:111], v[60:63], v[88:91], v[108:111]
    v_mfma_f32_16x16x32_bf16 v[124:127], v[60:63], v[92:95], v[124:127]
    v_mfma_f32_16x16x32_bf16 v[140:143], v[60:63], v[96:99], v[140:143]
    v_mfma_f32_16x16x32_bf16 v[156:159], v[60:63], v[100:103], v[156:159]
    s_waitcnt lgkmcnt(0)
    v_mfma_f32_16x16x32_bf16 v[112:115], v[48:51], v[72:75], v[112:115]
    ds_read_b128 v[88:91], v29 offset:1024
    ds_read_b128 v[92:95], v29 offset:3072
    v_mfma_f32_16x16x32_bf16 v[128:131], v[48:51], v[76:79], v[128:131]
    ds_read_b128 v[96:99], v29 offset:5120
    ds_read_b128 v[100:103], v29 offset:7168
    v_mfma_f32_16x16x32_bf16 v[144:147], v[48:51], v[80:83], v[144:147]
    ds_read_b64_tr_b16 v[64:65], v16 offset:4096
    ds_read_b64_tr_b16 v[66:67], v16 offset:6144
    v_mfma_f32_16x16x32_bf16 v[160:163], v[48:51], v[84:87], v[160:163]
    ds_read_b64_tr_b16 v[68:69], v17 offset:4096
    ds_read_b64_tr_b16 v[70:71], v17 offset:6144
    v_mfma_f32_16x16x32_bf16 v[116:119], v[52:55], v[72:75], v[116:119]
    ds_read_b64_tr_b16 v[56:57], v14 offset:4096
    ds_read_b64_tr_b16 v[58:59], v14 offset:6144
    v_mfma_f32_16x16x32_bf16 v[132:135], v[52:55], v[76:79], v[132:135]
    ds_read_b64_tr_b16 v[60:61], v15 offset:4096
    ds_read_b64_tr_b16 v[62:63], v15 offset:6144
    v_mfma_f32_16x16x32_bf16 v[148:151], v[52:55], v[80:83], v[148:151]
    v_mfma_f32_16x16x32_bf16 v[164:167], v[52:55], v[84:87], v[164:167]
    v_mfma_f32_16x16x32_bf16 v[104:107], v[40:43], v[72:75], v[104:107]
    v_mfma_f32_16x16x32_bf16 v[120:123], v[40:43], v[76:79], v[120:123]
    v_mfma_f32_16x16x32_bf16 v[136:139], v[40:43], v[80:83], v[136:139]
    v_mfma_f32_16x16x32_bf16 v[152:155], v[40:43], v[84:87], v[152:155]
    v_mfma_f32_16x16x32_bf16 v[108:111], v[44:47], v[72:75], v[108:111]
    v_mfma_f32_16x16x32_bf16 v[124:127], v[44:47], v[76:79], v[124:127]
    v_mfma_f32_16x16x32_bf16 v[140:143], v[44:47], v[80:83], v[140:143]
    v_mfma_f32_16x16x32_bf16 v[156:159], v[44:47], v[84:87], v[156:159]
    s_waitcnt lgkmcnt(0)
    s_waitcnt vmcnt(0)
    s_barrier
    v_mfma_f32_16x16x32_bf16 v[112:115], v[64:67], v[88:91], v[112:115]
    ds_read_b128 v[72:75], v29 offset:32768
    ds_read_b128 v[76:79], v29 offset:34816
    v_mfma_f32_16x16x32_bf16 v[128:131], v[64:67], v[92:95], v[128:131]
    ds_read_b128 v[80:83], v29 offset:36864
    ds_read_b128 v[84:87], v29 offset:38912
    v_mfma_f32_16x16x32_bf16 v[144:147], v[64:67], v[96:99], v[144:147]
    ds_read_b64_tr_b16 v[48:49], v16 offset:32768
    ds_read_b64_tr_b16 v[50:51], v16 offset:34816
    v_mfma_f32_16x16x32_bf16 v[160:163], v[64:67], v[100:103], v[160:163]
    ds_read_b64_tr_b16 v[52:53], v17 offset:32768
    ds_read_b64_tr_b16 v[54:55], v17 offset:34816
    v_mfma_f32_16x16x32_bf16 v[116:119], v[68:71], v[88:91], v[116:119]
    ds_read_b64_tr_b16 v[40:41], v14 offset:32768
    ds_read_b64_tr_b16 v[42:43], v14 offset:34816
    v_mfma_f32_16x16x32_bf16 v[132:135], v[68:71], v[92:95], v[132:135]
    ds_read_b64_tr_b16 v[44:45], v15 offset:32768
    ds_read_b64_tr_b16 v[46:47], v15 offset:34816
    v_mfma_f32_16x16x32_bf16 v[148:151], v[68:71], v[96:99], v[148:151]
    buffer_store_dword v39, v38, s[12:15], s61 offen sc0 sc1
    v_mfma_f32_16x16x32_bf16 v[164:167], v[68:71], v[100:103], v[164:167]
    s_mov_b32 s61, 0x7fff0000
    v_mfma_f32_16x16x32_bf16 v[104:107], v[56:59], v[88:91], v[104:107]
    v_mfma_f32_16x16x32_bf16 v[120:123], v[56:59], v[92:95], v[120:123]
    v_mfma_f32_16x16x32_bf16 v[136:139], v[56:59], v[96:99], v[136:139]
    v_mfma_f32_16x16x32_bf16 v[152:155], v[56:59], v[100:103], v[152:155]
    v_mfma_f32_16x16x32_bf16 v[108:111], v[60:63], v[88:91], v[108:111]
    v_mfma_f32_16x16x32_bf16 v[124:127], v[60:63], v[92:95], v[124:127]
    v_mfma_f32_16x16x32_bf16 v[140:143], v[60:63], v[96:99], v[140:143]
    v_mfma_f32_16x16x32_bf16 v[156:159], v[60:63], v[100:103], v[156:159]
    s_waitcnt lgkmcnt(0)
    v_mfma_f32_16x16x32_bf16 v[112:115], v[48:51], v[72:75], v[112:115]
    ds_read_b128 v[88:91], v29 offset:33792
    ds_read_b128 v[92:95], v29 offset:35840
    v_mfma_f32_16x16x32_bf16 v[128:131], v[48:51], v[76:79], v[128:131]
    ds_read_b128 v[96:99], v29 offset:37888
    ds_read_b128 v[100:103], v29 offset:39936
    v_mfma_f32_16x16x32_bf16 v[144:147], v[48:51], v[80:83], v[144:147]
    ds_read_b64_tr_b16 v[64:65], v16 offset:36864
    ds_read_b64_tr_b16 v[66:67], v16 offset:38912
    v_mfma_f32_16x16x32_bf16 v[160:163], v[48:51], v[84:87], v[160:163]
    ds_read_b64_tr_b16 v[68:69], v17 offset:36864
    ds_read_b64_tr_b16 v[70:71], v17 offset:38912
    v_mfma_f32_16x16x32_bf16 v[116:119], v[52:55], v[72:75], v[116:119]
    ds_read_b64_tr_b16 v[56:57], v14 offset:36864
    ds_read_b64_tr_b16 v[58:59], v14 offset:38912
    v_mfma_f32_16x16x32_bf16 v[132:135], v[52:55], v[76:79], v[132:135]
    ds_read_b64_tr_b16 v[60:61], v15 offset:36864
    ds_read_b64_tr_b16 v[62:63], v15 offset:38912
    v_mfma_f32_16x16x32_bf16 v[148:151], v[52:55], v[80:83], v[148:151]
    v_mfma_f32_16x16x32_bf16 v[164:167], v[52:55], v[84:87], v[164:167]
    v_mfma_f32_16x16x32_bf16 v[104:107], v[40:43], v[72:75], v[104:107]
    v_mfma_f32_16x16x32_bf16 v[120:123], v[40:43], v[76:79], v[120:123]
    v_mfma_f32_16x16x32_bf16 v[136:139], v[40:43], v[80:83], v[136:139]
    v_mfma_f32_16x16x32_bf16 v[152:155], v[40:43], v[84:87], v[152:155]
    v_mfma_f32_16x16x32_bf16 v[108:111], v[44:47], v[72:75], v[108:111]
    v_mfma_f32_16x16x32_bf16 v[124:127], v[44:47], v[76:79], v[124:127]
    v_mfma_f32_16x16x32_bf16 v[140:143], v[44:47], v[80:83], v[140:143]
    v_mfma_f32_16x16x32_bf16 v[156:159], v[44:47], v[84:87], v[156:159]
    s_waitcnt lgkmcnt(0)
    s_barrier
    s_branch L_fi_cloop
L_fi_cdone:
    v_mfma_f32_16x16x32_bf16 v[112:115], v[64:67], v[88:91], v[112:115]
    ds_read_b128 v[72:75], v28 offset:32768
    ds_read_b128 v[76:79], v28 offset:34816
    v_mfma_f32_16x16x32_bf16 v[128:131], v[64:67], v[92:95], v[128:131]
    ds_read_b128 v[80:83], v28 offset:36864
    ds_read_b128 v[84:87], v28 offset:38912
    v_mfma_f32_16x16x32_bf16 v[144:147], v[64:67], v[96:99], v[144:147]
    ds_read_b64_tr_b16 v[40:41], v22 offset:32768
    ds_read_b64_tr_b16 v[42:43], v22 offset:34816
    v_mfma_f32_16x16x32_bf16 v[160:163], v[64:67], v[100:103], v[160:163]
    ds_read_b64_tr_b16 v[44:45], v23 offset:32768
    ds_read_b64_tr_b16 v[46:47], v23 offset:34816
    v_mfma_f32_16x16x32_bf16 v[116:119], v[68:71], v[88:91], v[116:119]
    v_mfma_f32_16x16x32_bf16 v[132:135], v[68:71], v[92:95], v[132:135]
    v_mfma_f32_16x16x32_bf16 v[148:151], v[68:71], v[96:99], v[148:151]
    v_mfma_f32_16x16x32_bf16 v[164:167], v[68:71], v[100:103], v[164:167]
    v_mfma_f32_16x16x32_bf16 v[104:107], v[56:59], v[88:91], v[104:107]
    v_mfma_f32_16x16x32_bf16 v[120:123], v[56:59], v[92:95], v[120:123]
    v_mfma_f32_16x16x32_bf16 v[136:139], v[56:59], v[96:99], v[136:139]
    v_mfma_f32_16x16x32_bf16 v[152:155], v[56:59], v[100:103], v[152:155]
    v_mfma_f32_16x16x32_bf16 v[108:111], v[60:63], v[88:91], v[108:111]
    v_mfma_f32_16x16x32_bf16 v[124:127], v[60:63], v[92:95], v[124:127]
    v_mfma_f32_16x16x32_bf16 v[140:143], v[60:63], v[96:99], v[140:143]
    v_mfma_f32_16x16x32_bf16 v[156:159], v[60:63], v[100:103], v[156:159]
    s_waitcnt lgkmcnt(0)
    v_mfma_f32_16x16x32_bf16 v[168:171], v[40:43], v[72:75], 0
    ds_read_b128 v[88:91], v28 offset:33792
    ds_read_b128 v[92:95], v28 offset:35840
    v_mfma_f32_16x16x32_bf16 v[176:179], v[40:43], v[76:79], 0
    ds_read_b128 v[96:99], v28 offset:37888
    ds_read_b128 v[100:103], v28 offset:39936
    v_mfma_f32_16x16x32_bf16 v[184:187], v[40:43], v[80:83], 0
    ds_read_b64_tr_b16 v[56:57], v22 offset:36864
    ds_read_b64_tr_b16 v[58:59], v22 offset:38912
    v_mfma_f32_16x16x32_bf16 v[192:195], v[40:43], v[84:87], 0
    ds_read_b64_tr_b16 v[60:61], v23 offset:36864
    ds_read_b64_tr_b16 v[62:63], v23 offset:38912
    v_mfma_f32_16x16x32_bf16 v[172:175], v[44:47], v[72:75], 0
    v_cvt_pk_bf16_f32 v112, v112, v113
    v_cvt_pk_bf16_f32 v113, v114, v115
    v_cvt_pk_bf16_f32 v114, v116, v117
    v_mfma_f32_16x16x32_bf16 v[180:183], v[44:47], v[76:79], 0
    v_cvt_pk_bf16_f32 v115, v118, v119
    buffer_store_dwordx4 v[112:115], v34, s[12:15], s44 offen offset:0 sc0 sc1
    v_cvt_pk_bf16_f32 v128, v128, v129
    v_mfma_f32_16x16x32_bf16 v[188:191], v[44:47], v[80:83], 0
    v_cvt_pk_bf16_f32 v129, v130, v131
    v_cvt_pk_bf16_f32 v130, v132, v133
    v_cvt_pk_bf16_f32 v131, v134, v135
    v_mfma_f32_16x16x32_bf16 v[196:199], v[44:47], v[84:87], 0
    buffer_store_dwordx4 v[128:131], v34, s[12:15], s44 offen offset:1024 sc0 sc1
    s_waitcnt lgkmcnt(0)
    s_barrier
    v_mfma_f32_16x16x32_bf16 v[168:171], v[56:59], v[88:91], v[168:171]
    ds_read_b128 v[72:75], v29 offset:0
    ds_read_b128 v[76:79], v29 offset:2048
    v_mfma_f32_16x16x32_bf16 v[176:179], v[56:59], v[92:95], v[176:179]
    ds_read_b128 v[80:83], v29 offset:4096
    ds_read_b128 v[84:87], v29 offset:6144
    v_mfma_f32_16x16x32_bf16 v[184:187], v[56:59], v[96:99], v[184:187]
    ds_read_b64_tr_b16 v[40:41], v24 offset:0
    ds_read_b64_tr_b16 v[42:43], v24 offset:2048
    v_mfma_f32_16x16x32_bf16 v[192:195], v[56:59], v[100:103], v[192:195]
    ds_read_b64_tr_b16 v[44:45], v25 offset:0
    ds_read_b64_tr_b16 v[46:47], v25 offset:2048
    v_mfma_f32_16x16x32_bf16 v[172:175], v[60:63], v[88:91], v[172:175]
    v_cvt_pk_bf16_f32 v144, v144, v145
    v_cvt_pk_bf16_f32 v145, v146, v147
    v_cvt_pk_bf16_f32 v146, v148, v149
    v_mfma_f32_16x16x32_bf16 v[180:183], v[60:63], v[92:95], v[180:183]
    v_cvt_pk_bf16_f32 v147, v150, v151
    buffer_store_dwordx4 v[144:147], v34, s[12:15], s44 offen offset:2048 sc0 sc1
    v_cvt_pk_bf16_f32 v160, v160, v161
    v_mfma_f32_16x16x32_bf16 v[188:191], v[60:63], v[96:99], v[188:191]
    v_cvt_pk_bf16_f32 v161, v162, v163
    v_cvt_pk_bf16_f32 v162, v164, v165
    v_cvt_pk_bf16_f32 v163, v166, v167
    v_mfma_f32_16x16x32_bf16 v[196:199], v[60:63], v[100:103], v[196:199]
    buffer_store_dwordx4 v[160:163], v34, s[12:15], s44 offen offset:3072 sc0 sc1
    s_waitcnt lgkmcnt(0)
    v_mfma_f32_16x16x32_bf16 v[168:171], v[40:43], v[72:75], v[168:171]
    ds_read_b128 v[88:91], v29 offset:1024
    ds_read_b128 v[92:95], v29 offset:3072
    v_mfma_f32_16x16x32_bf16 v[176:179], v[40:43], v[76:79], v[176:179]
    ds_read_b128 v[96:99], v29 offset:5120
    ds_read_b128 v[100:103], v29 offset:7168
    v_mfma_f32_16x16x32_bf16 v[184:187], v[40:43], v[80:83], v[184:187]
    ds_read_b64_tr_b16 v[56:57], v24 offset:4096
    ds_read_b64_tr_b16 v[58:59], v24 offset:6144
    v_mfma_f32_16x16x32_bf16 v[192:195], v[40:43], v[84:87], v[192:195]
    ds_read_b64_tr_b16 v[60:61], v25 offset:4096
    ds_read_b64_tr_b16 v[62:63], v25 offset:6144
    v_mfma_f32_16x16x32_bf16 v[172:175], v[44:47], v[72:75], v[172:175]
    v_mfma_f32_16x16x32_bf16 v[180:183], v[44:47], v[76:79], v[180:183]
    v_mfma_f32_16x16x32_bf16 v[188:191], v[44:47], v[80:83], v[188:191]
    v_mfma_f32_16x16x32_bf16 v[196:199], v[44:47], v[84:87], v[196:199]
    s_waitcnt lgkmcnt(0)
    s_barrier
    v_mfma_f32_16x16x32_bf16 v[168:171], v[56:59], v[88:91], v[168:171]
    ds_read_b128 v[72:75], v29 offset:32768
    ds_read_b128 v[76:79], v29 offset:34816
    v_mfma_f32_16x16x32_bf16 v[176:179], v[56:59], v[92:95], v[176:179]
    ds_read_b128 v[80:83], v29 offset:36864
    ds_read_b128 v[84:87], v29 offset:38912
    v_mfma_f32_16x16x32_bf16 v[184:187], v[56:59], v[96:99], v[184:187]
    ds_read_b64_tr_b16 v[40:41], v24 offset:32768
    ds_read_b64_tr_b16 v[42:43], v24 offset:34816
    v_mfma_f32_16x16x32_bf16 v[192:195], v[56:59], v[100:103], v[192:195]
    ds_read_b64_tr_b16 v[44:45], v25 offset:32768
    ds_read_b64_tr_b16 v[46:47], v25 offset:34816
    v_mfma_f32_16x16x32_bf16 v[172:175], v[60:63], v[88:91], v[172:175]
    v_mfma_f32_16x16x32_bf16 v[180:183], v[60:63], v[92:95], v[180:183]
    v_mfma_f32_16x16x32_bf16 v[188:191], v[60:63], v[96:99], v[188:191]
    v_mfma_f32_16x16x32_bf16 v[196:199], v[60:63], v[100:103], v[196:199]
    s_waitcnt lgkmcnt(0)
    v_mfma_f32_16x16x32_bf16 v[168:171], v[40:43], v[72:75], v[168:171]
    ds_read_b128 v[88:91], v29 offset:33792
    ds_read_b128 v[92:95], v29 offset:35840
    v_mfma_f32_16x16x32_bf16 v[176:179], v[40:43], v[76:79], v[176:179]
    ds_read_b128 v[96:99], v29 offset:37888
    ds_read_b128 v[100:103], v29 offset:39936
    v_mfma_f32_16x16x32_bf16 v[184:187], v[40:43], v[80:83], v[184:187]
    ds_read_b64_tr_b16 v[56:57], v24 offset:36864
    ds_read_b64_tr_b16 v[58:59], v24 offset:38912
    v_mfma_f32_16x16x32_bf16 v[192:195], v[40:43], v[84:87], v[192:195]
    ds_read_b64_tr_b16 v[60:61], v25 offset:36864
    ds_read_b64_tr_b16 v[62:63], v25 offset:38912
    v_mfma_f32_16x16x32_bf16 v[172:175], v[44:47], v[72:75], v[172:175]
    v_mfma_f32_16x16x32_bf16 v[180:183], v[44:47], v[76:79], v[180:183]
    v_mfma_f32_16x16x32_bf16 v[188:191], v[44:47], v[80:83], v[188:191]
    v_mfma_f32_16x16x32_bf16 v[196:199], v[44:47], v[84:87], v[196:199]
    s_waitcnt lgkmcnt(0)
    s_barrier
    v_mfma_f32_16x16x32_bf16 v[168:171], v[56:59], v[88:91], v[168:171]
    ds_read_b128 v[72:75], v30 offset:0
    ds_read_b128 v[76:79], v30 offset:2048
    v_mfma_f32_16x16x32_bf16 v[176:179], v[56:59], v[92:95], v[176:179]
    ds_read_b128 v[80:83], v30 offset:4096
    ds_read_b128 v[84:87], v30 offset:6144
    v_mfma_f32_16x16x32_bf16 v[184:187], v[56:59], v[96:99], v[184:187]
    ds_read_b64_tr_b16 v[40:41], v26 offset:0
    ds_read_b64_tr_b16 v[42:43], v26 offset:2048
    v_mfma_f32_16x16x32_bf16 v[192:195], v[56:59], v[100:103], v[192:195]
    ds_read_b64_tr_b16 v[44:45], v27 offset:0
    ds_read_b64_tr_b16 v[46:47], v27 offset:2048
    v_mfma_f32_16x16x32_bf16 v[172:175], v[60:63], v[88:91], v[172:175]
    v_mfma_f32_16x16x32_bf16 v[180:183], v[60:63], v[92:95], v[180:183]
    v_mfma_f32_16x16x32_bf16 v[188:191], v[60:63], v[96:99], v[188:191]
    v_mfma_f32_16x16x32_bf16 v[196:199], v[60:63], v[100:103], v[196:199]
    s_waitcnt lgkmcnt(0)
    v_mfma_f32_16x16x32_bf16 v[168:171], v[40:43], v[72:75], v[168:171]
    ds_read_b128 v[88:91], v30 offset:1024
    ds_read_b128 v[92:95], v30 offset:3072
    v_mfma_f32_16x16x32_bf16 v[176:179], v[40:43], v[76:79], v[176:179]
    ds_read_b128 v[96:99], v30 offset:5120
    ds_read_b128 v[100:103], v30 offset:7168
    v_mfma_f32_16x16x32_bf16 v[184:187], v[40:43], v[80:83], v[184:187]
    ds_read_b64_tr_b16 v[56:57], v26 offset:4096
    ds_read_b64_tr_b16 v[58:59], v26 offset:6144
    v_mfma_f32_16x16x32_bf16 v[192:195], v[40:43], v[84:87], v[192:195]
    ds_read_b64_tr_b16 v[60:61], v27 offset:4096
    ds_read_b64_tr_b16 v[62:63], v27 offset:6144
    v_mfma_f32_16x16x32_bf16 v[172:175], v[44:47], v[72:75], v[172:175]
    v_mfma_f32_16x16x32_bf16 v[180:183], v[44:47], v[76:79], v[180:183]
    v_mfma_f32_16x16x32_bf16 v[188:191], v[44:47], v[80:83], v[188:191]
    v_mfma_f32_16x16x32_bf16 v[196:199], v[44:47], v[84:87], v[196:199]
    s_waitcnt lgkmcnt(0)
    s_barrier
    v_mfma_f32_16x16x32_bf16 v[168:171], v[56:59], v[88:91], v[168:171]
    ds_read_b128 v[72:75], v28 offset:0
    ds_read_b128 v[76:79], v28 offset:2048
    v_mfma_f32_16x16x32_bf16 v[176:179], v[56:59], v[92:95], v[176:179]
    ds_read_b128 v[80:83], v28 offset:4096
    ds_read_b128 v[84:87], v28 offset:6144
    v_mfma_f32_16x16x32_bf16 v[184:187], v[56:59], v[96:99], v[184:187]
    ds_read_b64_tr_b16 v[40:41], v22 offset:0
    ds_read_b64_tr_b16 v[42:43], v22 offset:2048
    v_mfma_f32_16x16x32_bf16 v[192:195], v[56:59], v[100:103], v[192:195]
    ds_read_b64_tr_b16 v[44:45], v23 offset:0
    ds_read_b64_tr_b16 v[46:47], v23 offset:2048
    v_mfma_f32_16x16x32_bf16 v[172:175], v[60:63], v[88:91], v[172:175]
    v_mfma_f32_16x16x32_bf16 v[180:183], v[60:63], v[92:95], v[180:183]
    v_mfma_f32_16x16x32_bf16 v[188:191], v[60:63], v[96:99], v[188:191]
    v_mfma_f32_16x16x32_bf16 v[196:199], v[60:63], v[100:103], v[196:199]
    s_waitcnt lgkmcnt(0)
    v_mfma_f32_16x16x32_bf16 v[168:171], v[40:43], v[72:75], v[168:171]
    ds_read_b128 v[88:91], v28 offset:1024
    ds_read_b128 v[92:95], v28 offset:3072
    v_mfma_f32_16x16x32_bf16 v[176:179], v[40:43], v[76:79], v[176:179]
    ds_read_b128 v[96:99], v28 offset:5120
    ds_read_b128 v[100:103], v28 offset:7168
    v_mfma_f32_16x16x32_bf16 v[184:187], v[40:43], v[80:83], v[184:187]
    ds_read_b64_tr_b16 v[56:57], v22 offset:4096
    ds_read_b64_tr_b16 v[58:59], v22 offset:6144
    v_mfma_f32_16x16x32_bf16 v[192:195], v[40:43], v[84:87], v[192:195]
    ds_read_b64_tr_b16 v[60:61], v23 offset:4096
    ds_read_b64_tr_b16 v[62:63], v23 offset:6144
    v_mfma_f32_16x16x32_bf16 v[172:175], v[44:47], v[72:75], v[172:175]
    v_mfma_f32_16x16x32_bf16 v[180:183], v[44:47], v[76:79], v[180:183]
    v_mfma_f32_16x16x32_bf16 v[188:191], v[44:47], v[80:83], v[188:191]
    v_mfma_f32_16x16x32_bf16 v[196:199], v[44:47], v[84:87], v[196:199]
    s_waitcnt lgkmcnt(0)
    s_barrier
    v_mfma_f32_16x16x32_bf16 v[168:171], v[56:59], v[88:91], v[168:171]
    ds_read_b128 v[72:75], v28 offset:32768
    ds_read_b128 v[76:79], v28 offset:34816
    v_mfma_f32_16x16x32_bf16 v[176:179], v[56:59], v[92:95], v[176:179]
    ds_read_b128 v[80:83], v28 offset:36864
    ds_read_b128 v[84:87], v28 offset:38912
    v_mfma_f32_16x16x32_bf16 v[184:187], v[56:59], v[96:99], v[184:187]
    ds_read_b64_tr_b16 v[40:41], v22 offset:32768
    ds_read_b64_tr_b16 v[42:43], v22 offset:34816
    v_mfma_f32_16x16x32_bf16 v[192:195], v[56:59], v[100:103], v[192:195]
    ds_read_b64_tr_b16 v[44:45], v23 offset:32768
    ds_read_b64_tr_b16 v[46:47], v23 offset:34816
    v_mfma_f32_16x16x32_bf16 v[172:175], v[60:63], v[88:91], v[172:175]
    v_mfma_f32_16x16x32_bf16 v[180:183], v[60:63], v[92:95], v[180:183]
    v_mfma_f32_16x16x32_bf16 v[188:191], v[60:63], v[96:99], v[188:191]
    v_mfma_f32_16x16x32_bf16 v[196:199], v[60:63], v[100:103], v[196:199]
    s_waitcnt lgkmcnt(0)
    v_mfma_f32_16x16x32_bf16 v[168:171], v[40:43], v[72:75], v[168:171]
    ds_read_b128 v[88:91], v28 offset:33792
    ds_read_b128 v[92:95], v28 offset:35840
    v_mfma_f32_16x16x32_bf16 v[176:179], v[40:43], v[76:79], v[176:179]
    ds_read_b128 v[96:99], v28 offset:37888
    ds_read_b128 v[100:103], v28 offset:39936
    v_mfma_f32_16x16x32_bf16 v[184:187], v[40:43], v[80:83], v[184:187]
    ds_read_b64_tr_b16 v[56:57], v22 offset:36864
    ds_read_b64_tr_b16 v[58:59], v22 offset:38912
    v_mfma_f32_16x16x32_bf16 v[192:195], v[40:43], v[84:87], v[192:195]
    ds_read_b64_tr_b16 v[60:61], v23 offset:36864
    ds_read_b64_tr_b16 v[62:63], v23 offset:38912
    v_mfma_f32_16x16x32_bf16 v[172:175], v[44:47], v[72:75], v[172:175]
    v_mfma_f32_16x16x32_bf16 v[180:183], v[44:47], v[76:79], v[180:183]
    v_mfma_f32_16x16x32_bf16 v[188:191], v[44:47], v[80:83], v[188:191]
    v_mfma_f32_16x16x32_bf16 v[196:199], v[44:47], v[84:87], v[196:199]
    s_waitcnt lgkmcnt(0)
    s_barrier
    v_mfma_f32_16x16x32_bf16 v[168:171], v[56:59], v[88:91], v[168:171]
    ds_read_b128 v[72:75], v29 offset:0
    ds_read_b128 v[76:79], v29 offset:2048
    v_mfma_f32_16x16x32_bf16 v[176:179], v[56:59], v[92:95], v[176:179]
    ds_read_b128 v[80:83], v29 offset:4096
    ds_read_b128 v[84:87], v29 offset:6144
    v_mfma_f32_16x16x32_bf16 v[184:187], v[56:59], v[96:99], v[184:187]
    ds_read_b64_tr_b16 v[40:41], v24 offset:0
    ds_read_b64_tr_b16 v[42:43], v24 offset:2048
    v_mfma_f32_16x16x32_bf16 v[192:195], v[56:59], v[100:103], v[192:195]
    ds_read_b64_tr_b16 v[44:45], v25 offset:0
    ds_read_b64_tr_b16 v[46:47], v25 offset:2048
    v_mfma_f32_16x16x32_bf16 v[172:175], v[60:63], v[88:91], v[172:175]
    buffer_load_dwordx4 v[116:119], v34, s[12:15], s45 offen offset:0 sc1
    v_mfma_f32_16x16x32_bf16 v[180:183], v[60:63], v[92:95], v[180:183]
    buffer_load_dwordx4 v[132:135], v34, s[12:15], s45 offen offset:1024 sc1
    v_mfma_f32_16x16x32_bf16 v[188:191], v[60:63], v[96:99], v[188:191]
    buffer_load_dwordx4 v[148:151], v34, s[12:15], s45 offen offset:2048 sc1
    v_mfma_f32_16x16x32_bf16 v[196:199], v[60:63], v[100:103], v[196:199]
    buffer_load_dwordx4 v[164:167], v34, s[12:15], s45 offen offset:3072 sc1
    s_waitcnt lgkmcnt(0)
    v_mfma_f32_16x16x32_bf16 v[168:171], v[40:43], v[72:75], v[168:171]
    ds_read_b128 v[88:91], v29 offset:1024
    ds_read_b128 v[92:95], v29 offset:3072
    v_mfma_f32_16x16x32_bf16 v[176:179], v[40:43], v[76:79], v[176:179]
    ds_read_b128 v[96:99], v29 offset:5120
    ds_read_b128 v[100:103], v29 offset:7168
    v_mfma_f32_16x16x32_bf16 v[184:187], v[40:43], v[80:83], v[184:187]
    ds_read_b64_tr_b16 v[56:57], v24 offset:4096
    ds_read_b64_tr_b16 v[58:59], v24 offset:6144
    v_mfma_f32_16x16x32_bf16 v[192:195], v[40:43], v[84:87], v[192:195]
    ds_read_b64_tr_b16 v[60:61], v25 offset:4096
    ds_read_b64_tr_b16 v[62:63], v25 offset:6144
    v_mfma_f32_16x16x32_bf16 v[172:175], v[44:47], v[72:75], v[172:175]
    v_mfma_f32_16x16x32_bf16 v[180:183], v[44:47], v[76:79], v[180:183]
    v_mfma_f32_16x16x32_bf16 v[188:191], v[44:47], v[80:83], v[188:191]
    v_mfma_f32_16x16x32_bf16 v[196:199], v[44:47], v[84:87], v[196:199]
    s_waitcnt lgkmcnt(0)
    s_barrier
    v_mfma_f32_16x16x32_bf16 v[168:171], v[56:59], v[88:91], v[168:171]
    ds_read_b128 v[72:75], v29 offset:32768
    ds_read_b128 v[76:79], v29 offset:34816
    v_mfma_f32_16x16x32_bf16 v[176:179], v[56:59], v[92:95], v[176:179]
    ds_read_b128 v[80:83], v29 offset:36864
    ds_read_b128 v[84:87], v29 offset:38912
    v_mfma_f32_16x16x32_bf16 v[184:187], v[56:59], v[96:99], v[184:187]
    ds_read_b64_tr_b16 v[40:41], v24 offset:32768
    ds_read_b64_tr_b16 v[42:43], v24 offset:34816
    v_mfma_f32_16x16x32_bf16 v[192:195], v[56:59], v[100:103], v[192:195]
    ds_read_b64_tr_b16 v[44:45], v25 offset:32768
    ds_read_b64_tr_b16 v[46:47], v25 offset:34816
    v_mfma_f32_16x16x32_bf16 v[172:175], v[60:63], v[88:91], v[172:175]
    v_mfma_f32_16x16x32_bf16 v[180:183], v[60:63], v[92:95], v[180:183]
    v_mfma_f32_16x16x32_bf16 v[188:191], v[60:63], v[96:99], v[188:191]
    v_mfma_f32_16x16x32_bf16 v[196:199], v[60:63], v[100:103], v[196:199]
    s_waitcnt lgkmcnt(0)
    v_mfma_f32_16x16x32_bf16 v[168:171], v[40:43], v[72:75], v[168:171]
    ds_read_b128 v[88:91], v29 offset:33792
    ds_read_b128 v[92:95], v29 offset:35840
    v_mfma_f32_16x16x32_bf16 v[176:179], v[40:43], v[76:79], v[176:179]
    ds_read_b128 v[96:99], v29 offset:37888
    ds_read_b128 v[100:103], v29 offset:39936
    v_mfma_f32_16x16x32_bf16 v[184:187], v[40:43], v[80:83], v[184:187]
    ds_read_b64_tr_b16 v[56:57], v24 offset:36864
    ds_read_b64_tr_b16 v[58:59], v24 offset:38912
    v_mfma_f32_16x16x32_bf16 v[192:195], v[40:43], v[84:87], v[192:195]
    ds_read_b64_tr_b16 v[60:61], v25 offset:36864
    ds_read_b64_tr_b16 v[62:63], v25 offset:38912
    v_mfma_f32_16x16x32_bf16 v[172:175], v[44:47], v[72:75], v[172:175]
    v_mfma_f32_16x16x32_bf16 v[180:183], v[44:47], v[76:79], v[180:183]
    v_mfma_f32_16x16x32_bf16 v[188:191], v[44:47], v[80:83], v[188:191]
    v_mfma_f32_16x16x32_bf16 v[196:199], v[44:47], v[84:87], v[196:199]
    s_waitcnt lgkmcnt(0)
    s_barrier
    v_mfma_f32_16x16x32_bf16 v[168:171], v[56:59], v[88:91], v[168:171]
    ds_read_b128 v[72:75], v30 offset:0
    ds_read_b128 v[76:79], v30 offset:2048
    v_mfma_f32_16x16x32_bf16 v[176:179], v[56:59], v[92:95], v[176:179]
    ds_read_b128 v[80:83], v30 offset:4096
    ds_read_b128 v[84:87], v30 offset:6144
    v_mfma_f32_16x16x32_bf16 v[184:187], v[56:59], v[96:99], v[184:187]
    ds_read_b64_tr_b16 v[40:41], v26 offset:0
    ds_read_b64_tr_b16 v[42:43], v26 offset:2048
    v_mfma_f32_16x16x32_bf16 v[192:195], v[56:59], v[100:103], v[192:195]
    ds_read_b64_tr_b16 v[44:45], v27 offset:0
    ds_read_b64_tr_b16 v[46:47], v27 offset:2048
    v_mfma_f32_16x16x32_bf16 v[172:175], v[60:63], v[88:91], v[172:175]
    v_mfma_f32_16x16x32_bf16 v[180:183], v[60:63], v[92:95], v[180:183]
    v_mfma_f32_16x16x32_bf16 v[188:191], v[60:63], v[96:99], v[188:191]
    v_mfma_f32_16x16x32_bf16 v[196:199], v[60:63], v[100:103], v[196:199]
    s_waitcnt lgkmcnt(0)
L_fi_poll_1003:
    s_waitcnt vmcnt(0)
    v_max3_u32 v36, v116, v117, v118
    v_max3_u32 v36, v119, v132, v36
    v_max3_u32 v36, v133, v134, v36
    v_max3_u32 v36, v135, v148, v36
    v_max3_u32 v36, v149, v150, v36
    v_max3_u32 v36, v151, v164, v36
    v_max3_u32 v36, v165, v166, v36
    v_max_u32 v36, v167, v36
    v_cmp_eq_u32 vcc, -1, v36
    s_cbranch_vccz L_fi_ok_1004
    s_add_u32 s60, s60, 1
    s_cmp_lt_u32 s60, 65536
    s_cbranch_scc0 L_fi_ok_1004
    buffer_load_dwordx4 v[116:119], v34, s[12:15], s45 offen offset:0 sc0 sc1
    buffer_load_dwordx4 v[132:135], v34, s[12:15], s45 offen offset:1024 sc0 sc1
    buffer_load_dwordx4 v[148:151], v34, s[12:15], s45 offen offset:2048 sc0 sc1
    buffer_load_dwordx4 v[164:167], v34, s[12:15], s45 offen offset:3072 sc0 sc1
    s_branch L_fi_poll_1003
L_fi_ok_1004:
    v_mfma_f32_16x16x32_bf16 v[168:171], v[40:43], v[72:75], v[168:171]
    ds_read_b128 v[88:91], v30 offset:1024
    ds_read_b128 v[92:95], v30 offset:3072
    v_mfma_f32_16x16x32_bf16 v[176:179], v[40:43], v[76:79], v[176:179]
    ds_read_b128 v[96:99], v30 offset:5120
    ds_read_b128 v[100:103], v30 offset:7168
    v_mfma_f32_16x16x32_bf16 v[184:187], v[40:43], v[80:83], v[184:187]
    ds_read_b64_tr_b16 v[56:57], v26 offset:4096
    ds_read_b64_tr_b16 v[58:59], v26 offset:6144
    v_mfma_f32_16x16x32_bf16 v[192:195], v[40:43], v[84:87], v[192:195]
    ds_read_b64_tr_b16 v[60:61], v27 offset:4096
    ds_read_b64_tr_b16 v[62:63], v27 offset:6144
    v_mfma_f32_16x16x32_bf16 v[172:175], v[44:47], v[72:75], v[172:175]
    v_lshlrev_b32 v112, 16, v116
    v_and_b32 v113, s50, v116
    v_lshlrev_b32 v114, 16, v117
    v_mfma_f32_16x16x32_bf16 v[180:183], v[44:47], v[76:79], v[180:183]
    v_and_b32 v115, s50, v117
    v_pk_add_f32 v[104:105], v[104:105], v[112:113]
    v_pk_add_f32 v[106:107], v[106:107], v[114:115]
    v_mfma_f32_16x16x32_bf16 v[188:191], v[44:47], v[80:83], v[188:191]
    v_pk_mul_f32 v[112:113], v[104:105], s[48:49]
    v_pk_mul_f32 v[114:115], v[106:107], s[48:49]
    v_exp_f32 v112, v112
    v_mfma_f32_16x16x32_bf16 v[196:199], v[44:47], v[84:87], v[196:199]
    v_exp_f32 v113, v113
    s_waitcnt lgkmcnt(0)
    s_barrier
    v_mfma_f32_16x16x32_bf16 v[168:171], v[56:59], v[88:91], v[168:171]
    ds_read_b128 v[72:75], v28 offset:0
    ds_read_b128 v[76:79], v28 offset:2048
    v_mfma_f32_16x16x32_bf16 v[176:179], v[56:59], v[92:95], v[176:179]
    ds_read_b128 v[80:83], v28 offset:4096
    ds_read_b128 v[84:87], v28 offset:6144
    v_mfma_f32_16x16x32_bf16 v[184:187], v[56:59], v[96:99], v[184:187]
    ds_read_b64_tr_b16 v[40:41], v22 offset:0
    ds_read_b64_tr_b16 v[42:43], v22 offset:2048
    v_mfma_f32_16x16x32_bf16 v[192:195], v[56:59], v[100:103], v[192:195]
    ds_read_b64_tr_b16 v[44:45], v23 offset:0
    ds_read_b64_tr_b16 v[46:47], v23 offset:2048
    v_mfma_f32_16x16x32_bf16 v[172:175], v[60:63], v[88:91], v[172:175]
    v_exp_f32 v114, v114
    v_exp_f32 v115, v115
    v_pk_add_f32 v[112:113], v[112:113], s[46:47]
    v_mfma_f32_16x16x32_bf16 v[180:183], v[60:63], v[92:95], v[180:183]
    v_pk_add_f32 v[114:115], v[114:115], s[46:47]
    v_rcp_f32 v112, v112
    v_rcp_f32 v113, v113
    v_mfma_f32_16x16x32_bf16 v[188:191], v[60:63], v[96:99], v[188:191]
    v_rcp_f32 v114, v114
    v_rcp_f32 v115, v115
    v_pk_mul_f32 v[104:105], v[104:105], v[112:113]
    v_mfma_f32_16x16x32_bf16 v[196:199], v[60:63], v[100:103], v[196:199]
    v_pk_mul_f32 v[106:107], v[106:107], v[114:115]
    s_waitcnt lgkmcnt(0)
    v_mfma_f32_16x16x32_bf16 v[168:171], v[40:43], v[72:75], v[168:171]
    ds_read_b128 v[88:91], v28 offset:1024
    ds_read_b128 v[92:95], v28 offset:3072
    v_mfma_f32_16x16x32_bf16 v[176:179], v[40:43], v[76:79], v[176:179]
    ds_read_b128 v[96:99], v28 offset:5120
    ds_read_b128 v[100:103], v28 offset:7168
    v_mfma_f32_16x16x32_bf16 v[184:187], v[40:43], v[80:83], v[184:187]
    ds_read_b64_tr_b16 v[56:57], v22 offset:4096
    ds_read_b64_tr_b16 v[58:59], v22 offset:6144
    v_mfma_f32_16x16x32_bf16 v[192:195], v[40:43], v[84:87], v[192:195]
    ds_read_b64_tr_b16 v[60:61], v23 offset:4096
    ds_read_b64_tr_b16 v[62:63], v23 offset:6144
    v_mfma_f32_16x16x32_bf16 v[172:175], v[44:47], v[72:75], v[172:175]
    v_lshlrev_b32 v112, 16, v118
    v_and_b32 v113, s50, v118
    v_lshlrev_b32 v114, 16, v119
    v_mfma_f32_16x16x32_bf16 v[180:183], v[44:47], v[76:79], v[180:183]
    v_and_b32 v115, s50, v119
    v_pk_add_f32 v[108:109], v[108:109], v[112:113]
    v_pk_add_f32 v[110:111], v[110:111], v[114:115]
    v_mfma_f32_16x16x32_bf16 v[188:191], v[44:47], v[80:83], v[188:191]
    v_pk_mul_f32 v[112:113], v[108:109], s[48:49]
    v_pk_mul_f32 v[114:115], v[110:111], s[48:49]
    v_exp_f32 v112, v112
    v_mfma_f32_16x16x32_bf16 v[196:199], v[44:47], v[84:87], v[196:199]
    v_exp_f32 v113, v113
    s_waitcnt lgkmcnt(0)
    s_barrier
    v_mfma_f32_16x16x32_bf16 v[168:171], v[56:59], v[88:91], v[168:171]
    ds_read_b128 v[72:75], v28 offset:32768
    ds_read_b128 v[76:79], v28 offset:34816
    v_mfma_f32_16x16x32_bf16 v[176:179], v[56:59], v[92:95], v[176:179]
    ds_read_b128 v[80:83], v28 offset:36864
    ds_read_b128 v[84:87], v28 offset:38912
    v_mfma_f32_16x16x32_bf16 v[184:187], v[56:59], v[96:99], v[184:187]
    ds_read_b64_tr_b16 v[40:41], v22 offset:32768
    ds_read_b64_tr_b16 v[42:43], v22 offset:34816
    v_mfma_f32_16x16x32_bf16 v[192:195], v[56:59], v[100:103], v[192:195]
    ds_read_b64_tr_b16 v[44:45], v23 offset:32768
    ds_read_b64_tr_b16 v[46:47], v23 offset:34816
    v_mfma_f32_16x16x32_bf16 v[172:175], v[60:63], v[88:91], v[172:175]
    v_exp_f32 v114, v114
    v_exp_f32 v115, v115
    v_pk_add_f32 v[112:113], v[112:113], s[46:47]
    v_mfma_f32_16x16x32_bf16 v[180:183], v[60:63], v[92:95], v[180:183]
    v_pk_add_f32 v[114:115], v[114:115], s[46:47]
    v_rcp_f32 v112, v112
    v_rcp_f32 v113, v113
    v_mfma_f32_16x16x32_bf16 v[188:191], v[60:63], v[96:99], v[188:191]
    v_rcp_f32 v114, v114
    v_rcp_f32 v115, v115
    v_pk_mul_f32 v[108:109], v[108:109], v[112:113]
    v_mfma_f32_16x16x32_bf16 v[196:199], v[60:63], v[100:103], v[196:199]
    v_pk_mul_f32 v[110:111], v[110:111], v[114:115]
    s_waitcnt lgkmcnt(0)
    v_mfma_f32_16x16x32_bf16 v[168:171], v[40:43], v[72:75], v[168:171]
    ds_read_b128 v[88:91], v28 offset:33792
    ds_read_b128 v[92:95], v28 offset:35840
    v_mfma_f32_16x16x32_bf16 v[176:179], v[40:43], v[76:79], v[176:179]
    ds_read_b128 v[96:99], v28 offset:37888
    ds_read_b128 v[100:103], v28 offset:39936
    v_mfma_f32_16x16x32_bf16 v[184:187], v[40:43], v[80:83], v[184:187]
    ds_read_b64_tr_b16 v[56:57], v22 offset:36864
    ds_read_b64_tr_b16 v[58:59], v22 offset:38912
    v_mfma_f32_16x16x32_bf16 v[192:195], v[40:43], v[84:87], v[192:195]
    ds_read_b64_tr_b16 v[60:61], v23 offset:36864
    ds_read_b64_tr_b16 v[62:63], v23 offset:38912
    v_mfma_f32_16x16x32_bf16 v[172:175], v[44:47], v[72:75], v[172:175]
    v_lshlrev_b32 v128, 16, v132
    v_and_b32 v129, s50, v132
    v_lshlrev_b32 v130, 16, v133
    v_mfma_f32_16x16x32_bf16 v[180:183], v[44:47], v[76:79], v[180:183]
    v_and_b32 v131, s50, v133
    v_pk_add_f32 v[120:121], v[120:121], v[128:129]
    v_pk_add_f32 v[122:123], v[122:123], v[130:131]
    v_mfma_f32_16x16x32_bf16 v[188:191], v[44:47], v[80:83], v[188:191]
    v_pk_mul_f32 v[128:129], v[120:121], s[48:49]
    v_pk_mul_f32 v[130:131], v[122:123], s[48:49]
    v_exp_f32 v128, v128
    v_mfma_f32_16x16x32_bf16 v[196:199], v[44:47], v[84:87], v[196:199]
    v_exp_f32 v129, v129
    s_waitcnt lgkmcnt(0)
    s_barrier
    v_mfma_f32_16x16x32_bf16 v[168:171], v[56:59], v[88:91], v[168:171]
    ds_read_b128 v[72:75], v29 offset:0
    ds_read_b128 v[76:79], v29 offset:2048
    v_mfma_f32_16x16x32_bf16 v[176:179], v[56:59], v[92:95], v[176:179]
    ds_read_b128 v[80:83], v29 offset:4096
    ds_read_b128 v[84:87], v29 offset:6144
    v_mfma_f32_16x16x32_bf16 v[184:187], v[56:59], v[96:99], v[184:187]
    ds_read_b64_tr_b16 v[40:41], v24 offset:0
    ds_read_b64_tr_b16 v[42:43], v24 offset:2048
    v_mfma_f32_16x16x32_bf16 v[192:195], v[56:59], v[100:103], v[192:195]
    ds_read_b64_tr_b16 v[44:45], v25 offset:0
    ds_read_b64_tr_b16 v[46:47], v25 offset:2048
    v_mfma_f32_16x16x32_bf16 v[172:175], v[60:63], v[88:91], v[172:175]
    v_exp_f32 v130, v130
    v_exp_f32 v131, v131
    v_pk_add_f32 v[128:129], v[128:129], s[46:47]
    v_mfma_f32_16x16x32_bf16 v[180:183], v[60:63], v[92:95], v[180:183]
    v_pk_add_f32 v[130:131], v[130:131], s[46:47]
    v_rcp_f32 v128, v128
    v_rcp_f32 v129, v129
    v_mfma_f32_16x16x32_bf16 v[188:191], v[60:63], v[96:99], v[188:191]
    v_rcp_f32 v130, v130
    v_rcp_f32 v131, v131
    v_pk_mul_f32 v[120:121], v[120:121], v[128:129]
    v_mfma_f32_16x16x32_bf16 v[196:199], v[60:63], v[100:103], v[196:199]
    v_pk_mul_f32 v[122:123], v[122:123], v[130:131]
    s_waitcnt lgkmcnt(0)
    v_mfma_f32_16x16x32_bf16 v[168:171], v[40:43], v[72:75], v[168:171]
    ds_read_b128 v[88:91], v29 offset:1024
    ds_read_b128 v[92:95], v29 offset:3072
    v_mfma_f32_16x16x32_bf16 v[176:179], v[40:43], v[76:79], v[176:179]
    ds_read_b128 v[96:99], v29 offset:5120
    ds_read_b128 v[100:103], v29 offset:7168
    v_mfma_f32_16x16x32_bf16 v[184:187], v[40:43], v[80:83], v[184:187]
    ds_read_b64_tr_b16 v[56:57], v24 offset:4096
    ds_read_b64_tr_b16 v[58:59], v24 offset:6144
    v_mfma_f32_16x16x32_bf16 v[192:195], v[40:43], v[84:87], v[192:195]
    ds_read_b64_tr_b16 v[60:61], v25 offset:4096
    ds_read_b64_tr_b16 v[62:63], v25 offset:6144
    v_mfma_f32_16x16x32_bf16 v[172:175], v[44:47], v[72:75], v[172:175]
    v_lshlrev_b32 v128, 16, v134
    v_and_b32 v129, s50, v134
    v_lshlrev_b32 v130, 16, v135
    v_mfma_f32_16x16x32_bf16 v[180:183], v[44:47], v[76:79], v[180:183]
    v_and_b32 v131, s50, v135
    v_pk_add_f32 v[124:125], v[124:125], v[128:129]
    v_pk_add_f32 v[126:127], v[126:127], v[130:131]
    v_mfma_f32_16x16x32_bf16 v[188:191], v[44:47], v[80:83], v[188:191]
    v_pk_mul_f32 v[128:129], v[124:125], s[48:49]
    v_pk_mul_f32 v[130:131], v[126:127], s[48:49]
    v_exp_f32 v128, v128
    v_mfma_f32_16x16x32_bf16 v[196:199], v[44:47], v[84:87], v[196:199]
    v_exp_f32 v129, v129
    s_waitcnt lgkmcnt(0)
    s_barrier
    v_mfma_f32_16x16x32_bf16 v[168:171], v[56:59], v[88:91], v[168:171]
    ds_read_b128 v[72:75], v29 offset:32768
    ds_read_b128 v[76:79], v29 offset:34816
    v_mfma_f32_16x16x32_bf16 v[176:179], v[56:59], v[92:95], v[176:179]
    ds_read_b128 v[80:83], v29 offset:36864
    ds_read_b128 v[84:87], v29 offset:38912
    v_mfma_f32_16x16x32_bf16 v[184:187], v[56:59], v[96:99], v[184:187]
    ds_read_b64_tr_b16 v[40:41], v24 offset:32768
    ds_read_b64_tr_b16 v[42:43], v24 offset:34816
    v_mfma_f32_16x16x32_bf16 v[192:195], v[56:59], v[100:103], v[192:195]
    ds_read_b64_tr_b16 v[44:45], v25 offset:32768
    ds_read_b64_tr_b16 v[46:47], v25 offset:34816
    v_mfma_f32_16x16x32_bf16 v[172:175], v[60:63], v[88:91], v[172:175]
    v_exp_f32 v130, v130
    v_exp_f32 v131, v131
    v_pk_add_f32 v[128:129], v[128:129], s[46:47]
    v_mfma_f32_16x16x32_bf16 v[180:183], v[60:63], v[92:95], v[180:183]
    v_pk_add_f32 v[130:131], v[130:131], s[46:47]
    v_rcp_f32 v128, v128
    v_rcp_f32 v129, v129
    v_mfma_f32_16x16x32_bf16 v[188:191], v[60:63], v[96:99], v[188:191]
    v_rcp_f32 v130, v130
    v_rcp_f32 v131, v131
    v_pk_mul_f32 v[124:125], v[124:125], v[128:129]
    v_mfma_f32_16x16x32_bf16 v[196:199], v[60:63], v[100:103], v[196:199]
    v_pk_mul_f32 v[126:127], v[126:127], v[130:131]
    s_waitcnt lgkmcnt(0)
    v_mfma_f32_16x16x32_bf16 v[168:171], v[40:43], v[72:75], v[168:171]
    ds_read_b128 v[88:91], v29 offset:33792
    ds_read_b128 v[92:95], v29 offset:35840
    v_mfma_f32_16x16x32_bf16 v[176:179], v[40:43], v[76:79], v[176:179]
    ds_read_b128 v[96:99], v29 offset:37888
    ds_read_b128 v[100:103], v29 offset:39936
    v_mfma_f32_16x16x32_bf16 v[184:187], v[40:43], v[80:83], v[184:187]
    ds_read_b64_tr_b16 v[56:57], v24 offset:36864
    ds_read_b64_tr_b16 v[58:59], v24 offset:38912
    v_mfma_f32_16x16x32_bf16 v[192:195], v[40:43], v[84:87], v[192:195]
    ds_read_b64_tr_b16 v[60:61], v25 offset:36864
    ds_read_b64_tr_b16 v[62:63], v25 offset:38912
    v_mfma_f32_16x16x32_bf16 v[172:175], v[44:47], v[72:75], v[172:175]
    v_lshlrev_b32 v144, 16, v148
    v_and_b32 v145, s50, v148
    v_lshlrev_b32 v146, 16, v149
    v_mfma_f32_16x16x32_bf16 v[180:183], v[44:47], v[76:79], v[180:183]
    v_and_b32 v147, s50, v149
    v_pk_add_f32 v[136:137], v[136:137], v[144:145]
    v_pk_add_f32 v[138:139], v[138:139], v[146:147]
    v_mfma_f32_16x16x32_bf16 v[188:191], v[44:47], v[80:83], v[188:191]
    v_pk_mul_f32 v[144:145], v[136:137], s[48:49]
    v_pk_mul_f32 v[146:147], v[138:139], s[48:49]
    v_exp_f32 v144, v144
    v_mfma_f32_16x16x32_bf16 v[196:199], v[44:47], v[84:87], v[196:199]
    v_exp_f32 v145, v145
    s_waitcnt lgkmcnt(0)
    s_barrier
    v_mfma_f32_16x16x32_bf16 v[168:171], v[56:59], v[88:91], v[168:171]
    ds_read_b128 v[72:75], v30 offset:0
    ds_read_b128 v[76:79], v30 offset:2048
    v_mfma_f32_16x16x32_bf16 v[176:179], v[56:59], v[92:95], v[176:179]
    ds_read_b128 v[80:83], v30 offset:4096
    ds_read_b128 v[84:87], v30 offset:6144
    v_mfma_f32_16x16x32_bf16 v[184:187], v[56:59], v[96:99], v[184:187]
    ds_read_b64_tr_b16 v[40:41], v26 offset:0
    ds_read_b64_tr_b16 v[42:43], v26 offset:2048
    v_mfma_f32_16x16x32_bf16 v[192:195], v[56:59], v[100:103], v[192:195]
    ds_read_b64_tr_b16 v[44:45], v27 offset:0
    ds_read_b64_tr_b16 v[46:47], v27 offset:2048
    v_mfma_f32_16x16x32_bf16 v[172:175], v[60:63], v[88:91], v[172:175]
    v_exp_f32 v146, v146
    v_exp_f32 v147, v147
    v_pk_add_f32 v[144:145], v[144:145], s[46:47]
    v_mfma_f32_16x16x32_bf16 v[180:183], v[60:63], v[92:95], v[180:183]
    v_pk_add_f32 v[146:147], v[146:147], s[46:47]
    v_rcp_f32 v144, v144
    v_rcp_f32 v145, v145
    v_mfma_f32_16x16x32_bf16 v[188:191], v[60:63], v[96:99], v[188:191]
    v_rcp_f32 v146, v146
    v_rcp_f32 v147, v147
    v_pk_mul_f32 v[136:137], v[136:137], v[144:145]
    v_mfma_f32_16x16x32_bf16 v[196:199], v[60:63], v[100:103], v[196:199]
    v_pk_mul_f32 v[138:139], v[138:139], v[146:147]
    s_waitcnt lgkmcnt(0)
    v_mfma_f32_16x16x32_bf16 v[168:171], v[40:43], v[72:75], v[168:171]
    ds_read_b128 v[88:91], v30 offset:1024
    ds_read_b128 v[92:95], v30 offset:3072
    v_mfma_f32_16x16x32_bf16 v[176:179], v[40:43], v[76:79], v[176:179]
    ds_read_b128 v[96:99], v30 offset:5120
    ds_read_b128 v[100:103], v30 offset:7168
    v_mfma_f32_16x16x32_bf16 v[184:187], v[40:43], v[80:83], v[184:187]
    ds_read_b64_tr_b16 v[56:57], v26 offset:4096
    ds_read_b64_tr_b16 v[58:59], v26 offset:6144
    v_mfma_f32_16x16x32_bf16 v[192:195], v[40:43], v[84:87], v[192:195]
    ds_read_b64_tr_b16 v[60:61], v27 offset:4096
    ds_read_b64_tr_b16 v[62:63], v27 offset:6144
    v_mfma_f32_16x16x32_bf16 v[172:175], v[44:47], v[72:75], v[172:175]
    v_lshlrev_b32 v144, 16, v150
    v_and_b32 v145, s50, v150
    v_lshlrev_b32 v146, 16, v151
    v_mfma_f32_16x16x32_bf16 v[180:183], v[44:47], v[76:79], v[180:183]
    v_and_b32 v147, s50, v151
    v_pk_add_f32 v[140:141], v[140:141], v[144:145]
    v_pk_add_f32 v[142:143], v[142:143], v[146:147]
    v_mfma_f32_16x16x32_bf16 v[188:191], v[44:47], v[80:83], v[188:191]
    v_pk_mul_f32 v[144:145], v[140:141], s[48:49]
    v_pk_mul_f32 v[146:147], v[142:143], s[48:49]
    v_exp_f32 v144, v144
    v_mfma_f32_16x16x32_bf16 v[196:199], v[44:47], v[84:87], v[196:199]
    v_exp_f32 v145, v145
    s_waitcnt lgkmcnt(0)
    s_barrier
    v_mfma_f32_16x16x32_bf16 v[168:171], v[56:59], v[88:91], v[168:171]
    ds_read_b128 v[72:75], v28 offset:0
    ds_read_b128 v[76:79], v28 offset:2048
    v_mfma_f32_16x16x32_bf16 v[176:179], v[56:59], v[92:95], v[176:179]
    ds_read_b128 v[80:83], v28 offset:4096
    ds_read_b128 v[84:87], v28 offset:6144
    v_mfma_f32_16x16x32_bf16 v[184:187], v[56:59], v[96:99], v[184:187]
    ds_read_b64_tr_b16 v[40:41], v22 offset:0
    ds_read_b64_tr_b16 v[42:43], v22 offset:2048
    v_mfma_f32_16x16x32_bf16 v[192:195], v[56:59], v[100:103], v[192:195]
    ds_read_b64_tr_b16 v[44:45], v23 offset:0
    ds_read_b64_tr_b16 v[46:47], v23 offset:2048
    v_mfma_f32_16x16x32_bf16 v[172:175], v[60:63], v[88:91], v[172:175]
    v_exp_f32 v146, v146
    v_exp_f32 v147, v147
    v_pk_add_f32 v[144:145], v[144:145], s[46:47]
    v_mfma_f32_16x16x32_bf16 v[180:183], v[60:63], v[92:95], v[180:183]
    v_pk_add_f32 v[146:147], v[146:147], s[46:47]
    v_rcp_f32 v144, v144
    v_rcp_f32 v145, v145
    v_mfma_f32_16x16x32_bf16 v[188:191], v[60:63], v[96:99], v[188:191]
    v_rcp_f32 v146, v146
    v_rcp_f32 v147, v147
    v_pk_mul_f32 v[140:141], v[140:141], v[144:145]
    v_mfma_f32_16x16x32_bf16 v[196:199], v[60:63], v[100:103], v[196:199]
    v_pk_mul_f32 v[142:143], v[142:143], v[146:147]
    s_waitcnt lgkmcnt(0)
    v_mfma_f32_16x16x32_bf16 v[168:171], v[40:43], v[72:75], v[168:171]
    ds_read_b128 v[88:91], v28 offset:1024
    ds_read_b128 v[92:95], v28 offset:3072
    v_mfma_f32_16x16x32_bf16 v[176:179], v[40:43], v[76:79], v[176:179]
    ds_read_b128 v[96:99], v28 offset:5120
    ds_read_b128 v[100:103], v28 offset:7168
    v_mfma_f32_16x16x32_bf16 v[184:187], v[40:43], v[80:83], v[184:187]
    ds_read_b64_tr_b16 v[56:57], v22 offset:4096
    ds_read_b64_tr_b16 v[58:59], v22 offset:6144
    v_mfma_f32_16x16x32_bf16 v[192:195], v[40:43], v[84:87], v[192:195]
    ds_read_b64_tr_b16 v[60:61], v23 offset:4096
    ds_read_b64_tr_b16 v[62:63], v23 offset:6144
    v_mfma_f32_16x16x32_bf16 v[172:175], v[44:47], v[72:75], v[172:175]
    v_lshlrev_b32 v160, 16, v164
    v_and_b32 v161, s50, v164
    v_lshlrev_b32 v162, 16, v165
    v_mfma_f32_16x16x32_bf16 v[180:183], v[44:47], v[76:79], v[180:183]
    v_and_b32 v163, s50, v165
    v_pk_add_f32 v[152:153], v[152:153], v[160:161]
    v_pk_add_f32 v[154:155], v[154:155], v[162:163]
    v_mfma_f32_16x16x32_bf16 v[188:191], v[44:47], v[80:83], v[188:191]
    v_pk_mul_f32 v[160:161], v[152:153], s[48:49]
    v_pk_mul_f32 v[162:163], v[154:155], s[48:49]
    v_exp_f32 v160, v160
    v_mfma_f32_16x16x32_bf16 v[196:199], v[44:47], v[84:87], v[196:199]
    v_exp_f32 v161, v161
    s_waitcnt lgkmcnt(0)
    s_barrier
    v_mfma_f32_16x16x32_bf16 v[168:171], v[56:59], v[88:91], v[168:171]
    ds_read_b128 v[72:75], v28 offset:32768
    ds_read_b128 v[76:79], v28 offset:34816
    v_mfma_f32_16x16x32_bf16 v[176:179], v[56:59], v[92:95], v[176:179]
    ds_read_b128 v[80:83], v28 offset:36864
    ds_read_b128 v[84:87], v28 offset:38912
    v_mfma_f32_16x16x32_bf16 v[184:187], v[56:59], v[96:99], v[184:187]
    ds_read_b64_tr_b16 v[40:41], v22 offset:32768
    ds_read_b64_tr_b16 v[42:43], v22 offset:34816
    v_mfma_f32_16x16x32_bf16 v[192:195], v[56:59], v[100:103], v[192:195]
    ds_read_b64_tr_b16 v[44:45], v23 offset:32768
    ds_read_b64_tr_b16 v[46:47], v23 offset:34816
    v_mfma_f32_16x16x32_bf16 v[172:175], v[60:63], v[88:91], v[172:175]
    v_exp_f32 v162, v162
    v_exp_f32 v163, v163
    v_pk_add_f32 v[160:161], v[160:161], s[46:47]
    v_mfma_f32_16x16x32_bf16 v[180:183], v[60:63], v[92:95], v[180:183]
    v_pk_add_f32 v[162:163], v[162:163], s[46:47]
    v_rcp_f32 v160, v160
    v_rcp_f32 v161, v161
    v_mfma_f32_16x16x32_bf16 v[188:191], v[60:63], v[96:99], v[188:191]
    v_rcp_f32 v162, v162
    v_rcp_f32 v163, v163
    v_pk_mul_f32 v[152:153], v[152:153], v[160:161]
    v_mfma_f32_16x16x32_bf16 v[196:199], v[60:63], v[100:103], v[196:199]
    v_pk_mul_f32 v[154:155], v[154:155], v[162:163]
    s_waitcnt lgkmcnt(0)
    v_mfma_f32_16x16x32_bf16 v[168:171], v[40:43], v[72:75], v[168:171]
    ds_read_b128 v[88:91], v28 offset:33792
    ds_read_b128 v[92:95], v28 offset:35840
    v_mfma_f32_16x16x32_bf16 v[176:179], v[40:43], v[76:79], v[176:179]
    ds_read_b128 v[96:99], v28 offset:37888
    ds_read_b128 v[100:103], v28 offset:39936
    v_mfma_f32_16x16x32_bf16 v[184:187], v[40:43], v[80:83], v[184:187]
    ds_read_b64_tr_b16 v[56:57], v22 offset:36864
    ds_read_b64_tr_b16 v[58:59], v22 offset:38912
    v_mfma_f32_16x16x32_bf16 v[192:195], v[40:43], v[84:87], v[192:195]
    ds_read_b64_tr_b16 v[60:61], v23 offset:36864
    ds_read_b64_tr_b16 v[62:63], v23 offset:38912
    v_mfma_f32_16x16x32_bf16 v[172:175], v[44:47], v[72:75], v[172:175]
    v_lshlrev_b32 v160, 16, v166
    v_and_b32 v161, s50, v166
    v_lshlrev_b32 v162, 16, v167
    v_mfma_f32_16x16x32_bf16 v[180:183], v[44:47], v[76:79], v[180:183]
    v_and_b32 v163, s50, v167
    v_pk_add_f32 v[156:157], v[156:157], v[160:161]
    v_pk_add_f32 v[158:159], v[158:159], v[162:163]
    v_mfma_f32_16x16x32_bf16 v[188:191], v[44:47], v[80:83], v[188:191]
    v_pk_mul_f32 v[160:161], v[156:157], s[48:49]
    v_pk_mul_f32 v[162:163], v[158:159], s[48:49]
    v_exp_f32 v160, v160
    v_mfma_f32_16x16x32_bf16 v[196:199], v[44:47], v[84:87], v[196:199]
    v_exp_f32 v161, v161
    s_waitcnt lgkmcnt(0)
    v_mfma_f32_16x16x32_bf16 v[168:171], v[56:59], v[88:91], v[168:171]
    v_mfma_f32_16x16x32_bf16 v[176:179], v[56:59], v[92:95], v[176:179]
    v_mfma_f32_16x16x32_bf16 v[184:187], v[56:59], v[96:99], v[184:187]
    v_mfma_f32_16x16x32_bf16 v[192:195], v[56:59], v[100:103], v[192:195]
    v_mfma_f32_16x16x32_bf16 v[172:175], v[60:63], v[88:91], v[172:175]
    v_mfma_f32_16x16x32_bf16 v[180:183], v[60:63], v[92:95], v[180:183]
    v_mfma_f32_16x16x32_bf16 v[188:191], v[60:63], v[96:99], v[188:191]
    v_mfma_f32_16x16x32_bf16 v[196:199], v[60:63], v[100:103], v[196:199]
    v_exp_f32 v162, v162
    v_exp_f32 v163, v163
    v_pk_add_f32 v[160:161], v[160:161], s[46:47]
    v_pk_add_f32 v[162:163], v[162:163], s[46:47]
    v_rcp_f32 v160, v160
    v_rcp_f32 v161, v161
    v_rcp_f32 v162, v162
    v_rcp_f32 v163, v163
    v_pk_mul_f32 v[156:157], v[156:157], v[160:161]
    v_pk_mul_f32 v[158:159], v[158:159], v[162:163]
    v_permlane16_swap_b32 v200, v202
    v_permlane16_swap_b32 v201, v203
    v_permlane16_swap_b32 v204, v206
    v_permlane16_swap_b32 v205, v207
    v_permlane16_swap_b32 v208, v210
    v_permlane16_swap_b32 v209, v211
    v_permlane16_swap_b32 v212, v214
    v_permlane16_swap_b32 v213, v215
    s_nop 7
    v_lshlrev_b32 v2, 16, v200
    v_and_b32 v3, 0xffff0000, v200
    v_fmac_f32 v2, v168, v104
    v_fmac_f32 v3, v169, v105
    v_cvt_pk_bf16_f32 v200, v2, v3
    v_lshlrev_b32 v2, 16, v201
    v_and_b32 v3, 0xffff0000, v201
    v_fmac_f32 v2, v170, v106
    v_fmac_f32 v3, v171, v107
    v_cvt_pk_bf16_f32 v201, v2, v3
    v_lshlrev_b32 v2, 16, v202
    v_and_b32 v3, 0xffff0000, v202
    v_fmac_f32 v2, v172, v108
    v_fmac_f32 v3, v173, v109
    v_cvt_pk_bf16_f32 v202, v2, v3
    v_lshlrev_b32 v2, 16, v203
    v_and_b32 v3, 0xffff0000, v203
    v_fmac_f32 v2, v174, v110
    v_fmac_f32 v3, v175, v111
    v_cvt_pk_bf16_f32 v203, v2, v3
    s_nop 1
    v_permlane16_swap_b32 v200, v202
    v_permlane16_swap_b32 v201, v203
    s_nop 1
    buffer_store_dwordx4 v[200:203], v35, s[20:23], s40 offen sc0 sc1
    v_lshlrev_b32 v2, 16, v204
    v_and_b32 v3, 0xffff0000, v204
    v_fmac_f32 v2, v176, v120
    v_fmac_f32 v3, v177, v121
    v_cvt_pk_bf16_f32 v204, v2, v3
    v_lshlrev_b32 v2, 16, v205
    v_and_b32 v3, 0xffff0000, v205
    v_fmac_f32 v2, v178, v122
    v_fmac_f32 v3, v179, v123
    v_cvt_pk_bf16_f32 v205, v2, v3
    v_lshlrev_b32 v2, 16, v206
    v_and_b32 v3, 0xffff0000, v206
    v_fmac_f32 v2, v180, v124
    v_fmac_f32 v3, v181, v125
    v_cvt_pk_bf16_f32 v206, v2, v3
    v_lshlrev_b32 v2, 16, v207
    v_and_b32 v3, 0xffff0000, v207
    v_fmac_f32 v2, v182, v126
    v_fmac_f32 v3, v183, v127
    v_cvt_pk_bf16_f32 v207, v2, v3
    s_nop 1
    v_permlane16_swap_b32 v204, v206
    v_permlane16_swap_b32 v205, v207
    s_nop 1
    buffer_store_dwordx4 v[204:207], v35, s[20:23], s41 offen sc0 sc1
    v_lshlrev_b32 v2, 16, v208
    v_and_b32 v3, 0xffff0000, v208
    v_fmac_f32 v2, v184, v136
    v_fmac_f32 v3, v185, v137
    v_cvt_pk_bf16_f32 v208, v2, v3
    v_lshlrev_b32 v2, 16, v209
    v_and_b32 v3, 0xffff0000, v209
    v_fmac_f32 v2, v186, v138
    v_fmac_f32 v3, v187, v139
    v_cvt_pk_bf16_f32 v209, v2, v3
    v_lshlrev_b32 v2, 16, v210
    v_and_b32 v3, 0xffff0000, v210
    v_fmac_f32 v2, v188, v140
    v_fmac_f32 v3, v189, v141
    v_cvt_pk_bf16_f32 v210, v2, v3
    v_lshlrev_b32 v2, 16, v211
    v_and_b32 v3, 0xffff0000, v211
    v_fmac_f32 v2, v190, v142
    v_fmac_f32 v3, v191, v143
    v_cvt_pk_bf16_f32 v211, v2, v3
    s_nop 1
    v_permlane16_swap_b32 v208, v210
    v_permlane16_swap_b32 v209, v211
    s_nop 1
    buffer_store_dwordx4 v[208:211], v35, s[20:23], s42 offen sc0 sc1
    v_lshlrev_b32 v2, 16, v212
    v_and_b32 v3, 0xffff0000, v212
    v_fmac_f32 v2, v192, v152
    v_fmac_f32 v3, v193, v153
    v_cvt_pk_bf16_f32 v212, v2, v3
    v_lshlrev_b32 v2, 16, v213
    v_and_b32 v3, 0xffff0000, v213
    v_fmac_f32 v2, v194, v154
    v_fmac_f32 v3, v195, v155
    v_cvt_pk_bf16_f32 v213, v2, v3
    v_lshlrev_b32 v2, 16, v214
    v_and_b32 v3, 0xffff0000, v214
    v_fmac_f32 v2, v196, v156
    v_fmac_f32 v3, v197, v157
    v_cvt_pk_bf16_f32 v214, v2, v3
    v_lshlrev_b32 v2, 16, v215
    v_and_b32 v3, 0xffff0000, v215
    v_fmac_f32 v2, v198, v158
    v_fmac_f32 v3, v199, v159
    v_cvt_pk_bf16_f32 v215, v2, v3
    s_nop 1
    v_permlane16_swap_b32 v212, v214
    v_permlane16_swap_b32 v213, v215
    s_nop 1
    buffer_store_dwordx4 v[212:215], v35, s[20:23], s43 offen sc0 sc1
L_g1_end:
    s_endpgm
.section .rodata,"a"
.p2align 6
.amdhsa_kernel block_kernel
  .amdhsa_next_free_vgpr 256
  .amdhsa_next_free_sgpr 102
  .amdhsa_accum_offset 256
  .amdhsa_group_segment_fixed_size 0
  .amdhsa_kernarg_size 80
  .amdhsa_user_sgpr_count 2
  .amdhsa_user_sgpr_kernarg_segment_ptr 1
  .amdhsa_system_sgpr_workgroup_id_x 1
  .amdhsa_float_denorm_mode_32 3
.end_amdhsa_kernel
```
